```python
import torch

def _softmax(x, axis=-1):
    return torch.softmax(x, dim=axis)

def _gelu(x):
    return torch.nn.functional.gelu(x, approximate='tanh')

def _silu(x):
    return torch.nn.functional.silu(x)

def _sigmoid(x):
    return torch.sigmoid(x)

def _layernorm(x, axis=-1, eps=1e-05):
    m = x.mean(dim=axis, keepdim=True)
    v = x.var(dim=axis, keepdim=True, unbiased=False)
    return (x - m) / torch.sqrt(v + eps)

def _scatter_add(tgt, idx, src, axis=0):
    return tgt.clone().index_add_(axis, idx, src)

def _segment_sum(src, seg, n):
    out = torch.zeros((n,) + src.shape[1:], dtype=src.dtype)
    return out.index_add_(0, seg, src)

def _pad(x, pw):
    flat = tuple((v for pair in reversed(pw) for v in pair))
    return torch.nn.functional.pad(x, flat)
kernel_name = 'adaLN_cond__sliding_block_cached__mixer_channel_mlp__prompt'

def setup_inputs():

    _w = lambda a: (lambda t: t.to(torch.bfloat16) if t.is_floating_point() else t)(torch.as_tensor(a))

    def _A_setup():
        B, Sq, D = (1, 2048, 512)
        Hq, Hkv, Sk, Dh = (32, 8, 2048, 128)
        assert Hq % Hkv == 0, (Hq, Hkv)
        return {'x': _w((lambda *s: torch.randn(*s, dtype=torch.bfloat16) * 0.1)(B, Sq, D)), 'k_cache': _w((lambda *s: torch.randn(*s, dtype=torch.bfloat16) * 0.8)(B, Hkv, Sk, Dh)), 'v_cache': _w((lambda *s: torch.randn(*s, dtype=torch.bfloat16) * 1.6)(B, Hkv, Sk, Dh)), 'wq': _w((lambda *s: torch.randn(*s, dtype=torch.bfloat16) * 0.8)(D, Hq * Dh) * D ** (-0.5)), 'wo': _w((lambda *s: torch.randn(*s, dtype=torch.bfloat16) * 1.6)(Hq * Dh, D) * (Hq * Dh) ** (-0.5))}
    _A_in = _A_setup()

    def _B_setup():
        B, S, D, F = (1, 2048, 512, 1792)
        return {'x': _w((lambda *s: torch.randn(*s, dtype=torch.bfloat16) * 0.1)(B, S, D)), 'w1': _w((lambda *s: torch.randn(*s, dtype=torch.bfloat16) * 3.2)(D, F) * D ** (-0.5)), 'b1': _w((lambda *s: torch.randn(*s, dtype=torch.bfloat16) * 3.2)(F)), 'w2': _w((lambda *s: torch.randn(*s, dtype=torch.bfloat16) * 3.2)(F, D) * F ** (-0.5)), 'b2': _w((lambda *s: torch.randn(*s, dtype=torch.bfloat16) * 3.2)(D))}
    _B_in = _B_setup()
    return {'A_x': _A_in['x'], 'A_k_cache': _A_in['k_cache'], 'A_v_cache': _A_in['v_cache'], 'A_wq': _A_in['wq'], 'A_wo': _A_in['wo'], 'B_x': _B_in['x'], 'B_w1': _B_in['w1'], 'B_b1': _B_in['b1'], 'B_w2': _B_in['w2'], 'B_b2': _B_in['b2'], 'c': _w((lambda *s: torch.randn(*s, dtype=torch.bfloat16) * 0.2)(1, 512) * 8.0), 'w_mod': _w((lambda *s: torch.randn(*s, dtype=torch.bfloat16) * 0.2)(512, 6 * 512) * 512 ** (-0.5) * 8.0)}

def reference(A_x, A_k_cache, A_v_cache, A_wq, A_wo, B_x, B_w1, B_b1, B_w2, B_b2, c, w_mod):

    def _A_ref(x, k_cache, v_cache, wq, wo):
        B, Sq, D = x.shape
        Hq, Dh = (32, 128)
        Hkv, Sk = (k_cache.shape[1], k_cache.shape[2])
        W = min(4096, max(256, Sk // 4))
        rep = Hq // Hkv
        q = (lambda x, *d: x.permute(*d))((x @ wq).reshape(B, Sq, Hq, Dh), 0, 2, 1, 3)
        k = (lambda x, n, axis: torch.repeat_interleave(x, n, dim=axis))(k_cache[:, :, Sk - W:, :], rep, axis=1)
        v = (lambda x, n, axis: torch.repeat_interleave(x, n, dim=axis))(v_cache[:, :, Sk - W:, :], rep, axis=1)
        scores = torch.einsum('bhqd,bhkd->bhqk', q, k) * Dh ** (-0.5)
        p = _softmax(scores, axis=-1)
        o = torch.einsum('bhqk,bhkd->bhqd', p, v)
        return (lambda x, *d: x.permute(*d))(o, 0, 2, 1, 3).reshape(B, Sq, Hq * Dh) @ wo

    def _B_ref(x, w1, b1, w2, b2):
        y = _layernorm(x, axis=-1)
        h = _gelu(torch.einsum('bsd,df->bsf', y, w1) + b1)
        return torch.einsum('bsf,fd->bsd', h, w2) + b2
    x = A_x
    mod = (_silu(c) @ w_mod).reshape(c.shape[0], 6, 1, -1)
    sa, ca, ga, sb, cb, gb = (mod[:, 0].clone(), mod[:, 1].clone(), mod[:, 2].clone(), mod[:, 3].clone(), mod[:, 4].clone(), mod[:, 5].clone())
    h = _layernorm(x, axis=-1) * (1 + ca) + sa
    x = x + ga * _A_ref(h, A_k_cache, A_v_cache, A_wq, A_wo)
    h = _layernorm(x, axis=-1) * (1 + cb) + sb
    x = x + gb * _B_ref(h, B_w1, B_b1, B_w2, B_b2)
    return x
```

```asm
; @launch grid=(256,1,1) block=(256,1,1) lds=163840
.amdgcn_target "amdgcn-amd-amdhsa--gfx950"
.text
.globl adaLN_cond__sliding_block_cached__mixer_channel_mlp__prompt_kernel
.p2align 8
.type adaLN_cond__sliding_block_cached__mixer_channel_mlp__prompt_kernel,@function
adaLN_cond__sliding_block_cached__mixer_channel_mlp__prompt_kernel:
L_start:
    s_cmp_ge_u32 s2, 256
    s_cbranch_scc1 L_end
    s_load_dwordx16 s[4:19], s[0:1], 0
    s_load_dwordx8 s[20:27], s[0:1], 64
    s_load_dwordx4 s[28:31], s[0:1], 96
    s_load_dwordx2 s[32:33], s[0:1], 112
    v_and_b32 v1, 63, v0
    v_lshrrev_b32 v2, 6, v0
    s_and_b32 s96, s2, 7
    s_lshr_b32 s97, s2, 3
    v_readfirstlane_b32 s35, v2
    s_and_b32 s56, s96, 3
    s_lshl_b32 s56, s56, 1
    s_and_b32 s60, s97, 1
    s_add_u32 s56, s56, s60
    s_lshr_b32 s57, s96, 2
    s_lshl_b32 s57, s57, 4
    s_lshr_b32 s61, s97, 1
    s_add_u32 s57, s57, s61
    s_lshl_b32 s60, s60, 2
    s_add_u32 s95, s57, s60
    s_and_b32 s95, s95, 7
    s_lshl_b32 s58, s96, 2
    s_lshr_b32 s59, s97, 3
    s_add_u32 s58, s58, s59
    s_and_b32 s59, s97, 7
    s_mul_i32 s63, s35, 16512
    s_add_u32 s63, s63, 82304
    s_movk_i32 s101, 1023
    v_lshlrev_b32 v16, 4, v1
    v_lshrrev_b32 v2, 4, v1
    v_and_b32 v5, 15, v1
    v_mul_u32_u24 v3, 1032, v2
    v_lshl_add_u32 v9, v5, 4, v3
    v_add_u32 v9, s63, v9
    v_and_b32 v3, 1, v2
    v_mul_u32_u24 v3, 1032, v3
    v_lshl_add_u32 v3, v5, 4, v3
    v_lshrrev_b32 v4, 1, v2
    v_lshl_add_u32 v10, v4, 9, v3
    v_add_u32 v10, s63, v10
    v_mul_u32_u24 v4, 2064, v4
    v_add_u32 v21, v3, v4
    v_add_u32 v21, 32896, v21
    s_lshl_b32 s60, s95, 7
    v_lshl_add_u32 v3, v5, 4, s60
    v_lshlrev_b32 v2, 10, v2
    v_and_or_b32 v124, v3, s101, v2
    v_add_u32 v3, 256, v3
    v_and_or_b32 v125, v3, s101, v2
    v_add_u32 v3, 256, v3
    v_and_or_b32 v126, v3, s101, v2
    v_add_u32 v3, 256, v3
    v_and_or_b32 v127, v3, s101, v2
    s_getpc_b64 s[92:93]
L_pc:
    s_sub_u32 s92, s92, L_pc-L_start
    s_subb_u32 s93, s93, 0
    s_lshl_b32 s3, s97, 12
    v_lshl_add_u32 v4, v0, 4, s3
    v_min_u32 v4, L_codeend-L_start-16, v4
    global_load_dwordx4 a[248:251], v4, s[92:93]
    s_waitcnt lgkmcnt(0)
    s_add_u32 s32, s32, 0
    s_addc_u32 s33, s33, 0
    s_load_dword s34, s[32:33], 0
    s_mov_b32 s48, s32
    s_mov_b32 s49, s33
    s_mov_b32 s50, 268435456
    s_mov_b32 s51, 0x20000
    s_cmp_lt_u32 s96, 2
    s_cselect_b32 s14, s97, 99
    s_cmp_lt_u32 s14, 32
    s_cbranch_scc1 L_prod
    s_mov_b32 s52, s4
    s_mov_b32 s53, s5
    s_mov_b32 s54, 2097152
    s_mov_b32 s55, 0x20000
    s_lshl_b32 s62, s57, 16
    s_lshl_b32 s61, s35, 14
    s_add_u32 s62, s62, s61
    s_add_u32 s0, s62, 4096
    s_add_u32 s1, s62, 8192
    s_add_u32 s100, s62, 12288
    buffer_load_dwordx4 v[32:35], v124, s[52:55], s62 offen
    buffer_load_dwordx4 v[36:39], v124, s[52:55], s0 offen
    buffer_load_dwordx4 v[40:43], v124, s[52:55], s1 offen
    buffer_load_dwordx4 v[44:47], v124, s[52:55], s100 offen
    buffer_load_dwordx4 v[48:51], v125, s[52:55], s62 offen
    buffer_load_dwordx4 v[52:55], v125, s[52:55], s0 offen
    buffer_load_dwordx4 v[56:59], v125, s[52:55], s1 offen
    buffer_load_dwordx4 v[60:63], v125, s[52:55], s100 offen
    s_branch L_join
L_prod:
    s_mov_b32 s52, s24
    s_mov_b32 s53, s25
    s_mov_b32 s54, 1024
    s_mov_b32 s55, 0x20000
    s_mov_b32 s36, s26
    s_mov_b32 s37, s27
    s_mov_b32 s38, 3145728
    s_mov_b32 s39, 0x20000
    v_lshlrev_b32 v2, 2, v0
    buffer_load_dword v31, v2, s[52:55], 0 offen
    v_bfe_u32 v2, v1, 2, 3
    v_mul_u32_u24 v2, 6144, v2
    v_lshrrev_b32 v3, 5, v1
    v_lshl_add_u32 v2, v3, 6, v2
    v_and_b32 v3, 3, v1
    v_lshl_add_u32 v11, v3, 4, v2
    v_add_u32 v12, 48120, v11
    v_add_u32 v13, 96240, v11
    v_add_u32 v14, 144360, v11
    s_mul_i32 s14, s97, 2
    s_add_u32 s14, s14, s96
    s_lshr_b32 s15, s14, 4
    s_and_b32 s14, s14, 15
    s_lshl_b32 s3, s15, 2
    s_add_u32 s3, s3, s35
    s_mul_i32 s60, s3, 196608
    s_lshl_b32 s61, s14, 7
    s_add_u32 s60, s60, s61
    s_add_u32 m0, s63, 8256
    s_nop 0
    buffer_load_dwordx4 v11, s[36:39], s60 offen offset:0 nt lds
    buffer_load_dwordx4 v12, s[36:39], s60 offen offset:1032 nt lds
    buffer_load_dwordx4 v13, s[36:39], s60 offen offset:2064 nt lds
    buffer_load_dwordx4 v14, s[36:39], s60 offen offset:3096 nt lds
    s_mov_b32 s52, s4
    s_mov_b32 s53, s5
    s_mov_b32 s54, 2097152
    s_mov_b32 s55, 0x20000
    s_lshl_b32 s62, s57, 16
    s_lshl_b32 s61, s35, 14
    s_add_u32 s62, s62, s61
    s_add_u32 s0, s62, 4096
    s_add_u32 s1, s62, 8192
    s_add_u32 s100, s62, 12288
    buffer_load_dwordx4 v[32:35], v124, s[52:55], s62 offen
    buffer_load_dwordx4 v[36:39], v124, s[52:55], s0 offen
    buffer_load_dwordx4 v[40:43], v124, s[52:55], s1 offen
    buffer_load_dwordx4 v[44:47], v124, s[52:55], s100 offen
    s_waitcnt vmcnt(8)
    v_lshlrev_b32 v2, 16, v31
    v_and_b32 v3, 0xffff0000, v31
    v_mul_f32 v4, 3216550459, v2
    v_mul_f32 v5, 3216550459, v3
    v_exp_f32 v4, v4
    v_exp_f32 v5, v5
    v_add_f32 v4, 1.0, v4
    v_add_f32 v5, 1.0, v5
    v_rcp_f32 v4, v4
    v_rcp_f32 v5, v5
    v_mul_f32 v2, v2, v4
    v_mul_f32 v3, v3, v5
    v_cvt_pk_bf16_f32 v2, v2, v3
    v_lshlrev_b32 v3, 2, v0
    v_add_u32 v3, 156544, v3
    ds_write_b32 v3, v2
    v_lshrrev_b32 v2, 4, v1
    v_lshlrev_b32 v2, 4, v2
    s_mul_i32 s60, s3, 64
    s_add_u32 s60, s60, 156544
    v_add_u32 v2, s60, v2
    s_waitcnt lgkmcnt(0)
    s_barrier
    ds_read_b128 a[0:3], v2 offset:0
    s_waitcnt vmcnt(4)
    ds_read_b64_tr_b16 a[16:17], v9 offset:8256
    ds_read_b64_tr_b16 a[18:19], v9 offset:8512
    ds_read_b64_tr_b16 a[20:21], v9 offset:8264
    ds_read_b64_tr_b16 a[22:23], v9 offset:8520
    ds_read_b64_tr_b16 a[24:25], v9 offset:8768
    ds_read_b64_tr_b16 a[26:27], v9 offset:9024
    ds_read_b64_tr_b16 a[28:29], v9 offset:8776
    ds_read_b64_tr_b16 a[30:31], v9 offset:9032
    buffer_load_dwordx4 v[48:51], v125, s[52:55], s62 offen
    buffer_load_dwordx4 v[52:55], v125, s[52:55], s0 offen
    buffer_load_dwordx4 v[56:59], v125, s[52:55], s1 offen
    buffer_load_dwordx4 v[60:63], v125, s[52:55], s100 offen
    s_waitcnt lgkmcnt(6)
    v_mfma_f32_16x16x32_bf16 v[96:99], a[16:19], a[0:3], 0
    s_waitcnt lgkmcnt(4)
    v_mfma_f32_16x16x32_bf16 v[100:103], a[20:23], a[0:3], 0
    s_waitcnt lgkmcnt(2)
    v_mfma_f32_16x16x32_bf16 v[104:107], a[24:27], a[0:3], 0
    s_waitcnt lgkmcnt(0)
    v_mfma_f32_16x16x32_bf16 v[108:111], a[28:31], a[0:3], 0
    s_lshl_b32 s3, s15, 12
    s_lshl_b32 s14, s14, 8
    s_add_u32 s3, s3, s14
    s_add_u32 s3, s3, 4096
    s_mul_i32 s15, s34, 0x9E3779B1
    s_add_u32 s15, s15, 0x7F4A7C15
    v_lshrrev_b32 v2, 4, v1
    v_lshlrev_b32 v2, 5, v2
    s_mul_i32 s60, s35, 256
    s_add_u32 s60, s60, 157568
    v_add_u32 v2, s60, v2
    s_mov_b32 exec_lo, 0x00010001
    s_mov_b32 exec_hi, 0x00010001
    ds_write_b128 v2, v[96:99] offset:0
    ds_write_b128 v2, v[100:103] offset:16
    ds_write_b128 v2, v[104:107] offset:128
    ds_write_b128 v2, v[108:111] offset:144
    s_mov_b64 exec, -1
    s_waitcnt lgkmcnt(0)
    s_barrier
    s_cmp_lg_u32 s35, 0
    s_cbranch_scc1 L_prod_x
    v_lshlrev_b32 v2, 3, v1
    v_add_u32 v3, 157568, v2
    s_mov_b32 exec_lo, 4294967295
    s_mov_b32 exec_hi, 0
    ds_read_b64 v[96:97], v3 offset:0
    ds_read_b64 v[98:99], v3 offset:256
    ds_read_b64 v[100:101], v3 offset:512
    ds_read_b64 v[102:103], v3 offset:768
    s_waitcnt lgkmcnt(2)
    v_pk_add_f32 v[96:97], v[96:97], v[98:99]
    s_waitcnt lgkmcnt(0)
    v_pk_add_f32 v[100:101], v[100:101], v[102:103]
    v_pk_add_f32 v[96:97], v[96:97], v[100:101]
    v_cvt_pk_bf16_f32 v96, v96, v97
    v_mov_b32 v97, s15
    buffer_store_dwordx2 v[96:97], v2, s[48:51], s3 offen sc1
    s_mov_b64 exec, -1
L_prod_x:
    s_branch L_join
.p2align 12
L_join:
    s_lshl_b32 s60, s56, 10
    s_lshl_b32 s61, s35, 8
    s_add_u32 s60, s60, s61
    s_add_u32 s36, s10, s60
    s_addc_u32 s37, s11, 0
    s_sub_u32 s38, 4194304, s60
    s_mov_b32 s39, 0x20000
    s_bfe_u32 s15, s57, 0x10003
    s_lshl_b32 s14, s15, 7
    s_lshl_b32 s92, s95, 19
    s_add_u32 s94, s92, s14
    s_xor_b32 s14, s14, 128
    s_add_u32 s92, s92, s14
    s_lshl_b32 s15, s15, 1
    s_mul_i32 s93, s35, 4128
    s_sub_u32 s60, s93, s63
    v_add_u32 v31, s60, v9
    v_bfe_u32 v2, v1, 2, 3
    v_mul_u32_u24 v2, 8192, v2
    v_lshrrev_b32 v3, 5, v1
    v_lshl_add_u32 v2, v3, 6, v2
    v_and_b32 v3, 3, v1
    v_lshl_add_u32 v11, v3, 4, v2
    v_add_u32 v12, 64504, v11
    v_add_u32 v13, 129008, v11
    v_add_u32 v14, 193512, v11
    v_lshrrev_b32 v2, 4, v1
    v_and_b32 v5, 15, v1
    v_bfe_u32 v6, v1, 2, 2
    v_lshlrev_b32 v6, 1, v6
    s_movk_i32 s60, 0x78
    v_lshrrev_b32 v6, v6, s60
    v_and_b32 v6, 3, v6
    v_xor_b32 v7, v6, v2
    v_lshlrev_b32 v7, 4, v7
    v_lshl_add_u32 v15, v5, 6, v7
    v_add_u32 v15, 16512, v15
    v_bfe_u32 v4, v1, 2, 2
    v_lshl_add_u32 v7, v4, 12, v7
    v_and_b32 v4, 3, v1
    v_lshl_add_u32 v7, v4, 8, v7
    s_bfe_u32 s15, s57, 0x10003
    s_lshl_b32 s15, s15, 1
    v_xor_b32 v4, s15, v4
    v_xor_b32 v5, 0, v4
    v_lshl_add_u32 v17, v5, 6, v7
    v_xor_b32 v5, 1, v4
    v_lshl_add_u32 v18, v5, 6, v7
    v_xor_b32 v5, 2, v4
    v_lshl_add_u32 v19, v5, 6, v7
    v_xor_b32 v5, 3, v4
    v_lshl_add_u32 v20, v5, 6, v7
    s_lshl_b32 s60, s35, 1
    s_lshr_b32 s60, 0x78, s60
    s_and_b32 s60, s60, 3
    v_lshlrev_b32 v3, 2, v2
    v_xor_b32 v3, s60, v3
    v_and_b32 v4, 15, v1
    v_xor_b32 v3, v3, v4
    v_lshlrev_b32 v3, 4, v3
    v_lshl_add_u32 v3, v2, 8, v3
    s_lshl_b32 s60, s35, 10
    v_add_u32 v22, s60, v3
    v_add_u32 v23, 3072, v22
    v_add_u32 v24, 6144, v22
    v_add_u32 v25, 9216, v22
    v_bfe_u32 v3, v1, 2, 2
    v_lshlrev_b32 v3, 8, v3
    v_lshl_add_u32 v3, v2, 6, v3
    v_and_b32 v4, 3, v1
    v_lshl_add_u32 v3, v4, 4, v3
    s_lshl_b32 s60, s35, 12
    s_add_u32 s60, s60, 64
    v_add_u32 v26, s60, v3
    v_subrev_u32 v27, 8, v26
    v_subrev_u32 v28, 16, v26
    v_subrev_u32 v29, 24, v26
    v_bfe_u32 v3, v1, 2, 1
    v_xor_b32 v3, v3, v2
    v_lshlrev_b32 v3, 6, v3
    v_bfe_u32 v4, v1, 2, 2
    v_lshl_add_u32 v3, v4, 12, v3
    s_lshl_b32 s60, s35, 10
    s_add_u32 s60, s60, 16512
    v_add_u32 v3, s60, v3
    v_and_b32 v4, 3, v1
    v_lshl_add_u32 v120, v4, 4, v3
    v_xor_b32 v121, 32, v120
    v_xor_b32 v122, 48, v120
    v_xor_b32 v123, 16, v120
    v_subrev_u32 v8, 16512, v15
    v_xor_b32 v8, 64, v8
    v_add_u32 v8, 16512, v8
    s_lshl_b32 s60, s56, 19
    s_add_u32 s60, s60, 393216
    s_add_u32 s40, s6, s60
    s_addc_u32 s41, s7, 0
    s_mov_b32 s42, 131072
    s_mov_b32 s43, 0x20000
    s_sub_u32 s60, s60, 64
    s_add_u32 s44, s8, s60
    s_addc_u32 s45, s9, 0
    s_mov_b32 s46, 131136
    s_mov_b32 s47, 0x20000
    s_lshl_b32 s6, s35, 12
    s_mul_i32 s7, s35, 4128
    s_add_u32 s7, s7, 32896
    s_lshl_b32 s8, s95, 14
    s_mov_b32 s9, s8
    buffer_load_dwordx4 v[64:67], v126, s[52:55], s62 offen
    buffer_load_dwordx4 v[68:71], v126, s[52:55], s0 offen
    buffer_load_dwordx4 v[72:75], v126, s[52:55], s1 offen
    buffer_load_dwordx4 v[76:79], v126, s[52:55], s100 offen
    buffer_load_dwordx4 v[80:83], v127, s[52:55], s62 offen
    buffer_load_dwordx4 v[84:87], v127, s[52:55], s0 offen
    buffer_load_dwordx4 v[88:91], v127, s[52:55], s1 offen
    buffer_load_dwordx4 v[92:95], v127, s[52:55], s100 offen
    s_waitcnt vmcnt(12)
    s_mov_b64 exec, 0
    s_cmp_eq_u32 s35, 0
    s_cbranch_scc0 L_w1_0
    s_call_b64 s[100:101], L_stub1
    s_branch L_w1_ret
L_w1_0:
    s_cmp_eq_u32 s35, 1
    s_cbranch_scc0 L_w1_1
    s_call_b64 s[100:101], L_stub2
    s_branch L_w1_ret
L_w1_1:
    s_cmp_eq_u32 s35, 2
    s_cbranch_scc0 L_w1_2
    s_call_b64 s[100:101], L_stub3
    s_branch L_w1_ret
L_w1_2:
    s_call_b64 s[100:101], L_stub4
L_w1_ret:
    s_mov_b64 exec, -1
    v_mov_b32 v112, 0
    v_mov_b32 v104, 0
    v_mov_b32 v114, 0
    v_mov_b32 v106, 0
    v_mov_b32 v116, 0
    v_mov_b32 v108, 0
    v_mov_b32 v118, 0
    v_mov_b32 v110, 0
    v_mov_b32 v7, 0x3f803f80
    v_lshlrev_b32 v30, 4, v0
    v_add_u32 v30, 4096, v30
    s_mov_b32 s10, 4096
    s_mov_b32 s11, 8192
    s_mov_b32 s14, 12288
    v_dot2c_f32_bf16 v112, v32, v7
    v_dot2c_f32_bf16 v104, v32, v32
    v_dot2c_f32_bf16 v112, v33, v7
    v_dot2c_f32_bf16 v104, v33, v33
    v_dot2c_f32_bf16 v112, v34, v7
    v_dot2c_f32_bf16 v104, v34, v34
    v_dot2c_f32_bf16 v112, v35, v7
    v_dot2c_f32_bf16 v104, v35, v35
    v_dot2c_f32_bf16 v114, v36, v7
    v_dot2c_f32_bf16 v106, v36, v36
    v_dot2c_f32_bf16 v114, v37, v7
    v_dot2c_f32_bf16 v106, v37, v37
    v_dot2c_f32_bf16 v114, v38, v7
    v_dot2c_f32_bf16 v106, v38, v38
    v_dot2c_f32_bf16 v114, v39, v7
    v_dot2c_f32_bf16 v106, v39, v39
    v_dot2c_f32_bf16 v116, v40, v7
    v_dot2c_f32_bf16 v108, v40, v40
    v_dot2c_f32_bf16 v116, v41, v7
    v_dot2c_f32_bf16 v108, v41, v41
    v_dot2c_f32_bf16 v116, v42, v7
    v_dot2c_f32_bf16 v108, v42, v42
    v_dot2c_f32_bf16 v116, v43, v7
    v_dot2c_f32_bf16 v108, v43, v43
    v_dot2c_f32_bf16 v118, v44, v7
    v_dot2c_f32_bf16 v110, v44, v44
    v_dot2c_f32_bf16 v118, v45, v7
    v_dot2c_f32_bf16 v110, v45, v45
    v_dot2c_f32_bf16 v118, v46, v7
    v_dot2c_f32_bf16 v110, v46, v46
    v_dot2c_f32_bf16 v118, v47, v7
    v_dot2c_f32_bf16 v110, v47, v47
    s_waitcnt vmcnt(11)
    v_dot2c_f32_bf16 v112, v48, v7
    v_dot2c_f32_bf16 v104, v48, v48
    v_dot2c_f32_bf16 v112, v49, v7
    v_dot2c_f32_bf16 v104, v49, v49
    v_dot2c_f32_bf16 v112, v50, v7
    v_dot2c_f32_bf16 v104, v50, v50
    v_dot2c_f32_bf16 v112, v51, v7
    v_dot2c_f32_bf16 v104, v51, v51
    s_waitcnt vmcnt(10)
    v_dot2c_f32_bf16 v114, v52, v7
    v_dot2c_f32_bf16 v106, v52, v52
    v_dot2c_f32_bf16 v114, v53, v7
    v_dot2c_f32_bf16 v106, v53, v53
    v_dot2c_f32_bf16 v114, v54, v7
    v_dot2c_f32_bf16 v106, v54, v54
    v_dot2c_f32_bf16 v114, v55, v7
    v_dot2c_f32_bf16 v106, v55, v55
    s_waitcnt vmcnt(9)
    v_dot2c_f32_bf16 v116, v56, v7
    v_dot2c_f32_bf16 v108, v56, v56
    v_dot2c_f32_bf16 v116, v57, v7
    v_dot2c_f32_bf16 v108, v57, v57
    v_dot2c_f32_bf16 v116, v58, v7
    v_dot2c_f32_bf16 v108, v58, v58
    v_dot2c_f32_bf16 v116, v59, v7
    v_dot2c_f32_bf16 v108, v59, v59
    s_waitcnt vmcnt(8)
    v_dot2c_f32_bf16 v118, v60, v7
    v_dot2c_f32_bf16 v110, v60, v60
    v_dot2c_f32_bf16 v118, v61, v7
    v_dot2c_f32_bf16 v110, v61, v61
    v_dot2c_f32_bf16 v118, v62, v7
    v_dot2c_f32_bf16 v110, v62, v62
    v_dot2c_f32_bf16 v118, v63, v7
    v_dot2c_f32_bf16 v110, v63, v63
    s_waitcnt vmcnt(7)
    v_dot2c_f32_bf16 v112, v64, v7
    v_dot2c_f32_bf16 v104, v64, v64
    v_dot2c_f32_bf16 v112, v65, v7
    v_dot2c_f32_bf16 v104, v65, v65
    v_dot2c_f32_bf16 v112, v66, v7
    v_dot2c_f32_bf16 v104, v66, v66
    v_dot2c_f32_bf16 v112, v67, v7
    v_dot2c_f32_bf16 v104, v67, v67
    s_waitcnt vmcnt(6)
    v_dot2c_f32_bf16 v114, v68, v7
    v_dot2c_f32_bf16 v106, v68, v68
    v_dot2c_f32_bf16 v114, v69, v7
    v_dot2c_f32_bf16 v106, v69, v69
    v_dot2c_f32_bf16 v114, v70, v7
    v_dot2c_f32_bf16 v106, v70, v70
    v_dot2c_f32_bf16 v114, v71, v7
    v_dot2c_f32_bf16 v106, v71, v71
    s_waitcnt vmcnt(5)
    v_dot2c_f32_bf16 v116, v72, v7
    v_dot2c_f32_bf16 v108, v72, v72
    v_dot2c_f32_bf16 v116, v73, v7
    v_dot2c_f32_bf16 v108, v73, v73
    v_dot2c_f32_bf16 v116, v74, v7
    v_dot2c_f32_bf16 v108, v74, v74
    v_dot2c_f32_bf16 v116, v75, v7
    v_dot2c_f32_bf16 v108, v75, v75
    s_waitcnt vmcnt(4)
    v_dot2c_f32_bf16 v118, v76, v7
    v_dot2c_f32_bf16 v110, v76, v76
    v_dot2c_f32_bf16 v118, v77, v7
    v_dot2c_f32_bf16 v110, v77, v77
    v_dot2c_f32_bf16 v118, v78, v7
    v_dot2c_f32_bf16 v110, v78, v78
    v_dot2c_f32_bf16 v118, v79, v7
    v_dot2c_f32_bf16 v110, v79, v79
    s_waitcnt vmcnt(3)
    v_dot2c_f32_bf16 v112, v80, v7
    v_dot2c_f32_bf16 v104, v80, v80
    v_dot2c_f32_bf16 v112, v81, v7
    v_dot2c_f32_bf16 v104, v81, v81
    v_dot2c_f32_bf16 v112, v82, v7
    v_dot2c_f32_bf16 v104, v82, v82
    v_dot2c_f32_bf16 v112, v83, v7
    v_dot2c_f32_bf16 v104, v83, v83
    s_waitcnt vmcnt(2)
    v_dot2c_f32_bf16 v114, v84, v7
    v_dot2c_f32_bf16 v106, v84, v84
    v_dot2c_f32_bf16 v114, v85, v7
    v_dot2c_f32_bf16 v106, v85, v85
    v_dot2c_f32_bf16 v114, v86, v7
    v_dot2c_f32_bf16 v106, v86, v86
    v_dot2c_f32_bf16 v114, v87, v7
    v_dot2c_f32_bf16 v106, v87, v87
    s_waitcnt vmcnt(1)
    v_dot2c_f32_bf16 v116, v88, v7
    v_dot2c_f32_bf16 v108, v88, v88
    v_dot2c_f32_bf16 v116, v89, v7
    v_dot2c_f32_bf16 v108, v89, v89
    v_dot2c_f32_bf16 v116, v90, v7
    v_dot2c_f32_bf16 v108, v90, v90
    v_dot2c_f32_bf16 v116, v91, v7
    v_dot2c_f32_bf16 v108, v91, v91
    s_waitcnt vmcnt(0)
    v_dot2c_f32_bf16 v118, v92, v7
    v_dot2c_f32_bf16 v110, v92, v92
    v_dot2c_f32_bf16 v118, v93, v7
    v_dot2c_f32_bf16 v110, v93, v93
    v_dot2c_f32_bf16 v118, v94, v7
    v_dot2c_f32_bf16 v110, v94, v94
    v_dot2c_f32_bf16 v118, v95, v7
    v_dot2c_f32_bf16 v110, v95, v95
    buffer_load_dwordx4 a[0:3], v30, s[48:51], 0 offen sc1
    buffer_load_dwordx4 a[4:7], v30, s[48:51], s10 offen sc1
    buffer_load_dwordx4 a[8:11], v30, s[48:51], s11 offen sc1
    buffer_load_dwordx4 a[12:15], v30, s[48:51], s14 offen sc1
    s_add_u32 m0, s63, 0
    s_add_u32 s60, s94, 0
    buffer_load_dwordx4 v11, s[36:39], s60 offen offset:0 lds
    buffer_load_dwordx4 v12, s[36:39], s60 offen offset:1032 lds
    buffer_load_dwordx4 v13, s[36:39], s60 offen offset:2064 lds
    buffer_load_dwordx4 v14, s[36:39], s60 offen offset:3096 lds
    v_add_f32_dpp v112, v112, v112 quad_perm:[1,0,3,2] row_mask:0xf bank_mask:0xf
    v_add_f32_dpp v104, v104, v104 quad_perm:[1,0,3,2] row_mask:0xf bank_mask:0xf
    v_add_f32_dpp v114, v114, v114 quad_perm:[1,0,3,2] row_mask:0xf bank_mask:0xf
    v_add_f32_dpp v106, v106, v106 quad_perm:[1,0,3,2] row_mask:0xf bank_mask:0xf
    v_add_f32_dpp v116, v116, v116 quad_perm:[1,0,3,2] row_mask:0xf bank_mask:0xf
    v_add_f32_dpp v108, v108, v108 quad_perm:[1,0,3,2] row_mask:0xf bank_mask:0xf
    v_add_f32_dpp v118, v118, v118 quad_perm:[1,0,3,2] row_mask:0xf bank_mask:0xf
    v_add_f32_dpp v110, v110, v110 quad_perm:[1,0,3,2] row_mask:0xf bank_mask:0xf
    v_add_f32_dpp v112, v112, v112 quad_perm:[2,3,0,1] row_mask:0xf bank_mask:0xf
    v_add_f32_dpp v104, v104, v104 quad_perm:[2,3,0,1] row_mask:0xf bank_mask:0xf
    v_add_f32_dpp v114, v114, v114 quad_perm:[2,3,0,1] row_mask:0xf bank_mask:0xf
    v_add_f32_dpp v106, v106, v106 quad_perm:[2,3,0,1] row_mask:0xf bank_mask:0xf
    v_add_f32_dpp v116, v116, v116 quad_perm:[2,3,0,1] row_mask:0xf bank_mask:0xf
    v_add_f32_dpp v108, v108, v108 quad_perm:[2,3,0,1] row_mask:0xf bank_mask:0xf
    v_add_f32_dpp v118, v118, v118 quad_perm:[2,3,0,1] row_mask:0xf bank_mask:0xf
    v_add_f32_dpp v110, v110, v110 quad_perm:[2,3,0,1] row_mask:0xf bank_mask:0xf
    v_add_f32_dpp v112, v112, v112 row_ror:4 row_mask:0xf bank_mask:0xf
    v_add_f32_dpp v104, v104, v104 row_ror:4 row_mask:0xf bank_mask:0xf
    v_add_f32_dpp v114, v114, v114 row_ror:4 row_mask:0xf bank_mask:0xf
    v_add_f32_dpp v106, v106, v106 row_ror:4 row_mask:0xf bank_mask:0xf
    v_add_f32_dpp v116, v116, v116 row_ror:4 row_mask:0xf bank_mask:0xf
    v_add_f32_dpp v108, v108, v108 row_ror:4 row_mask:0xf bank_mask:0xf
    v_add_f32_dpp v118, v118, v118 row_ror:4 row_mask:0xf bank_mask:0xf
    v_add_f32_dpp v110, v110, v110 row_ror:4 row_mask:0xf bank_mask:0xf
    v_add_f32_dpp v112, v112, v112 row_ror:8 row_mask:0xf bank_mask:0xf
    v_add_f32_dpp v104, v104, v104 row_ror:8 row_mask:0xf bank_mask:0xf
    v_add_f32_dpp v114, v114, v114 row_ror:8 row_mask:0xf bank_mask:0xf
    v_add_f32_dpp v106, v106, v106 row_ror:8 row_mask:0xf bank_mask:0xf
    v_add_f32_dpp v116, v116, v116 row_ror:8 row_mask:0xf bank_mask:0xf
    v_add_f32_dpp v108, v108, v108 row_ror:8 row_mask:0xf bank_mask:0xf
    v_add_f32_dpp v118, v118, v118 row_ror:8 row_mask:0xf bank_mask:0xf
    v_add_f32_dpp v110, v110, v110 row_ror:8 row_mask:0xf bank_mask:0xf
    v_mul_f32 v113, 989855744, v112
    v_mul_f32 v115, 989855744, v114
    v_mul_f32 v117, 989855744, v116
    v_mul_f32 v119, 989855744, v118
    v_mul_f32 v104, 989855744, v104
    v_mul_f32 v106, 989855744, v106
    v_mul_f32 v108, 989855744, v108
    v_mul_f32 v110, 989855744, v110
    v_fma_f32 v104, -v113, v113, v104
    v_fma_f32 v106, -v115, v115, v106
    v_fma_f32 v108, -v117, v117, v108
    v_fma_f32 v110, -v119, v119, v110
    v_max_f32 v104, 0, v104
    v_max_f32 v106, 0, v106
    v_max_f32 v108, 0, v108
    v_max_f32 v110, 0, v110
    v_add_f32 v104, 925353388, v104
    v_add_f32 v106, 925353388, v106
    v_add_f32 v108, 925353388, v108
    v_add_f32 v110, 925353388, v110
    v_rsq_f32 v112, v104
    v_rsq_f32 v114, v106
    v_rsq_f32 v116, v108
    v_rsq_f32 v118, v110
    v_mul_f32_e64 v104, -v113, v112
    v_mul_f32_e64 v106, -v115, v114
    v_mul_f32_e64 v108, -v117, v116
    v_mul_f32_e64 v110, -v119, v118
    v_lshlrev_b32 v128, 16, v32
    v_and_b32 v129, 0xffff0000, v32
    v_pk_fma_f32 v[128:129], v[128:129], v[112:113], v[104:105] op_sel_hi:[1,0,0]
    v_lshlrev_b32 v130, 16, v33
    v_and_b32 v131, 0xffff0000, v33
    v_pk_fma_f32 v[130:131], v[130:131], v[112:113], v[104:105] op_sel_hi:[1,0,0]
    v_lshlrev_b32 v132, 16, v34
    v_and_b32 v133, 0xffff0000, v34
    v_pk_fma_f32 v[132:133], v[132:133], v[112:113], v[104:105] op_sel_hi:[1,0,0]
    v_lshlrev_b32 v134, 16, v35
    v_and_b32 v135, 0xffff0000, v35
    v_pk_fma_f32 v[134:135], v[134:135], v[112:113], v[104:105] op_sel_hi:[1,0,0]
    v_lshlrev_b32 v136, 16, v36
    v_and_b32 v137, 0xffff0000, v36
    v_pk_fma_f32 v[136:137], v[136:137], v[114:115], v[106:107] op_sel_hi:[1,0,0]
    v_lshlrev_b32 v138, 16, v37
    v_and_b32 v139, 0xffff0000, v37
    v_pk_fma_f32 v[138:139], v[138:139], v[114:115], v[106:107] op_sel_hi:[1,0,0]
    v_lshlrev_b32 v140, 16, v38
    v_and_b32 v141, 0xffff0000, v38
    v_pk_fma_f32 v[140:141], v[140:141], v[114:115], v[106:107] op_sel_hi:[1,0,0]
    v_lshlrev_b32 v142, 16, v39
    v_and_b32 v143, 0xffff0000, v39
    v_pk_fma_f32 v[142:143], v[142:143], v[114:115], v[106:107] op_sel_hi:[1,0,0]
    v_lshlrev_b32 v144, 16, v40
    v_and_b32 v145, 0xffff0000, v40
    v_pk_fma_f32 v[144:145], v[144:145], v[116:117], v[108:109] op_sel_hi:[1,0,0]
    v_lshlrev_b32 v146, 16, v41
    v_and_b32 v147, 0xffff0000, v41
    v_pk_fma_f32 v[146:147], v[146:147], v[116:117], v[108:109] op_sel_hi:[1,0,0]
    v_lshlrev_b32 v148, 16, v42
    v_and_b32 v149, 0xffff0000, v42
    v_pk_fma_f32 v[148:149], v[148:149], v[116:117], v[108:109] op_sel_hi:[1,0,0]
    v_lshlrev_b32 v150, 16, v43
    v_and_b32 v151, 0xffff0000, v43
    v_pk_fma_f32 v[150:151], v[150:151], v[116:117], v[108:109] op_sel_hi:[1,0,0]
    v_lshlrev_b32 v152, 16, v44
    v_and_b32 v153, 0xffff0000, v44
    v_pk_fma_f32 v[152:153], v[152:153], v[118:119], v[110:111] op_sel_hi:[1,0,0]
    v_lshlrev_b32 v154, 16, v45
    v_and_b32 v155, 0xffff0000, v45
    v_pk_fma_f32 v[154:155], v[154:155], v[118:119], v[110:111] op_sel_hi:[1,0,0]
    v_lshlrev_b32 v156, 16, v46
    v_and_b32 v157, 0xffff0000, v46
    v_pk_fma_f32 v[156:157], v[156:157], v[118:119], v[110:111] op_sel_hi:[1,0,0]
    v_lshlrev_b32 v158, 16, v47
    v_and_b32 v159, 0xffff0000, v47
    v_pk_fma_f32 v[158:159], v[158:159], v[118:119], v[110:111] op_sel_hi:[1,0,0]
    v_lshlrev_b32 v160, 16, v48
    v_and_b32 v161, 0xffff0000, v48
    v_pk_fma_f32 v[160:161], v[160:161], v[112:113], v[104:105] op_sel_hi:[1,0,0]
    v_lshlrev_b32 v162, 16, v49
    v_and_b32 v163, 0xffff0000, v49
    v_pk_fma_f32 v[162:163], v[162:163], v[112:113], v[104:105] op_sel_hi:[1,0,0]
    v_lshlrev_b32 v164, 16, v50
    v_and_b32 v165, 0xffff0000, v50
    v_pk_fma_f32 v[164:165], v[164:165], v[112:113], v[104:105] op_sel_hi:[1,0,0]
    v_lshlrev_b32 v166, 16, v51
    v_and_b32 v167, 0xffff0000, v51
    v_pk_fma_f32 v[166:167], v[166:167], v[112:113], v[104:105] op_sel_hi:[1,0,0]
    v_lshlrev_b32 v168, 16, v52
    v_and_b32 v169, 0xffff0000, v52
    v_pk_fma_f32 v[168:169], v[168:169], v[114:115], v[106:107] op_sel_hi:[1,0,0]
    v_lshlrev_b32 v170, 16, v53
    v_and_b32 v171, 0xffff0000, v53
    v_pk_fma_f32 v[170:171], v[170:171], v[114:115], v[106:107] op_sel_hi:[1,0,0]
    v_lshlrev_b32 v172, 16, v54
    v_and_b32 v173, 0xffff0000, v54
    v_pk_fma_f32 v[172:173], v[172:173], v[114:115], v[106:107] op_sel_hi:[1,0,0]
    v_lshlrev_b32 v174, 16, v55
    v_and_b32 v175, 0xffff0000, v55
    v_pk_fma_f32 v[174:175], v[174:175], v[114:115], v[106:107] op_sel_hi:[1,0,0]
    v_lshlrev_b32 v176, 16, v56
    v_and_b32 v177, 0xffff0000, v56
    v_pk_fma_f32 v[176:177], v[176:177], v[116:117], v[108:109] op_sel_hi:[1,0,0]
    v_lshlrev_b32 v178, 16, v57
    v_and_b32 v179, 0xffff0000, v57
    v_pk_fma_f32 v[178:179], v[178:179], v[116:117], v[108:109] op_sel_hi:[1,0,0]
    v_lshlrev_b32 v180, 16, v58
    v_and_b32 v181, 0xffff0000, v58
    v_pk_fma_f32 v[180:181], v[180:181], v[116:117], v[108:109] op_sel_hi:[1,0,0]
    v_lshlrev_b32 v182, 16, v59
    v_and_b32 v183, 0xffff0000, v59
    v_pk_fma_f32 v[182:183], v[182:183], v[116:117], v[108:109] op_sel_hi:[1,0,0]
    v_lshlrev_b32 v184, 16, v60
    v_and_b32 v185, 0xffff0000, v60
    v_pk_fma_f32 v[184:185], v[184:185], v[118:119], v[110:111] op_sel_hi:[1,0,0]
    v_lshlrev_b32 v186, 16, v61
    v_and_b32 v187, 0xffff0000, v61
    v_pk_fma_f32 v[186:187], v[186:187], v[118:119], v[110:111] op_sel_hi:[1,0,0]
    v_lshlrev_b32 v188, 16, v62
    v_and_b32 v189, 0xffff0000, v62
    v_pk_fma_f32 v[188:189], v[188:189], v[118:119], v[110:111] op_sel_hi:[1,0,0]
    v_lshlrev_b32 v190, 16, v63
    v_and_b32 v191, 0xffff0000, v63
    v_pk_fma_f32 v[190:191], v[190:191], v[118:119], v[110:111] op_sel_hi:[1,0,0]
    v_lshlrev_b32 v192, 16, v64
    v_and_b32 v193, 0xffff0000, v64
    v_pk_fma_f32 v[192:193], v[192:193], v[112:113], v[104:105] op_sel_hi:[1,0,0]
    v_lshlrev_b32 v194, 16, v65
    v_and_b32 v195, 0xffff0000, v65
    v_pk_fma_f32 v[194:195], v[194:195], v[112:113], v[104:105] op_sel_hi:[1,0,0]
    v_lshlrev_b32 v196, 16, v66
    v_and_b32 v197, 0xffff0000, v66
    v_pk_fma_f32 v[196:197], v[196:197], v[112:113], v[104:105] op_sel_hi:[1,0,0]
    v_lshlrev_b32 v198, 16, v67
    v_and_b32 v199, 0xffff0000, v67
    v_pk_fma_f32 v[198:199], v[198:199], v[112:113], v[104:105] op_sel_hi:[1,0,0]
    s_waitcnt lgkmcnt(0)
    s_mul_i32 s34, s34, 0x9E3779B1
    s_add_u32 s34, s34, 0x7F4A7C15
    s_waitcnt vmcnt(7)
    v_accvgpr_read_b32 v32, a0
    v_accvgpr_read_b32 v33, a1
    v_accvgpr_read_b32 v34, a2
    v_accvgpr_read_b32 v35, a3
    s_waitcnt vmcnt(6)
    v_accvgpr_read_b32 v36, a4
    v_accvgpr_read_b32 v37, a5
    v_accvgpr_read_b32 v38, a6
    v_accvgpr_read_b32 v39, a7
    s_waitcnt vmcnt(5)
    v_accvgpr_read_b32 v40, a8
    v_accvgpr_read_b32 v41, a9
    v_accvgpr_read_b32 v42, a10
    v_accvgpr_read_b32 v43, a11
    s_waitcnt vmcnt(4)
    v_accvgpr_read_b32 v44, a12
    v_accvgpr_read_b32 v45, a13
    v_accvgpr_read_b32 v46, a14
    v_accvgpr_read_b32 v47, a15
    v_cmp_ne_u32 vcc, s34, v33
    v_cmp_ne_u32 s[100:101], s34, v35
    s_nop 0
    s_or_b64 vcc, vcc, s[100:101]
    v_cmp_ne_u32 s[100:101], s34, v37
    s_nop 0
    s_or_b64 vcc, vcc, s[100:101]
    v_cmp_ne_u32 s[100:101], s34, v39
    s_nop 0
    s_or_b64 vcc, vcc, s[100:101]
    v_cmp_ne_u32 s[100:101], s34, v41
    s_nop 0
    s_or_b64 vcc, vcc, s[100:101]
    v_cmp_ne_u32 s[100:101], s34, v43
    s_nop 0
    s_or_b64 vcc, vcc, s[100:101]
    v_cmp_ne_u32 s[100:101], s34, v45
    s_nop 0
    s_or_b64 vcc, vcc, s[100:101]
    v_cmp_ne_u32 s[100:101], s34, v47
    s_nop 0
    s_or_b64 vcc, vcc, s[100:101]
    s_cbranch_vccz L_pollmod_x
    s_mov_b32 s3, 262144
L_pollmod:
    s_sleep 4
    buffer_load_dwordx4 a[0:3], v30, s[48:51], 0 offen sc1
    buffer_load_dwordx4 a[4:7], v30, s[48:51], s10 offen sc1
    buffer_load_dwordx4 a[8:11], v30, s[48:51], s11 offen sc1
    buffer_load_dwordx4 a[12:15], v30, s[48:51], s14 offen sc1
    s_sub_u32 s3, s3, 1
    s_waitcnt vmcnt(0)
    v_accvgpr_read_b32 v32, a0
    v_accvgpr_read_b32 v33, a1
    v_accvgpr_read_b32 v34, a2
    v_accvgpr_read_b32 v35, a3
    v_accvgpr_read_b32 v36, a4
    v_accvgpr_read_b32 v37, a5
    v_accvgpr_read_b32 v38, a6
    v_accvgpr_read_b32 v39, a7
    v_accvgpr_read_b32 v40, a8
    v_accvgpr_read_b32 v41, a9
    v_accvgpr_read_b32 v42, a10
    v_accvgpr_read_b32 v43, a11
    v_accvgpr_read_b32 v44, a12
    v_accvgpr_read_b32 v45, a13
    v_accvgpr_read_b32 v46, a14
    v_accvgpr_read_b32 v47, a15
    v_cmp_ne_u32 vcc, s34, v33
    v_cmp_ne_u32 s[100:101], s34, v35
    s_nop 0
    s_or_b64 vcc, vcc, s[100:101]
    v_cmp_ne_u32 s[100:101], s34, v37
    s_nop 0
    s_or_b64 vcc, vcc, s[100:101]
    v_cmp_ne_u32 s[100:101], s34, v39
    s_nop 0
    s_or_b64 vcc, vcc, s[100:101]
    v_cmp_ne_u32 s[100:101], s34, v41
    s_nop 0
    s_or_b64 vcc, vcc, s[100:101]
    v_cmp_ne_u32 s[100:101], s34, v43
    s_nop 0
    s_or_b64 vcc, vcc, s[100:101]
    v_cmp_ne_u32 s[100:101], s34, v45
    s_nop 0
    s_or_b64 vcc, vcc, s[100:101]
    v_cmp_ne_u32 s[100:101], s34, v47
    s_nop 0
    s_or_b64 vcc, vcc, s[100:101]
    s_cmp_eq_u32 s3, 0
    s_cbranch_scc1 L_pollmod_x
    s_cbranch_vccnz L_pollmod
L_pollmod_x:
    s_cmp_ge_u32 s35, 2
    s_cselect_b32 s60, 1.0, 0
    s_cselect_b32 s3, 2048, 0
    s_add_u32 s3, s3, 148352
    s_mov_b32 s61, 1040356334
    v_lshlrev_b32 v2, 16, v32
    v_and_b32 v3, 0xffff0000, v32
    v_lshlrev_b32 v4, 16, v34
    v_and_b32 v5, 0xffff0000, v34
    v_add_f32 v100, s60, v2
    v_add_f32 v101, s60, v3
    v_add_f32 v102, s60, v4
    v_add_f32 v103, s60, v5
    v_lshlrev_b32 v2, 16, v36
    v_and_b32 v3, 0xffff0000, v36
    v_lshlrev_b32 v4, 16, v38
    v_and_b32 v5, 0xffff0000, v38
    v_add_f32 v100, v100, v2
    v_add_f32 v101, v101, v3
    v_add_f32 v102, v102, v4
    v_add_f32 v103, v103, v5
    v_lshlrev_b32 v2, 16, v40
    v_and_b32 v3, 0xffff0000, v40
    v_lshlrev_b32 v4, 16, v42
    v_and_b32 v5, 0xffff0000, v42
    v_add_f32 v100, v100, v2
    v_add_f32 v101, v101, v3
    v_add_f32 v102, v102, v4
    v_add_f32 v103, v103, v5
    v_lshlrev_b32 v2, 16, v44
    v_and_b32 v3, 0xffff0000, v44
    v_lshlrev_b32 v4, 16, v46
    v_and_b32 v5, 0xffff0000, v46
    v_add_f32 v100, v100, v2
    v_add_f32 v101, v101, v3
    v_add_f32 v102, v102, v4
    v_add_f32 v103, v103, v5
    v_mul_f32 v100, s61, v100
    v_mul_f32 v101, s61, v101
    v_mul_f32 v102, s61, v102
    v_mul_f32 v103, s61, v103
    s_lshl_b32 s60, s95, 8
    v_lshlrev_b32 v2, 4, v0
    v_subrev_u32 v2, s60, v2
    v_and_b32 v2, 2047, v2
    v_add_u32 v2, s3, v2
    ds_write_b128 v2, v[100:103]
    s_add_u32 m0, s63, 4128
    s_add_u32 s60, s94, 262144
    buffer_load_dwordx4 v11, s[36:39], s60 offen offset:0 lds
    buffer_load_dwordx4 v12, s[36:39], s60 offen offset:1032 lds
    buffer_load_dwordx4 v13, s[36:39], s60 offen offset:2064 lds
    buffer_load_dwordx4 v14, s[36:39], s60 offen offset:3096 lds
    s_add_u32 s94, s94, 524288
    s_and_b32 s94, s94, 4194303
    v_lshlrev_b32 v200, 16, v68
    v_and_b32 v201, 0xffff0000, v68
    v_pk_fma_f32 v[200:201], v[200:201], v[114:115], v[106:107] op_sel_hi:[1,0,0]
    v_lshlrev_b32 v202, 16, v69
    v_and_b32 v203, 0xffff0000, v69
    v_pk_fma_f32 v[202:203], v[202:203], v[114:115], v[106:107] op_sel_hi:[1,0,0]
    v_lshlrev_b32 v204, 16, v70
    v_and_b32 v205, 0xffff0000, v70
    v_pk_fma_f32 v[204:205], v[204:205], v[114:115], v[106:107] op_sel_hi:[1,0,0]
    v_lshlrev_b32 v206, 16, v71
    v_and_b32 v207, 0xffff0000, v71
    v_pk_fma_f32 v[206:207], v[206:207], v[114:115], v[106:107] op_sel_hi:[1,0,0]
    v_lshlrev_b32 v208, 16, v72
    v_and_b32 v209, 0xffff0000, v72
    v_pk_fma_f32 v[208:209], v[208:209], v[116:117], v[108:109] op_sel_hi:[1,0,0]
    v_lshlrev_b32 v210, 16, v73
    v_and_b32 v211, 0xffff0000, v73
    v_pk_fma_f32 v[210:211], v[210:211], v[116:117], v[108:109] op_sel_hi:[1,0,0]
    v_lshlrev_b32 v212, 16, v74
    v_and_b32 v213, 0xffff0000, v74
    v_pk_fma_f32 v[212:213], v[212:213], v[116:117], v[108:109] op_sel_hi:[1,0,0]
    v_lshlrev_b32 v214, 16, v75
    v_and_b32 v215, 0xffff0000, v75
    v_pk_fma_f32 v[214:215], v[214:215], v[116:117], v[108:109] op_sel_hi:[1,0,0]
    v_lshlrev_b32 v216, 16, v76
    v_and_b32 v217, 0xffff0000, v76
    v_pk_fma_f32 v[216:217], v[216:217], v[118:119], v[110:111] op_sel_hi:[1,0,0]
    v_lshlrev_b32 v218, 16, v77
    v_and_b32 v219, 0xffff0000, v77
    v_pk_fma_f32 v[218:219], v[218:219], v[118:119], v[110:111] op_sel_hi:[1,0,0]
    v_lshlrev_b32 v220, 16, v78
    v_and_b32 v221, 0xffff0000, v78
    v_pk_fma_f32 v[220:221], v[220:221], v[118:119], v[110:111] op_sel_hi:[1,0,0]
    v_lshlrev_b32 v222, 16, v79
    v_and_b32 v223, 0xffff0000, v79
    v_pk_fma_f32 v[222:223], v[222:223], v[118:119], v[110:111] op_sel_hi:[1,0,0]
    v_lshlrev_b32 v224, 16, v80
    v_and_b32 v225, 0xffff0000, v80
    v_pk_fma_f32 v[224:225], v[224:225], v[112:113], v[104:105] op_sel_hi:[1,0,0]
    v_lshlrev_b32 v226, 16, v81
    v_and_b32 v227, 0xffff0000, v81
    v_pk_fma_f32 v[226:227], v[226:227], v[112:113], v[104:105] op_sel_hi:[1,0,0]
    v_lshlrev_b32 v228, 16, v82
    v_and_b32 v229, 0xffff0000, v82
    v_pk_fma_f32 v[228:229], v[228:229], v[112:113], v[104:105] op_sel_hi:[1,0,0]
    v_lshlrev_b32 v230, 16, v83
    v_and_b32 v231, 0xffff0000, v83
    v_pk_fma_f32 v[230:231], v[230:231], v[112:113], v[104:105] op_sel_hi:[1,0,0]
    v_lshlrev_b32 v232, 16, v84
    v_and_b32 v233, 0xffff0000, v84
    v_pk_fma_f32 v[232:233], v[232:233], v[114:115], v[106:107] op_sel_hi:[1,0,0]
    v_lshlrev_b32 v234, 16, v85
    v_and_b32 v235, 0xffff0000, v85
    v_pk_fma_f32 v[234:235], v[234:235], v[114:115], v[106:107] op_sel_hi:[1,0,0]
    v_lshlrev_b32 v236, 16, v86
    v_and_b32 v237, 0xffff0000, v86
    v_pk_fma_f32 v[236:237], v[236:237], v[114:115], v[106:107] op_sel_hi:[1,0,0]
    v_lshlrev_b32 v238, 16, v87
    v_and_b32 v239, 0xffff0000, v87
    v_pk_fma_f32 v[238:239], v[238:239], v[114:115], v[106:107] op_sel_hi:[1,0,0]
    v_lshlrev_b32 v240, 16, v88
    v_and_b32 v241, 0xffff0000, v88
    v_pk_fma_f32 v[240:241], v[240:241], v[116:117], v[108:109] op_sel_hi:[1,0,0]
    v_lshlrev_b32 v242, 16, v89
    v_and_b32 v243, 0xffff0000, v89
    v_pk_fma_f32 v[242:243], v[242:243], v[116:117], v[108:109] op_sel_hi:[1,0,0]
    v_lshlrev_b32 v244, 16, v90
    v_and_b32 v245, 0xffff0000, v90
    v_pk_fma_f32 v[244:245], v[244:245], v[116:117], v[108:109] op_sel_hi:[1,0,0]
    v_lshlrev_b32 v246, 16, v91
    v_and_b32 v247, 0xffff0000, v91
    v_pk_fma_f32 v[246:247], v[246:247], v[116:117], v[108:109] op_sel_hi:[1,0,0]
    v_lshlrev_b32 v248, 16, v92
    v_and_b32 v249, 0xffff0000, v92
    v_pk_fma_f32 v[248:249], v[248:249], v[118:119], v[110:111] op_sel_hi:[1,0,0]
    v_lshlrev_b32 v250, 16, v93
    v_and_b32 v251, 0xffff0000, v93
    v_pk_fma_f32 v[250:251], v[250:251], v[118:119], v[110:111] op_sel_hi:[1,0,0]
    v_lshlrev_b32 v252, 16, v94
    v_and_b32 v253, 0xffff0000, v94
    v_pk_fma_f32 v[252:253], v[252:253], v[118:119], v[110:111] op_sel_hi:[1,0,0]
    v_lshlrev_b32 v254, 16, v95
    v_and_b32 v255, 0xffff0000, v95
    v_pk_fma_f32 v[254:255], v[254:255], v[118:119], v[110:111] op_sel_hi:[1,0,0]
    v_and_b32 v30, 15, v1
    v_lshlrev_b32 v30, 5, v30
    v_add_u32 v30, 148352, v30
L_stub1:
    s_cbranch_execz L_stub5
    s_waitcnt lgkmcnt(0)
    s_barrier
    ds_read_b128 v[32:35], v30 offset:0
    ds_read_b128 v[36:39], v30 offset:16
    ds_read_b128 v[40:43], v30 offset:2048
    ds_read_b128 v[44:47], v30 offset:2064
    ds_read_b128 v[48:51], v30 offset:512
    ds_read_b128 v[52:55], v30 offset:528
    ds_read_b128 v[56:59], v30 offset:2560
    ds_read_b128 v[60:63], v30 offset:2576
    ds_read_b128 v[64:67], v30 offset:1024
    ds_read_b128 v[68:71], v30 offset:1040
    ds_read_b128 v[72:75], v30 offset:3072
    ds_read_b128 v[76:79], v30 offset:3088
    ds_read_b128 v[80:83], v30 offset:1536
    ds_read_b128 v[84:87], v30 offset:1552
    ds_read_b128 v[88:91], v30 offset:3584
    ds_read_b128 v[92:95], v30 offset:3600
    s_add_u32 s61, s8, s6
    s_waitcnt lgkmcnt(13)
    v_pk_fma_f32 v[128:129], v[128:129], v[40:41], v[32:33]
    v_pk_fma_f32 v[130:131], v[130:131], v[42:43], v[34:35]
    s_waitcnt lgkmcnt(12)
    v_pk_fma_f32 v[132:133], v[132:133], v[44:45], v[36:37]
    v_pk_fma_f32 v[134:135], v[134:135], v[46:47], v[38:39]
    v_cvt_pk_bf16_f32 v96, v128, v129
    v_cvt_pk_bf16_f32 v97, v130, v131
    v_cvt_pk_bf16_f32 v98, v132, v133
    v_cvt_pk_bf16_f32 v99, v134, v135
    ds_write_b128 v120, v[96:99] offset:0
    buffer_load_dwordx4 a[244:247], v16, s[40:43], s61 offen offset:0
    v_pk_fma_f32 v[136:137], v[136:137], v[40:41], v[32:33]
    v_pk_fma_f32 v[138:139], v[138:139], v[42:43], v[34:35]
    v_pk_fma_f32 v[140:141], v[140:141], v[44:45], v[36:37]
    v_pk_fma_f32 v[142:143], v[142:143], v[46:47], v[38:39]
    v_cvt_pk_bf16_f32 v100, v136, v137
    v_cvt_pk_bf16_f32 v101, v138, v139
    v_cvt_pk_bf16_f32 v102, v140, v141
    v_cvt_pk_bf16_f32 v103, v142, v143
    ds_write_b128 v121, v[100:103] offset:256
    buffer_load_dwordx4 a[244:247], v16, s[40:43], s61 offen offset:1024
    v_pk_fma_f32 v[144:145], v[144:145], v[40:41], v[32:33]
    v_pk_fma_f32 v[146:147], v[146:147], v[42:43], v[34:35]
    v_pk_fma_f32 v[148:149], v[148:149], v[44:45], v[36:37]
    v_pk_fma_f32 v[150:151], v[150:151], v[46:47], v[38:39]
    v_cvt_pk_bf16_f32 v104, v144, v145
    v_cvt_pk_bf16_f32 v105, v146, v147
    v_cvt_pk_bf16_f32 v106, v148, v149
    v_cvt_pk_bf16_f32 v107, v150, v151
    ds_write_b128 v122, v[104:107] offset:512
    buffer_load_dwordx4 a[244:247], v16, s[40:43], s61 offen offset:2048
    v_pk_fma_f32 v[152:153], v[152:153], v[40:41], v[32:33]
    v_pk_fma_f32 v[154:155], v[154:155], v[42:43], v[34:35]
    v_pk_fma_f32 v[156:157], v[156:157], v[44:45], v[36:37]
    v_pk_fma_f32 v[158:159], v[158:159], v[46:47], v[38:39]
    v_cvt_pk_bf16_f32 v108, v152, v153
    v_cvt_pk_bf16_f32 v109, v154, v155
    v_cvt_pk_bf16_f32 v110, v156, v157
    v_cvt_pk_bf16_f32 v111, v158, v159
    ds_write_b128 v123, v[108:111] offset:768
    buffer_load_dwordx4 a[244:247], v16, s[40:43], s61 offen offset:3072
    s_waitcnt lgkmcnt(3)
    v_pk_fma_f32 v[160:161], v[160:161], v[56:57], v[48:49]
    v_pk_fma_f32 v[162:163], v[162:163], v[58:59], v[50:51]
    v_pk_fma_f32 v[164:165], v[164:165], v[60:61], v[52:53]
    v_pk_fma_f32 v[166:167], v[166:167], v[62:63], v[54:55]
    v_cvt_pk_bf16_f32 v96, v160, v161
    v_cvt_pk_bf16_f32 v97, v162, v163
    v_cvt_pk_bf16_f32 v98, v164, v165
    v_cvt_pk_bf16_f32 v99, v166, v167
    ds_write_b128 v120, v[96:99] offset:16384
    v_pk_fma_f32 v[168:169], v[168:169], v[56:57], v[48:49]
    v_pk_fma_f32 v[170:171], v[170:171], v[58:59], v[50:51]
    v_pk_fma_f32 v[172:173], v[172:173], v[60:61], v[52:53]
    v_pk_fma_f32 v[174:175], v[174:175], v[62:63], v[54:55]
    v_cvt_pk_bf16_f32 v100, v168, v169
    v_cvt_pk_bf16_f32 v101, v170, v171
    v_cvt_pk_bf16_f32 v102, v172, v173
    v_cvt_pk_bf16_f32 v103, v174, v175
    ds_write_b128 v121, v[100:103] offset:16640
    v_pk_fma_f32 v[176:177], v[176:177], v[56:57], v[48:49]
    v_pk_fma_f32 v[178:179], v[178:179], v[58:59], v[50:51]
    v_pk_fma_f32 v[180:181], v[180:181], v[60:61], v[52:53]
    v_pk_fma_f32 v[182:183], v[182:183], v[62:63], v[54:55]
    v_cvt_pk_bf16_f32 v104, v176, v177
    v_cvt_pk_bf16_f32 v105, v178, v179
    v_cvt_pk_bf16_f32 v106, v180, v181
    v_cvt_pk_bf16_f32 v107, v182, v183
    ds_write_b128 v122, v[104:107] offset:16896
    v_pk_fma_f32 v[184:185], v[184:185], v[56:57], v[48:49]
    v_pk_fma_f32 v[186:187], v[186:187], v[58:59], v[50:51]
    v_pk_fma_f32 v[188:189], v[188:189], v[60:61], v[52:53]
    v_pk_fma_f32 v[190:191], v[190:191], v[62:63], v[54:55]
    v_cvt_pk_bf16_f32 v108, v184, v185
    v_cvt_pk_bf16_f32 v109, v186, v187
    v_cvt_pk_bf16_f32 v110, v188, v189
    v_cvt_pk_bf16_f32 v111, v190, v191
    ds_write_b128 v123, v[108:111] offset:17152
    v_pk_fma_f32 v[192:193], v[192:193], v[72:73], v[64:65]
    v_pk_fma_f32 v[194:195], v[194:195], v[74:75], v[66:67]
    v_pk_fma_f32 v[196:197], v[196:197], v[76:77], v[68:69]
    v_pk_fma_f32 v[198:199], v[198:199], v[78:79], v[70:71]
    v_cvt_pk_bf16_f32 v96, v192, v193
    v_cvt_pk_bf16_f32 v97, v194, v195
    v_cvt_pk_bf16_f32 v98, v196, v197
    v_cvt_pk_bf16_f32 v99, v198, v199
    ds_write_b128 v120, v[96:99] offset:32768
    s_add_u32 m0, s63, 8256
    s_add_u32 s60, s92, 0
    buffer_load_dwordx4 v11, s[36:39], s60 offen offset:0 lds
    v_pk_fma_f32 v[200:201], v[200:201], v[72:73], v[64:65]
    v_pk_fma_f32 v[202:203], v[202:203], v[74:75], v[66:67]
    v_pk_fma_f32 v[204:205], v[204:205], v[76:77], v[68:69]
    v_pk_fma_f32 v[206:207], v[206:207], v[78:79], v[70:71]
    v_cvt_pk_bf16_f32 v100, v200, v201
    v_cvt_pk_bf16_f32 v101, v202, v203
    v_cvt_pk_bf16_f32 v102, v204, v205
    v_cvt_pk_bf16_f32 v103, v206, v207
    ds_write_b128 v121, v[100:103] offset:33024
    buffer_load_dwordx4 v12, s[36:39], s60 offen offset:1032 lds
    v_pk_fma_f32 v[208:209], v[208:209], v[72:73], v[64:65]
    v_pk_fma_f32 v[210:211], v[210:211], v[74:75], v[66:67]
    v_pk_fma_f32 v[212:213], v[212:213], v[76:77], v[68:69]
    v_pk_fma_f32 v[214:215], v[214:215], v[78:79], v[70:71]
    v_cvt_pk_bf16_f32 v104, v208, v209
    v_cvt_pk_bf16_f32 v105, v210, v211
    v_cvt_pk_bf16_f32 v106, v212, v213
    v_cvt_pk_bf16_f32 v107, v214, v215
    ds_write_b128 v122, v[104:107] offset:33280
    buffer_load_dwordx4 v13, s[36:39], s60 offen offset:2064 lds
    v_pk_fma_f32 v[216:217], v[216:217], v[72:73], v[64:65]
    v_pk_fma_f32 v[218:219], v[218:219], v[74:75], v[66:67]
    v_pk_fma_f32 v[220:221], v[220:221], v[76:77], v[68:69]
    v_pk_fma_f32 v[222:223], v[222:223], v[78:79], v[70:71]
    v_cvt_pk_bf16_f32 v108, v216, v217
    v_cvt_pk_bf16_f32 v109, v218, v219
    v_cvt_pk_bf16_f32 v110, v220, v221
    v_cvt_pk_bf16_f32 v111, v222, v223
    ds_write_b128 v123, v[108:111] offset:33536
    buffer_load_dwordx4 v14, s[36:39], s60 offen offset:3096 lds
    v_pk_fma_f32 v[224:225], v[224:225], v[88:89], v[80:81]
    v_pk_fma_f32 v[226:227], v[226:227], v[90:91], v[82:83]
    v_pk_fma_f32 v[228:229], v[228:229], v[92:93], v[84:85]
    v_pk_fma_f32 v[230:231], v[230:231], v[94:95], v[86:87]
    v_cvt_pk_bf16_f32 v96, v224, v225
    v_cvt_pk_bf16_f32 v97, v226, v227
    v_cvt_pk_bf16_f32 v98, v228, v229
    v_cvt_pk_bf16_f32 v99, v230, v231
    ds_write_b128 v120, v[96:99] offset:49152
    s_add_u32 m0, s63, 12384
    s_add_u32 s60, s92, 262144
    buffer_load_dwordx4 v11, s[36:39], s60 offen offset:0 lds
    v_pk_fma_f32 v[232:233], v[232:233], v[88:89], v[80:81]
    v_pk_fma_f32 v[234:235], v[234:235], v[90:91], v[82:83]
    v_pk_fma_f32 v[236:237], v[236:237], v[92:93], v[84:85]
    v_pk_fma_f32 v[238:239], v[238:239], v[94:95], v[86:87]
    v_cvt_pk_bf16_f32 v100, v232, v233
    v_cvt_pk_bf16_f32 v101, v234, v235
    v_cvt_pk_bf16_f32 v102, v236, v237
    v_cvt_pk_bf16_f32 v103, v238, v239
    ds_write_b128 v121, v[100:103] offset:49408
    buffer_load_dwordx4 v12, s[36:39], s60 offen offset:1032 lds
    v_pk_fma_f32 v[240:241], v[240:241], v[88:89], v[80:81]
    v_pk_fma_f32 v[242:243], v[242:243], v[90:91], v[82:83]
    v_pk_fma_f32 v[244:245], v[244:245], v[92:93], v[84:85]
    v_pk_fma_f32 v[246:247], v[246:247], v[94:95], v[86:87]
    v_cvt_pk_bf16_f32 v104, v240, v241
    v_cvt_pk_bf16_f32 v105, v242, v243
    v_cvt_pk_bf16_f32 v106, v244, v245
    v_cvt_pk_bf16_f32 v107, v246, v247
    ds_write_b128 v122, v[104:107] offset:49664
    buffer_load_dwordx4 v13, s[36:39], s60 offen offset:2064 lds
    v_pk_fma_f32 v[248:249], v[248:249], v[88:89], v[80:81]
    v_pk_fma_f32 v[250:251], v[250:251], v[90:91], v[82:83]
    v_pk_fma_f32 v[252:253], v[252:253], v[92:93], v[84:85]
    v_pk_fma_f32 v[254:255], v[254:255], v[94:95], v[86:87]
    v_cvt_pk_bf16_f32 v108, v248, v249
    v_cvt_pk_bf16_f32 v109, v250, v251
    v_cvt_pk_bf16_f32 v110, v252, v253
    v_cvt_pk_bf16_f32 v111, v254, v255
    ds_write_b128 v123, v[108:111] offset:49920
    buffer_load_dwordx4 v14, s[36:39], s60 offen offset:3096 lds
    s_waitcnt vmcnt(16)
    ds_read_b64_tr_b16 a[64:65], v9 offset:0
    ds_read_b64_tr_b16 a[66:67], v9 offset:256
    ds_read_b64_tr_b16 a[68:69], v9 offset:8
    ds_read_b64_tr_b16 a[70:71], v9 offset:264
    ds_read_b64_tr_b16 a[72:73], v9 offset:512
    ds_read_b64_tr_b16 a[74:75], v9 offset:768
    ds_read_b64_tr_b16 a[76:77], v9 offset:520
    ds_read_b64_tr_b16 a[78:79], v9 offset:776
    s_waitcnt vmcnt(12)
    ds_read_b64_tr_b16 a[80:81], v9 offset:4128
    ds_read_b64_tr_b16 a[82:83], v9 offset:4384
    ds_read_b64_tr_b16 a[84:85], v9 offset:4136
    ds_read_b64_tr_b16 a[86:87], v9 offset:4392
    ds_read_b64_tr_b16 a[88:89], v9 offset:4640
    ds_read_b64_tr_b16 a[90:91], v9 offset:4896
    ds_read_b64_tr_b16 a[92:93], v9 offset:4648
    ds_read_b64_tr_b16 a[94:95], v9 offset:4904
    s_add_u32 s92, s92, 524288
    s_and_b32 s92, s92, 4194303
    s_mov_b32 m0, s93
    s_add_u32 s60, s94, 0
    buffer_load_dwordx4 v11, s[36:39], s60 offen offset:0 lds
    buffer_load_dwordx4 v12, s[36:39], s60 offen offset:1032 lds
    buffer_load_dwordx4 v13, s[36:39], s60 offen offset:2064 lds
    buffer_load_dwordx4 v14, s[36:39], s60 offen offset:3096 lds
    s_waitcnt lgkmcnt(0)
    s_barrier
    ds_read_b128 a[0:3], v15 offset:0
    ds_read_b128 a[4:7], v15 offset:1024
    ds_read_b128 a[8:11], v15 offset:2048
    ds_read_b128 a[12:15], v15 offset:3072
    ds_read_b128 a[16:19], v8 offset:4096
    ds_read_b128 a[20:23], v8 offset:5120
    ds_read_b128 a[24:27], v8 offset:6144
    ds_read_b128 a[28:31], v8 offset:7168
    s_waitcnt lgkmcnt(7)
    v_mfma_f32_16x16x32_bf16 v[128:131], a[64:67], a[0:3], 0
    s_add_u32 m0, s63, 0
    s_add_u32 s60, s94, 262144
    s_waitcnt lgkmcnt(3)
    v_mfma_f32_16x16x32_bf16 v[128:131], a[80:83], a[16:19], v[128:131]
    v_mfma_f32_16x16x32_bf16 v[132:135], a[64:67], a[4:7], 0
    s_waitcnt lgkmcnt(2)
    v_mfma_f32_16x16x32_bf16 v[132:135], a[80:83], a[20:23], v[132:135]
    buffer_load_dwordx4 v11, s[36:39], s60 offen offset:0 lds
    v_mfma_f32_16x16x32_bf16 v[136:139], a[64:67], a[8:11], 0
    s_waitcnt lgkmcnt(1)
    v_mfma_f32_16x16x32_bf16 v[136:139], a[80:83], a[24:27], v[136:139]
    buffer_load_dwordx4 v12, s[36:39], s60 offen offset:1032 lds
    v_mfma_f32_16x16x32_bf16 v[140:143], a[64:67], a[12:15], 0
    s_waitcnt lgkmcnt(0)
    v_mfma_f32_16x16x32_bf16 v[140:143], a[80:83], a[28:31], v[140:143]
    buffer_load_dwordx4 v13, s[36:39], s60 offen offset:2064 lds
    v_mfma_f32_16x16x32_bf16 v[144:147], a[68:71], a[0:3], 0
    ds_read_b128 a[32:35], v15 offset:8192
    v_mfma_f32_16x16x32_bf16 v[144:147], a[84:87], a[16:19], v[144:147]
    buffer_load_dwordx4 v14, s[36:39], s60 offen offset:3096 lds
    s_add_u32 s94, s94, 524288
    v_mfma_f32_16x16x32_bf16 v[148:151], a[68:71], a[4:7], 0
    s_waitcnt vmcnt(12)
    ds_read_b64_tr_b16 a[96:97], v9 offset:8256
    s_and_b32 s94, s94, 4194303
    v_mfma_f32_16x16x32_bf16 v[148:151], a[84:87], a[20:23], v[148:151]
    s_add_u32 m0, s63, 4128
    s_add_u32 s60, s92, 0
    v_mfma_f32_16x16x32_bf16 v[152:155], a[68:71], a[8:11], 0
    buffer_load_dwordx4 v11, s[36:39], s60 offen offset:0 lds
    ds_read_b64_tr_b16 a[98:99], v9 offset:8512
    v_mfma_f32_16x16x32_bf16 v[152:155], a[84:87], a[24:27], v[152:155]
    ds_read_b64_tr_b16 a[100:101], v9 offset:8264
    ds_read_b128 a[36:39], v15 offset:9216
    v_mfma_f32_16x16x32_bf16 v[156:159], a[68:71], a[12:15], 0
    buffer_load_dwordx4 v12, s[36:39], s60 offen offset:1032 lds
    ds_read_b64_tr_b16 a[102:103], v9 offset:8520
    v_mfma_f32_16x16x32_bf16 v[156:159], a[84:87], a[28:31], v[156:159]
    ds_read_b64_tr_b16 a[104:105], v9 offset:8768
    v_mfma_f32_16x16x32_bf16 v[160:163], a[72:75], a[0:3], 0
    buffer_load_dwordx4 v13, s[36:39], s60 offen offset:2064 lds
    ds_read_b64_tr_b16 a[106:107], v9 offset:9024
    v_mfma_f32_16x16x32_bf16 v[160:163], a[88:91], a[16:19], v[160:163]
    ds_read_b64_tr_b16 a[108:109], v9 offset:8776
    v_mfma_f32_16x16x32_bf16 v[164:167], a[72:75], a[4:7], 0
    buffer_load_dwordx4 v14, s[36:39], s60 offen offset:3096 lds
    ds_read_b64_tr_b16 a[110:111], v9 offset:9032
    v_mfma_f32_16x16x32_bf16 v[164:167], a[88:91], a[20:23], v[164:167]
    s_add_u32 m0, s63, 8256
    s_add_u32 s60, s92, 262144
    v_mfma_f32_16x16x32_bf16 v[168:171], a[72:75], a[8:11], 0
    s_waitcnt vmcnt(12)
    ds_read_b64_tr_b16 a[112:113], v9 offset:12384
    v_mfma_f32_16x16x32_bf16 v[168:171], a[88:91], a[24:27], v[168:171]
    s_waitcnt lgkmcnt(1)
    buffer_load_dwordx4 v11, s[36:39], s60 offen offset:0 lds
    v_mfma_f32_16x16x32_bf16 v[172:175], a[72:75], a[12:15], 0
    ds_read_b64_tr_b16 a[114:115], v9 offset:12640
    v_mfma_f32_16x16x32_bf16 v[172:175], a[88:91], a[28:31], v[172:175]
    ds_read_b64_tr_b16 a[116:117], v9 offset:12392
    v_mfma_f32_16x16x32_bf16 v[176:179], a[76:79], a[0:3], 0
    buffer_load_dwordx4 v12, s[36:39], s60 offen offset:1032 lds
    ds_read_b64_tr_b16 a[118:119], v9 offset:12648
    v_mfma_f32_16x16x32_bf16 v[176:179], a[92:95], a[16:19], v[176:179]
    ds_read_b64_tr_b16 a[120:121], v9 offset:12896
    v_mfma_f32_16x16x32_bf16 v[180:183], a[76:79], a[4:7], 0
    buffer_load_dwordx4 v13, s[36:39], s60 offen offset:2064 lds
    ds_read_b64_tr_b16 a[122:123], v9 offset:13152
    v_mfma_f32_16x16x32_bf16 v[180:183], a[92:95], a[20:23], v[180:183]
    ds_read_b64_tr_b16 a[124:125], v9 offset:12904
    v_mfma_f32_16x16x32_bf16 v[184:187], a[76:79], a[8:11], 0
    buffer_load_dwordx4 v14, s[36:39], s60 offen offset:3096 lds
    ds_read_b64_tr_b16 a[126:127], v9 offset:13160
    ds_read_b128 a[40:43], v15 offset:10240
    v_mfma_f32_16x16x32_bf16 v[184:187], a[92:95], a[24:27], v[184:187]
    ds_read_b128 a[44:47], v15 offset:11264
    s_add_u32 s92, s92, 524288
    s_and_b32 s92, s92, 4194303
    v_mfma_f32_16x16x32_bf16 v[188:191], a[76:79], a[12:15], 0
    s_add_u32 m0, s63, 12384
    s_add_u32 s60, s94, 0
    v_mfma_f32_16x16x32_bf16 v[188:191], a[92:95], a[28:31], v[188:191]
    s_waitcnt lgkmcnt(2)
    buffer_load_dwordx4 v11, s[36:39], s60 offen offset:0 lds
    v_mfma_f32_16x16x32_bf16 v[192:195], a[96:99], a[0:3], 0
    s_waitcnt vmcnt(13)
    ds_read_b64_tr_b16 a[64:65], v31 offset:0
    v_mfma_f32_16x16x32_bf16 v[192:195], a[112:115], a[16:19], v[192:195]
    ds_read_b64_tr_b16 a[66:67], v31 offset:256
    v_mfma_f32_16x16x32_bf16 v[196:199], a[96:99], a[4:7], 0
    buffer_load_dwordx4 v12, s[36:39], s60 offen offset:1032 lds
    v_mfma_f32_16x16x32_bf16 v[196:199], a[112:115], a[20:23], v[196:199]
    ds_read_b64_tr_b16 a[68:69], v31 offset:8
    v_mfma_f32_16x16x32_bf16 v[200:203], a[96:99], a[8:11], 0
    ds_read_b64_tr_b16 a[70:71], v31 offset:264
    v_mfma_f32_16x16x32_bf16 v[200:203], a[112:115], a[24:27], v[200:203]
    ds_read_b64_tr_b16 a[72:73], v31 offset:512
    v_mfma_f32_16x16x32_bf16 v[204:207], a[96:99], a[12:15], 0
    buffer_load_dwordx4 v13, s[36:39], s60 offen offset:2064 lds
    ds_read_b64_tr_b16 a[74:75], v31 offset:768
    v_mfma_f32_16x16x32_bf16 v[204:207], a[112:115], a[28:31], v[204:207]
    ds_read_b64_tr_b16 a[76:77], v31 offset:520
    v_mfma_f32_16x16x32_bf16 v[208:211], a[100:103], a[0:3], 0
    ds_read_b64_tr_b16 a[78:79], v31 offset:776
    v_mfma_f32_16x16x32_bf16 v[208:211], a[116:119], a[16:19], v[208:211]
    buffer_load_dwordx4 v14, s[36:39], s60 offen offset:3096 lds
    s_mov_b32 m0, s93
    v_mfma_f32_16x16x32_bf16 v[212:215], a[100:103], a[4:7], 0
    ds_read_b128 a[48:51], v8 offset:12288
    s_add_u32 s60, s94, 262144
    v_mfma_f32_16x16x32_bf16 v[212:215], a[116:119], a[20:23], v[212:215]
    s_waitcnt lgkmcnt(1)
    buffer_load_dwordx4 v11, s[36:39], s60 offen offset:0 lds
    v_mfma_f32_16x16x32_bf16 v[216:219], a[100:103], a[8:11], 0
    ds_read_b128 a[52:55], v8 offset:13312
    v_mfma_f32_16x16x32_bf16 v[216:219], a[116:119], a[24:27], v[216:219]
    v_mfma_f32_16x16x32_bf16 v[220:223], a[100:103], a[12:15], 0
    buffer_load_dwordx4 v12, s[36:39], s60 offen offset:1032 lds
    v_mfma_f32_16x16x32_bf16 v[220:223], a[116:119], a[28:31], v[220:223]
    v_mfma_f32_16x16x32_bf16 v[224:227], a[104:107], a[0:3], 0
    s_waitcnt vmcnt(14)
    ds_read_b64_tr_b16 a[80:81], v9 offset:0
    v_mfma_f32_16x16x32_bf16 v[224:227], a[120:123], a[16:19], v[224:227]
    buffer_load_dwordx4 v13, s[36:39], s60 offen offset:2064 lds
    v_mfma_f32_16x16x32_bf16 v[228:231], a[104:107], a[4:7], 0
    ds_read_b64_tr_b16 a[82:83], v9 offset:256
    v_mfma_f32_16x16x32_bf16 v[228:231], a[120:123], a[20:23], v[228:231]
    ds_read_b64_tr_b16 a[84:85], v9 offset:8
    v_mfma_f32_16x16x32_bf16 v[232:235], a[104:107], a[8:11], 0
    ds_read_b64_tr_b16 a[86:87], v9 offset:264
    v_mfma_f32_16x16x32_bf16 v[232:235], a[120:123], a[24:27], v[232:235]
    buffer_load_dwordx4 v14, s[36:39], s60 offen offset:3096 lds
    ds_read_b64_tr_b16 a[88:89], v9 offset:512
    v_mfma_f32_16x16x32_bf16 v[236:239], a[104:107], a[12:15], 0
    ds_read_b64_tr_b16 a[90:91], v9 offset:768
    s_add_u32 s94, s94, 524288
    s_and_b32 s94, s94, 4194303
    v_mfma_f32_16x16x32_bf16 v[236:239], a[120:123], a[28:31], v[236:239]
    ds_read_b64_tr_b16 a[92:93], v9 offset:520
    v_mfma_f32_16x16x32_bf16 v[240:243], a[108:111], a[0:3], 0
    ds_read_b64_tr_b16 a[94:95], v9 offset:776
    s_add_u32 m0, s63, 0
    v_mfma_f32_16x16x32_bf16 v[240:243], a[124:127], a[16:19], v[240:243]
    ds_read_b128 a[56:59], v8 offset:14336
    s_add_u32 s60, s92, 0
    v_mfma_f32_16x16x32_bf16 v[244:247], a[108:111], a[4:7], 0
    ds_read_b128 a[60:63], v8 offset:15360
    v_mfma_f32_16x16x32_bf16 v[244:247], a[124:127], a[20:23], v[244:247]
    s_waitcnt lgkmcnt(2)
    buffer_load_dwordx4 v11, s[36:39], s60 offen offset:0 lds
    v_mfma_f32_16x16x32_bf16 v[248:251], a[108:111], a[8:11], 0
    v_mfma_f32_16x16x32_bf16 v[248:251], a[124:127], a[24:27], v[248:251]
    v_mfma_f32_16x16x32_bf16 v[252:255], a[108:111], a[12:15], 0
    v_mfma_f32_16x16x32_bf16 v[252:255], a[124:127], a[28:31], v[252:255]
    buffer_load_dwordx4 v12, s[36:39], s60 offen offset:1032 lds
    v_mfma_f32_16x16x32_bf16 v[128:131], a[64:67], a[32:35], v[128:131]
    s_waitcnt vmcnt(14)
    ds_read_b64_tr_b16 a[96:97], v9 offset:4128
    v_mfma_f32_16x16x32_bf16 v[128:131], a[80:83], a[48:51], v[128:131]
    ds_read_b64_tr_b16 a[98:99], v9 offset:4384
    v_mfma_f32_16x16x32_bf16 v[132:135], a[64:67], a[36:39], v[132:135]
    ds_read_b64_tr_b16 a[100:101], v9 offset:4136
    v_mfma_f32_16x16x32_bf16 v[132:135], a[80:83], a[52:55], v[132:135]
    buffer_load_dwordx4 v13, s[36:39], s60 offen offset:2064 lds
    v_mfma_f32_16x16x32_bf16 v[136:139], a[64:67], a[40:43], v[136:139]
    ds_read_b64_tr_b16 a[102:103], v9 offset:4392
    s_waitcnt lgkmcnt(4)
    v_mfma_f32_16x16x32_bf16 v[136:139], a[80:83], a[56:59], v[136:139]
    ds_read_b64_tr_b16 a[104:105], v9 offset:4640
    v_mfma_f32_16x16x32_bf16 v[140:143], a[64:67], a[44:47], v[140:143]
    ds_read_b64_tr_b16 a[106:107], v9 offset:4896
    v_mfma_f32_16x16x32_bf16 v[140:143], a[80:83], a[60:63], v[140:143]
    ds_read_b64_tr_b16 a[108:109], v9 offset:4648
    v_mfma_f32_16x16x32_bf16 v[144:147], a[68:71], a[32:35], v[144:147]
    buffer_load_dwordx4 v14, s[36:39], s60 offen offset:3096 lds
    ds_read_b64_tr_b16 a[110:111], v9 offset:4904
    v_mfma_f32_16x16x32_bf16 v[144:147], a[84:87], a[48:51], v[144:147]
    ds_read_b128 a[0:3], v15 offset:16384
    s_add_u32 m0, s63, 4128
    v_mfma_f32_16x16x32_bf16 v[148:151], a[68:71], a[36:39], v[148:151]
    ds_read_b128 a[4:7], v15 offset:17408
    s_add_u32 s60, s92, 262144
    v_mfma_f32_16x16x32_bf16 v[148:151], a[84:87], a[52:55], v[148:151]
    s_waitcnt lgkmcnt(2)
    buffer_load_dwordx4 v11, s[36:39], s60 offen offset:0 lds
    v_mfma_f32_16x16x32_bf16 v[152:155], a[68:71], a[40:43], v[152:155]
    v_mfma_f32_16x16x32_bf16 v[152:155], a[84:87], a[56:59], v[152:155]
    v_mfma_f32_16x16x32_bf16 v[156:159], a[68:71], a[44:47], v[156:159]
    v_mfma_f32_16x16x32_bf16 v[156:159], a[84:87], a[60:63], v[156:159]
    buffer_load_dwordx4 v12, s[36:39], s60 offen offset:1032 lds
    v_mfma_f32_16x16x32_bf16 v[160:163], a[72:75], a[32:35], v[160:163]
    s_waitcnt vmcnt(14)
    ds_read_b64_tr_b16 a[112:113], v9 offset:8256
    v_mfma_f32_16x16x32_bf16 v[160:163], a[88:91], a[48:51], v[160:163]
    ds_read_b64_tr_b16 a[114:115], v9 offset:8512
    v_mfma_f32_16x16x32_bf16 v[164:167], a[72:75], a[36:39], v[164:167]
    ds_read_b64_tr_b16 a[116:117], v9 offset:8264
    v_mfma_f32_16x16x32_bf16 v[164:167], a[88:91], a[52:55], v[164:167]
    buffer_load_dwordx4 v13, s[36:39], s60 offen offset:2064 lds
    v_mfma_f32_16x16x32_bf16 v[168:171], a[72:75], a[40:43], v[168:171]
    ds_read_b64_tr_b16 a[118:119], v9 offset:8520
    v_mfma_f32_16x16x32_bf16 v[168:171], a[88:91], a[56:59], v[168:171]
    ds_read_b64_tr_b16 a[120:121], v9 offset:8768
    v_mfma_f32_16x16x32_bf16 v[172:175], a[72:75], a[44:47], v[172:175]
    ds_read_b64_tr_b16 a[122:123], v9 offset:9024
    v_mfma_f32_16x16x32_bf16 v[172:175], a[88:91], a[60:63], v[172:175]
    ds_read_b64_tr_b16 a[124:125], v9 offset:8776
    v_mfma_f32_16x16x32_bf16 v[176:179], a[76:79], a[32:35], v[176:179]
    buffer_load_dwordx4 v14, s[36:39], s60 offen offset:3096 lds
    ds_read_b64_tr_b16 a[126:127], v9 offset:9032
    v_mfma_f32_16x16x32_bf16 v[176:179], a[92:95], a[48:51], v[176:179]
    s_add_u32 s92, s92, 524288
    s_and_b32 s92, s92, 4194303
    v_mfma_f32_16x16x32_bf16 v[180:183], a[76:79], a[36:39], v[180:183]
    ds_read_b128 a[8:11], v15 offset:18432
    s_add_u32 m0, s63, 8256
    v_mfma_f32_16x16x32_bf16 v[180:183], a[92:95], a[52:55], v[180:183]
    s_add_u32 s60, s94, 0
    v_mfma_f32_16x16x32_bf16 v[184:187], a[76:79], a[40:43], v[184:187]
    s_waitcnt lgkmcnt(1)
    buffer_load_dwordx4 v11, s[36:39], s60 offen offset:0 lds
    v_mfma_f32_16x16x32_bf16 v[184:187], a[92:95], a[56:59], v[184:187]
    ds_read_b128 a[12:15], v15 offset:19456
    v_mfma_f32_16x16x32_bf16 v[188:191], a[76:79], a[44:47], v[188:191]
    v_mfma_f32_16x16x32_bf16 v[188:191], a[92:95], a[60:63], v[188:191]
    buffer_load_dwordx4 v12, s[36:39], s60 offen offset:1032 lds
    v_mfma_f32_16x16x32_bf16 v[192:195], a[96:99], a[32:35], v[192:195]
    s_waitcnt vmcnt(14)
    ds_read_b64_tr_b16 a[64:65], v9 offset:12384
    v_mfma_f32_16x16x32_bf16 v[192:195], a[112:115], a[48:51], v[192:195]
    ds_read_b64_tr_b16 a[66:67], v9 offset:12640
    v_mfma_f32_16x16x32_bf16 v[196:199], a[96:99], a[36:39], v[196:199]
    ds_read_b64_tr_b16 a[68:69], v9 offset:12392
    v_mfma_f32_16x16x32_bf16 v[196:199], a[112:115], a[52:55], v[196:199]
    buffer_load_dwordx4 v13, s[36:39], s60 offen offset:2064 lds
    v_mfma_f32_16x16x32_bf16 v[200:203], a[96:99], a[40:43], v[200:203]
    ds_read_b64_tr_b16 a[70:71], v9 offset:12648
    v_mfma_f32_16x16x32_bf16 v[200:203], a[112:115], a[56:59], v[200:203]
    ds_read_b64_tr_b16 a[72:73], v9 offset:12896
    v_mfma_f32_16x16x32_bf16 v[204:207], a[96:99], a[44:47], v[204:207]
    ds_read_b64_tr_b16 a[74:75], v9 offset:13152
    v_mfma_f32_16x16x32_bf16 v[204:207], a[112:115], a[60:63], v[204:207]
    ds_read_b64_tr_b16 a[76:77], v9 offset:12904
    v_mfma_f32_16x16x32_bf16 v[208:211], a[100:103], a[32:35], v[208:211]
    buffer_load_dwordx4 v14, s[36:39], s60 offen offset:3096 lds
    ds_read_b64_tr_b16 a[78:79], v9 offset:13160
    v_mfma_f32_16x16x32_bf16 v[208:211], a[116:119], a[48:51], v[208:211]
    ds_read_b128 a[16:19], v8 offset:20480
    s_add_u32 m0, s63, 12384
    v_mfma_f32_16x16x32_bf16 v[212:215], a[100:103], a[36:39], v[212:215]
    ds_read_b128 a[20:23], v8 offset:21504
    s_add_u32 s60, s94, 262144
    v_mfma_f32_16x16x32_bf16 v[212:215], a[116:119], a[52:55], v[212:215]
    s_waitcnt lgkmcnt(2)
    buffer_load_dwordx4 v11, s[36:39], s60 offen offset:0 lds
    v_mfma_f32_16x16x32_bf16 v[216:219], a[100:103], a[40:43], v[216:219]
    v_mfma_f32_16x16x32_bf16 v[216:219], a[116:119], a[56:59], v[216:219]
    v_mfma_f32_16x16x32_bf16 v[220:223], a[100:103], a[44:47], v[220:223]
    v_mfma_f32_16x16x32_bf16 v[220:223], a[116:119], a[60:63], v[220:223]
    buffer_load_dwordx4 v12, s[36:39], s60 offen offset:1032 lds
    v_mfma_f32_16x16x32_bf16 v[224:227], a[104:107], a[32:35], v[224:227]
    s_waitcnt vmcnt(14)
    ds_read_b64_tr_b16 a[80:81], v31 offset:0
    v_mfma_f32_16x16x32_bf16 v[224:227], a[120:123], a[48:51], v[224:227]
    ds_read_b64_tr_b16 a[82:83], v31 offset:256
    v_mfma_f32_16x16x32_bf16 v[228:231], a[104:107], a[36:39], v[228:231]
    ds_read_b64_tr_b16 a[84:85], v31 offset:8
    v_mfma_f32_16x16x32_bf16 v[228:231], a[120:123], a[52:55], v[228:231]
    buffer_load_dwordx4 v13, s[36:39], s60 offen offset:2064 lds
    v_mfma_f32_16x16x32_bf16 v[232:235], a[104:107], a[40:43], v[232:235]
    ds_read_b64_tr_b16 a[86:87], v31 offset:264
    v_mfma_f32_16x16x32_bf16 v[232:235], a[120:123], a[56:59], v[232:235]
    ds_read_b64_tr_b16 a[88:89], v31 offset:512
    v_mfma_f32_16x16x32_bf16 v[236:239], a[104:107], a[44:47], v[236:239]
    ds_read_b64_tr_b16 a[90:91], v31 offset:768
    v_mfma_f32_16x16x32_bf16 v[236:239], a[120:123], a[60:63], v[236:239]
    ds_read_b64_tr_b16 a[92:93], v31 offset:520
    v_mfma_f32_16x16x32_bf16 v[240:243], a[108:111], a[32:35], v[240:243]
    buffer_load_dwordx4 v14, s[36:39], s60 offen offset:3096 lds
    ds_read_b64_tr_b16 a[94:95], v31 offset:776
    v_mfma_f32_16x16x32_bf16 v[240:243], a[124:127], a[48:51], v[240:243]
    s_add_u32 s94, s94, 524288
    s_and_b32 s94, s94, 4194303
    v_mfma_f32_16x16x32_bf16 v[244:247], a[108:111], a[36:39], v[244:247]
    ds_read_b128 a[24:27], v8 offset:22528
    s_mov_b32 m0, s93
    v_mfma_f32_16x16x32_bf16 v[244:247], a[124:127], a[52:55], v[244:247]
    s_add_u32 s60, s92, 0
    v_mfma_f32_16x16x32_bf16 v[248:251], a[108:111], a[40:43], v[248:251]
    s_waitcnt lgkmcnt(1)
    buffer_load_dwordx4 v11, s[36:39], s60 offen offset:0 lds
    v_mfma_f32_16x16x32_bf16 v[248:251], a[124:127], a[56:59], v[248:251]
    ds_read_b128 a[28:31], v8 offset:23552
    v_mfma_f32_16x16x32_bf16 v[252:255], a[108:111], a[44:47], v[252:255]
    v_mfma_f32_16x16x32_bf16 v[252:255], a[124:127], a[60:63], v[252:255]
    buffer_load_dwordx4 v12, s[36:39], s60 offen offset:1032 lds
    v_mfma_f32_16x16x32_bf16 v[128:131], a[64:67], a[0:3], v[128:131]
    s_waitcnt vmcnt(14)
    ds_read_b64_tr_b16 a[96:97], v9 offset:0
    v_mfma_f32_16x16x32_bf16 v[128:131], a[80:83], a[16:19], v[128:131]
    ds_read_b64_tr_b16 a[98:99], v9 offset:256
    v_mfma_f32_16x16x32_bf16 v[132:135], a[64:67], a[4:7], v[132:135]
    ds_read_b64_tr_b16 a[100:101], v9 offset:8
    v_mfma_f32_16x16x32_bf16 v[132:135], a[80:83], a[20:23], v[132:135]
    buffer_load_dwordx4 v13, s[36:39], s60 offen offset:2064 lds
    v_mfma_f32_16x16x32_bf16 v[136:139], a[64:67], a[8:11], v[136:139]
    ds_read_b64_tr_b16 a[102:103], v9 offset:264
    s_waitcnt lgkmcnt(4)
    v_mfma_f32_16x16x32_bf16 v[136:139], a[80:83], a[24:27], v[136:139]
    ds_read_b64_tr_b16 a[104:105], v9 offset:512
    v_mfma_f32_16x16x32_bf16 v[140:143], a[64:67], a[12:15], v[140:143]
    ds_read_b64_tr_b16 a[106:107], v9 offset:768
    v_mfma_f32_16x16x32_bf16 v[140:143], a[80:83], a[28:31], v[140:143]
    ds_read_b64_tr_b16 a[108:109], v9 offset:520
    v_mfma_f32_16x16x32_bf16 v[144:147], a[68:71], a[0:3], v[144:147]
L_stub2:
    s_cbranch_execz L_stub6
    buffer_load_dwordx4 v14, s[36:39], s60 offen offset:3096 lds
    ds_read_b64_tr_b16 a[110:111], v9 offset:776
    v_mfma_f32_16x16x32_bf16 v[144:147], a[84:87], a[16:19], v[144:147]
    ds_read_b128 a[32:35], v15 offset:24576
    s_add_u32 m0, s63, 0
    v_mfma_f32_16x16x32_bf16 v[148:151], a[68:71], a[4:7], v[148:151]
    ds_read_b128 a[36:39], v15 offset:25600
    s_add_u32 s60, s92, 262144
    v_mfma_f32_16x16x32_bf16 v[148:151], a[84:87], a[20:23], v[148:151]
    s_waitcnt lgkmcnt(2)
    buffer_load_dwordx4 v11, s[36:39], s60 offen offset:0 lds
    v_mfma_f32_16x16x32_bf16 v[152:155], a[68:71], a[8:11], v[152:155]
    v_mfma_f32_16x16x32_bf16 v[152:155], a[84:87], a[24:27], v[152:155]
    v_mfma_f32_16x16x32_bf16 v[156:159], a[68:71], a[12:15], v[156:159]
    v_mfma_f32_16x16x32_bf16 v[156:159], a[84:87], a[28:31], v[156:159]
    buffer_load_dwordx4 v12, s[36:39], s60 offen offset:1032 lds
    v_mfma_f32_16x16x32_bf16 v[160:163], a[72:75], a[0:3], v[160:163]
    s_waitcnt vmcnt(14)
    ds_read_b64_tr_b16 a[112:113], v9 offset:4128
    v_mfma_f32_16x16x32_bf16 v[160:163], a[88:91], a[16:19], v[160:163]
    ds_read_b64_tr_b16 a[114:115], v9 offset:4384
    v_mfma_f32_16x16x32_bf16 v[164:167], a[72:75], a[4:7], v[164:167]
    ds_read_b64_tr_b16 a[116:117], v9 offset:4136
    v_mfma_f32_16x16x32_bf16 v[164:167], a[88:91], a[20:23], v[164:167]
    buffer_load_dwordx4 v13, s[36:39], s60 offen offset:2064 lds
    v_mfma_f32_16x16x32_bf16 v[168:171], a[72:75], a[8:11], v[168:171]
    ds_read_b64_tr_b16 a[118:119], v9 offset:4392
    v_mfma_f32_16x16x32_bf16 v[168:171], a[88:91], a[24:27], v[168:171]
    ds_read_b64_tr_b16 a[120:121], v9 offset:4640
    v_mfma_f32_16x16x32_bf16 v[172:175], a[72:75], a[12:15], v[172:175]
    ds_read_b64_tr_b16 a[122:123], v9 offset:4896
    v_mfma_f32_16x16x32_bf16 v[172:175], a[88:91], a[28:31], v[172:175]
    ds_read_b64_tr_b16 a[124:125], v9 offset:4648
    v_mfma_f32_16x16x32_bf16 v[176:179], a[76:79], a[0:3], v[176:179]
    buffer_load_dwordx4 v14, s[36:39], s60 offen offset:3096 lds
    ds_read_b64_tr_b16 a[126:127], v9 offset:4904
    v_mfma_f32_16x16x32_bf16 v[176:179], a[92:95], a[16:19], v[176:179]
    s_add_u32 s92, s92, 524288
    s_and_b32 s92, s92, 4194303
    v_mfma_f32_16x16x32_bf16 v[180:183], a[76:79], a[4:7], v[180:183]
    ds_read_b128 a[40:43], v15 offset:26624
    s_add_u32 m0, s63, 4128
    v_mfma_f32_16x16x32_bf16 v[180:183], a[92:95], a[20:23], v[180:183]
    s_add_u32 s60, s94, 0
    v_mfma_f32_16x16x32_bf16 v[184:187], a[76:79], a[8:11], v[184:187]
    s_waitcnt lgkmcnt(1)
    buffer_load_dwordx4 v11, s[36:39], s60 offen offset:0 lds
    v_mfma_f32_16x16x32_bf16 v[184:187], a[92:95], a[24:27], v[184:187]
    ds_read_b128 a[44:47], v15 offset:27648
    v_mfma_f32_16x16x32_bf16 v[188:191], a[76:79], a[12:15], v[188:191]
    v_mfma_f32_16x16x32_bf16 v[188:191], a[92:95], a[28:31], v[188:191]
    buffer_load_dwordx4 v12, s[36:39], s60 offen offset:1032 lds
    v_mfma_f32_16x16x32_bf16 v[192:195], a[96:99], a[0:3], v[192:195]
    s_waitcnt vmcnt(14)
    ds_read_b64_tr_b16 a[64:65], v9 offset:8256
    v_mfma_f32_16x16x32_bf16 v[192:195], a[112:115], a[16:19], v[192:195]
    ds_read_b64_tr_b16 a[66:67], v9 offset:8512
    v_mfma_f32_16x16x32_bf16 v[196:199], a[96:99], a[4:7], v[196:199]
    ds_read_b64_tr_b16 a[68:69], v9 offset:8264
    v_mfma_f32_16x16x32_bf16 v[196:199], a[112:115], a[20:23], v[196:199]
    buffer_load_dwordx4 v13, s[36:39], s60 offen offset:2064 lds
    v_mfma_f32_16x16x32_bf16 v[200:203], a[96:99], a[8:11], v[200:203]
    ds_read_b64_tr_b16 a[70:71], v9 offset:8520
    v_mfma_f32_16x16x32_bf16 v[200:203], a[112:115], a[24:27], v[200:203]
    ds_read_b64_tr_b16 a[72:73], v9 offset:8768
    v_mfma_f32_16x16x32_bf16 v[204:207], a[96:99], a[12:15], v[204:207]
    ds_read_b64_tr_b16 a[74:75], v9 offset:9024
    v_mfma_f32_16x16x32_bf16 v[204:207], a[112:115], a[28:31], v[204:207]
    ds_read_b64_tr_b16 a[76:77], v9 offset:8776
    v_mfma_f32_16x16x32_bf16 v[208:211], a[100:103], a[0:3], v[208:211]
    buffer_load_dwordx4 v14, s[36:39], s60 offen offset:3096 lds
    ds_read_b64_tr_b16 a[78:79], v9 offset:9032
    v_mfma_f32_16x16x32_bf16 v[208:211], a[116:119], a[16:19], v[208:211]
    ds_read_b128 a[48:51], v8 offset:28672
    s_add_u32 m0, s63, 8256
    v_mfma_f32_16x16x32_bf16 v[212:215], a[100:103], a[4:7], v[212:215]
    ds_read_b128 a[52:55], v8 offset:29696
    s_add_u32 s60, s94, 262144
    v_mfma_f32_16x16x32_bf16 v[212:215], a[116:119], a[20:23], v[212:215]
    s_waitcnt lgkmcnt(2)
    buffer_load_dwordx4 v11, s[36:39], s60 offen offset:0 lds
    v_mfma_f32_16x16x32_bf16 v[216:219], a[100:103], a[8:11], v[216:219]
    v_mfma_f32_16x16x32_bf16 v[216:219], a[116:119], a[24:27], v[216:219]
    v_mfma_f32_16x16x32_bf16 v[220:223], a[100:103], a[12:15], v[220:223]
    v_mfma_f32_16x16x32_bf16 v[220:223], a[116:119], a[28:31], v[220:223]
    buffer_load_dwordx4 v12, s[36:39], s60 offen offset:1032 lds
    v_mfma_f32_16x16x32_bf16 v[224:227], a[104:107], a[0:3], v[224:227]
    s_waitcnt vmcnt(14)
    ds_read_b64_tr_b16 a[80:81], v9 offset:12384
    v_mfma_f32_16x16x32_bf16 v[224:227], a[120:123], a[16:19], v[224:227]
    ds_read_b64_tr_b16 a[82:83], v9 offset:12640
    v_mfma_f32_16x16x32_bf16 v[228:231], a[104:107], a[4:7], v[228:231]
    ds_read_b64_tr_b16 a[84:85], v9 offset:12392
    v_mfma_f32_16x16x32_bf16 v[228:231], a[120:123], a[20:23], v[228:231]
    buffer_load_dwordx4 v13, s[36:39], s60 offen offset:2064 lds
    v_mfma_f32_16x16x32_bf16 v[232:235], a[104:107], a[8:11], v[232:235]
    ds_read_b64_tr_b16 a[86:87], v9 offset:12648
    v_mfma_f32_16x16x32_bf16 v[232:235], a[120:123], a[24:27], v[232:235]
    ds_read_b64_tr_b16 a[88:89], v9 offset:12896
    v_mfma_f32_16x16x32_bf16 v[236:239], a[104:107], a[12:15], v[236:239]
    ds_read_b64_tr_b16 a[90:91], v9 offset:13152
    v_mfma_f32_16x16x32_bf16 v[236:239], a[120:123], a[28:31], v[236:239]
    ds_read_b64_tr_b16 a[92:93], v9 offset:12904
    v_mfma_f32_16x16x32_bf16 v[240:243], a[108:111], a[0:3], v[240:243]
    buffer_load_dwordx4 v14, s[36:39], s60 offen offset:3096 lds
    ds_read_b64_tr_b16 a[94:95], v9 offset:13160
    v_mfma_f32_16x16x32_bf16 v[240:243], a[124:127], a[16:19], v[240:243]
    s_add_u32 s94, s94, 524288
    s_and_b32 s94, s94, 4194303
    v_mfma_f32_16x16x32_bf16 v[244:247], a[108:111], a[4:7], v[244:247]
    ds_read_b128 a[56:59], v8 offset:30720
    s_add_u32 m0, s63, 12384
    v_mfma_f32_16x16x32_bf16 v[244:247], a[124:127], a[20:23], v[244:247]
    s_add_u32 s60, s92, 0
    v_mfma_f32_16x16x32_bf16 v[248:251], a[108:111], a[8:11], v[248:251]
    s_waitcnt lgkmcnt(1)
    buffer_load_dwordx4 v11, s[36:39], s60 offen offset:0 lds
    v_mfma_f32_16x16x32_bf16 v[248:251], a[124:127], a[24:27], v[248:251]
    ds_read_b128 a[60:63], v8 offset:31744
    v_mfma_f32_16x16x32_bf16 v[252:255], a[108:111], a[12:15], v[252:255]
    v_mfma_f32_16x16x32_bf16 v[252:255], a[124:127], a[28:31], v[252:255]
    buffer_load_dwordx4 v12, s[36:39], s60 offen offset:1032 lds
    v_mfma_f32_16x16x32_bf16 v[128:131], a[64:67], a[32:35], v[128:131]
    s_waitcnt vmcnt(14)
    ds_read_b64_tr_b16 a[96:97], v31 offset:0
    v_mfma_f32_16x16x32_bf16 v[128:131], a[80:83], a[48:51], v[128:131]
    ds_read_b64_tr_b16 a[98:99], v31 offset:256
    v_mfma_f32_16x16x32_bf16 v[132:135], a[64:67], a[36:39], v[132:135]
    ds_read_b64_tr_b16 a[100:101], v31 offset:8
    v_mfma_f32_16x16x32_bf16 v[132:135], a[80:83], a[52:55], v[132:135]
    buffer_load_dwordx4 v13, s[36:39], s60 offen offset:2064 lds
    v_mfma_f32_16x16x32_bf16 v[136:139], a[64:67], a[40:43], v[136:139]
    ds_read_b64_tr_b16 a[102:103], v31 offset:264
    s_waitcnt lgkmcnt(4)
    v_mfma_f32_16x16x32_bf16 v[136:139], a[80:83], a[56:59], v[136:139]
    ds_read_b64_tr_b16 a[104:105], v31 offset:512
    v_mfma_f32_16x16x32_bf16 v[140:143], a[64:67], a[44:47], v[140:143]
    ds_read_b64_tr_b16 a[106:107], v31 offset:768
    v_mfma_f32_16x16x32_bf16 v[140:143], a[80:83], a[60:63], v[140:143]
    ds_read_b64_tr_b16 a[108:109], v31 offset:520
    v_mfma_f32_16x16x32_bf16 v[144:147], a[68:71], a[32:35], v[144:147]
    buffer_load_dwordx4 v14, s[36:39], s60 offen offset:3096 lds
    ds_read_b64_tr_b16 a[110:111], v31 offset:776
    v_mfma_f32_16x16x32_bf16 v[144:147], a[84:87], a[48:51], v[144:147]
    ds_read_b128 a[0:3], v15 offset:32768
    s_mov_b32 m0, s93
    v_mfma_f32_16x16x32_bf16 v[148:151], a[68:71], a[36:39], v[148:151]
    ds_read_b128 a[4:7], v15 offset:33792
    s_add_u32 s60, s92, 262144
    v_mfma_f32_16x16x32_bf16 v[148:151], a[84:87], a[52:55], v[148:151]
    s_waitcnt lgkmcnt(2)
    buffer_load_dwordx4 v11, s[36:39], s60 offen offset:0 lds
    v_mfma_f32_16x16x32_bf16 v[152:155], a[68:71], a[40:43], v[152:155]
    v_mfma_f32_16x16x32_bf16 v[152:155], a[84:87], a[56:59], v[152:155]
    v_mfma_f32_16x16x32_bf16 v[156:159], a[68:71], a[44:47], v[156:159]
    v_mfma_f32_16x16x32_bf16 v[156:159], a[84:87], a[60:63], v[156:159]
    buffer_load_dwordx4 v12, s[36:39], s60 offen offset:1032 lds
    v_mfma_f32_16x16x32_bf16 v[160:163], a[72:75], a[32:35], v[160:163]
    s_waitcnt vmcnt(14)
    ds_read_b64_tr_b16 a[112:113], v9 offset:0
    v_mfma_f32_16x16x32_bf16 v[160:163], a[88:91], a[48:51], v[160:163]
    ds_read_b64_tr_b16 a[114:115], v9 offset:256
    v_mfma_f32_16x16x32_bf16 v[164:167], a[72:75], a[36:39], v[164:167]
    ds_read_b64_tr_b16 a[116:117], v9 offset:8
    v_mfma_f32_16x16x32_bf16 v[164:167], a[88:91], a[52:55], v[164:167]
    buffer_load_dwordx4 v13, s[36:39], s60 offen offset:2064 lds
    v_mfma_f32_16x16x32_bf16 v[168:171], a[72:75], a[40:43], v[168:171]
    ds_read_b64_tr_b16 a[118:119], v9 offset:264
    v_mfma_f32_16x16x32_bf16 v[168:171], a[88:91], a[56:59], v[168:171]
    ds_read_b64_tr_b16 a[120:121], v9 offset:512
    v_mfma_f32_16x16x32_bf16 v[172:175], a[72:75], a[44:47], v[172:175]
    ds_read_b64_tr_b16 a[122:123], v9 offset:768
    v_mfma_f32_16x16x32_bf16 v[172:175], a[88:91], a[60:63], v[172:175]
    ds_read_b64_tr_b16 a[124:125], v9 offset:520
    v_mfma_f32_16x16x32_bf16 v[176:179], a[76:79], a[32:35], v[176:179]
    buffer_load_dwordx4 v14, s[36:39], s60 offen offset:3096 lds
    ds_read_b64_tr_b16 a[126:127], v9 offset:776
    v_mfma_f32_16x16x32_bf16 v[176:179], a[92:95], a[48:51], v[176:179]
    s_add_u32 s92, s92, 524288
    s_and_b32 s92, s92, 4194303
    v_mfma_f32_16x16x32_bf16 v[180:183], a[76:79], a[36:39], v[180:183]
    ds_read_b128 a[8:11], v15 offset:34816
    s_add_u32 m0, s63, 0
    v_mfma_f32_16x16x32_bf16 v[180:183], a[92:95], a[52:55], v[180:183]
    s_add_u32 s60, s94, 0
    v_mfma_f32_16x16x32_bf16 v[184:187], a[76:79], a[40:43], v[184:187]
    s_waitcnt lgkmcnt(1)
    buffer_load_dwordx4 v11, s[36:39], s60 offen offset:0 lds
    v_mfma_f32_16x16x32_bf16 v[184:187], a[92:95], a[56:59], v[184:187]
    ds_read_b128 a[12:15], v15 offset:35840
    v_mfma_f32_16x16x32_bf16 v[188:191], a[76:79], a[44:47], v[188:191]
    v_mfma_f32_16x16x32_bf16 v[188:191], a[92:95], a[60:63], v[188:191]
    buffer_load_dwordx4 v12, s[36:39], s60 offen offset:1032 lds
    v_mfma_f32_16x16x32_bf16 v[192:195], a[96:99], a[32:35], v[192:195]
    s_waitcnt vmcnt(14)
    ds_read_b64_tr_b16 a[64:65], v9 offset:4128
    v_mfma_f32_16x16x32_bf16 v[192:195], a[112:115], a[48:51], v[192:195]
    ds_read_b64_tr_b16 a[66:67], v9 offset:4384
    v_mfma_f32_16x16x32_bf16 v[196:199], a[96:99], a[36:39], v[196:199]
    ds_read_b64_tr_b16 a[68:69], v9 offset:4136
    v_mfma_f32_16x16x32_bf16 v[196:199], a[112:115], a[52:55], v[196:199]
    buffer_load_dwordx4 v13, s[36:39], s60 offen offset:2064 lds
    v_mfma_f32_16x16x32_bf16 v[200:203], a[96:99], a[40:43], v[200:203]
    ds_read_b64_tr_b16 a[70:71], v9 offset:4392
    v_mfma_f32_16x16x32_bf16 v[200:203], a[112:115], a[56:59], v[200:203]
    ds_read_b64_tr_b16 a[72:73], v9 offset:4640
    v_mfma_f32_16x16x32_bf16 v[204:207], a[96:99], a[44:47], v[204:207]
    ds_read_b64_tr_b16 a[74:75], v9 offset:4896
    v_mfma_f32_16x16x32_bf16 v[204:207], a[112:115], a[60:63], v[204:207]
    ds_read_b64_tr_b16 a[76:77], v9 offset:4648
    v_mfma_f32_16x16x32_bf16 v[208:211], a[100:103], a[32:35], v[208:211]
    buffer_load_dwordx4 v14, s[36:39], s60 offen offset:3096 lds
    ds_read_b64_tr_b16 a[78:79], v9 offset:4904
    v_mfma_f32_16x16x32_bf16 v[208:211], a[116:119], a[48:51], v[208:211]
    ds_read_b128 a[16:19], v8 offset:36864
    s_add_u32 m0, s63, 4128
    v_mfma_f32_16x16x32_bf16 v[212:215], a[100:103], a[36:39], v[212:215]
    ds_read_b128 a[20:23], v8 offset:37888
    s_add_u32 s60, s94, 262144
    v_mfma_f32_16x16x32_bf16 v[212:215], a[116:119], a[52:55], v[212:215]
    s_waitcnt lgkmcnt(2)
    buffer_load_dwordx4 v11, s[36:39], s60 offen offset:0 lds
    v_mfma_f32_16x16x32_bf16 v[216:219], a[100:103], a[40:43], v[216:219]
    v_mfma_f32_16x16x32_bf16 v[216:219], a[116:119], a[56:59], v[216:219]
    v_mfma_f32_16x16x32_bf16 v[220:223], a[100:103], a[44:47], v[220:223]
    v_mfma_f32_16x16x32_bf16 v[220:223], a[116:119], a[60:63], v[220:223]
    buffer_load_dwordx4 v12, s[36:39], s60 offen offset:1032 lds
    v_mfma_f32_16x16x32_bf16 v[224:227], a[104:107], a[32:35], v[224:227]
    s_waitcnt vmcnt(14)
    ds_read_b64_tr_b16 a[80:81], v9 offset:8256
    v_mfma_f32_16x16x32_bf16 v[224:227], a[120:123], a[48:51], v[224:227]
    ds_read_b64_tr_b16 a[82:83], v9 offset:8512
    v_mfma_f32_16x16x32_bf16 v[228:231], a[104:107], a[36:39], v[228:231]
    ds_read_b64_tr_b16 a[84:85], v9 offset:8264
    v_mfma_f32_16x16x32_bf16 v[228:231], a[120:123], a[52:55], v[228:231]
    buffer_load_dwordx4 v13, s[36:39], s60 offen offset:2064 lds
    v_mfma_f32_16x16x32_bf16 v[232:235], a[104:107], a[40:43], v[232:235]
    ds_read_b64_tr_b16 a[86:87], v9 offset:8520
    v_mfma_f32_16x16x32_bf16 v[232:235], a[120:123], a[56:59], v[232:235]
    ds_read_b64_tr_b16 a[88:89], v9 offset:8768
    v_mfma_f32_16x16x32_bf16 v[236:239], a[104:107], a[44:47], v[236:239]
    ds_read_b64_tr_b16 a[90:91], v9 offset:9024
    v_mfma_f32_16x16x32_bf16 v[236:239], a[120:123], a[60:63], v[236:239]
    ds_read_b64_tr_b16 a[92:93], v9 offset:8776
    v_mfma_f32_16x16x32_bf16 v[240:243], a[108:111], a[32:35], v[240:243]
    buffer_load_dwordx4 v14, s[36:39], s60 offen offset:3096 lds
    ds_read_b64_tr_b16 a[94:95], v9 offset:9032
    v_mfma_f32_16x16x32_bf16 v[240:243], a[124:127], a[48:51], v[240:243]
    s_add_u32 s94, s94, 524288
    s_and_b32 s94, s94, 4194303
    v_mfma_f32_16x16x32_bf16 v[244:247], a[108:111], a[36:39], v[244:247]
    ds_read_b128 a[24:27], v8 offset:38912
    s_add_u32 m0, s63, 8256
    v_mfma_f32_16x16x32_bf16 v[244:247], a[124:127], a[52:55], v[244:247]
    s_add_u32 s60, s92, 0
    v_mfma_f32_16x16x32_bf16 v[248:251], a[108:111], a[40:43], v[248:251]
    s_waitcnt lgkmcnt(1)
    buffer_load_dwordx4 v11, s[36:39], s60 offen offset:0 lds
    v_mfma_f32_16x16x32_bf16 v[248:251], a[124:127], a[56:59], v[248:251]
    ds_read_b128 a[28:31], v8 offset:39936
    v_mfma_f32_16x16x32_bf16 v[252:255], a[108:111], a[44:47], v[252:255]
    v_mfma_f32_16x16x32_bf16 v[252:255], a[124:127], a[60:63], v[252:255]
    buffer_load_dwordx4 v12, s[36:39], s60 offen offset:1032 lds
    v_mfma_f32_16x16x32_bf16 v[128:131], a[64:67], a[0:3], v[128:131]
    s_waitcnt vmcnt(14)
    ds_read_b64_tr_b16 a[96:97], v9 offset:12384
    v_mfma_f32_16x16x32_bf16 v[128:131], a[80:83], a[16:19], v[128:131]
    ds_read_b64_tr_b16 a[98:99], v9 offset:12640
    v_mfma_f32_16x16x32_bf16 v[132:135], a[64:67], a[4:7], v[132:135]
    ds_read_b64_tr_b16 a[100:101], v9 offset:12392
    v_mfma_f32_16x16x32_bf16 v[132:135], a[80:83], a[20:23], v[132:135]
    buffer_load_dwordx4 v13, s[36:39], s60 offen offset:2064 lds
    v_mfma_f32_16x16x32_bf16 v[136:139], a[64:67], a[8:11], v[136:139]
    ds_read_b64_tr_b16 a[102:103], v9 offset:12648
    s_waitcnt lgkmcnt(4)
    v_mfma_f32_16x16x32_bf16 v[136:139], a[80:83], a[24:27], v[136:139]
    ds_read_b64_tr_b16 a[104:105], v9 offset:12896
    v_mfma_f32_16x16x32_bf16 v[140:143], a[64:67], a[12:15], v[140:143]
    ds_read_b64_tr_b16 a[106:107], v9 offset:13152
    v_mfma_f32_16x16x32_bf16 v[140:143], a[80:83], a[28:31], v[140:143]
    ds_read_b64_tr_b16 a[108:109], v9 offset:12904
    v_mfma_f32_16x16x32_bf16 v[144:147], a[68:71], a[0:3], v[144:147]
    buffer_load_dwordx4 v14, s[36:39], s60 offen offset:3096 lds
    ds_read_b64_tr_b16 a[110:111], v9 offset:13160
    v_mfma_f32_16x16x32_bf16 v[144:147], a[84:87], a[16:19], v[144:147]
    ds_read_b128 a[32:35], v15 offset:40960
    s_add_u32 m0, s63, 12384
    v_mfma_f32_16x16x32_bf16 v[148:151], a[68:71], a[4:7], v[148:151]
    ds_read_b128 a[36:39], v15 offset:41984
    s_add_u32 s60, s92, 262144
    v_mfma_f32_16x16x32_bf16 v[148:151], a[84:87], a[20:23], v[148:151]
    s_waitcnt lgkmcnt(2)
    buffer_load_dwordx4 v11, s[36:39], s60 offen offset:0 lds
    v_mfma_f32_16x16x32_bf16 v[152:155], a[68:71], a[8:11], v[152:155]
    v_mfma_f32_16x16x32_bf16 v[152:155], a[84:87], a[24:27], v[152:155]
    v_mfma_f32_16x16x32_bf16 v[156:159], a[68:71], a[12:15], v[156:159]
    v_mfma_f32_16x16x32_bf16 v[156:159], a[84:87], a[28:31], v[156:159]
    buffer_load_dwordx4 v12, s[36:39], s60 offen offset:1032 lds
    v_mfma_f32_16x16x32_bf16 v[160:163], a[72:75], a[0:3], v[160:163]
    s_waitcnt vmcnt(14)
    ds_read_b64_tr_b16 a[112:113], v31 offset:0
    v_mfma_f32_16x16x32_bf16 v[160:163], a[88:91], a[16:19], v[160:163]
    ds_read_b64_tr_b16 a[114:115], v31 offset:256
    v_mfma_f32_16x16x32_bf16 v[164:167], a[72:75], a[4:7], v[164:167]
    ds_read_b64_tr_b16 a[116:117], v31 offset:8
    v_mfma_f32_16x16x32_bf16 v[164:167], a[88:91], a[20:23], v[164:167]
    buffer_load_dwordx4 v13, s[36:39], s60 offen offset:2064 lds
    v_mfma_f32_16x16x32_bf16 v[168:171], a[72:75], a[8:11], v[168:171]
    ds_read_b64_tr_b16 a[118:119], v31 offset:264
    v_mfma_f32_16x16x32_bf16 v[168:171], a[88:91], a[24:27], v[168:171]
    ds_read_b64_tr_b16 a[120:121], v31 offset:512
    v_mfma_f32_16x16x32_bf16 v[172:175], a[72:75], a[12:15], v[172:175]
    ds_read_b64_tr_b16 a[122:123], v31 offset:768
    v_mfma_f32_16x16x32_bf16 v[172:175], a[88:91], a[28:31], v[172:175]
    ds_read_b64_tr_b16 a[124:125], v31 offset:520
    v_mfma_f32_16x16x32_bf16 v[176:179], a[76:79], a[0:3], v[176:179]
    buffer_load_dwordx4 v14, s[36:39], s60 offen offset:3096 lds
    ds_read_b64_tr_b16 a[126:127], v31 offset:776
    v_mfma_f32_16x16x32_bf16 v[176:179], a[92:95], a[16:19], v[176:179]
    s_add_u32 s92, s92, 524288
    s_and_b32 s92, s92, 4194303
    v_mfma_f32_16x16x32_bf16 v[180:183], a[76:79], a[4:7], v[180:183]
    ds_read_b128 a[40:43], v15 offset:43008
    s_mov_b32 m0, s93
    v_mfma_f32_16x16x32_bf16 v[180:183], a[92:95], a[20:23], v[180:183]
    s_add_u32 s60, s94, 0
    v_mfma_f32_16x16x32_bf16 v[184:187], a[76:79], a[8:11], v[184:187]
    s_waitcnt lgkmcnt(1)
    buffer_load_dwordx4 v11, s[36:39], s60 offen offset:0 lds
    v_mfma_f32_16x16x32_bf16 v[184:187], a[92:95], a[24:27], v[184:187]
    ds_read_b128 a[44:47], v15 offset:44032
    v_mfma_f32_16x16x32_bf16 v[188:191], a[76:79], a[12:15], v[188:191]
    v_mfma_f32_16x16x32_bf16 v[188:191], a[92:95], a[28:31], v[188:191]
    buffer_load_dwordx4 v12, s[36:39], s60 offen offset:1032 lds
    v_mfma_f32_16x16x32_bf16 v[192:195], a[96:99], a[0:3], v[192:195]
    s_waitcnt vmcnt(14)
    ds_read_b64_tr_b16 a[64:65], v9 offset:0
    v_mfma_f32_16x16x32_bf16 v[192:195], a[112:115], a[16:19], v[192:195]
    ds_read_b64_tr_b16 a[66:67], v9 offset:256
    v_mfma_f32_16x16x32_bf16 v[196:199], a[96:99], a[4:7], v[196:199]
    ds_read_b64_tr_b16 a[68:69], v9 offset:8
    v_mfma_f32_16x16x32_bf16 v[196:199], a[112:115], a[20:23], v[196:199]
    buffer_load_dwordx4 v13, s[36:39], s60 offen offset:2064 lds
    v_mfma_f32_16x16x32_bf16 v[200:203], a[96:99], a[8:11], v[200:203]
    ds_read_b64_tr_b16 a[70:71], v9 offset:264
    v_mfma_f32_16x16x32_bf16 v[200:203], a[112:115], a[24:27], v[200:203]
    ds_read_b64_tr_b16 a[72:73], v9 offset:512
    v_mfma_f32_16x16x32_bf16 v[204:207], a[96:99], a[12:15], v[204:207]
    ds_read_b64_tr_b16 a[74:75], v9 offset:768
    v_mfma_f32_16x16x32_bf16 v[204:207], a[112:115], a[28:31], v[204:207]
    ds_read_b64_tr_b16 a[76:77], v9 offset:520
    v_mfma_f32_16x16x32_bf16 v[208:211], a[100:103], a[0:3], v[208:211]
    buffer_load_dwordx4 v14, s[36:39], s60 offen offset:3096 lds
    ds_read_b64_tr_b16 a[78:79], v9 offset:776
    v_mfma_f32_16x16x32_bf16 v[208:211], a[116:119], a[16:19], v[208:211]
    ds_read_b128 a[48:51], v8 offset:45056
    s_add_u32 m0, s63, 0
    v_mfma_f32_16x16x32_bf16 v[212:215], a[100:103], a[4:7], v[212:215]
    ds_read_b128 a[52:55], v8 offset:46080
    s_add_u32 s60, s94, 262144
    v_mfma_f32_16x16x32_bf16 v[212:215], a[116:119], a[20:23], v[212:215]
    s_waitcnt lgkmcnt(2)
    buffer_load_dwordx4 v11, s[36:39], s60 offen offset:0 lds
    v_mfma_f32_16x16x32_bf16 v[216:219], a[100:103], a[8:11], v[216:219]
    v_mfma_f32_16x16x32_bf16 v[216:219], a[116:119], a[24:27], v[216:219]
    v_mfma_f32_16x16x32_bf16 v[220:223], a[100:103], a[12:15], v[220:223]
    v_mfma_f32_16x16x32_bf16 v[220:223], a[116:119], a[28:31], v[220:223]
    buffer_load_dwordx4 v12, s[36:39], s60 offen offset:1032 lds
    v_mfma_f32_16x16x32_bf16 v[224:227], a[104:107], a[0:3], v[224:227]
    s_waitcnt vmcnt(14)
    ds_read_b64_tr_b16 a[80:81], v9 offset:4128
    v_mfma_f32_16x16x32_bf16 v[224:227], a[120:123], a[16:19], v[224:227]
    ds_read_b64_tr_b16 a[82:83], v9 offset:4384
    v_mfma_f32_16x16x32_bf16 v[228:231], a[104:107], a[4:7], v[228:231]
    ds_read_b64_tr_b16 a[84:85], v9 offset:4136
    v_mfma_f32_16x16x32_bf16 v[228:231], a[120:123], a[20:23], v[228:231]
    buffer_load_dwordx4 v13, s[36:39], s60 offen offset:2064 lds
    v_mfma_f32_16x16x32_bf16 v[232:235], a[104:107], a[8:11], v[232:235]
    ds_read_b64_tr_b16 a[86:87], v9 offset:4392
    v_mfma_f32_16x16x32_bf16 v[232:235], a[120:123], a[24:27], v[232:235]
    ds_read_b64_tr_b16 a[88:89], v9 offset:4640
    v_mfma_f32_16x16x32_bf16 v[236:239], a[104:107], a[12:15], v[236:239]
    ds_read_b64_tr_b16 a[90:91], v9 offset:4896
    v_mfma_f32_16x16x32_bf16 v[236:239], a[120:123], a[28:31], v[236:239]
    ds_read_b64_tr_b16 a[92:93], v9 offset:4648
    v_mfma_f32_16x16x32_bf16 v[240:243], a[108:111], a[0:3], v[240:243]
    buffer_load_dwordx4 v14, s[36:39], s60 offen offset:3096 lds
    ds_read_b64_tr_b16 a[94:95], v9 offset:4904
    v_mfma_f32_16x16x32_bf16 v[240:243], a[124:127], a[16:19], v[240:243]
    s_add_u32 s94, s94, 524288
    s_and_b32 s94, s94, 4194303
    v_mfma_f32_16x16x32_bf16 v[244:247], a[108:111], a[4:7], v[244:247]
    ds_read_b128 a[56:59], v8 offset:47104
    s_add_u32 m0, s63, 4128
    v_mfma_f32_16x16x32_bf16 v[244:247], a[124:127], a[20:23], v[244:247]
    s_add_u32 s60, s92, 0
    v_mfma_f32_16x16x32_bf16 v[248:251], a[108:111], a[8:11], v[248:251]
    s_waitcnt lgkmcnt(1)
    buffer_load_dwordx4 v11, s[36:39], s60 offen offset:0 lds
    v_mfma_f32_16x16x32_bf16 v[248:251], a[124:127], a[24:27], v[248:251]
    ds_read_b128 a[60:63], v8 offset:48128
    v_mfma_f32_16x16x32_bf16 v[252:255], a[108:111], a[12:15], v[252:255]
    v_mfma_f32_16x16x32_bf16 v[252:255], a[124:127], a[28:31], v[252:255]
    buffer_load_dwordx4 v12, s[36:39], s60 offen offset:1032 lds
    v_mfma_f32_16x16x32_bf16 v[128:131], a[64:67], a[32:35], v[128:131]
    s_waitcnt vmcnt(14)
    ds_read_b64_tr_b16 a[96:97], v9 offset:8256
    v_mfma_f32_16x16x32_bf16 v[128:131], a[80:83], a[48:51], v[128:131]
    ds_read_b64_tr_b16 a[98:99], v9 offset:8512
    v_mfma_f32_16x16x32_bf16 v[132:135], a[64:67], a[36:39], v[132:135]
    ds_read_b64_tr_b16 a[100:101], v9 offset:8264
    v_mfma_f32_16x16x32_bf16 v[132:135], a[80:83], a[52:55], v[132:135]
    buffer_load_dwordx4 v13, s[36:39], s60 offen offset:2064 lds
    v_mfma_f32_16x16x32_bf16 v[136:139], a[64:67], a[40:43], v[136:139]
    ds_read_b64_tr_b16 a[102:103], v9 offset:8520
    s_waitcnt lgkmcnt(4)
    v_mfma_f32_16x16x32_bf16 v[136:139], a[80:83], a[56:59], v[136:139]
    ds_read_b64_tr_b16 a[104:105], v9 offset:8768
    v_mfma_f32_16x16x32_bf16 v[140:143], a[64:67], a[44:47], v[140:143]
    ds_read_b64_tr_b16 a[106:107], v9 offset:9024
    v_mfma_f32_16x16x32_bf16 v[140:143], a[80:83], a[60:63], v[140:143]
    ds_read_b64_tr_b16 a[108:109], v9 offset:8776
    v_mfma_f32_16x16x32_bf16 v[144:147], a[68:71], a[32:35], v[144:147]
    buffer_load_dwordx4 v14, s[36:39], s60 offen offset:3096 lds
    ds_read_b64_tr_b16 a[110:111], v9 offset:9032
    v_mfma_f32_16x16x32_bf16 v[144:147], a[84:87], a[48:51], v[144:147]
    ds_read_b128 a[0:3], v15 offset:49152
    s_add_u32 m0, s63, 8256
    v_mfma_f32_16x16x32_bf16 v[148:151], a[68:71], a[36:39], v[148:151]
    ds_read_b128 a[4:7], v15 offset:50176
    s_add_u32 s60, s92, 262144
    v_mfma_f32_16x16x32_bf16 v[148:151], a[84:87], a[52:55], v[148:151]
    s_waitcnt lgkmcnt(2)
    buffer_load_dwordx4 v11, s[36:39], s60 offen offset:0 lds
    v_mfma_f32_16x16x32_bf16 v[152:155], a[68:71], a[40:43], v[152:155]
    v_mfma_f32_16x16x32_bf16 v[152:155], a[84:87], a[56:59], v[152:155]
    v_mfma_f32_16x16x32_bf16 v[156:159], a[68:71], a[44:47], v[156:159]
    v_mfma_f32_16x16x32_bf16 v[156:159], a[84:87], a[60:63], v[156:159]
    buffer_load_dwordx4 v12, s[36:39], s60 offen offset:1032 lds
    v_mfma_f32_16x16x32_bf16 v[160:163], a[72:75], a[32:35], v[160:163]
    s_waitcnt vmcnt(14)
    ds_read_b64_tr_b16 a[112:113], v9 offset:12384
    v_mfma_f32_16x16x32_bf16 v[160:163], a[88:91], a[48:51], v[160:163]
    ds_read_b64_tr_b16 a[114:115], v9 offset:12640
    v_mfma_f32_16x16x32_bf16 v[164:167], a[72:75], a[36:39], v[164:167]
    ds_read_b64_tr_b16 a[116:117], v9 offset:12392
    v_mfma_f32_16x16x32_bf16 v[164:167], a[88:91], a[52:55], v[164:167]
    buffer_load_dwordx4 v13, s[36:39], s60 offen offset:2064 lds
    v_mfma_f32_16x16x32_bf16 v[168:171], a[72:75], a[40:43], v[168:171]
    ds_read_b64_tr_b16 a[118:119], v9 offset:12648
    v_mfma_f32_16x16x32_bf16 v[168:171], a[88:91], a[56:59], v[168:171]
    ds_read_b64_tr_b16 a[120:121], v9 offset:12896
    v_mfma_f32_16x16x32_bf16 v[172:175], a[72:75], a[44:47], v[172:175]
    ds_read_b64_tr_b16 a[122:123], v9 offset:13152
    v_mfma_f32_16x16x32_bf16 v[172:175], a[88:91], a[60:63], v[172:175]
    ds_read_b64_tr_b16 a[124:125], v9 offset:12904
    v_mfma_f32_16x16x32_bf16 v[176:179], a[76:79], a[32:35], v[176:179]
    buffer_load_dwordx4 v14, s[36:39], s60 offen offset:3096 lds
    ds_read_b64_tr_b16 a[126:127], v9 offset:13160
    v_mfma_f32_16x16x32_bf16 v[176:179], a[92:95], a[48:51], v[176:179]
    s_add_u32 s92, s92, 524288
    s_and_b32 s92, s92, 4194303
    v_mfma_f32_16x16x32_bf16 v[180:183], a[76:79], a[36:39], v[180:183]
    ds_read_b128 a[8:11], v15 offset:51200
    s_add_u32 m0, s63, 12384
    v_mfma_f32_16x16x32_bf16 v[180:183], a[92:95], a[52:55], v[180:183]
    s_add_u32 s60, s94, 0
    v_mfma_f32_16x16x32_bf16 v[184:187], a[76:79], a[40:43], v[184:187]
    s_waitcnt lgkmcnt(1)
    buffer_load_dwordx4 v11, s[36:39], s60 offen offset:0 lds
    v_mfma_f32_16x16x32_bf16 v[184:187], a[92:95], a[56:59], v[184:187]
    ds_read_b128 a[12:15], v15 offset:52224
    v_mfma_f32_16x16x32_bf16 v[188:191], a[76:79], a[44:47], v[188:191]
    v_mfma_f32_16x16x32_bf16 v[188:191], a[92:95], a[60:63], v[188:191]
    buffer_load_dwordx4 v12, s[36:39], s60 offen offset:1032 lds
    v_mfma_f32_16x16x32_bf16 v[192:195], a[96:99], a[32:35], v[192:195]
    s_waitcnt vmcnt(14)
    ds_read_b64_tr_b16 a[64:65], v31 offset:0
    v_mfma_f32_16x16x32_bf16 v[192:195], a[112:115], a[48:51], v[192:195]
    ds_read_b64_tr_b16 a[66:67], v31 offset:256
    v_mfma_f32_16x16x32_bf16 v[196:199], a[96:99], a[36:39], v[196:199]
    ds_read_b64_tr_b16 a[68:69], v31 offset:8
    v_mfma_f32_16x16x32_bf16 v[196:199], a[112:115], a[52:55], v[196:199]
    buffer_load_dwordx4 v13, s[36:39], s60 offen offset:2064 lds
    v_mfma_f32_16x16x32_bf16 v[200:203], a[96:99], a[40:43], v[200:203]
    ds_read_b64_tr_b16 a[70:71], v31 offset:264
    v_mfma_f32_16x16x32_bf16 v[200:203], a[112:115], a[56:59], v[200:203]
    ds_read_b64_tr_b16 a[72:73], v31 offset:512
    v_mfma_f32_16x16x32_bf16 v[204:207], a[96:99], a[44:47], v[204:207]
    ds_read_b64_tr_b16 a[74:75], v31 offset:768
    v_mfma_f32_16x16x32_bf16 v[204:207], a[112:115], a[60:63], v[204:207]
    ds_read_b64_tr_b16 a[76:77], v31 offset:520
    v_mfma_f32_16x16x32_bf16 v[208:211], a[100:103], a[32:35], v[208:211]
    buffer_load_dwordx4 v14, s[36:39], s60 offen offset:3096 lds
    ds_read_b64_tr_b16 a[78:79], v31 offset:776
    v_mfma_f32_16x16x32_bf16 v[208:211], a[116:119], a[48:51], v[208:211]
    ds_read_b128 a[16:19], v8 offset:53248
    s_mov_b32 m0, s93
    v_mfma_f32_16x16x32_bf16 v[212:215], a[100:103], a[36:39], v[212:215]
    ds_read_b128 a[20:23], v8 offset:54272
    s_add_u32 s60, s94, 262144
    v_mfma_f32_16x16x32_bf16 v[212:215], a[116:119], a[52:55], v[212:215]
    s_waitcnt lgkmcnt(2)
    buffer_load_dwordx4 v11, s[36:39], s60 offen offset:0 lds
    v_mfma_f32_16x16x32_bf16 v[216:219], a[100:103], a[40:43], v[216:219]
    v_mfma_f32_16x16x32_bf16 v[216:219], a[116:119], a[56:59], v[216:219]
    v_mfma_f32_16x16x32_bf16 v[220:223], a[100:103], a[44:47], v[220:223]
    v_mfma_f32_16x16x32_bf16 v[220:223], a[116:119], a[60:63], v[220:223]
    buffer_load_dwordx4 v12, s[36:39], s60 offen offset:1032 lds
    v_mfma_f32_16x16x32_bf16 v[224:227], a[104:107], a[32:35], v[224:227]
    s_waitcnt vmcnt(14)
    ds_read_b64_tr_b16 a[80:81], v9 offset:0
    v_mfma_f32_16x16x32_bf16 v[224:227], a[120:123], a[48:51], v[224:227]
    ds_read_b64_tr_b16 a[82:83], v9 offset:256
    v_mfma_f32_16x16x32_bf16 v[228:231], a[104:107], a[36:39], v[228:231]
    ds_read_b64_tr_b16 a[84:85], v9 offset:8
    v_mfma_f32_16x16x32_bf16 v[228:231], a[120:123], a[52:55], v[228:231]
    buffer_load_dwordx4 v13, s[36:39], s60 offen offset:2064 lds
    v_mfma_f32_16x16x32_bf16 v[232:235], a[104:107], a[40:43], v[232:235]
    ds_read_b64_tr_b16 a[86:87], v9 offset:264
    v_mfma_f32_16x16x32_bf16 v[232:235], a[120:123], a[56:59], v[232:235]
    ds_read_b64_tr_b16 a[88:89], v9 offset:512
    v_mfma_f32_16x16x32_bf16 v[236:239], a[104:107], a[44:47], v[236:239]
    ds_read_b64_tr_b16 a[90:91], v9 offset:768
    v_mfma_f32_16x16x32_bf16 v[236:239], a[120:123], a[60:63], v[236:239]
    ds_read_b64_tr_b16 a[92:93], v9 offset:520
    v_mfma_f32_16x16x32_bf16 v[240:243], a[108:111], a[32:35], v[240:243]
    buffer_load_dwordx4 v14, s[36:39], s60 offen offset:3096 lds
    ds_read_b64_tr_b16 a[94:95], v9 offset:776
    v_mfma_f32_16x16x32_bf16 v[240:243], a[124:127], a[48:51], v[240:243]
    s_add_u32 s94, s94, 524288
    s_and_b32 s94, s94, 4194303
    v_mfma_f32_16x16x32_bf16 v[244:247], a[108:111], a[36:39], v[244:247]
    ds_read_b128 a[24:27], v8 offset:55296
L_stub3:
    s_cbranch_execz L_stub7
    s_add_u32 m0, s63, 0
    v_mfma_f32_16x16x32_bf16 v[244:247], a[124:127], a[52:55], v[244:247]
    s_add_u32 s60, s92, 0
    v_mfma_f32_16x16x32_bf16 v[248:251], a[108:111], a[40:43], v[248:251]
    s_waitcnt lgkmcnt(1)
    buffer_load_dwordx4 v11, s[36:39], s60 offen offset:0 lds
    v_mfma_f32_16x16x32_bf16 v[248:251], a[124:127], a[56:59], v[248:251]
    ds_read_b128 a[28:31], v8 offset:56320
    v_mfma_f32_16x16x32_bf16 v[252:255], a[108:111], a[44:47], v[252:255]
    v_mfma_f32_16x16x32_bf16 v[252:255], a[124:127], a[60:63], v[252:255]
    buffer_load_dwordx4 v12, s[36:39], s60 offen offset:1032 lds
    v_mfma_f32_16x16x32_bf16 v[128:131], a[64:67], a[0:3], v[128:131]
    s_waitcnt vmcnt(14)
    ds_read_b64_tr_b16 a[96:97], v9 offset:4128
    v_mfma_f32_16x16x32_bf16 v[128:131], a[80:83], a[16:19], v[128:131]
    ds_read_b64_tr_b16 a[98:99], v9 offset:4384
    v_mfma_f32_16x16x32_bf16 v[132:135], a[64:67], a[4:7], v[132:135]
    ds_read_b64_tr_b16 a[100:101], v9 offset:4136
    v_mfma_f32_16x16x32_bf16 v[132:135], a[80:83], a[20:23], v[132:135]
    buffer_load_dwordx4 v13, s[36:39], s60 offen offset:2064 lds
    v_mfma_f32_16x16x32_bf16 v[136:139], a[64:67], a[8:11], v[136:139]
    ds_read_b64_tr_b16 a[102:103], v9 offset:4392
    s_waitcnt lgkmcnt(4)
    v_mfma_f32_16x16x32_bf16 v[136:139], a[80:83], a[24:27], v[136:139]
    ds_read_b64_tr_b16 a[104:105], v9 offset:4640
    v_mfma_f32_16x16x32_bf16 v[140:143], a[64:67], a[12:15], v[140:143]
    ds_read_b64_tr_b16 a[106:107], v9 offset:4896
    v_mfma_f32_16x16x32_bf16 v[140:143], a[80:83], a[28:31], v[140:143]
    ds_read_b64_tr_b16 a[108:109], v9 offset:4648
    v_mfma_f32_16x16x32_bf16 v[144:147], a[68:71], a[0:3], v[144:147]
    buffer_load_dwordx4 v14, s[36:39], s60 offen offset:3096 lds
    ds_read_b64_tr_b16 a[110:111], v9 offset:4904
    v_mfma_f32_16x16x32_bf16 v[144:147], a[84:87], a[16:19], v[144:147]
    ds_read_b128 a[32:35], v15 offset:57344
    s_add_u32 m0, s63, 4128
    v_mfma_f32_16x16x32_bf16 v[148:151], a[68:71], a[4:7], v[148:151]
    ds_read_b128 a[36:39], v15 offset:58368
    s_add_u32 s60, s92, 262144
    v_mfma_f32_16x16x32_bf16 v[148:151], a[84:87], a[20:23], v[148:151]
    s_waitcnt lgkmcnt(2)
    buffer_load_dwordx4 v11, s[36:39], s60 offen offset:0 lds
    v_mfma_f32_16x16x32_bf16 v[152:155], a[68:71], a[8:11], v[152:155]
    v_mfma_f32_16x16x32_bf16 v[152:155], a[84:87], a[24:27], v[152:155]
    v_mfma_f32_16x16x32_bf16 v[156:159], a[68:71], a[12:15], v[156:159]
    v_mfma_f32_16x16x32_bf16 v[156:159], a[84:87], a[28:31], v[156:159]
    buffer_load_dwordx4 v12, s[36:39], s60 offen offset:1032 lds
    v_mfma_f32_16x16x32_bf16 v[160:163], a[72:75], a[0:3], v[160:163]
    s_waitcnt vmcnt(14)
    ds_read_b64_tr_b16 a[112:113], v9 offset:8256
    v_mfma_f32_16x16x32_bf16 v[160:163], a[88:91], a[16:19], v[160:163]
    ds_read_b64_tr_b16 a[114:115], v9 offset:8512
    v_mfma_f32_16x16x32_bf16 v[164:167], a[72:75], a[4:7], v[164:167]
    ds_read_b64_tr_b16 a[116:117], v9 offset:8264
    v_mfma_f32_16x16x32_bf16 v[164:167], a[88:91], a[20:23], v[164:167]
    buffer_load_dwordx4 v13, s[36:39], s60 offen offset:2064 lds
    v_mfma_f32_16x16x32_bf16 v[168:171], a[72:75], a[8:11], v[168:171]
    ds_read_b64_tr_b16 a[118:119], v9 offset:8520
    v_mfma_f32_16x16x32_bf16 v[168:171], a[88:91], a[24:27], v[168:171]
    ds_read_b64_tr_b16 a[120:121], v9 offset:8768
    v_mfma_f32_16x16x32_bf16 v[172:175], a[72:75], a[12:15], v[172:175]
    ds_read_b64_tr_b16 a[122:123], v9 offset:9024
    v_mfma_f32_16x16x32_bf16 v[172:175], a[88:91], a[28:31], v[172:175]
    ds_read_b64_tr_b16 a[124:125], v9 offset:8776
    v_mfma_f32_16x16x32_bf16 v[176:179], a[76:79], a[0:3], v[176:179]
    buffer_load_dwordx4 v14, s[36:39], s60 offen offset:3096 lds
    ds_read_b64_tr_b16 a[126:127], v9 offset:9032
    v_mfma_f32_16x16x32_bf16 v[176:179], a[92:95], a[16:19], v[176:179]
    s_add_u32 s92, s92, 524288
    s_and_b32 s92, s92, 4194303
    v_mfma_f32_16x16x32_bf16 v[180:183], a[76:79], a[4:7], v[180:183]
    ds_read_b128 a[40:43], v15 offset:59392
    v_mfma_f32_16x16x32_bf16 v[180:183], a[92:95], a[20:23], v[180:183]
    ds_read_b128 a[44:47], v15 offset:60416
    v_mfma_f32_16x16x32_bf16 v[184:187], a[76:79], a[8:11], v[184:187]
    v_lshrrev_b32 v2, 5, v1
    v_lshlrev_b32 v2, 4, v2
    v_mfma_f32_16x16x32_bf16 v[184:187], a[92:95], a[24:27], v[184:187]
    v_bfe_u32 v3, v1, 2, 3
    v_add_u32 v2, v2, v3
    v_mfma_f32_16x16x32_bf16 v[188:191], a[76:79], a[12:15], v[188:191]
    v_mul_u32_u24 v2, 1024, v2
    v_and_b32 v3, 3, v1
    v_mfma_f32_16x16x32_bf16 v[188:191], a[92:95], a[28:31], v[188:191]
    v_lshl_add_u32 v11, v3, 4, v2
    v_mfma_f32_16x16x32_bf16 v[192:195], a[96:99], a[0:3], v[192:195]
    s_waitcnt vmcnt(12)
    ds_read_b64_tr_b16 a[64:65], v9 offset:12384
    v_add_u32 v12, 7160, v11
    s_waitcnt lgkmcnt(3)
    v_mfma_f32_16x16x32_bf16 v[192:195], a[112:115], a[16:19], v[192:195]
    ds_read_b64_tr_b16 a[66:67], v9 offset:12640
    v_add_u32 v13, 30704, v11
    v_mfma_f32_16x16x32_bf16 v[196:199], a[96:99], a[4:7], v[196:199]
    ds_read_b64_tr_b16 a[68:69], v9 offset:12392
    v_add_u32 v14, 37864, v11
    v_mfma_f32_16x16x32_bf16 v[196:199], a[112:115], a[20:23], v[196:199]
    ds_read_b64_tr_b16 a[70:71], v9 offset:12648
    s_lshl_b32 s100, s56, 19
    v_mfma_f32_16x16x32_bf16 v[200:203], a[96:99], a[8:11], v[200:203]
    ds_read_b64_tr_b16 a[72:73], v9 offset:12896
    s_lshl_b32 s101, s35, 6
    v_mfma_f32_16x16x32_bf16 v[200:203], a[112:115], a[24:27], v[200:203]
    ds_read_b64_tr_b16 a[74:75], v9 offset:13152
    s_and_b32 s101, s101, 1023
    v_mfma_f32_16x16x32_bf16 v[204:207], a[96:99], a[12:15], v[204:207]
    ds_read_b64_tr_b16 a[76:77], v9 offset:12904
    s_add_u32 s100, s100, s101
    v_mfma_f32_16x16x32_bf16 v[204:207], a[112:115], a[28:31], v[204:207]
    ds_read_b64_tr_b16 a[78:79], v9 offset:13160
    s_add_u32 s36, s12, s100
    s_addc_u32 s37, s13, 0
    v_mfma_f32_16x16x32_bf16 v[208:211], a[100:103], a[0:3], v[208:211]
    ds_read_b128 a[48:51], v8 offset:61440
    s_sub_u32 s38, 4194304, s100
    v_mfma_f32_16x16x32_bf16 v[208:211], a[116:119], a[16:19], v[208:211]
    ds_read_b128 a[52:55], v8 offset:62464
    v_and_b32 v3, 3, v1
    v_mfma_f32_16x16x32_bf16 v[212:215], a[100:103], a[4:7], v[212:215]
    v_mov_b32 v2, 0x3f803f80
    v_cmp_eq_u32 vcc, 0, v3
    s_nop 1
    v_cndmask_b32 v2, 0, v2, vcc
    v_mfma_f32_16x16x32_bf16 v[212:215], a[116:119], a[20:23], v[212:215]
    v_accvgpr_write_b32 a240, v2
    v_accvgpr_write_b32 a241, v2
    v_mfma_f32_16x16x32_bf16 v[216:219], a[100:103], a[8:11], v[216:219]
    v_accvgpr_write_b32 a242, v2
    v_accvgpr_write_b32 a243, v2
    v_mfma_f32_16x16x32_bf16 v[216:219], a[116:119], a[24:27], v[216:219]
    s_and_b32 s14, s57, 3
    s_lshl_b32 s92, s14, 8
    v_mfma_f32_16x16x32_bf16 v[220:223], a[100:103], a[12:15], v[220:223]
    s_bfe_u32 s15, s57, 0x20002
    s_and_b32 s15, s15, 3
    v_mfma_f32_16x16x32_bf16 v[220:223], a[116:119], a[28:31], v[220:223]
    s_lshl_b32 s94, s15, 17
    s_mul_i32 s93, s97, 57344
    v_mfma_f32_16x16x32_bf16 v[224:227], a[104:107], a[0:3], v[224:227]
    s_waitcnt vmcnt(8)
    ds_read_b64_tr_b16 a[80:81], v31 offset:0
    s_mul_i32 s100, s35, 14336
    v_mfma_f32_16x16x32_bf16 v[224:227], a[120:123], a[16:19], v[224:227]
    ds_read_b64_tr_b16 a[82:83], v31 offset:256
    s_add_u32 s93, s93, s100
    v_mfma_f32_16x16x32_bf16 v[228:231], a[104:107], a[4:7], v[228:231]
    ds_read_b64_tr_b16 a[84:85], v31 offset:8
    s_mov_b32 s52, s16
    v_mfma_f32_16x16x32_bf16 v[228:231], a[120:123], a[20:23], v[228:231]
    ds_read_b64_tr_b16 a[86:87], v31 offset:264
    s_mov_b32 s53, s17
    v_mfma_f32_16x16x32_bf16 v[232:235], a[104:107], a[8:11], v[232:235]
    ds_read_b64_tr_b16 a[88:89], v31 offset:512
    s_mov_b32 s54, 1835008
    v_mfma_f32_16x16x32_bf16 v[232:235], a[120:123], a[24:27], v[232:235]
    ds_read_b64_tr_b16 a[90:91], v31 offset:768
    s_mov_b32 s55, 0x20000
    v_mfma_f32_16x16x32_bf16 v[236:239], a[104:107], a[12:15], v[236:239]
    ds_read_b64_tr_b16 a[92:93], v31 offset:520
    v_lshrrev_b32 v2, 5, v1
    v_mfma_f32_16x16x32_bf16 v[236:239], a[120:123], a[28:31], v[236:239]
    ds_read_b64_tr_b16 a[94:95], v31 offset:776
    v_lshlrev_b32 v2, 4, v2
    v_mfma_f32_16x16x32_bf16 v[240:243], a[108:111], a[0:3], v[240:243]
    ds_read_b128 a[56:59], v8 offset:63488
    v_bfe_u32 v3, v1, 2, 3
    v_mfma_f32_16x16x32_bf16 v[240:243], a[124:127], a[16:19], v[240:243]
    ds_read_b128 a[60:63], v8 offset:64512
    v_add_u32 v2, v2, v3
    v_mfma_f32_16x16x32_bf16 v[244:247], a[108:111], a[4:7], v[244:247]
    v_mul_u32_u24 v2, 6144, v2
    v_and_b32 v3, 3, v1
    v_mfma_f32_16x16x32_bf16 v[244:247], a[124:127], a[20:23], v[244:247]
    v_lshl_add_u32 v2, v3, 4, v2
    v_add_u32 v3, 48120, v2
    v_mfma_f32_16x16x32_bf16 v[248:251], a[108:111], a[8:11], v[248:251]
    v_add_u32 v4, 194544, v2
    v_add_u32 v5, 242664, v2
    v_mfma_f32_16x16x32_bf16 v[248:251], a[124:127], a[24:27], v[248:251]
    v_lshlrev_b32 v30, 2, v0
    s_add_u32 s100, s35, 0
    v_mfma_f32_16x16x32_bf16 v[252:255], a[108:111], a[12:15], v[252:255]
    s_and_b32 s100, s100, 3
    s_mul_i32 s101, s100, 16512
    v_mfma_f32_16x16x32_bf16 v[252:255], a[124:127], a[28:31], v[252:255]
    s_cmp_eq_u32 s100, 2
    s_cselect_b32 s101, 32896, s101
    s_waitcnt lgkmcnt(1)
    v_mfma_f32_16x16x32_bf16 v[128:131], a[64:67], a[32:35], v[128:131]
    s_waitcnt vmcnt(4)
    ds_read_b64_tr_b16 a[96:97], v9 offset:0
    s_cmp_eq_u32 s100, 3
    s_cselect_b32 s85, 65920, s101
    v_mfma_f32_16x16x32_bf16 v[128:131], a[80:83], a[48:51], v[128:131]
    s_waitcnt lgkmcnt(1)
    s_barrier
    s_add_u32 s100, s15, 0
    v_mfma_f32_16x16x32_bf16 v[132:135], a[64:67], a[36:39], v[132:135]
    ds_read_b64_tr_b16 a[98:99], v9 offset:256
    s_and_b32 s100, s100, 3
    v_mfma_f32_16x16x32_bf16 v[132:135], a[80:83], a[52:55], v[132:135]
    ds_read_b64_tr_b16 a[100:101], v9 offset:8
    s_add_u32 m0, s6, 0
    v_mfma_f32_16x16x32_bf16 v[136:139], a[64:67], a[40:43], v[136:139]
    ds_read_b64_tr_b16 a[102:103], v9 offset:264
    s_mul_i32 s101, s100, 16512
    v_mfma_f32_16x16x32_bf16 v[136:139], a[80:83], a[56:59], v[136:139]
    ds_read_b64_tr_b16 a[104:105], v9 offset:512
    s_cmp_eq_u32 s100, 2
    s_cselect_b32 s101, 32896, s101
    v_mfma_f32_16x16x32_bf16 v[140:143], a[64:67], a[44:47], v[140:143]
    ds_read_b64_tr_b16 a[106:107], v9 offset:768
    s_cmp_eq_u32 s100, 3
    s_cselect_b32 s86, 65920, s101
    v_mfma_f32_16x16x32_bf16 v[140:143], a[80:83], a[60:63], v[140:143]
    ds_read_b64_tr_b16 a[108:109], v9 offset:520
    s_add_u32 s100, s15, 1
    v_mfma_f32_16x16x32_bf16 v[144:147], a[68:71], a[32:35], v[144:147]
    ds_read_b64_tr_b16 a[110:111], v9 offset:776
    s_and_b32 s100, s100, 3
    v_mfma_f32_16x16x32_bf16 v[144:147], a[84:87], a[48:51], v[144:147]
    buffer_load_dwordx4 v22, s[40:43], s8 offen offset:0 lds
    s_mul_i32 s101, s100, 16512
    v_mfma_f32_16x16x32_bf16 v[148:151], a[68:71], a[36:39], v[148:151]
    buffer_load_dwordx4 v23, s[40:43], s8 offen offset:1024 lds
    s_cmp_eq_u32 s100, 2
    s_cselect_b32 s101, 32896, s101
    v_mfma_f32_16x16x32_bf16 v[148:151], a[84:87], a[52:55], v[148:151]
    buffer_load_dwordx4 v24, s[40:43], s8 offen offset:2048 lds
    s_cmp_eq_u32 s100, 3
    s_cselect_b32 s87, 65920, s101
    v_mfma_f32_16x16x32_bf16 v[152:155], a[68:71], a[40:43], v[152:155]
    buffer_load_dwordx4 v25, s[40:43], s8 offen offset:3072 lds
    s_add_u32 s8, s8, 16384
    v_mfma_f32_16x16x32_bf16 v[152:155], a[84:87], a[56:59], v[152:155]
    s_and_b32 s8, s8, 0x1ffff
    s_add_u32 s100, s15, 2
    v_mfma_f32_16x16x32_bf16 v[156:159], a[68:71], a[44:47], v[156:159]
    s_and_b32 s100, s100, 3
    s_mul_i32 s101, s100, 16512
    v_mfma_f32_16x16x32_bf16 v[156:159], a[84:87], a[60:63], v[156:159]
    s_cmp_eq_u32 s100, 2
    s_cselect_b32 s101, 32896, s101
    s_cmp_eq_u32 s100, 3
    s_cselect_b32 s88, 65920, s101
    v_mfma_f32_16x16x32_bf16 v[160:163], a[72:75], a[32:35], v[160:163]
    s_waitcnt vmcnt(4)
    ds_read_b64_tr_b16 a[112:113], v9 offset:4128
    s_add_u32 s100, s15, 3
    v_mfma_f32_16x16x32_bf16 v[160:163], a[88:91], a[48:51], v[160:163]
    ds_read_b64_tr_b16 a[114:115], v9 offset:4384
    s_and_b32 s100, s100, 3
    v_mfma_f32_16x16x32_bf16 v[164:167], a[72:75], a[36:39], v[164:167]
    ds_read_b64_tr_b16 a[116:117], v9 offset:4136
    v_cvt_pk_bf16_f32 v32, v128, v129
    v_mfma_f32_16x16x32_bf16 v[164:167], a[88:91], a[52:55], v[164:167]
    ds_read_b64_tr_b16 a[118:119], v9 offset:4392
    s_add_u32 m0, s6, 16512
    v_mfma_f32_16x16x32_bf16 v[168:171], a[72:75], a[40:43], v[168:171]
    ds_read_b64_tr_b16 a[120:121], v9 offset:4640
    v_cvt_pk_bf16_f32 v33, v130, v131
    v_mfma_f32_16x16x32_bf16 v[168:171], a[88:91], a[56:59], v[168:171]
    ds_read_b64_tr_b16 a[122:123], v9 offset:4896
    v_cvt_pk_bf16_f32 v34, v144, v145
    v_mfma_f32_16x16x32_bf16 v[172:175], a[72:75], a[44:47], v[172:175]
    ds_read_b64_tr_b16 a[124:125], v9 offset:4648
    v_cvt_pk_bf16_f32 v35, v146, v147
    v_mfma_f32_16x16x32_bf16 v[172:175], a[88:91], a[60:63], v[172:175]
    ds_read_b64_tr_b16 a[126:127], v9 offset:4904
    v_cvt_pk_bf16_f32 v36, v132, v133
    v_mfma_f32_16x16x32_bf16 v[176:179], a[76:79], a[32:35], v[176:179]
    buffer_load_dwordx4 v22, s[40:43], s8 offen offset:0 lds
    v_cvt_pk_bf16_f32 v37, v134, v135
    v_mfma_f32_16x16x32_bf16 v[176:179], a[92:95], a[48:51], v[176:179]
    buffer_load_dwordx4 v23, s[40:43], s8 offen offset:1024 lds
    v_cvt_pk_bf16_f32 v38, v148, v149
    v_mfma_f32_16x16x32_bf16 v[180:183], a[76:79], a[36:39], v[180:183]
    buffer_load_dwordx4 v24, s[40:43], s8 offen offset:2048 lds
    v_cvt_pk_bf16_f32 v39, v150, v151
    v_mfma_f32_16x16x32_bf16 v[180:183], a[92:95], a[52:55], v[180:183]
    buffer_load_dwordx4 v25, s[40:43], s8 offen offset:3072 lds
    v_cvt_pk_bf16_f32 v40, v136, v137
    v_mfma_f32_16x16x32_bf16 v[184:187], a[76:79], a[40:43], v[184:187]
    v_cvt_pk_bf16_f32 v41, v138, v139
    v_cvt_pk_bf16_f32 v42, v152, v153
    v_mfma_f32_16x16x32_bf16 v[184:187], a[92:95], a[56:59], v[184:187]
    v_cvt_pk_bf16_f32 v43, v154, v155
    v_cvt_pk_bf16_f32 v44, v140, v141
    v_mfma_f32_16x16x32_bf16 v[188:191], a[76:79], a[44:47], v[188:191]
    v_cvt_pk_bf16_f32 v45, v142, v143
    v_cvt_pk_bf16_f32 v46, v156, v157
    v_mfma_f32_16x16x32_bf16 v[188:191], a[92:95], a[60:63], v[188:191]
    v_cvt_pk_bf16_f32 v47, v158, v159
    s_waitcnt lgkmcnt(0)
    v_mfma_f32_16x16x32_bf16 v[192:195], a[96:99], a[32:35], v[192:195]
    s_add_u32 s8, s8, 16384
    s_and_b32 s8, s8, 0x1ffff
    v_mfma_f32_16x16x32_bf16 v[192:195], a[112:115], a[48:51], v[192:195]
    s_add_u32 m0, s7, 0
    s_mul_i32 s101, s100, 16512
    v_mfma_f32_16x16x32_bf16 v[196:199], a[96:99], a[36:39], v[196:199]
    buffer_load_dwordx4 v26, s[44:47], s9 offen offset:0 lds
    s_cmp_eq_u32 s100, 2
    s_cselect_b32 s101, 32896, s101
    v_mfma_f32_16x16x32_bf16 v[196:199], a[112:115], a[52:55], v[196:199]
    buffer_load_dwordx4 v27, s[44:47], s9 offen offset:1032 lds
    s_cmp_eq_u32 s100, 3
    s_cselect_b32 s89, 65920, s101
    v_mfma_f32_16x16x32_bf16 v[200:203], a[96:99], a[40:43], v[200:203]
    buffer_load_dwordx4 v28, s[44:47], s9 offen offset:2064 lds
    s_sub_u32 s3, s96, 2
    v_mfma_f32_16x16x32_bf16 v[200:203], a[112:115], a[56:59], v[200:203]
    buffer_load_dwordx4 v29, s[44:47], s9 offen offset:3096 lds
    s_add_u32 s9, s9, 16384
    v_mfma_f32_16x16x32_bf16 v[204:207], a[96:99], a[44:47], v[204:207]
    s_and_b32 s9, s9, 0x1ffff
    s_lshl_b32 s13, s3, 5
    v_mfma_f32_16x16x32_bf16 v[204:207], a[112:115], a[60:63], v[204:207]
    v_cvt_pk_bf16_f32 v48, v160, v161
    v_cvt_pk_bf16_f32 v49, v162, v163
    v_mfma_f32_16x16x32_bf16 v[208:211], a[100:103], a[32:35], v[208:211]
    v_cvt_pk_bf16_f32 v50, v176, v177
    v_cvt_pk_bf16_f32 v51, v178, v179
    v_mfma_f32_16x16x32_bf16 v[208:211], a[116:119], a[48:51], v[208:211]
    v_cvt_pk_bf16_f32 v52, v164, v165
    v_cvt_pk_bf16_f32 v53, v166, v167
    v_mfma_f32_16x16x32_bf16 v[212:215], a[100:103], a[36:39], v[212:215]
    v_cvt_pk_bf16_f32 v54, v180, v181
    v_cvt_pk_bf16_f32 v55, v182, v183
    v_mfma_f32_16x16x32_bf16 v[212:215], a[116:119], a[52:55], v[212:215]
    v_cvt_pk_bf16_f32 v56, v168, v169
    v_cvt_pk_bf16_f32 v57, v170, v171
    v_mfma_f32_16x16x32_bf16 v[216:219], a[100:103], a[40:43], v[216:219]
    v_cvt_pk_bf16_f32 v58, v184, v185
    v_cvt_pk_bf16_f32 v59, v186, v187
    v_mfma_f32_16x16x32_bf16 v[216:219], a[116:119], a[56:59], v[216:219]
    v_cvt_pk_bf16_f32 v60, v172, v173
    v_cvt_pk_bf16_f32 v61, v174, v175
    v_mfma_f32_16x16x32_bf16 v[220:223], a[100:103], a[44:47], v[220:223]
    v_cvt_pk_bf16_f32 v62, v188, v189
    v_cvt_pk_bf16_f32 v63, v190, v191
    v_mfma_f32_16x16x32_bf16 v[220:223], a[116:119], a[60:63], v[220:223]
    s_waitcnt vmcnt(8)
    s_barrier
    s_add_u32 s13, s13, s97
    v_mfma_f32_16x16x32_bf16 v[224:227], a[104:107], a[32:35], v[224:227]
    s_lshl_b32 s100, s13, 6
    s_mul_i32 s101, s35, 786432
    v_mfma_f32_16x16x32_bf16 v[224:227], a[120:123], a[48:51], v[224:227]
    ds_read_b128 a[192:195], v17 offset:0
    s_add_u32 s100, s100, s101
    v_mfma_f32_16x16x32_bf16 v[228:231], a[104:107], a[36:39], v[228:231]
    ds_read_b128 a[196:199], v18 offset:0
    s_add_u32 s100, s100, 2048
    v_mfma_f32_16x16x32_bf16 v[228:231], a[120:123], a[52:55], v[228:231]
    ds_read_b128 a[200:203], v19 offset:0
    s_cmp_lt_u32 s3, 2
    s_cselect_b32 s10, s100, 268435456
    s_cselect_b32 s62, 0, 268435456
    v_mfma_f32_16x16x32_bf16 v[232:235], a[104:107], a[40:43], v[232:235]
    ds_read_b128 a[204:207], v20 offset:0
    s_mov_b32 s12, s2
    v_mfma_f32_16x16x32_bf16 v[232:235], a[120:123], a[56:59], v[232:235]
    s_cmp_lg_u32 s35, 0
    s_cselect_b32 s11, 268435456, 0
    s_mov_b32 s0, s24
    v_mfma_f32_16x16x32_bf16 v[236:239], a[104:107], a[44:47], v[236:239]
    s_mov_b32 s1, s25
    s_mov_b32 s2, 1024
    v_mfma_f32_16x16x32_bf16 v[236:239], a[120:123], a[60:63], v[236:239]
    s_mov_b32 s3, 0x20000
    v_mov_b32 v6, 0xff800000
    v_mfma_f32_16x16x32_bf16 v[240:243], a[108:111], a[32:35], v[240:243]
    v_mov_b32 v7, 0xff800000
    v_mov_b32 v8, 0xff800000
    v_mfma_f32_16x16x32_bf16 v[240:243], a[124:127], a[48:51], v[240:243]
    v_mov_b32 v15, 0xff800000
    s_mov_b32 s95, 0
    v_mfma_f32_16x16x32_bf16 v[244:247], a[108:111], a[36:39], v[244:247]
    v_lshrrev_b32 v31, 6, v0
    v_lshlrev_b32 v31, 2, v31
    v_mfma_f32_16x16x32_bf16 v[244:247], a[124:127], a[52:55], v[244:247]
    v_add_u32 v31, 161168, v31
    v_cvt_pk_bf16_f32 v64, v192, v193
    v_mfma_f32_16x16x32_bf16 v[248:251], a[108:111], a[40:43], v[248:251]
    v_cvt_pk_bf16_f32 v65, v194, v195
    v_cvt_pk_bf16_f32 v66, v208, v209
    v_mfma_f32_16x16x32_bf16 v[248:251], a[124:127], a[56:59], v[248:251]
    v_cvt_pk_bf16_f32 v67, v210, v211
    v_cvt_pk_bf16_f32 v68, v196, v197
    v_mfma_f32_16x16x32_bf16 v[252:255], a[108:111], a[44:47], v[252:255]
    v_cvt_pk_bf16_f32 v69, v198, v199
    v_cvt_pk_bf16_f32 v70, v212, v213
    v_mfma_f32_16x16x32_bf16 v[252:255], a[124:127], a[60:63], v[252:255]
    v_cvt_pk_bf16_f32 v71, v214, v215
    v_cvt_pk_bf16_f32 v72, v200, v201
    v_cvt_pk_bf16_f32 v73, v202, v203
    v_cvt_pk_bf16_f32 v74, v216, v217
    v_cvt_pk_bf16_f32 v75, v218, v219
    v_cvt_pk_bf16_f32 v76, v204, v205
    v_cvt_pk_bf16_f32 v77, v206, v207
    v_cvt_pk_bf16_f32 v78, v220, v221
    v_cvt_pk_bf16_f32 v79, v222, v223
    v_cvt_pk_bf16_f32 v80, v224, v225
    v_cvt_pk_bf16_f32 v81, v226, v227
    v_cvt_pk_bf16_f32 v82, v240, v241
    v_cvt_pk_bf16_f32 v83, v242, v243
    v_cvt_pk_bf16_f32 v84, v228, v229
    v_cvt_pk_bf16_f32 v85, v230, v231
    v_cvt_pk_bf16_f32 v86, v244, v245
    v_cvt_pk_bf16_f32 v87, v246, v247
    v_cvt_pk_bf16_f32 v88, v232, v233
    v_cvt_pk_bf16_f32 v89, v234, v235
    v_cvt_pk_bf16_f32 v90, v248, v249
    v_cvt_pk_bf16_f32 v91, v250, v251
    v_cvt_pk_bf16_f32 v92, v236, v237
    v_cvt_pk_bf16_f32 v93, v238, v239
    v_cvt_pk_bf16_f32 v94, v252, v253
    v_cvt_pk_bf16_f32 v95, v254, v255
L_attn:
    s_waitcnt lgkmcnt(0)
    v_mfma_f32_16x16x32_bf16 v[96:99], a[192:195], v[32:35], 0
    ds_read_b128 a[208:211], v17 offset:1024
    v_mfma_f32_16x16x32_bf16 v[96:99], a[196:199], v[48:51], v[96:99]
    ds_read_b128 a[212:215], v18 offset:1024
    v_mfma_f32_16x16x32_bf16 v[96:99], a[200:203], v[64:67], v[96:99]
    ds_read_b128 a[216:219], v19 offset:1024
    v_mfma_f32_16x16x32_bf16 v[96:99], a[204:207], v[80:83], v[96:99]
    buffer_load_dword v30, v30, s[0:3], s62 offen
    s_mov_b32 s0, s26
    v_mfma_f32_16x16x32_bf16 v[100:103], a[192:195], v[36:39], 0
    ds_read_b128 a[220:223], v20 offset:1024
    s_mov_b32 s1, s27
    v_mfma_f32_16x16x32_bf16 v[100:103], a[196:199], v[52:55], v[100:103]
    s_mov_b32 s2, 3145728
    s_mov_b32 m0, s63
    v_mfma_f32_16x16x32_bf16 v[100:103], a[200:203], v[68:71], v[100:103]
    v_mfma_f32_16x16x32_bf16 v[100:103], a[204:207], v[84:87], v[100:103]
    v_max3_f32 v240, v96, v97, v98
    v_max3_f32 v240, v240, v99, v6
    v_mfma_f32_16x16x32_bf16 v[104:107], a[192:195], v[40:43], 0
    v_mov_b32 v241, v240
    s_nop 1
    v_permlane16_swap_b32 v240, v241
    v_mfma_f32_16x16x32_bf16 v[104:107], a[196:199], v[56:59], v[104:107]
    v_max_f32 v240, v240, v241
    v_mov_b32 v241, v240
    v_mfma_f32_16x16x32_bf16 v[104:107], a[200:203], v[72:75], v[104:107]
    s_nop 0
    v_permlane32_swap_b32 v240, v241
    v_max_f32 v240, v240, v241
    v_mfma_f32_16x16x32_bf16 v[104:107], a[204:207], v[88:91], v[104:107]
    v_sub_f32 v224, 0, v240
    v_sub_f32 v225, 0, v240
    v_mfma_f32_16x16x32_bf16 v[108:111], a[192:195], v[44:47], 0
    v_sub_f32 v226, 0, v240
    v_sub_f32 v227, 0, v240
    v_mfma_f32_16x16x32_bf16 v[108:111], a[196:199], v[60:63], v[108:111]
    buffer_load_dwordx4 v2, s[0:3], s10 offen offset:0 nt lds
    v_max3_f32 v242, v100, v101, v102
    v_mfma_f32_16x16x32_bf16 v[108:111], a[200:203], v[76:79], v[108:111]
    v_max3_f32 v242, v242, v103, v7
    v_mov_b32 v243, v242
    v_mfma_f32_16x16x32_bf16 v[108:111], a[204:207], v[92:95], v[108:111]
    s_nop 0
    v_permlane16_swap_b32 v242, v243
    s_waitcnt lgkmcnt(0)
    v_mfma_f32_16x16x32_bf16 v[112:115], a[208:211], v[32:35], v[224:227]
    ds_read_b128 a[192:195], v17 offset:2048
    v_max_f32 v242, v242, v243
    v_mfma_f32_16x16x32_bf16 v[112:115], a[212:215], v[48:51], v[112:115]
    ds_read_b128 a[196:199], v18 offset:2048
    v_mov_b32 v243, v242
    v_mfma_f32_16x16x32_bf16 v[112:115], a[216:219], v[64:67], v[112:115]
    s_nop 0
    v_permlane32_swap_b32 v242, v243
    v_max_f32 v242, v242, v243
    v_sub_f32 v228, 0, v242
    v_sub_f32 v229, 0, v242
    v_sub_f32 v230, 0, v242
    v_sub_f32 v231, 0, v242
    v_mfma_f32_16x16x32_bf16 v[112:115], a[220:223], v[80:83], v[112:115]
    ds_read_b128 a[200:203], v19 offset:2048
    v_max3_f32 v244, v104, v105, v106
    v_mfma_f32_16x16x32_bf16 v[116:119], a[208:211], v[36:39], v[228:231]
    ds_read_b128 a[204:207], v20 offset:2048
    v_max3_f32 v244, v244, v107, v8
    v_mfma_f32_16x16x32_bf16 v[116:119], a[212:215], v[52:55], v[116:119]
    v_mov_b32 v245, v244
    s_nop 1
    v_permlane16_swap_b32 v244, v245
    v_mfma_f32_16x16x32_bf16 v[116:119], a[216:219], v[68:71], v[116:119]
    v_max_f32 v244, v244, v245
    v_mov_b32 v245, v244
    s_nop 1
    v_permlane32_swap_b32 v244, v245
    v_max_f32 v244, v244, v245
    v_sub_f32 v232, 0, v244
    v_sub_f32 v233, 0, v244
    v_sub_f32 v234, 0, v244
    v_sub_f32 v235, 0, v244
    v_mfma_f32_16x16x32_bf16 v[116:119], a[220:223], v[84:87], v[116:119]
    buffer_load_dwordx4 v3, s[0:3], s10 offen offset:1032 nt lds
    v_max3_f32 v246, v108, v109, v110
    v_mfma_f32_16x16x32_bf16 v[120:123], a[208:211], v[40:43], v[232:235]
    v_max3_f32 v246, v246, v111, v15
    v_mov_b32 v247, v246
    v_mfma_f32_16x16x32_bf16 v[120:123], a[212:215], v[56:59], v[120:123]
    s_nop 0
    v_permlane16_swap_b32 v246, v247
    v_max_f32 v246, v246, v247
    v_mfma_f32_16x16x32_bf16 v[120:123], a[216:219], v[72:75], v[120:123]
    v_mov_b32 v247, v246
    s_nop 1
    v_permlane32_swap_b32 v246, v247
    v_max_f32 v246, v246, v247
    v_sub_f32 v236, 0, v246
    v_sub_f32 v237, 0, v246
    v_sub_f32 v238, 0, v246
    v_sub_f32 v239, 0, v246
    v_mfma_f32_16x16x32_bf16 v[120:123], a[220:223], v[88:91], v[120:123]
    v_exp_f32 v112, v112
    v_mfma_f32_16x16x32_bf16 v[124:127], a[208:211], v[44:47], v[236:239]
    v_exp_f32 v113, v113
    v_mfma_f32_16x16x32_bf16 v[124:127], a[212:215], v[60:63], v[124:127]
    v_exp_f32 v114, v114
    v_mfma_f32_16x16x32_bf16 v[124:127], a[216:219], v[76:79], v[124:127]
    v_exp_f32 v115, v115
    v_mfma_f32_16x16x32_bf16 v[124:127], a[220:223], v[92:95], v[124:127]
    buffer_load_dwordx4 v4, s[0:3], s10 offen offset:2064 nt lds
    s_waitcnt lgkmcnt(0)
    v_mfma_f32_16x16x32_bf16 v[128:131], a[192:195], v[32:35], v[224:227]
    ds_read_b128 a[208:211], v17 offset:3072
    v_add_f32 v96, v224, v96
    v_mfma_f32_16x16x32_bf16 v[128:131], a[196:199], v[48:51], v[128:131]
    ds_read_b128 a[212:215], v18 offset:3072
    v_add_f32 v97, v224, v97
    v_mfma_f32_16x16x32_bf16 v[128:131], a[200:203], v[64:67], v[128:131]
    ds_read_b128 a[216:219], v19 offset:3072
    v_add_f32 v98, v224, v98
    v_mfma_f32_16x16x32_bf16 v[128:131], a[204:207], v[80:83], v[128:131]
    ds_read_b128 a[220:223], v20 offset:3072
    v_add_f32 v99, v224, v99
    v_mfma_f32_16x16x32_bf16 v[132:135], a[192:195], v[36:39], v[228:231]
    v_exp_f32 v96, v96
    v_mfma_f32_16x16x32_bf16 v[132:135], a[196:199], v[52:55], v[132:135]
    v_exp_f32 v97, v97
    v_mfma_f32_16x16x32_bf16 v[132:135], a[200:203], v[68:71], v[132:135]
    v_exp_f32 v98, v98
    v_mfma_f32_16x16x32_bf16 v[132:135], a[204:207], v[84:87], v[132:135]
    v_exp_f32 v99, v99
    v_mfma_f32_16x16x32_bf16 v[136:139], a[192:195], v[40:43], v[232:235]
    buffer_load_dwordx4 v5, s[0:3], s10 offen offset:3096 nt lds
    v_cvt_pk_bf16_f32 v160, v96, v97
    v_mfma_f32_16x16x32_bf16 v[136:139], a[196:199], v[56:59], v[136:139]
    v_exp_f32 v116, v116
    v_mfma_f32_16x16x32_bf16 v[136:139], a[200:203], v[72:75], v[136:139]
    v_exp_f32 v117, v117
    v_mfma_f32_16x16x32_bf16 v[136:139], a[204:207], v[88:91], v[136:139]
    v_exp_f32 v118, v118
    v_mfma_f32_16x16x32_bf16 v[140:143], a[192:195], v[44:47], v[236:239]
    v_exp_f32 v119, v119
    v_mfma_f32_16x16x32_bf16 v[140:143], a[196:199], v[60:63], v[140:143]
    v_exp_f32 v120, v120
    v_mfma_f32_16x16x32_bf16 v[140:143], a[200:203], v[76:79], v[140:143]
    v_exp_f32 v121, v121
    v_mfma_f32_16x16x32_bf16 v[140:143], a[204:207], v[92:95], v[140:143]
    v_cvt_pk_bf16_f32 v161, v98, v99
    s_waitcnt lgkmcnt(0)
    v_mfma_f32_16x16x32_bf16 v[144:147], a[208:211], v[32:35], v[224:227]
    v_exp_f32 v122, v122
    v_mfma_f32_16x16x32_bf16 v[144:147], a[212:215], v[48:51], v[144:147]
    s_waitcnt vmcnt(5)
    s_barrier
    v_add_f32 v100, v228, v100
    v_mfma_f32_16x16x32_bf16 v[144:147], a[216:219], v[64:67], v[144:147]
    ds_read_b128 a[192:195], v17 offset:16512
    v_add_f32 v101, v228, v101
    v_mfma_f32_16x16x32_bf16 v[144:147], a[220:223], v[80:83], v[144:147]
    ds_read_b128 a[196:199], v18 offset:16512
    v_add_f32 v102, v228, v102
    v_mfma_f32_16x16x32_bf16 v[148:151], a[208:211], v[36:39], v[228:231]
    ds_read_b128 a[200:203], v19 offset:16512
    v_add_f32 v103, v228, v103
    v_mfma_f32_16x16x32_bf16 v[148:151], a[212:215], v[52:55], v[148:151]
    ds_read_b128 a[204:207], v20 offset:16512
    s_add_u32 m0, s6, 0
    v_mfma_f32_16x16x32_bf16 v[148:151], a[216:219], v[68:71], v[148:151]
    v_exp_f32 v100, v100
    v_mfma_f32_16x16x32_bf16 v[148:151], a[220:223], v[84:87], v[148:151]
    v_exp_f32 v101, v101
    v_mfma_f32_16x16x32_bf16 v[152:155], a[208:211], v[40:43], v[232:235]
    buffer_load_dwordx4 v22, s[40:43], s8 offen offset:0 lds
    v_add_f32 v104, v232, v104
    v_mfma_f32_16x16x32_bf16 v[152:155], a[212:215], v[56:59], v[152:155]
L_stub4:
    s_cbranch_execz L_stub8
    v_exp_f32 v102, v102
    v_mfma_f32_16x16x32_bf16 v[152:155], a[216:219], v[72:75], v[152:155]
    v_exp_f32 v103, v103
    v_mfma_f32_16x16x32_bf16 v[152:155], a[220:223], v[88:91], v[152:155]
    v_exp_f32 v123, v123
    v_mfma_f32_16x16x32_bf16 v[156:159], a[208:211], v[44:47], v[236:239]
    v_exp_f32 v124, v124
    v_mfma_f32_16x16x32_bf16 v[156:159], a[212:215], v[60:63], v[156:159]
    buffer_load_dwordx4 v23, s[40:43], s8 offen offset:1024 lds
    v_cvt_pk_bf16_f32 v164, v100, v101
    v_mfma_f32_16x16x32_bf16 v[156:159], a[216:219], v[76:79], v[156:159]
    v_cvt_pk_bf16_f32 v165, v102, v103
    v_add_f32 v105, v232, v105
    v_mfma_f32_16x16x32_bf16 v[156:159], a[220:223], v[92:95], v[156:159]
    v_add_f32 v106, v232, v106
    s_waitcnt lgkmcnt(0)
    v_mfma_f32_16x16x32_bf16 v[96:99], a[192:195], v[32:35], v[224:227]
    ds_read_b128 a[208:211], v17 offset:17536
    v_add_f32 v107, v232, v107
    v_mfma_f32_16x16x32_bf16 v[96:99], a[196:199], v[48:51], v[96:99]
    ds_read_b128 a[212:215], v18 offset:17536
    v_add_f32 v108, v236, v108
    v_mfma_f32_16x16x32_bf16 v[96:99], a[200:203], v[64:67], v[96:99]
    buffer_load_dwordx4 v24, s[40:43], s8 offen offset:2048 lds
    v_add_f32 v109, v236, v109
    v_mfma_f32_16x16x32_bf16 v[96:99], a[204:207], v[80:83], v[96:99]
    ds_read_b128 a[216:219], v19 offset:17536
    v_add_f32 v110, v236, v110
    v_mfma_f32_16x16x32_bf16 v[100:103], a[192:195], v[36:39], v[228:231]
    ds_read_b128 a[220:223], v20 offset:17536
    v_add_f32 v111, v236, v111
    v_mfma_f32_16x16x32_bf16 v[100:103], a[196:199], v[52:55], v[100:103]
    v_exp_f32 v104, v104
    v_mfma_f32_16x16x32_bf16 v[100:103], a[200:203], v[68:71], v[100:103]
    v_exp_f32 v105, v105
    v_mfma_f32_16x16x32_bf16 v[100:103], a[204:207], v[84:87], v[100:103]
    v_exp_f32 v106, v106
    v_exp_f32 v107, v107
    v_cvt_pk_bf16_f32 v168, v104, v105
    v_cvt_pk_bf16_f32 v169, v106, v107
    v_mfma_f32_16x16x32_bf16 v[104:107], a[192:195], v[40:43], v[232:235]
    buffer_load_dwordx4 v25, s[40:43], s8 offen offset:3072 lds
    s_add_u32 s8, s8, 16384
    v_mfma_f32_16x16x32_bf16 v[104:107], a[196:199], v[56:59], v[104:107]
    s_and_b32 s8, s8, 0x1ffff
    s_add_u32 m0, s7, 16512
    v_mfma_f32_16x16x32_bf16 v[104:107], a[200:203], v[72:75], v[104:107]
    v_exp_f32 v108, v108
    v_mfma_f32_16x16x32_bf16 v[104:107], a[204:207], v[88:91], v[104:107]
    v_exp_f32 v109, v109
    v_exp_f32 v110, v110
    v_exp_f32 v111, v111
    v_cvt_pk_bf16_f32 v172, v108, v109
    v_cvt_pk_bf16_f32 v173, v110, v111
    v_mfma_f32_16x16x32_bf16 v[108:111], a[192:195], v[44:47], v[236:239]
    buffer_load_dwordx4 v26, s[44:47], s9 offen offset:0 lds
    v_cvt_pk_bf16_f32 v162, v112, v113
    v_mfma_f32_16x16x32_bf16 v[108:111], a[196:199], v[60:63], v[108:111]
    v_cvt_pk_bf16_f32 v163, v114, v115
    v_cvt_pk_bf16_f32 v166, v116, v117
    v_mfma_f32_16x16x32_bf16 v[108:111], a[200:203], v[76:79], v[108:111]
    v_cvt_pk_bf16_f32 v167, v118, v119
    v_cvt_pk_bf16_f32 v170, v120, v121
    v_mfma_f32_16x16x32_bf16 v[108:111], a[204:207], v[92:95], v[108:111]
    v_cvt_pk_bf16_f32 v171, v122, v123
    s_waitcnt lgkmcnt(0)
    v_mfma_f32_16x16x32_bf16 v[112:115], a[208:211], v[32:35], v[224:227]
    ds_read_b128 a[192:195], v17 offset:18560
    ds_read_b128 a[196:199], v18 offset:18560
    v_mfma_f32_16x16x32_bf16 v[112:115], a[212:215], v[48:51], v[112:115]
    buffer_load_dwordx4 v27, s[44:47], s9 offen offset:1032 lds
    ds_read_b128 a[200:203], v19 offset:18560
    v_mfma_f32_16x16x32_bf16 v[112:115], a[216:219], v[64:67], v[112:115]
    ds_read_b128 a[204:207], v20 offset:18560
    v_mfma_f32_16x16x32_bf16 v[112:115], a[220:223], v[80:83], v[112:115]
    v_exp_f32 v125, v125
    v_mfma_f32_16x16x32_bf16 v[116:119], a[208:211], v[36:39], v[228:231]
    v_exp_f32 v126, v126
    v_mfma_f32_16x16x32_bf16 v[116:119], a[212:215], v[52:55], v[116:119]
    v_exp_f32 v127, v127
    v_mfma_f32_16x16x32_bf16 v[116:119], a[216:219], v[68:71], v[116:119]
    buffer_load_dwordx4 v28, s[44:47], s9 offen offset:2064 lds
    v_cvt_pk_bf16_f32 v174, v124, v125
    v_mfma_f32_16x16x32_bf16 v[116:119], a[220:223], v[84:87], v[116:119]
    v_cvt_pk_bf16_f32 v175, v126, v127
    v_mfma_f32_16x16x32_bf16 v[120:123], a[208:211], v[40:43], v[232:235]
    v_exp_f32 v128, v128
    v_mfma_f32_16x16x32_bf16 v[120:123], a[212:215], v[56:59], v[120:123]
    v_exp_f32 v129, v129
    v_mfma_f32_16x16x32_bf16 v[120:123], a[216:219], v[72:75], v[120:123]
    v_exp_f32 v130, v130
    v_mfma_f32_16x16x32_bf16 v[120:123], a[220:223], v[88:91], v[120:123]
    buffer_load_dwordx4 v29, s[44:47], s9 offen offset:3096 lds
    s_add_u32 s9, s9, 16384
    v_mfma_f32_16x16x32_bf16 v[124:127], a[208:211], v[44:47], v[236:239]
    s_and_b32 s9, s9, 0x1ffff
    v_mfma_f32_16x16x32_bf16 v[124:127], a[212:215], v[60:63], v[124:127]
    v_exp_f32 v131, v131
    v_mfma_f32_16x16x32_bf16 v[124:127], a[216:219], v[76:79], v[124:127]
    v_cvt_pk_bf16_f32 v176, v128, v129
    v_cvt_pk_bf16_f32 v177, v130, v131
    v_mfma_f32_16x16x32_bf16 v[124:127], a[220:223], v[92:95], v[124:127]
    s_waitcnt lgkmcnt(0)
    v_mfma_f32_16x16x32_bf16 v[128:131], a[192:195], v[32:35], v[224:227]
    ds_read_b128 a[208:211], v17 offset:19584
    ds_read_b128 a[212:215], v18 offset:19584
    v_mfma_f32_16x16x32_bf16 v[128:131], a[196:199], v[48:51], v[128:131]
    ds_read_b128 a[216:219], v19 offset:19584
    ds_read_b128 a[220:223], v20 offset:19584
    v_mfma_f32_16x16x32_bf16 v[128:131], a[200:203], v[64:67], v[128:131]
    v_exp_f32 v132, v132
    v_mfma_f32_16x16x32_bf16 v[128:131], a[204:207], v[80:83], v[128:131]
    v_exp_f32 v133, v133
    v_exp_f32 v134, v134
    v_exp_f32 v135, v135
    v_cvt_pk_bf16_f32 v180, v132, v133
    v_cvt_pk_bf16_f32 v181, v134, v135
    v_mfma_f32_16x16x32_bf16 v[132:135], a[192:195], v[36:39], v[228:231]
    v_exp_f32 v136, v136
    v_mfma_f32_16x16x32_bf16 v[132:135], a[196:199], v[52:55], v[132:135]
    v_exp_f32 v137, v137
    v_mfma_f32_16x16x32_bf16 v[132:135], a[200:203], v[68:71], v[132:135]
    v_exp_f32 v138, v138
    v_mfma_f32_16x16x32_bf16 v[132:135], a[204:207], v[84:87], v[132:135]
    v_exp_f32 v139, v139
    v_cvt_pk_bf16_f32 v184, v136, v137
    v_cvt_pk_bf16_f32 v185, v138, v139
    v_mfma_f32_16x16x32_bf16 v[136:139], a[192:195], v[40:43], v[232:235]
    v_exp_f32 v140, v140
    v_mfma_f32_16x16x32_bf16 v[136:139], a[196:199], v[56:59], v[136:139]
    v_exp_f32 v141, v141
    v_mfma_f32_16x16x32_bf16 v[136:139], a[200:203], v[72:75], v[136:139]
    v_exp_f32 v142, v142
    v_mfma_f32_16x16x32_bf16 v[136:139], a[204:207], v[88:91], v[136:139]
    v_exp_f32 v143, v143
    v_cvt_pk_bf16_f32 v188, v140, v141
    v_cvt_pk_bf16_f32 v189, v142, v143
    v_mfma_f32_16x16x32_bf16 v[140:143], a[192:195], v[44:47], v[236:239]
    v_exp_f32 v144, v144
    v_mfma_f32_16x16x32_bf16 v[140:143], a[196:199], v[60:63], v[140:143]
    v_exp_f32 v145, v145
    v_mfma_f32_16x16x32_bf16 v[140:143], a[200:203], v[76:79], v[140:143]
    v_exp_f32 v146, v146
    v_mfma_f32_16x16x32_bf16 v[140:143], a[204:207], v[92:95], v[140:143]
    v_exp_f32 v147, v147
    v_cvt_pk_bf16_f32 v178, v144, v145
    v_cvt_pk_bf16_f32 v179, v146, v147
    s_waitcnt lgkmcnt(0)
    v_mfma_f32_16x16x32_bf16 v[144:147], a[208:211], v[32:35], v[224:227]
    ds_read_b64_tr_b16 a[192:193], v21 offset:0
    ds_read_b64_tr_b16 a[194:195], v21 offset:4128
    v_mfma_f32_16x16x32_bf16 v[144:147], a[212:215], v[48:51], v[144:147]
    ds_read_b64_tr_b16 a[196:197], v21 offset:8256
    s_add_u32 m0, s63, 4128
    v_mfma_f32_16x16x32_bf16 v[144:147], a[216:219], v[64:67], v[144:147]
    ds_read_b64_tr_b16 a[198:199], v21 offset:12384
    s_add_u32 s10, s10, 393216
    v_mfma_f32_16x16x32_bf16 v[144:147], a[220:223], v[80:83], v[144:147]
    v_exp_f32 v148, v148
    v_exp_f32 v149, v149
    v_exp_f32 v150, v150
    v_exp_f32 v151, v151
    v_cvt_pk_bf16_f32 v182, v148, v149
    v_cvt_pk_bf16_f32 v183, v150, v151
    v_mfma_f32_16x16x32_bf16 v[148:151], a[208:211], v[36:39], v[228:231]
    ds_read_b64_tr_b16 a[200:201], v21 offset:8
    ds_read_b64_tr_b16 a[202:203], v21 offset:4136
    v_mfma_f32_16x16x32_bf16 v[148:151], a[212:215], v[52:55], v[148:151]
    buffer_load_dwordx4 v2, s[0:3], s10 offen offset:0 nt lds
    ds_read_b64_tr_b16 a[204:205], v21 offset:8264
    v_mfma_f32_16x16x32_bf16 v[148:151], a[216:219], v[68:71], v[148:151]
    ds_read_b64_tr_b16 a[206:207], v21 offset:12392
    v_mfma_f32_16x16x32_bf16 v[148:151], a[220:223], v[84:87], v[148:151]
    v_exp_f32 v152, v152
    v_exp_f32 v153, v153
    v_exp_f32 v154, v154
    v_exp_f32 v155, v155
    v_cvt_pk_bf16_f32 v186, v152, v153
    v_cvt_pk_bf16_f32 v187, v154, v155
    v_mfma_f32_16x16x32_bf16 v[152:155], a[208:211], v[40:43], v[232:235]
    v_exp_f32 v156, v156
    v_mfma_f32_16x16x32_bf16 v[152:155], a[212:215], v[56:59], v[152:155]
    buffer_load_dwordx4 v3, s[0:3], s10 offen offset:1032 nt lds
    v_mfma_f32_16x16x32_bf16 v[152:155], a[216:219], v[72:75], v[152:155]
    v_exp_f32 v157, v157
    v_mfma_f32_16x16x32_bf16 v[152:155], a[220:223], v[88:91], v[152:155]
    v_exp_f32 v158, v158
    v_exp_f32 v159, v159
    v_cvt_pk_bf16_f32 v190, v156, v157
    v_cvt_pk_bf16_f32 v191, v158, v159
    v_mfma_f32_16x16x32_bf16 v[156:159], a[208:211], v[44:47], v[236:239]
    v_exp_f32 v96, v96
    v_mfma_f32_16x16x32_bf16 v[156:159], a[212:215], v[60:63], v[156:159]
    v_exp_f32 v97, v97
    v_mfma_f32_16x16x32_bf16 v[156:159], a[216:219], v[76:79], v[156:159]
    buffer_load_dwordx4 v4, s[0:3], s10 offen offset:2064 nt lds
    v_mfma_f32_16x16x32_bf16 v[156:159], a[220:223], v[92:95], v[156:159]
    v_mfma_f32_16x16x32_bf16 a[224:227], a[240:243], v[160:163], 0
    v_exp_f32 v98, v98
    v_mfma_f32_16x16x32_bf16 a[224:227], a[240:243], v[176:179], a[224:227]
    v_exp_f32 v99, v99
    v_mfma_f32_16x16x32_bf16 a[228:231], a[240:243], v[164:167], 0
    v_exp_f32 v100, v100
    v_mfma_f32_16x16x32_bf16 a[228:231], a[240:243], v[180:183], a[228:231]
    buffer_load_dwordx4 v5, s[0:3], s10 offen offset:3096 nt lds
    s_mov_b32 s2, s12
    v_mfma_f32_16x16x32_bf16 a[232:235], a[240:243], v[168:171], 0
    v_exp_f32 v101, v101
    v_mfma_f32_16x16x32_bf16 a[232:235], a[240:243], v[184:187], a[232:235]
    v_exp_f32 v102, v102
    v_mfma_f32_16x16x32_bf16 a[236:239], a[240:243], v[172:175], 0
    v_exp_f32 v103, v103
    v_mfma_f32_16x16x32_bf16 a[236:239], a[240:243], v[188:191], a[236:239]
    v_exp_f32 v104, v104
    s_waitcnt lgkmcnt(0)
    v_mfma_f32_16x16x32_bf16 a[0:3], a[192:195], v[160:163], 0
    ds_read_b64_tr_b16 a[208:209], v21 offset:256
    s_lshl_b32 s100, s57, 3
    v_mfma_f32_16x16x32_bf16 a[0:3], a[196:199], v[176:179], a[0:3]
    ds_read_b64_tr_b16 a[210:211], v21 offset:4384
    s_add_u32 s100, s100, s56
    v_mfma_f32_16x16x32_bf16 a[4:7], a[192:195], v[164:167], 0
    ds_read_b64_tr_b16 a[212:213], v21 offset:8512
    s_lshl_b32 s100, s100, 7
    v_mfma_f32_16x16x32_bf16 a[4:7], a[196:199], v[180:183], a[4:7]
    ds_read_b64_tr_b16 a[214:215], v21 offset:12640
    s_add_u32 s100, s100, 1048576
    v_mfma_f32_16x16x32_bf16 a[8:11], a[192:195], v[168:171], 0
    ds_read_b64_tr_b16 a[216:217], v21 offset:264
    s_lshl_b32 s101, s58, 3
    v_mfma_f32_16x16x32_bf16 a[8:11], a[196:199], v[184:187], a[8:11]
    ds_read_b64_tr_b16 a[218:219], v21 offset:4392
    s_add_u32 s101, s101, s59
    v_mfma_f32_16x16x32_bf16 a[12:15], a[192:195], v[172:175], 0
    ds_read_b64_tr_b16 a[220:221], v21 offset:8520
    v_cvt_pk_bf16_f32 v192, v96, v97
    v_mfma_f32_16x16x32_bf16 a[12:15], a[196:199], v[188:191], a[12:15]
    ds_read_b64_tr_b16 a[222:223], v21 offset:12648
    v_cvt_pk_bf16_f32 v193, v98, v99
    v_mfma_f32_16x16x32_bf16 a[16:19], a[200:203], v[160:163], 0
    v_exp_f32 v105, v105
    v_mfma_f32_16x16x32_bf16 a[16:19], a[204:207], v[176:179], a[16:19]
    v_exp_f32 v106, v106
    v_mfma_f32_16x16x32_bf16 a[20:23], a[200:203], v[164:167], 0
    v_exp_f32 v107, v107
    v_mfma_f32_16x16x32_bf16 a[20:23], a[204:207], v[180:183], a[20:23]
    v_exp_f32 v108, v108
    v_mfma_f32_16x16x32_bf16 a[24:27], a[200:203], v[168:171], 0
    v_exp_f32 v109, v109
    v_mfma_f32_16x16x32_bf16 a[24:27], a[204:207], v[184:187], a[24:27]
    v_exp_f32 v110, v110
    v_mfma_f32_16x16x32_bf16 a[28:31], a[200:203], v[172:175], 0
    v_exp_f32 v111, v111
    v_mfma_f32_16x16x32_bf16 a[28:31], a[204:207], v[188:191], a[28:31]
    v_cvt_pk_bf16_f32 v196, v100, v101
    s_waitcnt lgkmcnt(0)
    v_mfma_f32_16x16x32_bf16 a[32:35], a[208:211], v[160:163], 0
    ds_read_b64_tr_b16 a[192:193], v21 offset:512
    v_cvt_pk_bf16_f32 v197, v102, v103
    v_mfma_f32_16x16x32_bf16 a[32:35], a[212:215], v[176:179], a[32:35]
    ds_read_b64_tr_b16 a[194:195], v21 offset:4640
    s_lshl_b32 s101, s101, 7
    v_mfma_f32_16x16x32_bf16 a[36:39], a[208:211], v[164:167], 0
    ds_read_b64_tr_b16 a[196:197], v21 offset:8768
    v_cvt_pk_bf16_f32 v200, v104, v105
    v_mfma_f32_16x16x32_bf16 a[36:39], a[212:215], v[180:183], a[36:39]
    ds_read_b64_tr_b16 a[198:199], v21 offset:12896
    v_cvt_pk_bf16_f32 v201, v106, v107
    v_mfma_f32_16x16x32_bf16 a[40:43], a[208:211], v[168:171], 0
    ds_read_b64_tr_b16 a[200:201], v21 offset:520
    v_cvt_pk_bf16_f32 v204, v108, v109
    v_mfma_f32_16x16x32_bf16 a[40:43], a[212:215], v[184:187], a[40:43]
    ds_read_b64_tr_b16 a[202:203], v21 offset:4648
    v_cvt_pk_bf16_f32 v205, v110, v111
    v_mfma_f32_16x16x32_bf16 a[44:47], a[208:211], v[172:175], 0
    ds_read_b64_tr_b16 a[204:205], v21 offset:8776
    s_add_u32 s101, s101, 130944
    v_mfma_f32_16x16x32_bf16 a[44:47], a[212:215], v[188:191], a[44:47]
    ds_read_b64_tr_b16 a[206:207], v21 offset:12904
    v_lshlrev_b32 v253, 2, v1
    v_mfma_f32_16x16x32_bf16 a[48:51], a[216:219], v[160:163], 0
    v_exp_f32 v112, v112
    v_mfma_f32_16x16x32_bf16 a[48:51], a[220:223], v[176:179], a[48:51]
    v_exp_f32 v113, v113
    v_mfma_f32_16x16x32_bf16 a[52:55], a[216:219], v[164:167], 0
    v_exp_f32 v114, v114
    v_mfma_f32_16x16x32_bf16 a[52:55], a[220:223], v[180:183], a[52:55]
    v_exp_f32 v115, v115
    v_mfma_f32_16x16x32_bf16 a[56:59], a[216:219], v[168:171], 0
    v_exp_f32 v116, v116
    v_mfma_f32_16x16x32_bf16 a[56:59], a[220:223], v[184:187], a[56:59]
    v_exp_f32 v117, v117
    v_mfma_f32_16x16x32_bf16 a[60:63], a[216:219], v[172:175], 0
    v_exp_f32 v118, v118
    v_mfma_f32_16x16x32_bf16 a[60:63], a[220:223], v[188:191], a[60:63]
    v_cvt_pk_bf16_f32 v194, v112, v113
    s_waitcnt lgkmcnt(0)
    v_mfma_f32_16x16x32_bf16 a[64:67], a[192:195], v[160:163], 0
    ds_read_b64_tr_b16 a[208:209], v21 offset:768
    v_cvt_pk_bf16_f32 v195, v114, v115
    v_mfma_f32_16x16x32_bf16 a[64:67], a[196:199], v[176:179], a[64:67]
    ds_read_b64_tr_b16 a[210:211], v21 offset:4896
    v_add_u32 v254, s100, v253
    v_mfma_f32_16x16x32_bf16 a[68:71], a[192:195], v[164:167], 0
    ds_read_b64_tr_b16 a[212:213], v21 offset:9024
    v_add_u32 v253, s101, v253
    v_mfma_f32_16x16x32_bf16 a[68:71], a[196:199], v[180:183], a[68:71]
    ds_read_b64_tr_b16 a[214:215], v21 offset:13152
    v_cmp_le_u32 vcc, 32, v1
    s_nop 1
    v_cndmask_b32 v254, v254, v253, vcc
    v_mfma_f32_16x16x32_bf16 a[72:75], a[192:195], v[168:171], 0
    ds_read_b64_tr_b16 a[216:217], v21 offset:776
    s_not_b32 s100, s34
    v_mfma_f32_16x16x32_bf16 a[72:75], a[196:199], v[184:187], a[72:75]
    ds_read_b64_tr_b16 a[218:219], v21 offset:4904
    v_mov_b32 v255, s100
    v_mfma_f32_16x16x32_bf16 a[76:79], a[192:195], v[172:175], 0
    ds_read_b64_tr_b16 a[220:221], v21 offset:9032
    ds_read_b64_tr_b16 a[222:223], v21 offset:13160
    v_mfma_f32_16x16x32_bf16 a[76:79], a[196:199], v[188:191], a[76:79]
    v_exp_f32 v119, v119
    v_mfma_f32_16x16x32_bf16 a[80:83], a[200:203], v[160:163], 0
    v_exp_f32 v120, v120
    v_mfma_f32_16x16x32_bf16 a[80:83], a[204:207], v[176:179], a[80:83]
    v_exp_f32 v121, v121
    v_mfma_f32_16x16x32_bf16 a[84:87], a[200:203], v[164:167], 0
    v_exp_f32 v122, v122
    v_mfma_f32_16x16x32_bf16 a[84:87], a[204:207], v[180:183], a[84:87]
    v_exp_f32 v123, v123
    v_mfma_f32_16x16x32_bf16 a[88:91], a[200:203], v[168:171], 0
    v_exp_f32 v124, v124
    v_mfma_f32_16x16x32_bf16 a[88:91], a[204:207], v[184:187], a[88:91]
    v_exp_f32 v125, v125
    v_mfma_f32_16x16x32_bf16 a[92:95], a[200:203], v[172:175], 0
    v_exp_f32 v126, v126
    v_mfma_f32_16x16x32_bf16 a[92:95], a[204:207], v[188:191], a[92:95]
    v_cvt_pk_bf16_f32 v198, v116, v117
    s_waitcnt lgkmcnt(0)
    v_mfma_f32_16x16x32_bf16 a[96:99], a[208:211], v[160:163], 0
    v_exp_f32 v127, v127
    v_mfma_f32_16x16x32_bf16 a[96:99], a[212:215], v[176:179], a[96:99]
    s_waitcnt vmcnt(4)
    s_barrier
    v_cvt_pk_bf16_f32 v199, v118, v119
    v_mfma_f32_16x16x32_bf16 a[100:103], a[208:211], v[164:167], 0
    ds_read_b128 a[192:195], v17 offset:0
    v_cvt_pk_bf16_f32 v202, v120, v121
    v_mfma_f32_16x16x32_bf16 a[100:103], a[212:215], v[180:183], a[100:103]
    ds_read_b128 a[196:199], v18 offset:0
    v_cvt_pk_bf16_f32 v203, v122, v123
    v_mfma_f32_16x16x32_bf16 a[104:107], a[208:211], v[168:171], 0
    ds_read_b128 a[200:203], v19 offset:0
    v_cvt_pk_bf16_f32 v206, v124, v125
    v_mfma_f32_16x16x32_bf16 a[104:107], a[212:215], v[184:187], a[104:107]
    ds_read_b128 a[204:207], v20 offset:0
    s_add_u32 m0, s6, 16512
    v_mfma_f32_16x16x32_bf16 a[108:111], a[208:211], v[172:175], 0
    v_exp_f32 v128, v128
    v_mfma_f32_16x16x32_bf16 a[108:111], a[212:215], v[188:191], a[108:111]
    v_exp_f32 v129, v129
    v_mfma_f32_16x16x32_bf16 a[112:115], a[216:219], v[160:163], 0
    buffer_load_dwordx4 v22, s[40:43], s8 offen offset:0 lds
    v_cvt_pk_bf16_f32 v207, v126, v127
    v_mfma_f32_16x16x32_bf16 a[112:115], a[220:223], v[176:179], a[112:115]
    v_exp_f32 v130, v130
    v_mfma_f32_16x16x32_bf16 a[116:119], a[216:219], v[164:167], 0
    v_exp_f32 v131, v131
    v_mfma_f32_16x16x32_bf16 a[116:119], a[220:223], v[180:183], a[116:119]
    v_exp_f32 v132, v132
    v_mfma_f32_16x16x32_bf16 a[120:123], a[216:219], v[168:171], 0
    v_exp_f32 v133, v133
    v_mfma_f32_16x16x32_bf16 a[120:123], a[220:223], v[184:187], a[120:123]
    buffer_load_dwordx4 v23, s[40:43], s8 offen offset:1024 lds
    v_cvt_pk_bf16_f32 v208, v128, v129
    v_mfma_f32_16x16x32_bf16 a[124:127], a[216:219], v[172:175], 0
    v_exp_f32 v134, v134
    v_mfma_f32_16x16x32_bf16 a[124:127], a[220:223], v[188:191], a[124:127]
    v_cvt_pk_bf16_f32 v209, v130, v131
    s_waitcnt lgkmcnt(0)
    v_mfma_f32_16x16x32_bf16 v[96:99], a[192:195], v[32:35], v[224:227]
    ds_read_b128 a[208:211], v17 offset:1024
    ds_read_b128 a[212:215], v18 offset:1024
    v_mfma_f32_16x16x32_bf16 v[96:99], a[196:199], v[48:51], v[96:99]
    ds_read_b128 a[216:219], v19 offset:1024
    ds_read_b128 a[220:223], v20 offset:1024
    v_mfma_f32_16x16x32_bf16 v[96:99], a[200:203], v[64:67], v[96:99]
    buffer_load_dwordx4 v24, s[40:43], s8 offen offset:2048 lds
    v_mfma_f32_16x16x32_bf16 v[96:99], a[204:207], v[80:83], v[96:99]
    v_exp_f32 v135, v135
    v_mfma_f32_16x16x32_bf16 v[100:103], a[192:195], v[36:39], v[228:231]
    v_exp_f32 v136, v136
    v_mfma_f32_16x16x32_bf16 v[100:103], a[196:199], v[52:55], v[100:103]
    v_exp_f32 v137, v137
    v_mfma_f32_16x16x32_bf16 v[100:103], a[200:203], v[68:71], v[100:103]
    v_exp_f32 v138, v138
    v_mfma_f32_16x16x32_bf16 v[100:103], a[204:207], v[84:87], v[100:103]
    buffer_load_dwordx4 v25, s[40:43], s8 offen offset:3072 lds
    s_add_u32 s8, s8, 16384
    v_mfma_f32_16x16x32_bf16 v[104:107], a[192:195], v[40:43], v[232:235]
    s_and_b32 s8, s8, 0x1ffff
    v_cvt_pk_bf16_f32 v212, v132, v133
    v_mfma_f32_16x16x32_bf16 v[104:107], a[196:199], v[56:59], v[104:107]
    s_add_u32 m0, s7, 0
    v_cvt_pk_bf16_f32 v213, v134, v135
    v_mfma_f32_16x16x32_bf16 v[104:107], a[200:203], v[72:75], v[104:107]
    v_exp_f32 v139, v139
    v_mfma_f32_16x16x32_bf16 v[104:107], a[204:207], v[88:91], v[104:107]
    v_exp_f32 v140, v140
    v_mfma_f32_16x16x32_bf16 v[108:111], a[192:195], v[44:47], v[236:239]
    buffer_load_dwordx4 v26, s[44:47], s9 offen offset:0 lds
    v_cvt_pk_bf16_f32 v216, v136, v137
    v_mfma_f32_16x16x32_bf16 v[108:111], a[196:199], v[60:63], v[108:111]
    v_exp_f32 v141, v141
    v_mfma_f32_16x16x32_bf16 v[108:111], a[200:203], v[76:79], v[108:111]
    v_exp_f32 v142, v142
    v_mfma_f32_16x16x32_bf16 v[108:111], a[204:207], v[92:95], v[108:111]
    v_cvt_pk_bf16_f32 v217, v138, v139
    s_waitcnt lgkmcnt(0)
    v_mfma_f32_16x16x32_bf16 v[112:115], a[208:211], v[32:35], v[224:227]
    ds_read_b128 a[192:195], v17 offset:2048
    ds_read_b128 a[196:199], v18 offset:2048
    v_mfma_f32_16x16x32_bf16 v[112:115], a[212:215], v[48:51], v[112:115]
    buffer_load_dwordx4 v27, s[44:47], s9 offen offset:1032 lds
    ds_read_b128 a[200:203], v19 offset:2048
    v_mfma_f32_16x16x32_bf16 v[112:115], a[216:219], v[64:67], v[112:115]
    ds_read_b128 a[204:207], v20 offset:2048
    v_mfma_f32_16x16x32_bf16 v[112:115], a[220:223], v[80:83], v[112:115]
    v_exp_f32 v143, v143
    v_mfma_f32_16x16x32_bf16 v[116:119], a[208:211], v[36:39], v[228:231]
    v_exp_f32 v144, v144
    v_mfma_f32_16x16x32_bf16 v[116:119], a[212:215], v[52:55], v[116:119]
    v_exp_f32 v145, v145
    v_mfma_f32_16x16x32_bf16 v[116:119], a[216:219], v[68:71], v[116:119]
    buffer_load_dwordx4 v28, s[44:47], s9 offen offset:2064 lds
    v_cvt_pk_bf16_f32 v220, v140, v141
    v_mfma_f32_16x16x32_bf16 v[116:119], a[220:223], v[84:87], v[116:119]
    v_exp_f32 v146, v146
    v_mfma_f32_16x16x32_bf16 v[120:123], a[208:211], v[40:43], v[232:235]
    v_exp_f32 v147, v147
    v_mfma_f32_16x16x32_bf16 v[120:123], a[212:215], v[56:59], v[120:123]
    v_exp_f32 v148, v148
    v_mfma_f32_16x16x32_bf16 v[120:123], a[216:219], v[72:75], v[120:123]
    v_exp_f32 v149, v149
    v_mfma_f32_16x16x32_bf16 v[120:123], a[220:223], v[88:91], v[120:123]
    buffer_load_dwordx4 v29, s[44:47], s9 offen offset:3096 lds
    s_add_u32 s9, s9, 16384
    v_mfma_f32_16x16x32_bf16 v[124:127], a[208:211], v[44:47], v[236:239]
    s_and_b32 s9, s9, 0x1ffff
    v_cvt_pk_bf16_f32 v221, v142, v143
    v_mfma_f32_16x16x32_bf16 v[124:127], a[212:215], v[60:63], v[124:127]
    s_add_u32 m0, s63, 8256
    s_add_u32 s60, s92, s94
    v_mfma_f32_16x16x32_bf16 v[124:127], a[216:219], v[76:79], v[124:127]
    v_exp_f32 v150, v150
    v_mfma_f32_16x16x32_bf16 v[124:127], a[220:223], v[92:95], v[124:127]
    v_cvt_pk_bf16_f32 v210, v144, v145
    s_waitcnt lgkmcnt(0)
    v_mfma_f32_16x16x32_bf16 v[128:131], a[192:195], v[32:35], v[224:227]
    buffer_load_dwordx4 v11, s[36:39], s60 offen offset:0 lds
    v_cvt_pk_bf16_f32 v211, v146, v147
    v_mfma_f32_16x16x32_bf16 v[128:131], a[196:199], v[48:51], v[128:131]
    ds_read_b128 a[208:211], v17 offset:3072
    ds_read_b128 a[212:215], v18 offset:3072
    v_mfma_f32_16x16x32_bf16 v[128:131], a[200:203], v[64:67], v[128:131]
    ds_read_b128 a[216:219], v19 offset:3072
    ds_read_b128 a[220:223], v20 offset:3072
    v_mfma_f32_16x16x32_bf16 v[128:131], a[204:207], v[80:83], v[128:131]
    v_exp_f32 v151, v151
    v_mfma_f32_16x16x32_bf16 v[132:135], a[192:195], v[36:39], v[228:231]
    v_exp_f32 v152, v152
    v_mfma_f32_16x16x32_bf16 v[132:135], a[196:199], v[52:55], v[132:135]
    buffer_load_dwordx4 v12, s[36:39], s60 offen offset:1032 lds
    v_cvt_pk_bf16_f32 v214, v148, v149
    v_mfma_f32_16x16x32_bf16 v[132:135], a[200:203], v[68:71], v[132:135]
    v_exp_f32 v153, v153
    v_mfma_f32_16x16x32_bf16 v[132:135], a[204:207], v[84:87], v[132:135]
    v_exp_f32 v154, v154
    v_mfma_f32_16x16x32_bf16 v[136:139], a[192:195], v[40:43], v[232:235]
    v_exp_f32 v155, v155
    v_mfma_f32_16x16x32_bf16 v[136:139], a[196:199], v[56:59], v[136:139]
    v_exp_f32 v156, v156
    v_mfma_f32_16x16x32_bf16 v[136:139], a[200:203], v[72:75], v[136:139]
    buffer_load_dwordx4 v13, s[36:39], s60 offen offset:2064 lds
    v_cvt_pk_bf16_f32 v215, v150, v151
    v_mfma_f32_16x16x32_bf16 v[136:139], a[204:207], v[88:91], v[136:139]
    v_exp_f32 v157, v157
    v_mfma_f32_16x16x32_bf16 v[140:143], a[192:195], v[44:47], v[236:239]
    v_exp_f32 v158, v158
    v_mfma_f32_16x16x32_bf16 v[140:143], a[196:199], v[60:63], v[140:143]
    v_exp_f32 v159, v159
    v_mfma_f32_16x16x32_bf16 v[140:143], a[200:203], v[76:79], v[140:143]
    v_exp_f32 v96, v96
    v_mfma_f32_16x16x32_bf16 v[140:143], a[204:207], v[92:95], v[140:143]
    buffer_load_dwordx4 v14, s[36:39], s60 offen offset:3096 lds
    s_waitcnt lgkmcnt(0)
    v_mfma_f32_16x16x32_bf16 v[144:147], a[208:211], v[32:35], v[224:227]
    ds_read_b64_tr_b16 a[192:193], v21 offset:16512
    s_add_u32 s94, s94, 0x20000
    v_mfma_f32_16x16x32_bf16 v[144:147], a[212:215], v[48:51], v[144:147]
    s_and_b32 s94, s94, 0x7ffff
    v_accvgpr_write_b32 a248, -1
    v_mfma_f32_16x16x32_bf16 v[144:147], a[216:219], v[64:67], v[144:147]
    ds_read_b64_tr_b16 a[194:195], v21 offset:20640
    v_accvgpr_write_b32 a249, -1
    v_mfma_f32_16x16x32_bf16 v[144:147], a[220:223], v[80:83], v[144:147]
    ds_read_b64_tr_b16 a[196:197], v21 offset:24768
    v_accvgpr_write_b32 a250, -1
    v_mfma_f32_16x16x32_bf16 v[148:151], a[208:211], v[36:39], v[228:231]
    ds_read_b64_tr_b16 a[198:199], v21 offset:28896
    v_accvgpr_write_b32 a251, -1
    s_lshl_b32 s10, s58, 3
    s_add_u32 s10, s10, s59
    s_lshl_b32 s10, s10, 3
    s_add_u32 s10, s10, s35
    s_mul_i32 s10, s10, 5120
    s_add_u32 s10, s10, 6291456
    s_cmp_eq_u32 s59, 9
    s_cselect_b32 s10, 268435456, s10
    v_mfma_f32_16x16x32_bf16 v[148:151], a[212:215], v[52:55], v[148:151]
    ds_read_b64_tr_b16 a[200:201], v21 offset:16520
    v_cvt_pk_bf16_f32 v218, v152, v153
    v_mfma_f32_16x16x32_bf16 v[148:151], a[216:219], v[68:71], v[148:151]
    buffer_store_dwordx4 a[248:251], v16, s[48:51], s10 offen offset:0 sc1
    ds_read_b64_tr_b16 a[202:203], v21 offset:20648
    v_mfma_f32_16x16x32_bf16 v[148:151], a[220:223], v[84:87], v[148:151]
    ds_read_b64_tr_b16 a[204:205], v21 offset:24776
    v_cvt_pk_bf16_f32 v219, v154, v155
    v_mfma_f32_16x16x32_bf16 v[152:155], a[208:211], v[40:43], v[232:235]
    ds_read_b64_tr_b16 a[206:207], v21 offset:28904
    v_cvt_pk_bf16_f32 v222, v156, v157
    v_mfma_f32_16x16x32_bf16 v[152:155], a[212:215], v[56:59], v[152:155]
    buffer_store_dwordx4 a[248:251], v16, s[48:51], s10 offen offset:1024 sc1
    v_cvt_pk_bf16_f32 v223, v158, v159
    v_mfma_f32_16x16x32_bf16 v[152:155], a[216:219], v[72:75], v[152:155]
    v_exp_f32 v97, v97
    v_mfma_f32_16x16x32_bf16 v[152:155], a[220:223], v[88:91], v[152:155]
    v_exp_f32 v98, v98
    v_mfma_f32_16x16x32_bf16 v[156:159], a[208:211], v[44:47], v[236:239]
    v_exp_f32 v99, v99
    v_mfma_f32_16x16x32_bf16 v[156:159], a[212:215], v[60:63], v[156:159]
    v_exp_f32 v100, v100
    v_mfma_f32_16x16x32_bf16 v[156:159], a[216:219], v[76:79], v[156:159]
    buffer_store_dwordx4 a[248:251], v16, s[48:51], s10 offen offset:2048 sc1
    v_cvt_pk_bf16_f32 v160, v96, v97
    v_mfma_f32_16x16x32_bf16 v[156:159], a[220:223], v[92:95], v[156:159]
    v_cvt_pk_bf16_f32 v161, v98, v99
    v_mfma_f32_16x16x32_bf16 a[224:227], a[240:243], v[192:195], a[224:227]
    v_exp_f32 v101, v101
    v_mfma_f32_16x16x32_bf16 a[224:227], a[240:243], v[208:211], a[224:227]
    v_exp_f32 v102, v102
    v_mfma_f32_16x16x32_bf16 a[228:231], a[240:243], v[196:199], a[228:231]
    v_exp_f32 v103, v103
    v_mfma_f32_16x16x32_bf16 a[228:231], a[240:243], v[212:215], a[228:231]
    v_exp_f32 v104, v104
    v_mfma_f32_16x16x32_bf16 a[232:235], a[240:243], v[200:203], a[232:235]
    v_exp_f32 v105, v105
    v_mfma_f32_16x16x32_bf16 a[232:235], a[240:243], v[216:219], a[232:235]
    v_exp_f32 v106, v106
    v_mfma_f32_16x16x32_bf16 a[236:239], a[240:243], v[204:207], a[236:239]
    v_exp_f32 v107, v107
    v_mfma_f32_16x16x32_bf16 a[236:239], a[240:243], v[220:223], a[236:239]
    v_exp_f32 v108, v108
    s_waitcnt lgkmcnt(0)
    v_mfma_f32_16x16x32_bf16 a[0:3], a[192:195], v[192:195], a[0:3]
    ds_read_b64_tr_b16 a[208:209], v21 offset:16768
    v_cvt_pk_bf16_f32 v164, v100, v101
    v_mfma_f32_16x16x32_bf16 a[0:3], a[196:199], v[208:211], a[0:3]
    ds_read_b64_tr_b16 a[210:211], v21 offset:20896
    v_cvt_pk_bf16_f32 v165, v102, v103
    v_mfma_f32_16x16x32_bf16 a[4:7], a[192:195], v[196:199], a[4:7]
    ds_read_b64_tr_b16 a[212:213], v21 offset:25024
    v_cvt_pk_bf16_f32 v168, v104, v105
    v_mfma_f32_16x16x32_bf16 a[4:7], a[196:199], v[212:215], a[4:7]
    ds_read_b64_tr_b16 a[214:215], v21 offset:29152
    v_cvt_pk_bf16_f32 v169, v106, v107
    v_mfma_f32_16x16x32_bf16 a[8:11], a[192:195], v[200:203], a[8:11]
    ds_read_b64_tr_b16 a[216:217], v21 offset:16776
    ds_read_b64_tr_b16 a[218:219], v21 offset:20904
    v_mfma_f32_16x16x32_bf16 a[8:11], a[196:199], v[216:219], a[8:11]
    ds_read_b64_tr_b16 a[220:221], v21 offset:25032
    ds_read_b64_tr_b16 a[222:223], v21 offset:29160
    v_mfma_f32_16x16x32_bf16 a[12:15], a[192:195], v[204:207], a[12:15]
    v_exp_f32 v109, v109
    v_mfma_f32_16x16x32_bf16 a[12:15], a[196:199], v[220:223], a[12:15]
    v_exp_f32 v110, v110
    v_mfma_f32_16x16x32_bf16 a[16:19], a[200:203], v[192:195], a[16:19]
    v_exp_f32 v111, v111
    v_mfma_f32_16x16x32_bf16 a[16:19], a[204:207], v[208:211], a[16:19]
    v_exp_f32 v112, v112
    v_mfma_f32_16x16x32_bf16 a[20:23], a[200:203], v[196:199], a[20:23]
    v_exp_f32 v113, v113
    v_mfma_f32_16x16x32_bf16 a[20:23], a[204:207], v[212:215], a[20:23]
    v_exp_f32 v114, v114
    v_mfma_f32_16x16x32_bf16 a[24:27], a[200:203], v[200:203], a[24:27]
    v_exp_f32 v115, v115
    v_mfma_f32_16x16x32_bf16 a[24:27], a[204:207], v[216:219], a[24:27]
    v_exp_f32 v116, v116
    v_mfma_f32_16x16x32_bf16 a[28:31], a[200:203], v[204:207], a[28:31]
L_stub5:
    s_cbranch_execz L_stub9
    v_exp_f32 v117, v117
    v_mfma_f32_16x16x32_bf16 a[28:31], a[204:207], v[220:223], a[28:31]
    v_cvt_pk_bf16_f32 v172, v108, v109
    s_waitcnt lgkmcnt(0)
    v_mfma_f32_16x16x32_bf16 a[32:35], a[208:211], v[192:195], a[32:35]
    ds_read_b64_tr_b16 a[192:193], v21 offset:17024
    v_cvt_pk_bf16_f32 v173, v110, v111
    v_mfma_f32_16x16x32_bf16 a[32:35], a[212:215], v[208:211], a[32:35]
    ds_read_b64_tr_b16 a[194:195], v21 offset:21152
    v_cvt_pk_bf16_f32 v162, v112, v113
    v_mfma_f32_16x16x32_bf16 a[36:39], a[208:211], v[196:199], a[36:39]
    ds_read_b64_tr_b16 a[196:197], v21 offset:25280
    v_cvt_pk_bf16_f32 v163, v114, v115
    v_mfma_f32_16x16x32_bf16 a[36:39], a[212:215], v[212:215], a[36:39]
    ds_read_b64_tr_b16 a[198:199], v21 offset:29408
    ds_read_b64_tr_b16 a[200:201], v21 offset:17032
    v_mfma_f32_16x16x32_bf16 a[40:43], a[208:211], v[200:203], a[40:43]
    ds_read_b64_tr_b16 a[202:203], v21 offset:21160
    ds_read_b64_tr_b16 a[204:205], v21 offset:25288
    v_mfma_f32_16x16x32_bf16 a[40:43], a[212:215], v[216:219], a[40:43]
    ds_read_b64_tr_b16 a[206:207], v21 offset:29416
    v_mfma_f32_16x16x32_bf16 a[44:47], a[208:211], v[204:207], a[44:47]
    v_exp_f32 v118, v118
    v_mfma_f32_16x16x32_bf16 a[44:47], a[212:215], v[220:223], a[44:47]
    v_exp_f32 v119, v119
    v_mfma_f32_16x16x32_bf16 a[48:51], a[216:219], v[192:195], a[48:51]
    v_exp_f32 v120, v120
    v_mfma_f32_16x16x32_bf16 a[48:51], a[220:223], v[208:211], a[48:51]
    buffer_store_dword v255, v254, s[48:51], s11 offen sc1
    v_cvt_pk_bf16_f32 v166, v116, v117
    v_mfma_f32_16x16x32_bf16 a[52:55], a[216:219], v[196:199], a[52:55]
    v_exp_f32 v121, v121
    v_mfma_f32_16x16x32_bf16 a[52:55], a[220:223], v[212:215], a[52:55]
    v_exp_f32 v122, v122
    v_mfma_f32_16x16x32_bf16 a[56:59], a[216:219], v[200:203], a[56:59]
    v_exp_f32 v123, v123
    v_mfma_f32_16x16x32_bf16 a[56:59], a[220:223], v[216:219], a[56:59]
    v_exp_f32 v124, v124
    v_mfma_f32_16x16x32_bf16 a[60:63], a[216:219], v[204:207], a[60:63]
    v_exp_f32 v125, v125
    v_mfma_f32_16x16x32_bf16 a[60:63], a[220:223], v[220:223], a[60:63]
    v_add_u32 v254, 131072, v254
    s_waitcnt lgkmcnt(0)
    v_mfma_f32_16x16x32_bf16 a[64:67], a[192:195], v[192:195], a[64:67]
    ds_read_b64_tr_b16 a[208:209], v21 offset:17280
    v_cvt_pk_bf16_f32 v167, v118, v119
    v_mfma_f32_16x16x32_bf16 a[64:67], a[196:199], v[208:211], a[64:67]
    ds_read_b64_tr_b16 a[210:211], v21 offset:21408
    v_cvt_pk_bf16_f32 v170, v120, v121
    v_mfma_f32_16x16x32_bf16 a[68:71], a[192:195], v[196:199], a[68:71]
    ds_read_b64_tr_b16 a[212:213], v21 offset:25536
    v_cvt_pk_bf16_f32 v171, v122, v123
    v_mfma_f32_16x16x32_bf16 a[68:71], a[196:199], v[212:215], a[68:71]
    ds_read_b64_tr_b16 a[214:215], v21 offset:29664
    ds_read_b64_tr_b16 a[216:217], v21 offset:17288
    v_mfma_f32_16x16x32_bf16 a[72:75], a[192:195], v[200:203], a[72:75]
    ds_read_b64_tr_b16 a[218:219], v21 offset:21416
    ds_read_b64_tr_b16 a[220:221], v21 offset:25544
    v_mfma_f32_16x16x32_bf16 a[72:75], a[196:199], v[216:219], a[72:75]
    ds_read_b64_tr_b16 a[222:223], v21 offset:29672
    v_mfma_f32_16x16x32_bf16 a[76:79], a[192:195], v[204:207], a[76:79]
    v_exp_f32 v126, v126
    v_mfma_f32_16x16x32_bf16 a[76:79], a[196:199], v[220:223], a[76:79]
    v_exp_f32 v127, v127
    v_mfma_f32_16x16x32_bf16 a[80:83], a[200:203], v[192:195], a[80:83]
    v_exp_f32 v128, v128
    v_mfma_f32_16x16x32_bf16 a[80:83], a[204:207], v[208:211], a[80:83]
    buffer_store_dword v255, v254, s[48:51], s11 offen sc1
    v_cvt_pk_bf16_f32 v174, v124, v125
    v_mfma_f32_16x16x32_bf16 a[84:87], a[200:203], v[196:199], a[84:87]
    v_exp_f32 v129, v129
    v_mfma_f32_16x16x32_bf16 a[84:87], a[204:207], v[212:215], a[84:87]
    v_exp_f32 v130, v130
    v_mfma_f32_16x16x32_bf16 a[88:91], a[200:203], v[200:203], a[88:91]
    v_exp_f32 v131, v131
    v_mfma_f32_16x16x32_bf16 a[88:91], a[204:207], v[216:219], a[88:91]
    v_exp_f32 v132, v132
    v_mfma_f32_16x16x32_bf16 a[92:95], a[200:203], v[204:207], a[92:95]
    v_exp_f32 v133, v133
    v_mfma_f32_16x16x32_bf16 a[92:95], a[204:207], v[220:223], a[92:95]
    v_cvt_pk_bf16_f32 v175, v126, v127
    s_waitcnt lgkmcnt(0)
    v_mfma_f32_16x16x32_bf16 a[96:99], a[208:211], v[192:195], a[96:99]
    v_exp_f32 v134, v134
    v_mfma_f32_16x16x32_bf16 a[96:99], a[212:215], v[208:211], a[96:99]
    s_waitcnt vmcnt(9)
    s_barrier
    v_cvt_pk_bf16_f32 v176, v128, v129
    v_mfma_f32_16x16x32_bf16 a[100:103], a[208:211], v[196:199], a[100:103]
    ds_read_b128 a[192:195], v17 offset:16512
    v_cvt_pk_bf16_f32 v177, v130, v131
    v_mfma_f32_16x16x32_bf16 a[100:103], a[212:215], v[212:215], a[100:103]
    ds_read_b128 a[196:199], v18 offset:16512
    ds_read_b128 a[200:203], v19 offset:16512
    v_mfma_f32_16x16x32_bf16 a[104:107], a[208:211], v[200:203], a[104:107]
    ds_read_b128 a[204:207], v20 offset:16512
    v_mfma_f32_16x16x32_bf16 a[104:107], a[212:215], v[216:219], a[104:107]
    s_add_u32 m0, s6, 0
    v_mfma_f32_16x16x32_bf16 a[108:111], a[208:211], v[204:207], a[108:111]
    v_exp_f32 v135, v135
    v_mfma_f32_16x16x32_bf16 a[108:111], a[212:215], v[220:223], a[108:111]
    v_exp_f32 v136, v136
    v_mfma_f32_16x16x32_bf16 a[112:115], a[216:219], v[192:195], a[112:115]
    buffer_load_dwordx4 v22, s[40:43], s8 offen offset:0 lds
    v_cvt_pk_bf16_f32 v180, v132, v133
    v_mfma_f32_16x16x32_bf16 a[112:115], a[220:223], v[208:211], a[112:115]
    v_exp_f32 v137, v137
    v_mfma_f32_16x16x32_bf16 a[116:119], a[216:219], v[196:199], a[116:119]
    v_exp_f32 v138, v138
    v_mfma_f32_16x16x32_bf16 a[116:119], a[220:223], v[212:215], a[116:119]
    v_exp_f32 v139, v139
    v_mfma_f32_16x16x32_bf16 a[120:123], a[216:219], v[200:203], a[120:123]
    v_exp_f32 v140, v140
    v_mfma_f32_16x16x32_bf16 a[120:123], a[220:223], v[216:219], a[120:123]
    buffer_load_dwordx4 v23, s[40:43], s8 offen offset:1024 lds
    v_cvt_pk_bf16_f32 v181, v134, v135
    v_mfma_f32_16x16x32_bf16 a[124:127], a[216:219], v[204:207], a[124:127]
    v_exp_f32 v141, v141
    v_mfma_f32_16x16x32_bf16 a[124:127], a[220:223], v[220:223], a[124:127]
    v_cvt_pk_bf16_f32 v184, v136, v137
    s_waitcnt lgkmcnt(0)
    v_mfma_f32_16x16x32_bf16 v[96:99], a[192:195], v[32:35], v[224:227]
    ds_read_b128 a[208:211], v17 offset:17536
    v_cvt_pk_bf16_f32 v185, v138, v139
    v_mfma_f32_16x16x32_bf16 v[96:99], a[196:199], v[48:51], v[96:99]
    ds_read_b128 a[212:215], v18 offset:17536
    ds_read_b128 a[216:219], v19 offset:17536
    v_mfma_f32_16x16x32_bf16 v[96:99], a[200:203], v[64:67], v[96:99]
    buffer_load_dwordx4 v24, s[40:43], s8 offen offset:2048 lds
    ds_read_b128 a[220:223], v20 offset:17536
    v_mfma_f32_16x16x32_bf16 v[96:99], a[204:207], v[80:83], v[96:99]
    v_exp_f32 v142, v142
    v_mfma_f32_16x16x32_bf16 v[100:103], a[192:195], v[36:39], v[228:231]
    v_exp_f32 v143, v143
    v_mfma_f32_16x16x32_bf16 v[100:103], a[196:199], v[52:55], v[100:103]
    v_exp_f32 v144, v144
    v_mfma_f32_16x16x32_bf16 v[100:103], a[200:203], v[68:71], v[100:103]
    v_exp_f32 v145, v145
    v_mfma_f32_16x16x32_bf16 v[100:103], a[204:207], v[84:87], v[100:103]
    buffer_load_dwordx4 v25, s[40:43], s8 offen offset:3072 lds
    s_add_u32 s8, s8, 16384
    v_mfma_f32_16x16x32_bf16 v[104:107], a[192:195], v[40:43], v[232:235]
    s_and_b32 s8, s8, 0x1ffff
    v_cvt_pk_bf16_f32 v188, v140, v141
    v_mfma_f32_16x16x32_bf16 v[104:107], a[196:199], v[56:59], v[104:107]
    s_add_u32 m0, s7, 16512
    v_cvt_pk_bf16_f32 v189, v142, v143
    v_mfma_f32_16x16x32_bf16 v[104:107], a[200:203], v[72:75], v[104:107]
    v_exp_f32 v146, v146
    v_mfma_f32_16x16x32_bf16 v[104:107], a[204:207], v[88:91], v[104:107]
    v_exp_f32 v147, v147
    v_mfma_f32_16x16x32_bf16 v[108:111], a[192:195], v[44:47], v[236:239]
    buffer_load_dwordx4 v26, s[44:47], s9 offen offset:0 lds
    v_cvt_pk_bf16_f32 v178, v144, v145
    v_mfma_f32_16x16x32_bf16 v[108:111], a[196:199], v[60:63], v[108:111]
    v_exp_f32 v148, v148
    v_mfma_f32_16x16x32_bf16 v[108:111], a[200:203], v[76:79], v[108:111]
    v_exp_f32 v149, v149
    v_mfma_f32_16x16x32_bf16 v[108:111], a[204:207], v[92:95], v[108:111]
    v_cvt_pk_bf16_f32 v179, v146, v147
    s_waitcnt lgkmcnt(0)
    v_mfma_f32_16x16x32_bf16 v[112:115], a[208:211], v[32:35], v[224:227]
    ds_read_b128 a[192:195], v17 offset:18560
    ds_read_b128 a[196:199], v18 offset:18560
    v_mfma_f32_16x16x32_bf16 v[112:115], a[212:215], v[48:51], v[112:115]
    buffer_load_dwordx4 v27, s[44:47], s9 offen offset:1032 lds
    ds_read_b128 a[200:203], v19 offset:18560
    v_mfma_f32_16x16x32_bf16 v[112:115], a[216:219], v[64:67], v[112:115]
    ds_read_b128 a[204:207], v20 offset:18560
    v_mfma_f32_16x16x32_bf16 v[112:115], a[220:223], v[80:83], v[112:115]
    v_exp_f32 v150, v150
    v_mfma_f32_16x16x32_bf16 v[116:119], a[208:211], v[36:39], v[228:231]
    v_exp_f32 v151, v151
    v_mfma_f32_16x16x32_bf16 v[116:119], a[212:215], v[52:55], v[116:119]
    v_exp_f32 v152, v152
    v_mfma_f32_16x16x32_bf16 v[116:119], a[216:219], v[68:71], v[116:119]
    buffer_load_dwordx4 v28, s[44:47], s9 offen offset:2064 lds
    v_cvt_pk_bf16_f32 v182, v148, v149
    v_mfma_f32_16x16x32_bf16 v[116:119], a[220:223], v[84:87], v[116:119]
    v_exp_f32 v153, v153
    v_mfma_f32_16x16x32_bf16 v[120:123], a[208:211], v[40:43], v[232:235]
    v_exp_f32 v154, v154
    v_mfma_f32_16x16x32_bf16 v[120:123], a[212:215], v[56:59], v[120:123]
    v_exp_f32 v155, v155
    v_mfma_f32_16x16x32_bf16 v[120:123], a[216:219], v[72:75], v[120:123]
    v_exp_f32 v156, v156
    v_mfma_f32_16x16x32_bf16 v[120:123], a[220:223], v[88:91], v[120:123]
    buffer_load_dwordx4 v29, s[44:47], s9 offen offset:3096 lds
    s_add_u32 s9, s9, 16384
    v_mfma_f32_16x16x32_bf16 v[124:127], a[208:211], v[44:47], v[236:239]
    s_and_b32 s9, s9, 0x1ffff
    v_cvt_pk_bf16_f32 v183, v150, v151
    v_mfma_f32_16x16x32_bf16 v[124:127], a[212:215], v[60:63], v[124:127]
    s_add_u32 m0, s63, 12384
    s_add_u32 s60, s92, s94
    v_mfma_f32_16x16x32_bf16 v[124:127], a[216:219], v[76:79], v[124:127]
    v_exp_f32 v157, v157
    v_mfma_f32_16x16x32_bf16 v[124:127], a[220:223], v[92:95], v[124:127]
    v_cvt_pk_bf16_f32 v186, v152, v153
    s_waitcnt lgkmcnt(0)
    v_mfma_f32_16x16x32_bf16 v[128:131], a[192:195], v[32:35], v[224:227]
    buffer_load_dwordx4 v11, s[36:39], s60 offen offset:0 lds
    v_cvt_pk_bf16_f32 v187, v154, v155
    v_mfma_f32_16x16x32_bf16 v[128:131], a[196:199], v[48:51], v[128:131]
    ds_read_b128 a[208:211], v17 offset:19584
    ds_read_b128 a[212:215], v18 offset:19584
    v_mfma_f32_16x16x32_bf16 v[128:131], a[200:203], v[64:67], v[128:131]
    ds_read_b128 a[216:219], v19 offset:19584
    ds_read_b128 a[220:223], v20 offset:19584
    v_mfma_f32_16x16x32_bf16 v[128:131], a[204:207], v[80:83], v[128:131]
    v_exp_f32 v158, v158
    v_mfma_f32_16x16x32_bf16 v[132:135], a[192:195], v[36:39], v[228:231]
    v_exp_f32 v159, v159
    v_mfma_f32_16x16x32_bf16 v[132:135], a[196:199], v[52:55], v[132:135]
    buffer_load_dwordx4 v12, s[36:39], s60 offen offset:1032 lds
    v_cvt_pk_bf16_f32 v190, v156, v157
    v_mfma_f32_16x16x32_bf16 v[132:135], a[200:203], v[68:71], v[132:135]
    v_exp_f32 v96, v96
    v_mfma_f32_16x16x32_bf16 v[132:135], a[204:207], v[84:87], v[132:135]
    v_exp_f32 v97, v97
    v_mfma_f32_16x16x32_bf16 v[136:139], a[192:195], v[40:43], v[232:235]
    v_exp_f32 v98, v98
    v_mfma_f32_16x16x32_bf16 v[136:139], a[196:199], v[56:59], v[136:139]
    v_exp_f32 v99, v99
    v_mfma_f32_16x16x32_bf16 v[136:139], a[200:203], v[72:75], v[136:139]
    buffer_load_dwordx4 v13, s[36:39], s60 offen offset:2064 lds
    v_cvt_pk_bf16_f32 v191, v158, v159
    v_mfma_f32_16x16x32_bf16 v[136:139], a[204:207], v[88:91], v[136:139]
    v_exp_f32 v100, v100
    v_mfma_f32_16x16x32_bf16 v[140:143], a[192:195], v[44:47], v[236:239]
    v_exp_f32 v101, v101
    v_mfma_f32_16x16x32_bf16 v[140:143], a[196:199], v[60:63], v[140:143]
    v_exp_f32 v102, v102
    v_mfma_f32_16x16x32_bf16 v[140:143], a[200:203], v[76:79], v[140:143]
    v_exp_f32 v103, v103
    v_mfma_f32_16x16x32_bf16 v[140:143], a[204:207], v[92:95], v[140:143]
    buffer_load_dwordx4 v14, s[36:39], s60 offen offset:3096 lds
    s_waitcnt lgkmcnt(0)
    v_mfma_f32_16x16x32_bf16 v[144:147], a[208:211], v[32:35], v[224:227]
    ds_read_b64_tr_b16 a[192:193], v21 offset:0
    s_add_u32 s94, s94, 0x20000
    v_mfma_f32_16x16x32_bf16 v[144:147], a[212:215], v[48:51], v[144:147]
    s_and_b32 s94, s94, 0x7ffff
    v_cvt_pk_bf16_f32 v192, v96, v97
    v_mfma_f32_16x16x32_bf16 v[144:147], a[216:219], v[64:67], v[144:147]
    ds_read_b64_tr_b16 a[194:195], v21 offset:4128
    v_cvt_pk_bf16_f32 v193, v98, v99
    v_mfma_f32_16x16x32_bf16 v[144:147], a[220:223], v[80:83], v[144:147]
    ds_read_b64_tr_b16 a[196:197], v21 offset:8256
    v_cvt_pk_bf16_f32 v196, v100, v101
    v_mfma_f32_16x16x32_bf16 v[148:151], a[208:211], v[36:39], v[228:231]
    ds_read_b64_tr_b16 a[198:199], v21 offset:12384
    v_cvt_pk_bf16_f32 v197, v102, v103
    v_mfma_f32_16x16x32_bf16 v[148:151], a[212:215], v[52:55], v[148:151]
    ds_read_b64_tr_b16 a[200:201], v21 offset:8
    ds_read_b64_tr_b16 a[202:203], v21 offset:4136
    v_mfma_f32_16x16x32_bf16 v[148:151], a[216:219], v[68:71], v[148:151]
    buffer_load_dwordx4 a[244:247], v16, s[52:55], s93 offen offset:0
    ds_read_b64_tr_b16 a[204:205], v21 offset:8264
    v_mfma_f32_16x16x32_bf16 v[148:151], a[220:223], v[84:87], v[148:151]
    ds_read_b64_tr_b16 a[206:207], v21 offset:12392
    v_mfma_f32_16x16x32_bf16 v[152:155], a[208:211], v[40:43], v[232:235]
    v_exp_f32 v104, v104
    v_mfma_f32_16x16x32_bf16 v[152:155], a[212:215], v[56:59], v[152:155]
    buffer_load_dwordx4 a[244:247], v16, s[52:55], s93 offen offset:1024
    v_mfma_f32_16x16x32_bf16 v[152:155], a[216:219], v[72:75], v[152:155]
    v_exp_f32 v105, v105
    v_mfma_f32_16x16x32_bf16 v[152:155], a[220:223], v[88:91], v[152:155]
    v_exp_f32 v106, v106
    v_mfma_f32_16x16x32_bf16 v[156:159], a[208:211], v[44:47], v[236:239]
    v_exp_f32 v107, v107
    v_mfma_f32_16x16x32_bf16 v[156:159], a[212:215], v[60:63], v[156:159]
    v_exp_f32 v108, v108
    v_mfma_f32_16x16x32_bf16 v[156:159], a[216:219], v[76:79], v[156:159]
    buffer_load_dwordx4 a[244:247], v16, s[52:55], s93 offen offset:2048
    v_cvt_pk_bf16_f32 v200, v104, v105
    v_mfma_f32_16x16x32_bf16 v[156:159], a[220:223], v[92:95], v[156:159]
    v_cvt_pk_bf16_f32 v201, v106, v107
    v_mfma_f32_16x16x32_bf16 a[224:227], a[240:243], v[160:163], a[224:227]
    v_exp_f32 v109, v109
    v_mfma_f32_16x16x32_bf16 a[224:227], a[240:243], v[176:179], a[224:227]
    v_exp_f32 v110, v110
    v_mfma_f32_16x16x32_bf16 a[228:231], a[240:243], v[164:167], a[228:231]
    v_exp_f32 v111, v111
    v_mfma_f32_16x16x32_bf16 a[228:231], a[240:243], v[180:183], a[228:231]
    buffer_load_dwordx4 a[244:247], v16, s[52:55], s93 offen offset:3072
    v_cvt_pk_bf16_f32 v204, v108, v109
    v_mfma_f32_16x16x32_bf16 a[232:235], a[240:243], v[168:171], a[232:235]
    v_exp_f32 v112, v112
    v_mfma_f32_16x16x32_bf16 a[232:235], a[240:243], v[184:187], a[232:235]
    v_exp_f32 v113, v113
    v_mfma_f32_16x16x32_bf16 a[236:239], a[240:243], v[172:175], a[236:239]
    v_exp_f32 v114, v114
    v_mfma_f32_16x16x32_bf16 a[236:239], a[240:243], v[188:191], a[236:239]
    v_exp_f32 v115, v115
    s_waitcnt lgkmcnt(0)
    v_mfma_f32_16x16x32_bf16 a[0:3], a[192:195], v[160:163], a[0:3]
    ds_read_b64_tr_b16 a[208:209], v21 offset:256
    v_cvt_pk_bf16_f32 v205, v110, v111
    v_mfma_f32_16x16x32_bf16 a[0:3], a[196:199], v[176:179], a[0:3]
    buffer_store_dwordx4 a[248:251], v16, s[48:51], s10 offen offset:3072 sc1
    s_add_u32 s10, s10, 20480
    v_mfma_f32_16x16x32_bf16 a[4:7], a[192:195], v[164:167], a[4:7]
    ds_read_b64_tr_b16 a[210:211], v21 offset:4384
    v_cvt_pk_bf16_f32 v194, v112, v113
    v_mfma_f32_16x16x32_bf16 a[4:7], a[196:199], v[180:183], a[4:7]
    ds_read_b64_tr_b16 a[212:213], v21 offset:8512
    v_cvt_pk_bf16_f32 v195, v114, v115
    v_mfma_f32_16x16x32_bf16 a[8:11], a[192:195], v[168:171], a[8:11]
    ds_read_b64_tr_b16 a[214:215], v21 offset:12640
    ds_read_b64_tr_b16 a[216:217], v21 offset:264
    v_mfma_f32_16x16x32_bf16 a[8:11], a[196:199], v[184:187], a[8:11]
    ds_read_b64_tr_b16 a[218:219], v21 offset:4392
    ds_read_b64_tr_b16 a[220:221], v21 offset:8520
    v_mfma_f32_16x16x32_bf16 a[12:15], a[192:195], v[172:175], a[12:15]
    buffer_store_dwordx4 a[248:251], v16, s[48:51], s10 offen offset:0 sc1
    ds_read_b64_tr_b16 a[222:223], v21 offset:12648
    v_mfma_f32_16x16x32_bf16 a[12:15], a[196:199], v[188:191], a[12:15]
    v_exp_f32 v116, v116
    v_mfma_f32_16x16x32_bf16 a[16:19], a[200:203], v[160:163], a[16:19]
    v_exp_f32 v117, v117
    v_mfma_f32_16x16x32_bf16 a[16:19], a[204:207], v[176:179], a[16:19]
    v_exp_f32 v118, v118
    v_mfma_f32_16x16x32_bf16 a[20:23], a[200:203], v[164:167], a[20:23]
    buffer_store_dwordx4 a[248:251], v16, s[48:51], s10 offen offset:1024 sc1
    v_mfma_f32_16x16x32_bf16 a[20:23], a[204:207], v[180:183], a[20:23]
    v_exp_f32 v119, v119
    v_mfma_f32_16x16x32_bf16 a[24:27], a[200:203], v[168:171], a[24:27]
    v_exp_f32 v120, v120
    v_mfma_f32_16x16x32_bf16 a[24:27], a[204:207], v[184:187], a[24:27]
    v_exp_f32 v121, v121
    v_mfma_f32_16x16x32_bf16 a[28:31], a[200:203], v[172:175], a[28:31]
    v_exp_f32 v122, v122
    v_mfma_f32_16x16x32_bf16 a[28:31], a[204:207], v[188:191], a[28:31]
    v_cvt_pk_bf16_f32 v198, v116, v117
    s_waitcnt lgkmcnt(0)
    v_mfma_f32_16x16x32_bf16 a[32:35], a[208:211], v[160:163], a[32:35]
    ds_read_b64_tr_b16 a[192:193], v21 offset:512
    v_cvt_pk_bf16_f32 v199, v118, v119
    v_mfma_f32_16x16x32_bf16 a[32:35], a[212:215], v[176:179], a[32:35]
    ds_read_b64_tr_b16 a[194:195], v21 offset:4640
    ds_read_b64_tr_b16 a[196:197], v21 offset:8768
    v_mfma_f32_16x16x32_bf16 a[36:39], a[208:211], v[164:167], a[36:39]
    ds_read_b64_tr_b16 a[198:199], v21 offset:12896
    ds_read_b64_tr_b16 a[200:201], v21 offset:520
    v_mfma_f32_16x16x32_bf16 a[36:39], a[212:215], v[180:183], a[36:39]
    ds_read_b64_tr_b16 a[202:203], v21 offset:4648
    ds_read_b64_tr_b16 a[204:205], v21 offset:8776
    v_mfma_f32_16x16x32_bf16 a[40:43], a[208:211], v[168:171], a[40:43]
    ds_read_b64_tr_b16 a[206:207], v21 offset:12904
    v_mfma_f32_16x16x32_bf16 a[40:43], a[212:215], v[184:187], a[40:43]
    v_exp_f32 v123, v123
    v_mfma_f32_16x16x32_bf16 a[44:47], a[208:211], v[172:175], a[44:47]
    v_exp_f32 v124, v124
    v_mfma_f32_16x16x32_bf16 a[44:47], a[212:215], v[188:191], a[44:47]
    v_exp_f32 v125, v125
    v_mfma_f32_16x16x32_bf16 a[48:51], a[216:219], v[160:163], a[48:51]
    v_exp_f32 v126, v126
    v_mfma_f32_16x16x32_bf16 a[48:51], a[220:223], v[176:179], a[48:51]
    v_exp_f32 v127, v127
    v_mfma_f32_16x16x32_bf16 a[52:55], a[216:219], v[164:167], a[52:55]
    v_exp_f32 v128, v128
    v_mfma_f32_16x16x32_bf16 a[52:55], a[220:223], v[180:183], a[52:55]
    v_exp_f32 v129, v129
    v_mfma_f32_16x16x32_bf16 a[56:59], a[216:219], v[168:171], a[56:59]
    v_exp_f32 v130, v130
    v_mfma_f32_16x16x32_bf16 a[56:59], a[220:223], v[184:187], a[56:59]
    v_exp_f32 v131, v131
    v_mfma_f32_16x16x32_bf16 a[60:63], a[216:219], v[172:175], a[60:63]
    v_exp_f32 v132, v132
    v_mfma_f32_16x16x32_bf16 a[60:63], a[220:223], v[188:191], a[60:63]
    v_cvt_pk_bf16_f32 v202, v120, v121
    s_waitcnt lgkmcnt(0)
    v_mfma_f32_16x16x32_bf16 a[64:67], a[192:195], v[160:163], a[64:67]
    ds_read_b64_tr_b16 a[208:209], v21 offset:768
    v_cvt_pk_bf16_f32 v203, v122, v123
    v_mfma_f32_16x16x32_bf16 a[64:67], a[196:199], v[176:179], a[64:67]
    ds_read_b64_tr_b16 a[210:211], v21 offset:4896
    v_cvt_pk_bf16_f32 v206, v124, v125
    v_mfma_f32_16x16x32_bf16 a[68:71], a[192:195], v[164:167], a[68:71]
    ds_read_b64_tr_b16 a[212:213], v21 offset:9024
    v_cvt_pk_bf16_f32 v207, v126, v127
    v_mfma_f32_16x16x32_bf16 a[68:71], a[196:199], v[180:183], a[68:71]
    ds_read_b64_tr_b16 a[214:215], v21 offset:13152
    v_cvt_pk_bf16_f32 v208, v128, v129
    v_mfma_f32_16x16x32_bf16 a[72:75], a[192:195], v[168:171], a[72:75]
    ds_read_b64_tr_b16 a[216:217], v21 offset:776
    v_cvt_pk_bf16_f32 v209, v130, v131
    v_mfma_f32_16x16x32_bf16 a[72:75], a[196:199], v[184:187], a[72:75]
    ds_read_b64_tr_b16 a[218:219], v21 offset:4904
    ds_read_b64_tr_b16 a[220:221], v21 offset:9032
    v_mfma_f32_16x16x32_bf16 a[76:79], a[192:195], v[172:175], a[76:79]
    ds_read_b64_tr_b16 a[222:223], v21 offset:13160
    v_mfma_f32_16x16x32_bf16 a[76:79], a[196:199], v[188:191], a[76:79]
    v_exp_f32 v133, v133
    v_mfma_f32_16x16x32_bf16 a[80:83], a[200:203], v[160:163], a[80:83]
    v_exp_f32 v134, v134
    v_mfma_f32_16x16x32_bf16 a[80:83], a[204:207], v[176:179], a[80:83]
    v_exp_f32 v135, v135
    v_mfma_f32_16x16x32_bf16 a[84:87], a[200:203], v[164:167], a[84:87]
    v_exp_f32 v136, v136
    v_mfma_f32_16x16x32_bf16 a[84:87], a[204:207], v[180:183], a[84:87]
    v_exp_f32 v137, v137
    v_mfma_f32_16x16x32_bf16 a[88:91], a[200:203], v[168:171], a[88:91]
    v_exp_f32 v138, v138
    v_mfma_f32_16x16x32_bf16 a[88:91], a[204:207], v[184:187], a[88:91]
    v_exp_f32 v139, v139
    v_mfma_f32_16x16x32_bf16 a[92:95], a[200:203], v[172:175], a[92:95]
    v_exp_f32 v140, v140
    v_mfma_f32_16x16x32_bf16 a[92:95], a[204:207], v[188:191], a[92:95]
    v_cvt_pk_bf16_f32 v212, v132, v133
    s_waitcnt lgkmcnt(0)
    v_mfma_f32_16x16x32_bf16 a[96:99], a[208:211], v[160:163], a[96:99]
    v_exp_f32 v141, v141
    v_mfma_f32_16x16x32_bf16 a[96:99], a[212:215], v[176:179], a[96:99]
    s_waitcnt vmcnt(11)
    s_barrier
    s_sub_u32 s3, s96, 2
    s_cmp_ge_u32 s3, 2
    s_cbranch_scc1 L_nolp
    v_lshlrev_b32 v240, 16, v30
    v_and_b32 v241, 0xffff0000, v30
    v_mul_f32 v242, 3216550459, v240
    v_mul_f32 v243, 3216550459, v241
    v_exp_f32 v242, v242
    v_exp_f32 v243, v243
    v_add_f32 v242, 1.0, v242
    v_add_f32 v243, 1.0, v243
    v_rcp_f32 v242, v242
    v_rcp_f32 v243, v243
    v_mul_f32 v240, v240, v242
    v_mul_f32 v241, v241, v243
    v_cvt_pk_bf16_f32 v240, v240, v241
    v_lshlrev_b32 v241, 2, v0
    v_add_u32 v241, 156544, v241
    ds_write_b32 v241, v240
    v_lshrrev_b32 v240, 4, v1
    v_lshlrev_b32 v240, 4, v240
    s_lshl_b32 s3, s35, 8
    s_add_u32 s3, s3, 156544
    v_add_u32 v240, s3, v240
    s_waitcnt lgkmcnt(0)
    s_barrier
    ds_read_b128 a[128:131], v240 offset:0
    ds_read_b128 a[132:135], v240 offset:64
    ds_read_b128 a[136:139], v240 offset:128
    ds_read_b128 a[140:143], v240 offset:192
    ds_read_b64_tr_b16 a[144:145], v10 offset:0
    ds_read_b64_tr_b16 a[146:147], v10 offset:256
    ds_read_b64_tr_b16 a[148:149], v10 offset:2064
    ds_read_b64_tr_b16 a[150:151], v10 offset:2320
    ds_read_b64_tr_b16 a[152:153], v10 offset:8
    ds_read_b64_tr_b16 a[154:155], v10 offset:264
    ds_read_b64_tr_b16 a[156:157], v10 offset:2072
    ds_read_b64_tr_b16 a[158:159], v10 offset:2328
    ds_read_b64_tr_b16 a[160:161], v10 offset:4128
    ds_read_b64_tr_b16 a[162:163], v10 offset:4384
    ds_read_b64_tr_b16 a[164:165], v10 offset:6192
    ds_read_b64_tr_b16 a[166:167], v10 offset:6448
    ds_read_b64_tr_b16 a[168:169], v10 offset:4136
    ds_read_b64_tr_b16 a[170:171], v10 offset:4392
    ds_read_b64_tr_b16 a[172:173], v10 offset:6200
    ds_read_b64_tr_b16 a[174:175], v10 offset:6456
    s_waitcnt lgkmcnt(14)
    v_mfma_f32_16x16x32_bf16 v[244:247], a[144:147], a[128:131], 0
    s_waitcnt lgkmcnt(10)
    v_mfma_f32_16x16x32_bf16 v[248:251], a[152:155], a[128:131], 0
    v_mfma_f32_16x16x32_bf16 v[244:247], a[148:151], a[132:135], v[244:247]
    s_waitcnt lgkmcnt(8)
    v_mfma_f32_16x16x32_bf16 v[248:251], a[156:159], a[132:135], v[248:251]
    s_waitcnt lgkmcnt(6)
    v_mfma_f32_16x16x32_bf16 v[244:247], a[160:163], a[136:139], v[244:247]
    s_waitcnt lgkmcnt(2)
    v_mfma_f32_16x16x32_bf16 v[248:251], a[168:171], a[136:139], v[248:251]
    v_mfma_f32_16x16x32_bf16 v[244:247], a[164:167], a[140:143], v[244:247]
    s_waitcnt lgkmcnt(0)
    v_mfma_f32_16x16x32_bf16 v[248:251], a[172:175], a[140:143], v[248:251]
    s_lshl_b32 s13, s13, 7
    s_add_u32 s13, s13, 20480
    v_lshrrev_b32 v240, 4, v1
    v_lshlrev_b32 v240, 5, v240
    s_mul_i32 s3, s35, 128
    s_add_u32 s3, s3, 157568
    v_add_u32 v240, s3, v240
    s_mov_b32 exec_lo, 0x00010001
    s_mov_b32 exec_hi, 0x00010001
    ds_write_b128 v240, v[244:247] offset:0
    ds_write_b128 v240, v[248:251] offset:16
    s_mov_b64 exec, -1
    s_waitcnt lgkmcnt(0)
    s_barrier
    s_cmp_lg_u32 s35, 0
    s_cbranch_scc1 L_lp_x
    v_lshlrev_b32 v240, 3, v1
    v_add_u32 v241, 157568, v240
    s_mov_b32 exec_lo, 65535
    s_mov_b32 exec_hi, 0
    ds_read_b64 v[244:245], v241 offset:0
    ds_read_b64 v[246:247], v241 offset:128
    ds_read_b64 v[248:249], v241 offset:256
    ds_read_b64 v[250:251], v241 offset:384
    s_waitcnt lgkmcnt(2)
    v_pk_add_f32 v[244:245], v[244:245], v[246:247]
    s_waitcnt lgkmcnt(0)
    v_pk_add_f32 v[248:249], v[248:249], v[250:251]
    v_pk_add_f32 v[244:245], v[244:245], v[248:249]
    v_cvt_pk_bf16_f32 v244, v244, v245
    v_mov_b32 v245, s34
    buffer_store_dwordx2 v[244:245], v240, s[48:51], s13 offen sc1
    s_mov_b64 exec, -1
L_lp_x:
    s_waitcnt lgkmcnt(0)
    s_nop 7
L_nolp:
    v_mfma_f32_16x16x32_bf16 a[100:103], a[208:211], v[164:167], a[100:103]
    ds_read_b128 a[192:195], v17 offset:0
    v_cvt_pk_bf16_f32 v213, v134, v135
    v_mfma_f32_16x16x32_bf16 a[100:103], a[212:215], v[180:183], a[100:103]
    ds_read_b128 a[196:199], v18 offset:0
    v_cvt_pk_bf16_f32 v216, v136, v137
    v_mfma_f32_16x16x32_bf16 a[104:107], a[208:211], v[168:171], a[104:107]
    ds_read_b128 a[200:203], v19 offset:0
    v_cvt_pk_bf16_f32 v217, v138, v139
    v_mfma_f32_16x16x32_bf16 a[104:107], a[212:215], v[184:187], a[104:107]
    ds_read_b128 a[204:207], v20 offset:0
    s_add_u32 m0, s6, 16512
    v_mfma_f32_16x16x32_bf16 a[108:111], a[208:211], v[172:175], a[108:111]
    v_exp_f32 v142, v142
    v_mfma_f32_16x16x32_bf16 a[108:111], a[212:215], v[188:191], a[108:111]
    v_exp_f32 v143, v143
    v_mfma_f32_16x16x32_bf16 a[112:115], a[216:219], v[160:163], a[112:115]
    buffer_load_dwordx4 v22, s[40:43], s8 offen offset:0 lds
    v_cvt_pk_bf16_f32 v220, v140, v141
    v_mfma_f32_16x16x32_bf16 a[112:115], a[220:223], v[176:179], a[112:115]
    v_exp_f32 v144, v144
    v_mfma_f32_16x16x32_bf16 a[116:119], a[216:219], v[164:167], a[116:119]
    v_exp_f32 v145, v145
    v_mfma_f32_16x16x32_bf16 a[116:119], a[220:223], v[180:183], a[116:119]
    v_exp_f32 v146, v146
    v_mfma_f32_16x16x32_bf16 a[120:123], a[216:219], v[168:171], a[120:123]
    v_exp_f32 v147, v147
    v_mfma_f32_16x16x32_bf16 a[120:123], a[220:223], v[184:187], a[120:123]
    buffer_load_dwordx4 v23, s[40:43], s8 offen offset:1024 lds
    v_cvt_pk_bf16_f32 v221, v142, v143
    v_mfma_f32_16x16x32_bf16 a[124:127], a[216:219], v[172:175], a[124:127]
    v_exp_f32 v148, v148
    v_mfma_f32_16x16x32_bf16 a[124:127], a[220:223], v[188:191], a[124:127]
    v_cvt_pk_bf16_f32 v210, v144, v145
    s_waitcnt lgkmcnt(0)
    v_mfma_f32_16x16x32_bf16 v[96:99], a[192:195], v[32:35], v[224:227]
    ds_read_b128 a[208:211], v17 offset:1024
    v_cvt_pk_bf16_f32 v211, v146, v147
    v_mfma_f32_16x16x32_bf16 v[96:99], a[196:199], v[48:51], v[96:99]
    ds_read_b128 a[212:215], v18 offset:1024
    v_add_u32 v30, s85, v16
    v_mfma_f32_16x16x32_bf16 v[96:99], a[200:203], v[64:67], v[96:99]
    buffer_load_dwordx4 v24, s[40:43], s8 offen offset:2048 lds
    v_add_u32 v2, s86, v16
    v_mfma_f32_16x16x32_bf16 v[96:99], a[204:207], v[80:83], v[96:99]
    ds_read_b128 a[216:219], v19 offset:1024
    v_add_u32 v3, s87, v16
    v_mfma_f32_16x16x32_bf16 v[100:103], a[192:195], v[36:39], v[228:231]
    ds_read_b128 a[220:223], v20 offset:1024
    v_add_u32 v4, s88, v16
    v_mfma_f32_16x16x32_bf16 v[100:103], a[196:199], v[52:55], v[100:103]
    ds_read_b64_tr_b16 a[128:129], v10 offset:8256
    v_add_u32 v5, s89, v16
    v_mfma_f32_16x16x32_bf16 v[100:103], a[200:203], v[68:71], v[100:103]
    ds_read_b64_tr_b16 a[130:131], v10 offset:8512
    v_mfma_f32_16x16x32_bf16 v[100:103], a[204:207], v[84:87], v[100:103]
    buffer_load_dwordx4 v25, s[40:43], s8 offen offset:3072 lds
    s_add_u32 s8, s8, 16384
    v_mfma_f32_16x16x32_bf16 v[104:107], a[192:195], v[40:43], v[232:235]
    ds_read_b64_tr_b16 a[132:133], v10 offset:10320
    s_and_b32 s8, s8, 0x1ffff
    v_mfma_f32_16x16x32_bf16 v[104:107], a[196:199], v[56:59], v[104:107]
    s_add_u32 m0, s7, 0
    v_mfma_f32_16x16x32_bf16 v[104:107], a[200:203], v[72:75], v[104:107]
    ds_read_b64_tr_b16 a[134:135], v10 offset:10576
    v_mfma_f32_16x16x32_bf16 v[104:107], a[204:207], v[88:91], v[104:107]
    v_exp_f32 v149, v149
    v_mfma_f32_16x16x32_bf16 v[108:111], a[192:195], v[44:47], v[236:239]
    buffer_load_dwordx4 v26, s[44:47], s9 offen offset:0 lds
    ds_read_b64_tr_b16 a[136:137], v10 offset:8264
    v_mfma_f32_16x16x32_bf16 v[108:111], a[196:199], v[60:63], v[108:111]
    v_exp_f32 v150, v150
    v_mfma_f32_16x16x32_bf16 v[108:111], a[200:203], v[76:79], v[108:111]
    ds_read_b64_tr_b16 a[138:139], v10 offset:8520
    v_mfma_f32_16x16x32_bf16 v[108:111], a[204:207], v[92:95], v[108:111]
    s_waitcnt lgkmcnt(4)
    v_mfma_f32_16x16x32_bf16 v[112:115], a[208:211], v[32:35], v[224:227]
    ds_read_b128 a[192:195], v17 offset:2048
    ds_read_b128 a[196:199], v18 offset:2048
    v_mfma_f32_16x16x32_bf16 v[112:115], a[212:215], v[48:51], v[112:115]
    buffer_load_dwordx4 v27, s[44:47], s9 offen offset:1032 lds
    ds_read_b64_tr_b16 a[140:141], v10 offset:10328
L_stub6:
    s_cbranch_execz L_stub10
    v_mfma_f32_16x16x32_bf16 v[112:115], a[216:219], v[64:67], v[112:115]
    ds_read_b128 a[200:203], v19 offset:2048
    ds_read_b128 a[204:207], v20 offset:2048
    v_mfma_f32_16x16x32_bf16 v[112:115], a[220:223], v[80:83], v[112:115]
    ds_read_b64_tr_b16 a[142:143], v10 offset:10584
    v_mfma_f32_16x16x32_bf16 v[116:119], a[208:211], v[36:39], v[228:231]
    v_exp_f32 v151, v151
    v_mfma_f32_16x16x32_bf16 v[116:119], a[212:215], v[52:55], v[116:119]
    v_exp_f32 v152, v152
    v_mfma_f32_16x16x32_bf16 v[116:119], a[216:219], v[68:71], v[116:119]
    buffer_load_dwordx4 v28, s[44:47], s9 offen offset:2064 lds
    v_cvt_pk_bf16_f32 v214, v148, v149
    v_mfma_f32_16x16x32_bf16 v[116:119], a[220:223], v[84:87], v[116:119]
    v_exp_f32 v153, v153
    v_mfma_f32_16x16x32_bf16 v[120:123], a[208:211], v[40:43], v[232:235]
    v_exp_f32 v154, v154
    v_mfma_f32_16x16x32_bf16 v[120:123], a[212:215], v[56:59], v[120:123]
    v_exp_f32 v155, v155
    v_mfma_f32_16x16x32_bf16 v[120:123], a[216:219], v[72:75], v[120:123]
    v_exp_f32 v156, v156
    v_mfma_f32_16x16x32_bf16 v[120:123], a[220:223], v[88:91], v[120:123]
    buffer_load_dwordx4 v29, s[44:47], s9 offen offset:3096 lds
    s_add_u32 s9, s9, 16384
    v_mfma_f32_16x16x32_bf16 v[124:127], a[208:211], v[44:47], v[236:239]
    s_and_b32 s9, s9, 0x1ffff
    v_cvt_pk_bf16_f32 v215, v150, v151
    v_mfma_f32_16x16x32_bf16 v[124:127], a[212:215], v[60:63], v[124:127]
    s_add_u32 m0, s63, 0
    s_add_u32 s60, s92, s94
    v_mfma_f32_16x16x32_bf16 v[124:127], a[216:219], v[76:79], v[124:127]
    v_exp_f32 v157, v157
    v_mfma_f32_16x16x32_bf16 v[124:127], a[220:223], v[92:95], v[124:127]
    v_cvt_pk_bf16_f32 v218, v152, v153
    s_waitcnt lgkmcnt(0)
    v_mfma_f32_16x16x32_bf16 v[128:131], a[192:195], v[32:35], v[224:227]
    buffer_load_dwordx4 v11, s[36:39], s60 offen offset:0 lds
    v_cvt_pk_bf16_f32 v219, v154, v155
    v_mfma_f32_16x16x32_bf16 v[128:131], a[196:199], v[48:51], v[128:131]
    ds_read_b128 a[208:211], v17 offset:3072
    ds_read_b128 a[212:215], v18 offset:3072
    v_mfma_f32_16x16x32_bf16 v[128:131], a[200:203], v[64:67], v[128:131]
    ds_read_b128 a[216:219], v19 offset:3072
    ds_read_b128 a[220:223], v20 offset:3072
    v_mfma_f32_16x16x32_bf16 v[128:131], a[204:207], v[80:83], v[128:131]
    v_exp_f32 v158, v158
    v_mfma_f32_16x16x32_bf16 v[132:135], a[192:195], v[36:39], v[228:231]
    v_exp_f32 v159, v159
    v_mfma_f32_16x16x32_bf16 v[132:135], a[196:199], v[52:55], v[132:135]
    buffer_load_dwordx4 v12, s[36:39], s60 offen offset:1032 lds
    v_cvt_pk_bf16_f32 v222, v156, v157
    v_mfma_f32_16x16x32_bf16 v[132:135], a[200:203], v[68:71], v[132:135]
    v_exp_f32 v96, v96
    v_mfma_f32_16x16x32_bf16 v[132:135], a[204:207], v[84:87], v[132:135]
    v_exp_f32 v97, v97
    v_mfma_f32_16x16x32_bf16 v[136:139], a[192:195], v[40:43], v[232:235]
    v_exp_f32 v98, v98
    v_mfma_f32_16x16x32_bf16 v[136:139], a[196:199], v[56:59], v[136:139]
    v_exp_f32 v99, v99
    v_mfma_f32_16x16x32_bf16 v[136:139], a[200:203], v[72:75], v[136:139]
    buffer_load_dwordx4 v13, s[36:39], s60 offen offset:2064 lds
    v_cvt_pk_bf16_f32 v223, v158, v159
    v_mfma_f32_16x16x32_bf16 v[136:139], a[204:207], v[88:91], v[136:139]
    v_exp_f32 v100, v100
    v_mfma_f32_16x16x32_bf16 v[140:143], a[192:195], v[44:47], v[236:239]
    v_exp_f32 v101, v101
    v_mfma_f32_16x16x32_bf16 v[140:143], a[196:199], v[60:63], v[140:143]
    v_exp_f32 v102, v102
    v_mfma_f32_16x16x32_bf16 v[140:143], a[200:203], v[76:79], v[140:143]
    v_exp_f32 v103, v103
    v_mfma_f32_16x16x32_bf16 v[140:143], a[204:207], v[92:95], v[140:143]
    buffer_load_dwordx4 v14, s[36:39], s60 offen offset:3096 lds
    s_waitcnt lgkmcnt(0)
    v_mfma_f32_16x16x32_bf16 v[144:147], a[208:211], v[32:35], v[224:227]
    ds_read_b64_tr_b16 a[192:193], v21 offset:16512
    s_add_u32 s94, s94, 0x20000
    v_mfma_f32_16x16x32_bf16 v[144:147], a[212:215], v[48:51], v[144:147]
    s_and_b32 s94, s94, 0x7ffff
    s_add_u32 m0, s63, 4128
    v_mfma_f32_16x16x32_bf16 v[144:147], a[216:219], v[64:67], v[144:147]
    ds_read_b64_tr_b16 a[194:195], v21 offset:20640
    s_add_u32 s60, s92, s94
    v_mfma_f32_16x16x32_bf16 v[144:147], a[220:223], v[80:83], v[144:147]
    ds_read_b64_tr_b16 a[196:197], v21 offset:24768
    v_cvt_pk_bf16_f32 v160, v96, v97
    v_mfma_f32_16x16x32_bf16 v[148:151], a[208:211], v[36:39], v[228:231]
    ds_read_b64_tr_b16 a[198:199], v21 offset:28896
    v_cvt_pk_bf16_f32 v161, v98, v99
    v_mfma_f32_16x16x32_bf16 v[148:151], a[212:215], v[52:55], v[148:151]
    buffer_load_dwordx4 v11, s[36:39], s60 offen offset:0 lds
    ds_read_b64_tr_b16 a[200:201], v21 offset:16520
    v_mfma_f32_16x16x32_bf16 v[148:151], a[216:219], v[68:71], v[148:151]
    ds_read_b64_tr_b16 a[202:203], v21 offset:20648
    v_cvt_pk_bf16_f32 v164, v100, v101
    v_mfma_f32_16x16x32_bf16 v[148:151], a[220:223], v[84:87], v[148:151]
    ds_read_b64_tr_b16 a[204:205], v21 offset:24776
    v_cvt_pk_bf16_f32 v165, v102, v103
    v_mfma_f32_16x16x32_bf16 v[152:155], a[208:211], v[40:43], v[232:235]
    ds_read_b64_tr_b16 a[206:207], v21 offset:28904
    v_mfma_f32_16x16x32_bf16 v[152:155], a[212:215], v[56:59], v[152:155]
    buffer_load_dwordx4 v12, s[36:39], s60 offen offset:1032 lds
    v_mfma_f32_16x16x32_bf16 v[152:155], a[216:219], v[72:75], v[152:155]
    v_exp_f32 v104, v104
    v_mfma_f32_16x16x32_bf16 v[152:155], a[220:223], v[88:91], v[152:155]
    v_exp_f32 v105, v105
    v_mfma_f32_16x16x32_bf16 v[156:159], a[208:211], v[44:47], v[236:239]
    v_exp_f32 v106, v106
    v_mfma_f32_16x16x32_bf16 v[156:159], a[212:215], v[60:63], v[156:159]
    v_exp_f32 v107, v107
    v_mfma_f32_16x16x32_bf16 v[156:159], a[216:219], v[76:79], v[156:159]
    buffer_load_dwordx4 v13, s[36:39], s60 offen offset:2064 lds
    v_cvt_pk_bf16_f32 v168, v104, v105
    v_mfma_f32_16x16x32_bf16 v[156:159], a[220:223], v[92:95], v[156:159]
    v_cvt_pk_bf16_f32 v169, v106, v107
    v_mfma_f32_16x16x32_bf16 a[224:227], a[240:243], v[192:195], a[224:227]
    v_exp_f32 v108, v108
    v_mfma_f32_16x16x32_bf16 a[224:227], a[240:243], v[208:211], a[224:227]
    v_exp_f32 v109, v109
    v_mfma_f32_16x16x32_bf16 a[228:231], a[240:243], v[196:199], a[228:231]
    v_exp_f32 v110, v110
    v_mfma_f32_16x16x32_bf16 a[228:231], a[240:243], v[212:215], a[228:231]
    buffer_load_dwordx4 v14, s[36:39], s60 offen offset:3096 lds
    s_add_u32 s94, s94, 0x20000
    v_mfma_f32_16x16x32_bf16 a[232:235], a[240:243], v[200:203], a[232:235]
    s_and_b32 s94, s94, 0x7ffff
    v_mfma_f32_16x16x32_bf16 a[232:235], a[240:243], v[216:219], a[232:235]
    s_add_u32 s93, s93, 4096
    v_mfma_f32_16x16x32_bf16 a[236:239], a[240:243], v[204:207], a[236:239]
    v_exp_f32 v111, v111
    v_mfma_f32_16x16x32_bf16 a[236:239], a[240:243], v[220:223], a[236:239]
    v_exp_f32 v112, v112
    s_waitcnt lgkmcnt(0)
    v_mfma_f32_16x16x32_bf16 a[0:3], a[192:195], v[192:195], a[0:3]
    ds_read_b64_tr_b16 a[208:209], v21 offset:16768
    v_cvt_pk_bf16_f32 v172, v108, v109
    v_mfma_f32_16x16x32_bf16 a[0:3], a[196:199], v[208:211], a[0:3]
    buffer_load_dwordx4 a[244:247], v16, s[52:55], s93 offen offset:0
    v_cvt_pk_bf16_f32 v173, v110, v111
    v_mfma_f32_16x16x32_bf16 a[4:7], a[192:195], v[196:199], a[4:7]
    ds_read_b64_tr_b16 a[210:211], v21 offset:20896
    ds_read_b64_tr_b16 a[212:213], v21 offset:25024
    v_mfma_f32_16x16x32_bf16 a[4:7], a[196:199], v[212:215], a[4:7]
    ds_read_b64_tr_b16 a[214:215], v21 offset:29152
    ds_read_b64_tr_b16 a[216:217], v21 offset:16776
    v_mfma_f32_16x16x32_bf16 a[8:11], a[192:195], v[200:203], a[8:11]
    ds_read_b64_tr_b16 a[218:219], v21 offset:20904
    ds_read_b64_tr_b16 a[220:221], v21 offset:25032
    v_mfma_f32_16x16x32_bf16 a[8:11], a[196:199], v[216:219], a[8:11]
    buffer_load_dwordx4 a[244:247], v16, s[52:55], s93 offen offset:1024
    ds_read_b64_tr_b16 a[222:223], v21 offset:29160
    v_mfma_f32_16x16x32_bf16 a[12:15], a[192:195], v[204:207], a[12:15]
    v_exp_f32 v113, v113
    v_mfma_f32_16x16x32_bf16 a[12:15], a[196:199], v[220:223], a[12:15]
    v_exp_f32 v114, v114
    v_mfma_f32_16x16x32_bf16 a[16:19], a[200:203], v[192:195], a[16:19]
    v_exp_f32 v115, v115
    v_mfma_f32_16x16x32_bf16 a[16:19], a[204:207], v[208:211], a[16:19]
    v_exp_f32 v116, v116
    v_mfma_f32_16x16x32_bf16 a[20:23], a[200:203], v[196:199], a[20:23]
    buffer_load_dwordx4 a[244:247], v16, s[52:55], s93 offen offset:2048
    v_cvt_pk_bf16_f32 v162, v112, v113
    v_mfma_f32_16x16x32_bf16 a[20:23], a[204:207], v[212:215], a[20:23]
    v_exp_f32 v117, v117
    v_mfma_f32_16x16x32_bf16 a[24:27], a[200:203], v[200:203], a[24:27]
    v_exp_f32 v118, v118
    v_mfma_f32_16x16x32_bf16 a[24:27], a[204:207], v[216:219], a[24:27]
    v_exp_f32 v119, v119
    v_mfma_f32_16x16x32_bf16 a[28:31], a[200:203], v[204:207], a[28:31]
    v_exp_f32 v120, v120
    v_mfma_f32_16x16x32_bf16 a[28:31], a[204:207], v[220:223], a[28:31]
    buffer_load_dwordx4 a[244:247], v16, s[52:55], s93 offen offset:3072
    s_waitcnt lgkmcnt(0)
    v_mfma_f32_16x16x32_bf16 a[32:35], a[208:211], v[192:195], a[32:35]
    ds_read_b64_tr_b16 a[192:193], v21 offset:17024
    v_cvt_pk_bf16_f32 v163, v114, v115
    v_mfma_f32_16x16x32_bf16 a[32:35], a[212:215], v[208:211], a[32:35]
    ds_read_b64_tr_b16 a[194:195], v21 offset:21152
    v_cvt_pk_bf16_f32 v166, v116, v117
    v_mfma_f32_16x16x32_bf16 a[36:39], a[208:211], v[196:199], a[36:39]
    ds_read_b64_tr_b16 a[196:197], v21 offset:25280
    v_cvt_pk_bf16_f32 v167, v118, v119
    v_mfma_f32_16x16x32_bf16 a[36:39], a[212:215], v[212:215], a[36:39]
    ds_read_b64_tr_b16 a[198:199], v21 offset:29408
    ds_read_b64_tr_b16 a[200:201], v21 offset:17032
    v_mfma_f32_16x16x32_bf16 a[40:43], a[208:211], v[200:203], a[40:43]
    buffer_store_dwordx4 a[248:251], v16, s[48:51], s10 offen offset:2048 sc1
    ds_read_b64_tr_b16 a[202:203], v21 offset:21160
    v_mfma_f32_16x16x32_bf16 a[40:43], a[212:215], v[216:219], a[40:43]
    ds_read_b64_tr_b16 a[204:205], v21 offset:25288
    ds_read_b64_tr_b16 a[206:207], v21 offset:29416
    v_mfma_f32_16x16x32_bf16 a[44:47], a[208:211], v[204:207], a[44:47]
    v_exp_f32 v121, v121
    v_mfma_f32_16x16x32_bf16 a[44:47], a[212:215], v[220:223], a[44:47]
    v_exp_f32 v122, v122
    v_mfma_f32_16x16x32_bf16 a[48:51], a[216:219], v[192:195], a[48:51]
    v_exp_f32 v123, v123
    v_mfma_f32_16x16x32_bf16 a[48:51], a[220:223], v[208:211], a[48:51]
    buffer_store_dwordx4 a[248:251], v16, s[48:51], s10 offen offset:3072 sc1
    v_cvt_pk_bf16_f32 v170, v120, v121
    v_mfma_f32_16x16x32_bf16 a[52:55], a[216:219], v[196:199], a[52:55]
    v_exp_f32 v124, v124
    v_mfma_f32_16x16x32_bf16 a[52:55], a[220:223], v[212:215], a[52:55]
    v_exp_f32 v125, v125
    v_mfma_f32_16x16x32_bf16 a[56:59], a[216:219], v[200:203], a[56:59]
    v_exp_f32 v126, v126
    v_mfma_f32_16x16x32_bf16 a[56:59], a[220:223], v[216:219], a[56:59]
    v_exp_f32 v127, v127
    v_mfma_f32_16x16x32_bf16 a[60:63], a[216:219], v[204:207], a[60:63]
    v_exp_f32 v128, v128
    v_mfma_f32_16x16x32_bf16 a[60:63], a[220:223], v[220:223], a[60:63]
    v_cvt_pk_bf16_f32 v171, v122, v123
    s_waitcnt lgkmcnt(0)
    v_mfma_f32_16x16x32_bf16 a[64:67], a[192:195], v[192:195], a[64:67]
    ds_read_b64_tr_b16 a[208:209], v21 offset:17280
    v_cvt_pk_bf16_f32 v174, v124, v125
    v_mfma_f32_16x16x32_bf16 a[64:67], a[196:199], v[208:211], a[64:67]
    ds_read_b64_tr_b16 a[210:211], v21 offset:21408
    v_cvt_pk_bf16_f32 v175, v126, v127
    v_mfma_f32_16x16x32_bf16 a[68:71], a[192:195], v[196:199], a[68:71]
    ds_read_b64_tr_b16 a[212:213], v21 offset:25536
    ds_read_b64_tr_b16 a[214:215], v21 offset:29664
    v_mfma_f32_16x16x32_bf16 a[68:71], a[196:199], v[212:215], a[68:71]
    ds_read_b64_tr_b16 a[216:217], v21 offset:17288
    ds_read_b64_tr_b16 a[218:219], v21 offset:21416
    v_mfma_f32_16x16x32_bf16 a[72:75], a[192:195], v[200:203], a[72:75]
    ds_read_b64_tr_b16 a[220:221], v21 offset:25544
    ds_read_b64_tr_b16 a[222:223], v21 offset:29672
    v_mfma_f32_16x16x32_bf16 a[72:75], a[196:199], v[216:219], a[72:75]
    v_exp_f32 v129, v129
    v_mfma_f32_16x16x32_bf16 a[76:79], a[192:195], v[204:207], a[76:79]
    v_exp_f32 v130, v130
    v_mfma_f32_16x16x32_bf16 a[76:79], a[196:199], v[220:223], a[76:79]
    v_exp_f32 v131, v131
    v_mfma_f32_16x16x32_bf16 a[80:83], a[200:203], v[192:195], a[80:83]
    v_exp_f32 v132, v132
    v_mfma_f32_16x16x32_bf16 a[80:83], a[204:207], v[208:211], a[80:83]
    v_exp_f32 v133, v133
    v_mfma_f32_16x16x32_bf16 a[84:87], a[200:203], v[196:199], a[84:87]
    v_exp_f32 v134, v134
    v_mfma_f32_16x16x32_bf16 a[84:87], a[204:207], v[212:215], a[84:87]
    v_exp_f32 v135, v135
    v_mfma_f32_16x16x32_bf16 a[88:91], a[200:203], v[200:203], a[88:91]
    v_exp_f32 v136, v136
    v_mfma_f32_16x16x32_bf16 a[88:91], a[204:207], v[216:219], a[88:91]
    v_exp_f32 v137, v137
    v_mfma_f32_16x16x32_bf16 a[92:95], a[200:203], v[204:207], a[92:95]
    v_exp_f32 v138, v138
    v_mfma_f32_16x16x32_bf16 a[92:95], a[204:207], v[220:223], a[92:95]
    v_cvt_pk_bf16_f32 v176, v128, v129
    s_waitcnt lgkmcnt(0)
    v_mfma_f32_16x16x32_bf16 a[96:99], a[208:211], v[192:195], a[96:99]
    v_exp_f32 v139, v139
    v_mfma_f32_16x16x32_bf16 a[96:99], a[212:215], v[208:211], a[96:99]
    s_waitcnt vmcnt(14)
    s_barrier
    v_cvt_pk_bf16_f32 v177, v130, v131
    v_mfma_f32_16x16x32_bf16 a[100:103], a[208:211], v[196:199], a[100:103]
    ds_read_b128 a[192:195], v17 offset:16512
    v_cvt_pk_bf16_f32 v180, v132, v133
    v_mfma_f32_16x16x32_bf16 a[100:103], a[212:215], v[212:215], a[100:103]
    ds_read_b128 a[196:199], v18 offset:16512
    v_cvt_pk_bf16_f32 v181, v134, v135
    v_mfma_f32_16x16x32_bf16 a[104:107], a[208:211], v[200:203], a[104:107]
    ds_read_b128 a[200:203], v19 offset:16512
    v_cvt_pk_bf16_f32 v184, v136, v137
    v_mfma_f32_16x16x32_bf16 a[104:107], a[212:215], v[216:219], a[104:107]
    ds_read_b128 a[204:207], v20 offset:16512
    s_add_u32 m0, s6, 0
    v_mfma_f32_16x16x32_bf16 a[108:111], a[208:211], v[204:207], a[108:111]
    v_exp_f32 v140, v140
    v_mfma_f32_16x16x32_bf16 a[108:111], a[212:215], v[220:223], a[108:111]
    v_exp_f32 v141, v141
    v_mfma_f32_16x16x32_bf16 a[112:115], a[216:219], v[192:195], a[112:115]
    buffer_load_dwordx4 v22, s[40:43], s8 offen offset:0 lds
    v_cvt_pk_bf16_f32 v185, v138, v139
    v_mfma_f32_16x16x32_bf16 a[112:115], a[220:223], v[208:211], a[112:115]
    v_exp_f32 v142, v142
    v_mfma_f32_16x16x32_bf16 a[116:119], a[216:219], v[196:199], a[116:119]
    v_exp_f32 v143, v143
    v_mfma_f32_16x16x32_bf16 a[116:119], a[220:223], v[212:215], a[116:119]
    v_exp_f32 v144, v144
    v_mfma_f32_16x16x32_bf16 a[120:123], a[216:219], v[200:203], a[120:123]
    v_exp_f32 v145, v145
    v_mfma_f32_16x16x32_bf16 a[120:123], a[220:223], v[216:219], a[120:123]
    buffer_load_dwordx4 v23, s[40:43], s8 offen offset:1024 lds
    v_cvt_pk_bf16_f32 v188, v140, v141
    v_mfma_f32_16x16x32_bf16 a[124:127], a[216:219], v[204:207], a[124:127]
    v_exp_f32 v146, v146
    v_mfma_f32_16x16x32_bf16 a[124:127], a[220:223], v[220:223], a[124:127]
    v_cvt_pk_bf16_f32 v189, v142, v143
    s_waitcnt lgkmcnt(0)
    v_mfma_f32_16x16x32_bf16 v[96:99], a[192:195], v[32:35], v[224:227]
    ds_read_b128 a[208:211], v17 offset:17536
    ds_read_b128 a[212:215], v18 offset:17536
    v_mfma_f32_16x16x32_bf16 v[96:99], a[196:199], v[48:51], v[96:99]
    ds_read_b128 a[216:219], v19 offset:17536
    ds_read_b128 a[220:223], v20 offset:17536
    v_mfma_f32_16x16x32_bf16 v[96:99], a[200:203], v[64:67], v[96:99]
    buffer_load_dwordx4 v24, s[40:43], s8 offen offset:2048 lds
    v_mfma_f32_16x16x32_bf16 v[96:99], a[204:207], v[80:83], v[96:99]
    v_exp_f32 v147, v147
    v_mfma_f32_16x16x32_bf16 v[100:103], a[192:195], v[36:39], v[228:231]
    ds_read_b64_tr_b16 a[144:145], v10 offset:12384
    v_cvt_pk_bf16_f32 v178, v144, v145
    v_mfma_f32_16x16x32_bf16 v[100:103], a[196:199], v[52:55], v[100:103]
    v_exp_f32 v148, v148
    v_mfma_f32_16x16x32_bf16 v[100:103], a[200:203], v[68:71], v[100:103]
    ds_read_b64_tr_b16 a[146:147], v10 offset:12640
    v_cvt_pk_bf16_f32 v179, v146, v147
    v_mfma_f32_16x16x32_bf16 v[100:103], a[204:207], v[84:87], v[100:103]
    buffer_load_dwordx4 v25, s[40:43], s8 offen offset:3072 lds
    s_add_u32 s8, s8, 16384
    v_mfma_f32_16x16x32_bf16 v[104:107], a[192:195], v[40:43], v[232:235]
    ds_read_b64_tr_b16 a[148:149], v10 offset:14448
    s_and_b32 s8, s8, 0x1ffff
    v_mfma_f32_16x16x32_bf16 v[104:107], a[196:199], v[56:59], v[104:107]
    s_add_u32 m0, s7, 16512
    v_mfma_f32_16x16x32_bf16 v[104:107], a[200:203], v[72:75], v[104:107]
    ds_read_b64_tr_b16 a[150:151], v10 offset:14704
    v_mfma_f32_16x16x32_bf16 v[104:107], a[204:207], v[88:91], v[104:107]
    v_exp_f32 v149, v149
    v_mfma_f32_16x16x32_bf16 v[108:111], a[192:195], v[44:47], v[236:239]
    buffer_load_dwordx4 v26, s[44:47], s9 offen offset:0 lds
    ds_read_b64_tr_b16 a[152:153], v10 offset:12392
    v_mfma_f32_16x16x32_bf16 v[108:111], a[196:199], v[60:63], v[108:111]
    v_exp_f32 v150, v150
    v_mfma_f32_16x16x32_bf16 v[108:111], a[200:203], v[76:79], v[108:111]
    ds_read_b64_tr_b16 a[154:155], v10 offset:12648
    v_mfma_f32_16x16x32_bf16 v[108:111], a[204:207], v[92:95], v[108:111]
    s_waitcnt lgkmcnt(4)
    v_mfma_f32_16x16x32_bf16 v[112:115], a[208:211], v[32:35], v[224:227]
    ds_read_b128 a[192:195], v17 offset:18560
    ds_read_b128 a[196:199], v18 offset:18560
    v_mfma_f32_16x16x32_bf16 v[112:115], a[212:215], v[48:51], v[112:115]
    buffer_load_dwordx4 v27, s[44:47], s9 offen offset:1032 lds
    ds_read_b64_tr_b16 a[156:157], v10 offset:14456
    v_mfma_f32_16x16x32_bf16 v[112:115], a[216:219], v[64:67], v[112:115]
    ds_read_b128 a[200:203], v19 offset:18560
    ds_read_b128 a[204:207], v20 offset:18560
    v_mfma_f32_16x16x32_bf16 v[112:115], a[220:223], v[80:83], v[112:115]
    ds_read_b64_tr_b16 a[158:159], v10 offset:14712
    v_mfma_f32_16x16x32_bf16 v[116:119], a[208:211], v[36:39], v[228:231]
    s_waitcnt vmcnt(16)
    ds_read_b64_tr_b16 a[160:161], v10 offset:0
    v_mfma_f32_16x16x32_bf16 v[116:119], a[212:215], v[52:55], v[116:119]
    v_exp_f32 v151, v151
    v_mfma_f32_16x16x32_bf16 v[116:119], a[216:219], v[68:71], v[116:119]
    buffer_load_dwordx4 v28, s[44:47], s9 offen offset:2064 lds
    v_cvt_pk_bf16_f32 v182, v148, v149
    v_mfma_f32_16x16x32_bf16 v[116:119], a[220:223], v[84:87], v[116:119]
    ds_read_b64_tr_b16 a[162:163], v10 offset:256
    v_cvt_pk_bf16_f32 v183, v150, v151
    v_mfma_f32_16x16x32_bf16 v[120:123], a[208:211], v[40:43], v[232:235]
    ds_read_b64_tr_b16 a[164:165], v10 offset:2064
    v_mfma_f32_16x16x32_bf16 v[120:123], a[212:215], v[56:59], v[120:123]
    v_exp_f32 v152, v152
    v_mfma_f32_16x16x32_bf16 v[120:123], a[216:219], v[72:75], v[120:123]
    ds_read_b64_tr_b16 a[166:167], v10 offset:2320
    v_mfma_f32_16x16x32_bf16 v[120:123], a[220:223], v[88:91], v[120:123]
    buffer_load_dwordx4 v29, s[44:47], s9 offen offset:3096 lds
    s_add_u32 s9, s9, 16384
    v_mfma_f32_16x16x32_bf16 v[124:127], a[208:211], v[44:47], v[236:239]
    ds_read_b64_tr_b16 a[168:169], v10 offset:8
    s_and_b32 s9, s9, 0x1ffff
    v_mfma_f32_16x16x32_bf16 v[124:127], a[212:215], v[60:63], v[124:127]
    s_add_u32 m0, s63, 8256
    s_add_u32 s60, s92, s94
    s_add_u32 s60, s60, 0x10000
    v_mfma_f32_16x16x32_bf16 v[124:127], a[216:219], v[76:79], v[124:127]
    ds_read_b64_tr_b16 a[170:171], v10 offset:264
    v_mfma_f32_16x16x32_bf16 v[124:127], a[220:223], v[92:95], v[124:127]
    s_waitcnt lgkmcnt(3)
    v_mfma_f32_16x16x32_bf16 v[128:131], a[192:195], v[32:35], v[224:227]
    buffer_load_dwordx4 v11, s[36:39], s60 offen offset:0 lds
    ds_read_b128 a[208:211], v17 offset:19584
    v_mfma_f32_16x16x32_bf16 v[128:131], a[196:199], v[48:51], v[128:131]
    ds_read_b128 a[212:215], v18 offset:19584
    ds_read_b64_tr_b16 a[172:173], v10 offset:2072
    v_mfma_f32_16x16x32_bf16 v[128:131], a[200:203], v[64:67], v[128:131]
    ds_read_b128 a[216:219], v19 offset:19584
    ds_read_b128 a[220:223], v20 offset:19584
    v_mfma_f32_16x16x32_bf16 v[128:131], a[204:207], v[80:83], v[128:131]
    ds_read_b64_tr_b16 a[174:175], v10 offset:2328
    v_mfma_f32_16x16x32_bf16 v[132:135], a[192:195], v[36:39], v[228:231]
    v_exp_f32 v153, v153
    v_mfma_f32_16x16x32_bf16 v[132:135], a[196:199], v[52:55], v[132:135]
    buffer_load_dwordx4 v12, s[36:39], s60 offen offset:1032 lds
    v_mfma_f32_16x16x32_bf16 v[132:135], a[200:203], v[68:71], v[132:135]
    v_exp_f32 v154, v154
    v_mfma_f32_16x16x32_bf16 v[132:135], a[204:207], v[84:87], v[132:135]
    v_exp_f32 v155, v155
    v_mfma_f32_16x16x32_bf16 v[136:139], a[192:195], v[40:43], v[232:235]
    v_exp_f32 v156, v156
    v_mfma_f32_16x16x32_bf16 v[136:139], a[196:199], v[56:59], v[136:139]
    v_exp_f32 v157, v157
    v_mfma_f32_16x16x32_bf16 v[136:139], a[200:203], v[72:75], v[136:139]
    buffer_load_dwordx4 v13, s[36:39], s60 offen offset:2064 lds
    v_cvt_pk_bf16_f32 v186, v152, v153
    v_mfma_f32_16x16x32_bf16 v[136:139], a[204:207], v[88:91], v[136:139]
    v_exp_f32 v158, v158
    v_mfma_f32_16x16x32_bf16 v[140:143], a[192:195], v[44:47], v[236:239]
    v_exp_f32 v159, v159
    v_mfma_f32_16x16x32_bf16 v[140:143], a[196:199], v[60:63], v[140:143]
    v_exp_f32 v96, v96
    v_mfma_f32_16x16x32_bf16 v[140:143], a[200:203], v[76:79], v[140:143]
    v_exp_f32 v97, v97
    v_mfma_f32_16x16x32_bf16 v[140:143], a[204:207], v[92:95], v[140:143]
    buffer_load_dwordx4 v14, s[36:39], s60 offen offset:3096 lds
    s_waitcnt lgkmcnt(0)
    v_mfma_f32_16x16x32_bf16 v[144:147], a[208:211], v[32:35], v[224:227]
    ds_read_b64_tr_b16 a[192:193], v21 offset:0
    s_add_u32 s94, s94, 0x20000
    v_mfma_f32_16x16x32_bf16 v[144:147], a[212:215], v[48:51], v[144:147]
    s_and_b32 s94, s94, 0x7ffff
    s_add_u32 m0, s63, 12384
    v_mfma_f32_16x16x32_bf16 v[144:147], a[216:219], v[64:67], v[144:147]
    ds_read_b64_tr_b16 a[194:195], v21 offset:4128
    s_add_u32 s60, s92, s94
    s_add_u32 s60, s60, 0x10000
    v_mfma_f32_16x16x32_bf16 v[144:147], a[220:223], v[80:83], v[144:147]
    ds_read_b64_tr_b16 a[196:197], v21 offset:8256
    v_cvt_pk_bf16_f32 v187, v154, v155
    v_mfma_f32_16x16x32_bf16 v[148:151], a[208:211], v[36:39], v[228:231]
    ds_read_b64_tr_b16 a[198:199], v21 offset:12384
    v_cvt_pk_bf16_f32 v190, v156, v157
    v_mfma_f32_16x16x32_bf16 v[148:151], a[212:215], v[52:55], v[148:151]
    buffer_load_dwordx4 v11, s[36:39], s60 offen offset:0 lds
    ds_read_b64_tr_b16 a[200:201], v21 offset:8
    v_mfma_f32_16x16x32_bf16 v[148:151], a[216:219], v[68:71], v[148:151]
    ds_read_b64_tr_b16 a[202:203], v21 offset:4136
    v_cvt_pk_bf16_f32 v191, v158, v159
    v_mfma_f32_16x16x32_bf16 v[148:151], a[220:223], v[84:87], v[148:151]
    ds_read_b64_tr_b16 a[204:205], v21 offset:8264
    ds_read_b64_tr_b16 a[206:207], v21 offset:12392
    v_mfma_f32_16x16x32_bf16 v[152:155], a[208:211], v[40:43], v[232:235]
    v_exp_f32 v98, v98
    v_mfma_f32_16x16x32_bf16 v[152:155], a[212:215], v[56:59], v[152:155]
    buffer_load_dwordx4 v12, s[36:39], s60 offen offset:1032 lds
    v_mfma_f32_16x16x32_bf16 v[152:155], a[216:219], v[72:75], v[152:155]
    v_exp_f32 v99, v99
    v_mfma_f32_16x16x32_bf16 v[152:155], a[220:223], v[88:91], v[152:155]
    v_exp_f32 v100, v100
    v_mfma_f32_16x16x32_bf16 v[156:159], a[208:211], v[44:47], v[236:239]
    v_exp_f32 v101, v101
    v_mfma_f32_16x16x32_bf16 v[156:159], a[212:215], v[60:63], v[156:159]
    v_exp_f32 v102, v102
    v_mfma_f32_16x16x32_bf16 v[156:159], a[216:219], v[76:79], v[156:159]
    buffer_load_dwordx4 v13, s[36:39], s60 offen offset:2064 lds
    v_cvt_pk_bf16_f32 v192, v96, v97
    v_mfma_f32_16x16x32_bf16 v[156:159], a[220:223], v[92:95], v[156:159]
    v_cvt_pk_bf16_f32 v193, v98, v99
    v_mfma_f32_16x16x32_bf16 a[224:227], a[240:243], v[160:163], a[224:227]
    v_exp_f32 v103, v103
    v_mfma_f32_16x16x32_bf16 a[224:227], a[240:243], v[176:179], a[224:227]
    v_exp_f32 v104, v104
    v_mfma_f32_16x16x32_bf16 a[228:231], a[240:243], v[164:167], a[228:231]
    v_exp_f32 v105, v105
    v_mfma_f32_16x16x32_bf16 a[228:231], a[240:243], v[180:183], a[228:231]
    buffer_load_dwordx4 v14, s[36:39], s60 offen offset:3096 lds
    s_add_u32 s94, s94, 0x20000
    v_mfma_f32_16x16x32_bf16 a[232:235], a[240:243], v[168:171], a[232:235]
    s_and_b32 s94, s94, 0x7ffff
    v_lshrrev_b32 v253, 5, v1
    v_mfma_f32_16x16x32_bf16 a[232:235], a[240:243], v[184:187], a[232:235]
    v_lshlrev_b32 v253, 11, v253
    v_and_b32 v255, 31, v1
    v_mfma_f32_16x16x32_bf16 a[236:239], a[240:243], v[172:175], a[236:239]
    v_lshl_add_u32 v253, v255, 4, v253
    s_lshl_b32 s10, s57, 3
    v_mfma_f32_16x16x32_bf16 a[236:239], a[240:243], v[188:191], a[236:239]
    s_add_u32 s10, s10, s56
    s_lshl_b32 s10, s10, 2
    s_waitcnt lgkmcnt(0)
    v_mfma_f32_16x16x32_bf16 a[0:3], a[192:195], v[160:163], a[0:3]
    s_add_u32 s10, s10, s35
    s_lshl_b32 s10, s10, 5
    s_add_u32 s11, s14, 2
    s_and_b32 s11, s11, 3
    s_add_u32 s10, s10, s11
    s_lshl_b32 s10, s10, 9
    s_add_u32 s10, s10, 16777216
    v_mfma_f32_16x16x32_bf16 a[0:3], a[196:199], v[176:179], a[0:3]
    ds_read_b64_tr_b16 a[208:209], v21 offset:256
    v_cvt_pk_bf16_f32 v196, v100, v101
    v_mfma_f32_16x16x32_bf16 a[4:7], a[192:195], v[164:167], a[4:7]
    buffer_store_dwordx4 a[248:251], v253, s[48:51], s10 offen offset:0 sc1
    ds_read_b64_tr_b16 a[210:211], v21 offset:4384
    v_mfma_f32_16x16x32_bf16 a[4:7], a[196:199], v[180:183], a[4:7]
    ds_read_b64_tr_b16 a[212:213], v21 offset:8512
    s_add_u32 s10, s10, 4096
    v_mfma_f32_16x16x32_bf16 a[8:11], a[192:195], v[168:171], a[8:11]
    ds_read_b64_tr_b16 a[214:215], v21 offset:12640
    v_cvt_pk_bf16_f32 v197, v102, v103
    v_mfma_f32_16x16x32_bf16 a[8:11], a[196:199], v[184:187], a[8:11]
    ds_read_b64_tr_b16 a[216:217], v21 offset:264
    ds_read_b64_tr_b16 a[218:219], v21 offset:4392
    v_mfma_f32_16x16x32_bf16 a[12:15], a[192:195], v[172:175], a[12:15]
    buffer_store_dwordx4 a[248:251], v253, s[48:51], s10 offen offset:0 sc1
    ds_read_b64_tr_b16 a[220:221], v21 offset:8520
    v_mfma_f32_16x16x32_bf16 a[12:15], a[196:199], v[188:191], a[12:15]
    ds_read_b64_tr_b16 a[222:223], v21 offset:12648
    v_mfma_f32_16x16x32_bf16 a[16:19], a[200:203], v[160:163], a[16:19]
    v_exp_f32 v106, v106
    v_mfma_f32_16x16x32_bf16 a[16:19], a[204:207], v[176:179], a[16:19]
    v_exp_f32 v107, v107
    v_mfma_f32_16x16x32_bf16 a[20:23], a[200:203], v[164:167], a[20:23]
    v_exp_f32 v108, v108
    v_mfma_f32_16x16x32_bf16 a[20:23], a[204:207], v[180:183], a[20:23]
    v_exp_f32 v109, v109
    v_mfma_f32_16x16x32_bf16 a[24:27], a[200:203], v[168:171], a[24:27]
    v_exp_f32 v110, v110
    v_mfma_f32_16x16x32_bf16 a[24:27], a[204:207], v[184:187], a[24:27]
    v_exp_f32 v111, v111
    v_mfma_f32_16x16x32_bf16 a[28:31], a[200:203], v[172:175], a[28:31]
    v_exp_f32 v112, v112
    v_mfma_f32_16x16x32_bf16 a[28:31], a[204:207], v[188:191], a[28:31]
    v_cvt_pk_bf16_f32 v200, v104, v105
    s_waitcnt lgkmcnt(0)
    v_mfma_f32_16x16x32_bf16 a[32:35], a[208:211], v[160:163], a[32:35]
    ds_read_b64_tr_b16 a[192:193], v21 offset:512
    v_cvt_pk_bf16_f32 v201, v106, v107
    v_mfma_f32_16x16x32_bf16 a[32:35], a[212:215], v[176:179], a[32:35]
    ds_read_b64_tr_b16 a[194:195], v21 offset:4640
    v_cvt_pk_bf16_f32 v204, v108, v109
    v_mfma_f32_16x16x32_bf16 a[36:39], a[208:211], v[164:167], a[36:39]
    ds_read_b64_tr_b16 a[196:197], v21 offset:8768
    v_cvt_pk_bf16_f32 v205, v110, v111
    v_mfma_f32_16x16x32_bf16 a[36:39], a[212:215], v[180:183], a[36:39]
    ds_read_b64_tr_b16 a[198:199], v21 offset:12896
    ds_read_b64_tr_b16 a[200:201], v21 offset:520
    v_mfma_f32_16x16x32_bf16 a[40:43], a[208:211], v[168:171], a[40:43]
    ds_read_b64_tr_b16 a[202:203], v21 offset:4648
    ds_read_b64_tr_b16 a[204:205], v21 offset:8776
    v_mfma_f32_16x16x32_bf16 a[40:43], a[212:215], v[184:187], a[40:43]
    ds_read_b64_tr_b16 a[206:207], v21 offset:12904
    v_mfma_f32_16x16x32_bf16 a[44:47], a[208:211], v[172:175], a[44:47]
    v_exp_f32 v113, v113
    v_mfma_f32_16x16x32_bf16 a[44:47], a[212:215], v[188:191], a[44:47]
    v_exp_f32 v114, v114
    v_mfma_f32_16x16x32_bf16 a[48:51], a[216:219], v[160:163], a[48:51]
    v_exp_f32 v115, v115
    v_mfma_f32_16x16x32_bf16 a[48:51], a[220:223], v[176:179], a[48:51]
    v_exp_f32 v116, v116
    v_mfma_f32_16x16x32_bf16 a[52:55], a[216:219], v[164:167], a[52:55]
    v_exp_f32 v117, v117
    v_mfma_f32_16x16x32_bf16 a[52:55], a[220:223], v[180:183], a[52:55]
    v_exp_f32 v118, v118
    v_mfma_f32_16x16x32_bf16 a[56:59], a[216:219], v[168:171], a[56:59]
    v_exp_f32 v119, v119
    v_mfma_f32_16x16x32_bf16 a[56:59], a[220:223], v[184:187], a[56:59]
    v_exp_f32 v120, v120
    v_mfma_f32_16x16x32_bf16 a[60:63], a[216:219], v[172:175], a[60:63]
    v_exp_f32 v121, v121
    v_mfma_f32_16x16x32_bf16 a[60:63], a[220:223], v[188:191], a[60:63]
    v_cvt_pk_bf16_f32 v194, v112, v113
    s_waitcnt lgkmcnt(0)
    v_mfma_f32_16x16x32_bf16 a[64:67], a[192:195], v[160:163], a[64:67]
    ds_read_b64_tr_b16 a[208:209], v21 offset:768
    v_cvt_pk_bf16_f32 v195, v114, v115
    v_mfma_f32_16x16x32_bf16 a[64:67], a[196:199], v[176:179], a[64:67]
    ds_read_b64_tr_b16 a[210:211], v21 offset:4896
    v_cvt_pk_bf16_f32 v198, v116, v117
    v_mfma_f32_16x16x32_bf16 a[68:71], a[192:195], v[164:167], a[68:71]
    ds_read_b64_tr_b16 a[212:213], v21 offset:9024
    v_cvt_pk_bf16_f32 v199, v118, v119
    v_mfma_f32_16x16x32_bf16 a[68:71], a[196:199], v[180:183], a[68:71]
    ds_read_b64_tr_b16 a[214:215], v21 offset:13152
    ds_read_b64_tr_b16 a[216:217], v21 offset:776
    v_mfma_f32_16x16x32_bf16 a[72:75], a[192:195], v[168:171], a[72:75]
    ds_read_b64_tr_b16 a[218:219], v21 offset:4904
    ds_read_b64_tr_b16 a[220:221], v21 offset:9032
    v_mfma_f32_16x16x32_bf16 a[72:75], a[196:199], v[184:187], a[72:75]
    ds_read_b64_tr_b16 a[222:223], v21 offset:13160
    v_mfma_f32_16x16x32_bf16 a[76:79], a[192:195], v[172:175], a[76:79]
    v_exp_f32 v122, v122
    v_mfma_f32_16x16x32_bf16 a[76:79], a[196:199], v[188:191], a[76:79]
    v_exp_f32 v123, v123
    v_mfma_f32_16x16x32_bf16 a[80:83], a[200:203], v[160:163], a[80:83]
    v_exp_f32 v124, v124
    v_mfma_f32_16x16x32_bf16 a[80:83], a[204:207], v[176:179], a[80:83]
    v_exp_f32 v125, v125
L_stub7:
    s_cbranch_execz L_stub11
    v_mfma_f32_16x16x32_bf16 a[84:87], a[200:203], v[164:167], a[84:87]
    v_exp_f32 v126, v126
    v_mfma_f32_16x16x32_bf16 a[84:87], a[204:207], v[180:183], a[84:87]
    v_exp_f32 v127, v127
    v_mfma_f32_16x16x32_bf16 a[88:91], a[200:203], v[168:171], a[88:91]
    v_exp_f32 v128, v128
    v_mfma_f32_16x16x32_bf16 a[88:91], a[204:207], v[184:187], a[88:91]
    v_exp_f32 v129, v129
    v_mfma_f32_16x16x32_bf16 a[92:95], a[200:203], v[172:175], a[92:95]
    v_exp_f32 v130, v130
    v_mfma_f32_16x16x32_bf16 a[92:95], a[204:207], v[188:191], a[92:95]
    v_cvt_pk_bf16_f32 v202, v120, v121
    s_waitcnt lgkmcnt(0)
    v_mfma_f32_16x16x32_bf16 a[96:99], a[208:211], v[160:163], a[96:99]
    v_exp_f32 v131, v131
    v_mfma_f32_16x16x32_bf16 a[96:99], a[212:215], v[176:179], a[96:99]
    s_waitcnt vmcnt(10)
    s_barrier
    v_cvt_pk_bf16_f32 v203, v122, v123
    v_mfma_f32_16x16x32_bf16 a[100:103], a[208:211], v[164:167], a[100:103]
    ds_read_b128 a[192:195], v17 offset:0
    v_cvt_pk_bf16_f32 v206, v124, v125
    v_mfma_f32_16x16x32_bf16 a[100:103], a[212:215], v[180:183], a[100:103]
    ds_read_b128 a[196:199], v18 offset:0
    v_cvt_pk_bf16_f32 v207, v126, v127
    v_mfma_f32_16x16x32_bf16 a[104:107], a[208:211], v[168:171], a[104:107]
    ds_read_b128 a[200:203], v19 offset:0
    v_cvt_pk_bf16_f32 v208, v128, v129
    v_mfma_f32_16x16x32_bf16 a[104:107], a[212:215], v[184:187], a[104:107]
    ds_read_b128 a[204:207], v20 offset:0
    s_add_u32 m0, s6, 16512
    v_mfma_f32_16x16x32_bf16 a[108:111], a[208:211], v[172:175], a[108:111]
    v_exp_f32 v132, v132
    v_mfma_f32_16x16x32_bf16 a[108:111], a[212:215], v[188:191], a[108:111]
    v_exp_f32 v133, v133
    v_mfma_f32_16x16x32_bf16 a[112:115], a[216:219], v[160:163], a[112:115]
    buffer_load_dwordx4 v22, s[40:43], s8 offen offset:0 lds
    v_cvt_pk_bf16_f32 v209, v130, v131
    v_mfma_f32_16x16x32_bf16 a[112:115], a[220:223], v[176:179], a[112:115]
    v_exp_f32 v134, v134
    v_mfma_f32_16x16x32_bf16 a[116:119], a[216:219], v[164:167], a[116:119]
    v_exp_f32 v135, v135
    v_mfma_f32_16x16x32_bf16 a[116:119], a[220:223], v[180:183], a[116:119]
    v_exp_f32 v136, v136
    v_mfma_f32_16x16x32_bf16 a[120:123], a[216:219], v[168:171], a[120:123]
    v_exp_f32 v137, v137
    v_mfma_f32_16x16x32_bf16 a[120:123], a[220:223], v[184:187], a[120:123]
    buffer_load_dwordx4 v23, s[40:43], s8 offen offset:1024 lds
    v_cvt_pk_bf16_f32 v212, v132, v133
    v_mfma_f32_16x16x32_bf16 a[124:127], a[216:219], v[172:175], a[124:127]
    v_exp_f32 v138, v138
    v_mfma_f32_16x16x32_bf16 a[124:127], a[220:223], v[188:191], a[124:127]
    v_cvt_pk_bf16_f32 v213, v134, v135
    s_waitcnt lgkmcnt(0)
    v_mfma_f32_16x16x32_bf16 v[96:99], a[192:195], v[32:35], v[224:227]
    ds_read_b128 a[208:211], v17 offset:1024
    ds_read_b128 a[212:215], v18 offset:1024
    v_mfma_f32_16x16x32_bf16 v[96:99], a[196:199], v[48:51], v[96:99]
    ds_read_b128 a[216:219], v19 offset:1024
    ds_read_b128 a[220:223], v20 offset:1024
    v_mfma_f32_16x16x32_bf16 v[96:99], a[200:203], v[64:67], v[96:99]
    buffer_load_dwordx4 v24, s[40:43], s8 offen offset:2048 lds
    v_mfma_f32_16x16x32_bf16 v[96:99], a[204:207], v[80:83], v[96:99]
    v_exp_f32 v139, v139
    v_mfma_f32_16x16x32_bf16 v[100:103], a[192:195], v[36:39], v[228:231]
    ds_read_b64_tr_b16 a[176:177], v10 offset:4128
    v_cvt_pk_bf16_f32 v216, v136, v137
    v_mfma_f32_16x16x32_bf16 v[100:103], a[196:199], v[52:55], v[100:103]
    v_exp_f32 v140, v140
    v_mfma_f32_16x16x32_bf16 v[100:103], a[200:203], v[68:71], v[100:103]
    ds_read_b64_tr_b16 a[178:179], v10 offset:4384
    v_cvt_pk_bf16_f32 v217, v138, v139
    v_mfma_f32_16x16x32_bf16 v[100:103], a[204:207], v[84:87], v[100:103]
    buffer_load_dwordx4 v25, s[40:43], s8 offen offset:3072 lds
    s_add_u32 s8, s8, 16384
    v_mfma_f32_16x16x32_bf16 v[104:107], a[192:195], v[40:43], v[232:235]
    ds_read_b64_tr_b16 a[180:181], v10 offset:6192
    s_and_b32 s8, s8, 0x1ffff
    v_mfma_f32_16x16x32_bf16 v[104:107], a[196:199], v[56:59], v[104:107]
    s_add_u32 m0, s7, 0
    v_mfma_f32_16x16x32_bf16 v[104:107], a[200:203], v[72:75], v[104:107]
    ds_read_b64_tr_b16 a[182:183], v10 offset:6448
    v_mfma_f32_16x16x32_bf16 v[104:107], a[204:207], v[88:91], v[104:107]
    v_exp_f32 v141, v141
    v_mfma_f32_16x16x32_bf16 v[108:111], a[192:195], v[44:47], v[236:239]
    buffer_load_dwordx4 v26, s[44:47], s9 offen offset:0 lds
    ds_read_b64_tr_b16 a[184:185], v10 offset:4136
    v_mfma_f32_16x16x32_bf16 v[108:111], a[196:199], v[60:63], v[108:111]
    v_exp_f32 v142, v142
    v_mfma_f32_16x16x32_bf16 v[108:111], a[200:203], v[76:79], v[108:111]
    ds_read_b64_tr_b16 a[186:187], v10 offset:4392
    v_mfma_f32_16x16x32_bf16 v[108:111], a[204:207], v[92:95], v[108:111]
    s_waitcnt lgkmcnt(4)
    v_mfma_f32_16x16x32_bf16 v[112:115], a[208:211], v[32:35], v[224:227]
    ds_read_b128 a[192:195], v17 offset:2048
    ds_read_b128 a[196:199], v18 offset:2048
    v_mfma_f32_16x16x32_bf16 v[112:115], a[212:215], v[48:51], v[112:115]
    buffer_load_dwordx4 v27, s[44:47], s9 offen offset:1032 lds
    ds_read_b64_tr_b16 a[188:189], v10 offset:6200
    v_mfma_f32_16x16x32_bf16 v[112:115], a[216:219], v[64:67], v[112:115]
    ds_read_b128 a[200:203], v19 offset:2048
    ds_read_b128 a[204:207], v20 offset:2048
    v_mfma_f32_16x16x32_bf16 v[112:115], a[220:223], v[80:83], v[112:115]
    ds_read_b64_tr_b16 a[190:191], v10 offset:6456
    v_mfma_f32_16x16x32_bf16 v[116:119], a[208:211], v[36:39], v[228:231]
    v_exp_f32 v143, v143
    v_mfma_f32_16x16x32_bf16 v[116:119], a[212:215], v[52:55], v[116:119]
    v_exp_f32 v144, v144
    v_mfma_f32_16x16x32_bf16 v[116:119], a[216:219], v[68:71], v[116:119]
    buffer_load_dwordx4 v28, s[44:47], s9 offen offset:2064 lds
    v_cvt_pk_bf16_f32 v220, v140, v141
    v_mfma_f32_16x16x32_bf16 v[116:119], a[220:223], v[84:87], v[116:119]
    v_exp_f32 v145, v145
    v_mfma_f32_16x16x32_bf16 v[120:123], a[208:211], v[40:43], v[232:235]
    v_exp_f32 v146, v146
    v_mfma_f32_16x16x32_bf16 v[120:123], a[212:215], v[56:59], v[120:123]
    v_exp_f32 v147, v147
    v_mfma_f32_16x16x32_bf16 v[120:123], a[216:219], v[72:75], v[120:123]
    v_exp_f32 v148, v148
    v_mfma_f32_16x16x32_bf16 v[120:123], a[220:223], v[88:91], v[120:123]
    buffer_load_dwordx4 v29, s[44:47], s9 offen offset:3096 lds
    s_add_u32 s9, s9, 16384
    v_mfma_f32_16x16x32_bf16 v[124:127], a[208:211], v[44:47], v[236:239]
    s_and_b32 s9, s9, 0x1ffff
    v_cvt_pk_bf16_f32 v221, v142, v143
    v_mfma_f32_16x16x32_bf16 v[124:127], a[212:215], v[60:63], v[124:127]
    s_add_u32 m0, s63, 0
    s_add_u32 s60, s92, s94
    s_add_u32 s60, s60, 0x10000
    v_mfma_f32_16x16x32_bf16 v[124:127], a[216:219], v[76:79], v[124:127]
    v_exp_f32 v149, v149
    v_mfma_f32_16x16x32_bf16 v[124:127], a[220:223], v[92:95], v[124:127]
    v_cvt_pk_bf16_f32 v210, v144, v145
    s_waitcnt lgkmcnt(0)
    v_mfma_f32_16x16x32_bf16 v[128:131], a[192:195], v[32:35], v[224:227]
    buffer_load_dwordx4 v11, s[36:39], s60 offen offset:0 lds
    v_cvt_pk_bf16_f32 v211, v146, v147
    v_mfma_f32_16x16x32_bf16 v[128:131], a[196:199], v[48:51], v[128:131]
    ds_read_b128 a[208:211], v17 offset:3072
    ds_read_b128 a[212:215], v18 offset:3072
    v_mfma_f32_16x16x32_bf16 v[128:131], a[200:203], v[64:67], v[128:131]
    ds_read_b128 a[216:219], v19 offset:3072
    ds_read_b128 a[220:223], v20 offset:3072
    v_mfma_f32_16x16x32_bf16 v[128:131], a[204:207], v[80:83], v[128:131]
    v_exp_f32 v150, v150
    v_mfma_f32_16x16x32_bf16 v[132:135], a[192:195], v[36:39], v[228:231]
    v_exp_f32 v151, v151
    v_mfma_f32_16x16x32_bf16 v[132:135], a[196:199], v[52:55], v[132:135]
    buffer_load_dwordx4 v12, s[36:39], s60 offen offset:1032 lds
    v_cvt_pk_bf16_f32 v214, v148, v149
    v_mfma_f32_16x16x32_bf16 v[132:135], a[200:203], v[68:71], v[132:135]
    v_exp_f32 v152, v152
    v_mfma_f32_16x16x32_bf16 v[132:135], a[204:207], v[84:87], v[132:135]
    v_exp_f32 v153, v153
    v_mfma_f32_16x16x32_bf16 v[136:139], a[192:195], v[40:43], v[232:235]
    v_exp_f32 v154, v154
    v_mfma_f32_16x16x32_bf16 v[136:139], a[196:199], v[56:59], v[136:139]
    v_exp_f32 v155, v155
    v_mfma_f32_16x16x32_bf16 v[136:139], a[200:203], v[72:75], v[136:139]
    buffer_load_dwordx4 v13, s[36:39], s60 offen offset:2064 lds
    v_cvt_pk_bf16_f32 v215, v150, v151
    v_mfma_f32_16x16x32_bf16 v[136:139], a[204:207], v[88:91], v[136:139]
    v_exp_f32 v156, v156
    v_mfma_f32_16x16x32_bf16 v[140:143], a[192:195], v[44:47], v[236:239]
    v_exp_f32 v157, v157
    v_mfma_f32_16x16x32_bf16 v[140:143], a[196:199], v[60:63], v[140:143]
    v_exp_f32 v158, v158
    v_mfma_f32_16x16x32_bf16 v[140:143], a[200:203], v[76:79], v[140:143]
    v_exp_f32 v159, v159
    v_mfma_f32_16x16x32_bf16 v[140:143], a[204:207], v[92:95], v[140:143]
    buffer_load_dwordx4 v14, s[36:39], s60 offen offset:3096 lds
    s_waitcnt lgkmcnt(0)
    v_mfma_f32_16x16x32_bf16 v[144:147], a[208:211], v[32:35], v[224:227]
    ds_read_b64_tr_b16 a[192:193], v21 offset:16512
    s_add_u32 s94, s94, 0x20000
    v_mfma_f32_16x16x32_bf16 v[144:147], a[212:215], v[48:51], v[144:147]
    s_and_b32 s94, s94, 0x7ffff
    s_add_u32 s93, s93, 4096
    v_mfma_f32_16x16x32_bf16 v[144:147], a[216:219], v[64:67], v[144:147]
    ds_read_b64_tr_b16 a[194:195], v21 offset:20640
    v_cvt_pk_bf16_f32 v218, v152, v153
    v_mfma_f32_16x16x32_bf16 v[144:147], a[220:223], v[80:83], v[144:147]
    ds_read_b64_tr_b16 a[196:197], v21 offset:24768
    v_cvt_pk_bf16_f32 v219, v154, v155
    v_mfma_f32_16x16x32_bf16 v[148:151], a[208:211], v[36:39], v[228:231]
    ds_read_b64_tr_b16 a[198:199], v21 offset:28896
    v_cvt_pk_bf16_f32 v222, v156, v157
    v_mfma_f32_16x16x32_bf16 v[148:151], a[212:215], v[52:55], v[148:151]
    ds_read_b64_tr_b16 a[200:201], v21 offset:16520
    v_cvt_pk_bf16_f32 v223, v158, v159
    v_mfma_f32_16x16x32_bf16 v[148:151], a[216:219], v[68:71], v[148:151]
    buffer_load_dwordx4 a[244:247], v16, s[52:55], s93 offen offset:0
    ds_read_b64_tr_b16 a[202:203], v21 offset:20648
    v_mfma_f32_16x16x32_bf16 v[148:151], a[220:223], v[84:87], v[148:151]
    ds_read_b64_tr_b16 a[204:205], v21 offset:24776
    ds_read_b64_tr_b16 a[206:207], v21 offset:28904
    v_mfma_f32_16x16x32_bf16 v[152:155], a[208:211], v[40:43], v[232:235]
    v_exp_f32 v96, v96
    v_mfma_f32_16x16x32_bf16 v[152:155], a[212:215], v[56:59], v[152:155]
    buffer_load_dwordx4 a[244:247], v16, s[52:55], s93 offen offset:1024
    v_mfma_f32_16x16x32_bf16 v[152:155], a[216:219], v[72:75], v[152:155]
    v_exp_f32 v97, v97
    v_mfma_f32_16x16x32_bf16 v[152:155], a[220:223], v[88:91], v[152:155]
    v_exp_f32 v98, v98
    v_mfma_f32_16x16x32_bf16 v[156:159], a[208:211], v[44:47], v[236:239]
    v_exp_f32 v99, v99
    v_mfma_f32_16x16x32_bf16 v[156:159], a[212:215], v[60:63], v[156:159]
    v_exp_f32 v100, v100
    v_mfma_f32_16x16x32_bf16 v[156:159], a[216:219], v[76:79], v[156:159]
    buffer_load_dwordx4 a[244:247], v16, s[52:55], s93 offen offset:2048
    v_cvt_pk_bf16_f32 v160, v96, v97
    v_mfma_f32_16x16x32_bf16 v[156:159], a[220:223], v[92:95], v[156:159]
    v_cvt_pk_bf16_f32 v161, v98, v99
    v_mfma_f32_16x16x32_bf16 a[224:227], a[240:243], v[192:195], a[224:227]
    v_exp_f32 v101, v101
    v_mfma_f32_16x16x32_bf16 a[224:227], a[240:243], v[208:211], a[224:227]
    v_exp_f32 v102, v102
    v_mfma_f32_16x16x32_bf16 a[228:231], a[240:243], v[196:199], a[228:231]
    v_exp_f32 v103, v103
    v_mfma_f32_16x16x32_bf16 a[228:231], a[240:243], v[212:215], a[228:231]
    buffer_load_dwordx4 a[244:247], v16, s[52:55], s93 offen offset:3072
    v_cvt_pk_bf16_f32 v164, v100, v101
    v_mfma_f32_16x16x32_bf16 a[232:235], a[240:243], v[200:203], a[232:235]
    s_add_u32 s10, s10, 4096
    v_cvt_pk_bf16_f32 v165, v102, v103
    v_mfma_f32_16x16x32_bf16 a[232:235], a[240:243], v[216:219], a[232:235]
    v_exp_f32 v104, v104
    v_mfma_f32_16x16x32_bf16 a[236:239], a[240:243], v[204:207], a[236:239]
    v_exp_f32 v105, v105
    v_mfma_f32_16x16x32_bf16 a[236:239], a[240:243], v[220:223], a[236:239]
    v_exp_f32 v106, v106
    s_waitcnt lgkmcnt(0)
    v_mfma_f32_16x16x32_bf16 a[0:3], a[192:195], v[192:195], a[0:3]
    ds_read_b64_tr_b16 a[208:209], v21 offset:16768
    ds_read_b64_tr_b16 a[210:211], v21 offset:20896
    v_mfma_f32_16x16x32_bf16 a[0:3], a[196:199], v[208:211], a[0:3]
    buffer_store_dwordx4 a[248:251], v253, s[48:51], s10 offen offset:0 sc1
    s_add_u32 s10, s10, 4096
    v_mfma_f32_16x16x32_bf16 a[4:7], a[192:195], v[196:199], a[4:7]
    ds_read_b64_tr_b16 a[212:213], v21 offset:25024
    ds_read_b64_tr_b16 a[214:215], v21 offset:29152
    v_mfma_f32_16x16x32_bf16 a[4:7], a[196:199], v[212:215], a[4:7]
    ds_read_b64_tr_b16 a[216:217], v21 offset:16776
    ds_read_b64_tr_b16 a[218:219], v21 offset:20904
    v_mfma_f32_16x16x32_bf16 a[8:11], a[192:195], v[200:203], a[8:11]
    ds_read_b64_tr_b16 a[220:221], v21 offset:25032
    ds_read_b64_tr_b16 a[222:223], v21 offset:29160
    v_mfma_f32_16x16x32_bf16 a[8:11], a[196:199], v[216:219], a[8:11]
    buffer_store_dwordx4 a[248:251], v253, s[48:51], s10 offen offset:0 sc1
    v_mfma_f32_16x16x32_bf16 a[12:15], a[192:195], v[204:207], a[12:15]
    s_lshl_b32 s10, s57, 3
    s_add_u32 s10, s10, s56
    v_mfma_f32_16x16x32_bf16 a[12:15], a[196:199], v[220:223], a[12:15]
    s_lshl_b32 s10, s10, 2
    s_add_u32 s10, s10, s35
    v_mfma_f32_16x16x32_bf16 a[16:19], a[200:203], v[192:195], a[16:19]
    s_lshl_b32 s10, s10, 5
    s_add_u32 s11, s14, 3
    v_mfma_f32_16x16x32_bf16 a[16:19], a[204:207], v[208:211], a[16:19]
    s_and_b32 s11, s11, 3
    s_add_u32 s10, s10, s11
    v_mfma_f32_16x16x32_bf16 a[20:23], a[200:203], v[196:199], a[20:23]
    s_lshl_b32 s10, s10, 9
    s_add_u32 s10, s10, 16777216
    v_mfma_f32_16x16x32_bf16 a[20:23], a[204:207], v[212:215], a[20:23]
    buffer_store_dwordx4 a[248:251], v253, s[48:51], s10 offen offset:0 sc1
    v_mfma_f32_16x16x32_bf16 a[24:27], a[200:203], v[200:203], a[24:27]
    v_exp_f32 v107, v107
    v_mfma_f32_16x16x32_bf16 a[24:27], a[204:207], v[216:219], a[24:27]
    v_exp_f32 v108, v108
    v_mfma_f32_16x16x32_bf16 a[28:31], a[200:203], v[204:207], a[28:31]
    v_exp_f32 v109, v109
    v_mfma_f32_16x16x32_bf16 a[28:31], a[204:207], v[220:223], a[28:31]
    v_cvt_pk_bf16_f32 v168, v104, v105
    s_waitcnt lgkmcnt(0)
    v_mfma_f32_16x16x32_bf16 a[32:35], a[208:211], v[192:195], a[32:35]
    ds_read_b64_tr_b16 a[192:193], v21 offset:17024
    v_cvt_pk_bf16_f32 v169, v106, v107
    v_mfma_f32_16x16x32_bf16 a[32:35], a[212:215], v[208:211], a[32:35]
    ds_read_b64_tr_b16 a[194:195], v21 offset:21152
    ds_read_b64_tr_b16 a[196:197], v21 offset:25280
    v_mfma_f32_16x16x32_bf16 a[36:39], a[208:211], v[196:199], a[36:39]
    ds_read_b64_tr_b16 a[198:199], v21 offset:29408
    ds_read_b64_tr_b16 a[200:201], v21 offset:17032
    v_mfma_f32_16x16x32_bf16 a[36:39], a[212:215], v[212:215], a[36:39]
    ds_read_b64_tr_b16 a[202:203], v21 offset:21160
    ds_read_b64_tr_b16 a[204:205], v21 offset:25288
    v_mfma_f32_16x16x32_bf16 a[40:43], a[208:211], v[200:203], a[40:43]
    ds_read_b64_tr_b16 a[206:207], v21 offset:29416
    v_mfma_f32_16x16x32_bf16 a[40:43], a[212:215], v[216:219], a[40:43]
    v_exp_f32 v110, v110
    v_mfma_f32_16x16x32_bf16 a[44:47], a[208:211], v[204:207], a[44:47]
    v_exp_f32 v111, v111
    v_mfma_f32_16x16x32_bf16 a[44:47], a[212:215], v[220:223], a[44:47]
    v_exp_f32 v112, v112
    v_mfma_f32_16x16x32_bf16 a[48:51], a[216:219], v[192:195], a[48:51]
    v_exp_f32 v113, v113
    v_mfma_f32_16x16x32_bf16 a[48:51], a[220:223], v[208:211], a[48:51]
    v_exp_f32 v114, v114
    v_mfma_f32_16x16x32_bf16 a[52:55], a[216:219], v[196:199], a[52:55]
    v_exp_f32 v115, v115
    v_mfma_f32_16x16x32_bf16 a[52:55], a[220:223], v[212:215], a[52:55]
    v_exp_f32 v116, v116
    v_mfma_f32_16x16x32_bf16 a[56:59], a[216:219], v[200:203], a[56:59]
    v_exp_f32 v117, v117
    v_mfma_f32_16x16x32_bf16 a[56:59], a[220:223], v[216:219], a[56:59]
    v_exp_f32 v118, v118
    v_mfma_f32_16x16x32_bf16 a[60:63], a[216:219], v[204:207], a[60:63]
    v_exp_f32 v119, v119
    v_mfma_f32_16x16x32_bf16 a[60:63], a[220:223], v[220:223], a[60:63]
    v_cvt_pk_bf16_f32 v172, v108, v109
    s_waitcnt lgkmcnt(0)
    v_mfma_f32_16x16x32_bf16 a[64:67], a[192:195], v[192:195], a[64:67]
    ds_read_b64_tr_b16 a[208:209], v21 offset:17280
    v_cvt_pk_bf16_f32 v173, v110, v111
    v_mfma_f32_16x16x32_bf16 a[64:67], a[196:199], v[208:211], a[64:67]
    ds_read_b64_tr_b16 a[210:211], v21 offset:21408
    v_cvt_pk_bf16_f32 v162, v112, v113
    v_mfma_f32_16x16x32_bf16 a[68:71], a[192:195], v[196:199], a[68:71]
    ds_read_b64_tr_b16 a[212:213], v21 offset:25536
    v_cvt_pk_bf16_f32 v163, v114, v115
    v_mfma_f32_16x16x32_bf16 a[68:71], a[196:199], v[212:215], a[68:71]
    ds_read_b64_tr_b16 a[214:215], v21 offset:29664
    v_cvt_pk_bf16_f32 v166, v116, v117
    v_mfma_f32_16x16x32_bf16 a[72:75], a[192:195], v[200:203], a[72:75]
    ds_read_b64_tr_b16 a[216:217], v21 offset:17288
    v_cvt_pk_bf16_f32 v167, v118, v119
    v_mfma_f32_16x16x32_bf16 a[72:75], a[196:199], v[216:219], a[72:75]
    ds_read_b64_tr_b16 a[218:219], v21 offset:21416
    ds_read_b64_tr_b16 a[220:221], v21 offset:25544
    v_mfma_f32_16x16x32_bf16 a[76:79], a[192:195], v[204:207], a[76:79]
    ds_read_b64_tr_b16 a[222:223], v21 offset:29672
    v_mfma_f32_16x16x32_bf16 a[76:79], a[196:199], v[220:223], a[76:79]
    v_exp_f32 v120, v120
    v_mfma_f32_16x16x32_bf16 a[80:83], a[200:203], v[192:195], a[80:83]
    v_exp_f32 v121, v121
    v_mfma_f32_16x16x32_bf16 a[80:83], a[204:207], v[208:211], a[80:83]
    v_exp_f32 v122, v122
    v_mfma_f32_16x16x32_bf16 a[84:87], a[200:203], v[196:199], a[84:87]
    v_exp_f32 v123, v123
    v_mfma_f32_16x16x32_bf16 a[84:87], a[204:207], v[212:215], a[84:87]
    v_exp_f32 v124, v124
    v_mfma_f32_16x16x32_bf16 a[88:91], a[200:203], v[200:203], a[88:91]
    v_exp_f32 v125, v125
    v_mfma_f32_16x16x32_bf16 a[88:91], a[204:207], v[216:219], a[88:91]
    v_exp_f32 v126, v126
    v_mfma_f32_16x16x32_bf16 a[92:95], a[200:203], v[204:207], a[92:95]
    v_exp_f32 v127, v127
    v_mfma_f32_16x16x32_bf16 a[92:95], a[204:207], v[220:223], a[92:95]
    v_cvt_pk_bf16_f32 v170, v120, v121
    s_waitcnt lgkmcnt(0)
    v_mfma_f32_16x16x32_bf16 a[96:99], a[208:211], v[192:195], a[96:99]
    v_exp_f32 v128, v128
    v_mfma_f32_16x16x32_bf16 a[96:99], a[212:215], v[208:211], a[96:99]
    s_waitcnt vmcnt(11)
    s_barrier
    v_cvt_pk_bf16_f32 v171, v122, v123
    v_mfma_f32_16x16x32_bf16 a[100:103], a[208:211], v[196:199], a[100:103]
    ds_read_b128 a[192:195], v17 offset:16512
    v_cvt_pk_bf16_f32 v174, v124, v125
    v_mfma_f32_16x16x32_bf16 a[100:103], a[212:215], v[212:215], a[100:103]
    ds_read_b128 a[196:199], v18 offset:16512
    v_cvt_pk_bf16_f32 v175, v126, v127
    v_mfma_f32_16x16x32_bf16 a[104:107], a[208:211], v[200:203], a[104:107]
    ds_read_b128 a[200:203], v19 offset:16512
    ds_read_b128 a[204:207], v20 offset:16512
    v_mfma_f32_16x16x32_bf16 a[104:107], a[212:215], v[216:219], a[104:107]
    s_add_u32 m0, s7, 16512
    v_mfma_f32_16x16x32_bf16 a[108:111], a[208:211], v[204:207], a[108:111]
    v_exp_f32 v129, v129
    v_mfma_f32_16x16x32_bf16 a[108:111], a[212:215], v[220:223], a[108:111]
    v_exp_f32 v130, v130
    v_mfma_f32_16x16x32_bf16 a[112:115], a[216:219], v[192:195], a[112:115]
    buffer_load_dwordx4 v26, s[44:47], s9 offen offset:0 lds
    v_mfma_f32_16x16x32_bf16 a[112:115], a[220:223], v[208:211], a[112:115]
    v_exp_f32 v131, v131
    v_mfma_f32_16x16x32_bf16 a[116:119], a[216:219], v[196:199], a[116:119]
    v_exp_f32 v132, v132
    v_mfma_f32_16x16x32_bf16 a[116:119], a[220:223], v[212:215], a[116:119]
    v_exp_f32 v133, v133
    v_mfma_f32_16x16x32_bf16 a[120:123], a[216:219], v[200:203], a[120:123]
    v_exp_f32 v134, v134
    v_mfma_f32_16x16x32_bf16 a[120:123], a[220:223], v[216:219], a[120:123]
    buffer_load_dwordx4 v27, s[44:47], s9 offen offset:1032 lds
    v_cvt_pk_bf16_f32 v176, v128, v129
    v_mfma_f32_16x16x32_bf16 a[124:127], a[216:219], v[204:207], a[124:127]
    v_exp_f32 v135, v135
    v_mfma_f32_16x16x32_bf16 a[124:127], a[220:223], v[220:223], a[124:127]
    v_cvt_pk_bf16_f32 v177, v130, v131
    s_waitcnt lgkmcnt(0)
    v_mfma_f32_16x16x32_bf16 v[96:99], a[192:195], v[32:35], v[224:227]
    ds_read_b128 a[208:211], v17 offset:17536
    v_cvt_pk_bf16_f32 v180, v132, v133
    v_mfma_f32_16x16x32_bf16 v[96:99], a[196:199], v[48:51], v[96:99]
    ds_read_b128 a[212:215], v18 offset:17536
    v_cvt_pk_bf16_f32 v181, v134, v135
    v_mfma_f32_16x16x32_bf16 v[96:99], a[200:203], v[64:67], v[96:99]
    buffer_load_dwordx4 v28, s[44:47], s9 offen offset:2064 lds
    ds_read_b128 a[216:219], v19 offset:17536
    v_mfma_f32_16x16x32_bf16 v[96:99], a[204:207], v[80:83], v[96:99]
    ds_read_b128 a[220:223], v20 offset:17536
    v_mfma_f32_16x16x32_bf16 v[100:103], a[192:195], v[36:39], v[228:231]
    v_exp_f32 v136, v136
    v_mfma_f32_16x16x32_bf16 v[100:103], a[196:199], v[52:55], v[100:103]
    v_exp_f32 v137, v137
    v_mfma_f32_16x16x32_bf16 v[100:103], a[200:203], v[68:71], v[100:103]
    v_exp_f32 v138, v138
    v_mfma_f32_16x16x32_bf16 v[100:103], a[204:207], v[84:87], v[100:103]
    buffer_load_dwordx4 v29, s[44:47], s9 offen offset:3096 lds
    s_add_u32 s9, s9, 16384
    v_mfma_f32_16x16x32_bf16 v[104:107], a[192:195], v[40:43], v[232:235]
    s_and_b32 s9, s9, 0x1ffff
    v_mfma_f32_16x16x32_bf16 v[104:107], a[196:199], v[56:59], v[104:107]
    s_add_u32 m0, s63, 4128
    s_add_u32 s60, s92, s94
    s_add_u32 s60, s60, 0x10000
    v_mfma_f32_16x16x32_bf16 v[104:107], a[200:203], v[72:75], v[104:107]
    v_exp_f32 v139, v139
    v_mfma_f32_16x16x32_bf16 v[104:107], a[204:207], v[88:91], v[104:107]
    v_exp_f32 v140, v140
    v_mfma_f32_16x16x32_bf16 v[108:111], a[192:195], v[44:47], v[236:239]
    buffer_load_dwordx4 v11, s[36:39], s60 offen offset:0 lds
    v_cvt_pk_bf16_f32 v184, v136, v137
    v_mfma_f32_16x16x32_bf16 v[108:111], a[196:199], v[60:63], v[108:111]
    v_exp_f32 v141, v141
    v_mfma_f32_16x16x32_bf16 v[108:111], a[200:203], v[76:79], v[108:111]
    v_exp_f32 v142, v142
    v_mfma_f32_16x16x32_bf16 v[108:111], a[204:207], v[92:95], v[108:111]
    v_cvt_pk_bf16_f32 v185, v138, v139
    s_waitcnt lgkmcnt(0)
    v_mfma_f32_16x16x32_bf16 v[112:115], a[208:211], v[32:35], v[224:227]
    ds_read_b128 a[192:195], v17 offset:18560
    ds_read_b128 a[196:199], v18 offset:18560
    v_mfma_f32_16x16x32_bf16 v[112:115], a[212:215], v[48:51], v[112:115]
    buffer_load_dwordx4 v12, s[36:39], s60 offen offset:1032 lds
    ds_read_b128 a[200:203], v19 offset:18560
    v_mfma_f32_16x16x32_bf16 v[112:115], a[216:219], v[64:67], v[112:115]
    ds_read_b128 a[204:207], v20 offset:18560
    v_mfma_f32_16x16x32_bf16 v[112:115], a[220:223], v[80:83], v[112:115]
    v_exp_f32 v143, v143
    v_mfma_f32_16x16x32_bf16 v[116:119], a[208:211], v[36:39], v[228:231]
    v_exp_f32 v144, v144
    v_mfma_f32_16x16x32_bf16 v[116:119], a[212:215], v[52:55], v[116:119]
    v_exp_f32 v145, v145
    v_mfma_f32_16x16x32_bf16 v[116:119], a[216:219], v[68:71], v[116:119]
    buffer_load_dwordx4 v13, s[36:39], s60 offen offset:2064 lds
    v_cvt_pk_bf16_f32 v188, v140, v141
    v_mfma_f32_16x16x32_bf16 v[116:119], a[220:223], v[84:87], v[116:119]
    v_exp_f32 v146, v146
    v_mfma_f32_16x16x32_bf16 v[120:123], a[208:211], v[40:43], v[232:235]
    v_exp_f32 v147, v147
    v_mfma_f32_16x16x32_bf16 v[120:123], a[212:215], v[56:59], v[120:123]
    v_exp_f32 v148, v148
    v_mfma_f32_16x16x32_bf16 v[120:123], a[216:219], v[72:75], v[120:123]
    v_exp_f32 v149, v149
    v_mfma_f32_16x16x32_bf16 v[120:123], a[220:223], v[88:91], v[120:123]
    buffer_load_dwordx4 v14, s[36:39], s60 offen offset:3096 lds
    s_add_u32 s94, s94, 0x20000
    v_mfma_f32_16x16x32_bf16 v[124:127], a[208:211], v[44:47], v[236:239]
    s_and_b32 s94, s94, 0x7ffff
    s_add_u32 s92, s92, 256
    v_mfma_f32_16x16x32_bf16 v[124:127], a[212:215], v[60:63], v[124:127]
    s_and_b32 s92, s92, 1023
    s_add_u32 s93, s93, 4096
    v_mfma_f32_16x16x32_bf16 v[124:127], a[216:219], v[76:79], v[124:127]
    v_exp_f32 v150, v150
    v_mfma_f32_16x16x32_bf16 v[124:127], a[220:223], v[92:95], v[124:127]
    v_cvt_pk_bf16_f32 v189, v142, v143
    s_waitcnt lgkmcnt(0)
    v_mfma_f32_16x16x32_bf16 v[128:131], a[192:195], v[32:35], v[224:227]
    buffer_load_dwordx4 a[244:247], v16, s[52:55], s93 offen offset:0
    v_cvt_pk_bf16_f32 v178, v144, v145
    v_mfma_f32_16x16x32_bf16 v[128:131], a[196:199], v[48:51], v[128:131]
    ds_read_b128 a[208:211], v17 offset:19584
    v_cvt_pk_bf16_f32 v179, v146, v147
    v_mfma_f32_16x16x32_bf16 v[128:131], a[200:203], v[64:67], v[128:131]
    ds_read_b128 a[212:215], v18 offset:19584
    ds_read_b128 a[216:219], v19 offset:19584
    v_mfma_f32_16x16x32_bf16 v[128:131], a[204:207], v[80:83], v[128:131]
    ds_read_b128 a[220:223], v20 offset:19584
    v_mfma_f32_16x16x32_bf16 v[132:135], a[192:195], v[36:39], v[228:231]
    v_exp_f32 v151, v151
    v_mfma_f32_16x16x32_bf16 v[132:135], a[196:199], v[52:55], v[132:135]
    buffer_load_dwordx4 a[244:247], v16, s[52:55], s93 offen offset:1024
    v_cvt_pk_bf16_f32 v182, v148, v149
    v_mfma_f32_16x16x32_bf16 v[132:135], a[200:203], v[68:71], v[132:135]
    v_exp_f32 v152, v152
    v_mfma_f32_16x16x32_bf16 v[132:135], a[204:207], v[84:87], v[132:135]
    s_mov_b32 s52, s20
    s_mov_b32 s53, s21
    v_mfma_f32_16x16x32_bf16 v[136:139], a[192:195], v[40:43], v[232:235]
    s_mul_i32 s93, s2, 7168
    s_lshl_b32 s60, s35, 11
    s_add_u32 s93, s93, s60
    v_mfma_f32_16x16x32_bf16 v[136:139], a[196:199], v[56:59], v[136:139]
    v_exp_f32 v153, v153
    v_mfma_f32_16x16x32_bf16 v[136:139], a[200:203], v[72:75], v[136:139]
    buffer_load_dwordx4 a[244:247], v16, s[52:55], s93 offen offset:0
    v_cvt_pk_bf16_f32 v183, v150, v151
    v_mfma_f32_16x16x32_bf16 v[136:139], a[204:207], v[88:91], v[136:139]
    v_exp_f32 v154, v154
    v_mfma_f32_16x16x32_bf16 v[140:143], a[192:195], v[44:47], v[236:239]
    v_exp_f32 v155, v155
    v_mfma_f32_16x16x32_bf16 v[140:143], a[196:199], v[60:63], v[140:143]
    v_exp_f32 v156, v156
    v_mfma_f32_16x16x32_bf16 v[140:143], a[200:203], v[76:79], v[140:143]
    v_exp_f32 v157, v157
    v_mfma_f32_16x16x32_bf16 v[140:143], a[204:207], v[92:95], v[140:143]
    buffer_load_dwordx4 a[244:247], v16, s[52:55], s93 offen offset:1024
    s_waitcnt lgkmcnt(0)
    v_mfma_f32_16x16x32_bf16 v[144:147], a[208:211], v[32:35], v[224:227]
    ds_read_b64_tr_b16 a[192:193], v21 offset:0
    s_add_u32 s10, s10, 4096
    v_mfma_f32_16x16x32_bf16 v[144:147], a[212:215], v[48:51], v[144:147]
    ds_read_b64_tr_b16 a[194:195], v21 offset:4128
    v_cvt_pk_bf16_f32 v186, v152, v153
    v_mfma_f32_16x16x32_bf16 v[144:147], a[216:219], v[64:67], v[144:147]
    ds_read_b64_tr_b16 a[196:197], v21 offset:8256
    v_cvt_pk_bf16_f32 v187, v154, v155
    v_mfma_f32_16x16x32_bf16 v[144:147], a[220:223], v[80:83], v[144:147]
    ds_read_b64_tr_b16 a[198:199], v21 offset:12384
    ds_read_b64_tr_b16 a[200:201], v21 offset:8
    v_mfma_f32_16x16x32_bf16 v[148:151], a[208:211], v[36:39], v[228:231]
    buffer_store_dwordx4 a[248:251], v253, s[48:51], s10 offen offset:0 sc1
    ds_read_b64_tr_b16 a[202:203], v21 offset:4136
    v_mfma_f32_16x16x32_bf16 v[148:151], a[212:215], v[52:55], v[148:151]
    ds_read_b64_tr_b16 a[204:205], v21 offset:8264
    s_add_u32 s10, s10, 4096
    v_mfma_f32_16x16x32_bf16 v[148:151], a[216:219], v[68:71], v[148:151]
    ds_read_b64_tr_b16 a[206:207], v21 offset:12392
    v_mfma_f32_16x16x32_bf16 v[148:151], a[220:223], v[84:87], v[148:151]
    v_exp_f32 v158, v158
    v_mfma_f32_16x16x32_bf16 v[152:155], a[208:211], v[40:43], v[232:235]
    v_exp_f32 v159, v159
    v_mfma_f32_16x16x32_bf16 v[152:155], a[212:215], v[56:59], v[152:155]
    buffer_store_dwordx4 a[248:251], v253, s[48:51], s10 offen offset:0 sc1
    v_cvt_pk_bf16_f32 v190, v156, v157
    v_mfma_f32_16x16x32_bf16 v[152:155], a[216:219], v[72:75], v[152:155]
    v_cvt_pk_bf16_f32 v191, v158, v159
    s_add_u32 s10, s10, 4096
    v_mfma_f32_16x16x32_bf16 v[152:155], a[220:223], v[88:91], v[152:155]
    v_exp_f32 v96, v96
    v_mfma_f32_16x16x32_bf16 v[156:159], a[208:211], v[44:47], v[236:239]
    v_exp_f32 v97, v97
    v_mfma_f32_16x16x32_bf16 v[156:159], a[212:215], v[60:63], v[156:159]
    v_exp_f32 v98, v98
    v_mfma_f32_16x16x32_bf16 v[156:159], a[216:219], v[76:79], v[156:159]
    buffer_store_dwordx4 a[248:251], v253, s[48:51], s10 offen offset:0 sc1
    v_mfma_f32_16x16x32_bf16 v[156:159], a[220:223], v[92:95], v[156:159]
    v_mfma_f32_16x16x32_bf16 a[224:227], a[240:243], v[160:163], a[224:227]
    v_exp_f32 v99, v99
    v_mfma_f32_16x16x32_bf16 a[224:227], a[240:243], v[176:179], a[224:227]
    v_exp_f32 v100, v100
    v_mfma_f32_16x16x32_bf16 a[228:231], a[240:243], v[164:167], a[228:231]
    v_exp_f32 v101, v101
    v_mfma_f32_16x16x32_bf16 a[228:231], a[240:243], v[180:183], a[228:231]
    v_exp_f32 v102, v102
    v_mfma_f32_16x16x32_bf16 a[232:235], a[240:243], v[168:171], a[232:235]
    v_exp_f32 v103, v103
    v_mfma_f32_16x16x32_bf16 a[232:235], a[240:243], v[184:187], a[232:235]
    v_exp_f32 v104, v104
    v_mfma_f32_16x16x32_bf16 a[236:239], a[240:243], v[172:175], a[236:239]
    v_exp_f32 v105, v105
    v_mfma_f32_16x16x32_bf16 a[236:239], a[240:243], v[188:191], a[236:239]
    v_exp_f32 v106, v106
    s_waitcnt lgkmcnt(0)
    v_mfma_f32_16x16x32_bf16 a[0:3], a[192:195], v[160:163], a[0:3]
    ds_read_b64_tr_b16 a[208:209], v21 offset:256
    v_cvt_pk_bf16_f32 v192, v96, v97
    v_mfma_f32_16x16x32_bf16 a[0:3], a[196:199], v[176:179], a[0:3]
    ds_read_b64_tr_b16 a[210:211], v21 offset:4384
    v_cvt_pk_bf16_f32 v193, v98, v99
    v_mfma_f32_16x16x32_bf16 a[4:7], a[192:195], v[164:167], a[4:7]
    ds_read_b64_tr_b16 a[212:213], v21 offset:8512
    v_cvt_pk_bf16_f32 v196, v100, v101
    v_mfma_f32_16x16x32_bf16 a[4:7], a[196:199], v[180:183], a[4:7]
    ds_read_b64_tr_b16 a[214:215], v21 offset:12640
    v_cvt_pk_bf16_f32 v197, v102, v103
    v_mfma_f32_16x16x32_bf16 a[8:11], a[192:195], v[168:171], a[8:11]
    ds_read_b64_tr_b16 a[216:217], v21 offset:264
    ds_read_b64_tr_b16 a[218:219], v21 offset:4392
    v_mfma_f32_16x16x32_bf16 a[8:11], a[196:199], v[184:187], a[8:11]
    ds_read_b64_tr_b16 a[220:221], v21 offset:8520
    ds_read_b64_tr_b16 a[222:223], v21 offset:12648
L_stub8:
    s_cbranch_execz L_stub12
    v_mfma_f32_16x16x32_bf16 a[12:15], a[192:195], v[172:175], a[12:15]
    v_exp_f32 v107, v107
    v_mfma_f32_16x16x32_bf16 a[12:15], a[196:199], v[188:191], a[12:15]
    v_exp_f32 v108, v108
    v_mfma_f32_16x16x32_bf16 a[16:19], a[200:203], v[160:163], a[16:19]
    v_exp_f32 v109, v109
    v_mfma_f32_16x16x32_bf16 a[16:19], a[204:207], v[176:179], a[16:19]
    v_exp_f32 v110, v110
    v_mfma_f32_16x16x32_bf16 a[20:23], a[200:203], v[164:167], a[20:23]
    v_exp_f32 v111, v111
    v_mfma_f32_16x16x32_bf16 a[20:23], a[204:207], v[180:183], a[20:23]
    v_exp_f32 v112, v112
    v_mfma_f32_16x16x32_bf16 a[24:27], a[200:203], v[168:171], a[24:27]
    v_exp_f32 v113, v113
    v_mfma_f32_16x16x32_bf16 a[24:27], a[204:207], v[184:187], a[24:27]
    v_exp_f32 v114, v114
    v_mfma_f32_16x16x32_bf16 a[28:31], a[200:203], v[172:175], a[28:31]
    v_exp_f32 v115, v115
    v_mfma_f32_16x16x32_bf16 a[28:31], a[204:207], v[188:191], a[28:31]
    v_cvt_pk_bf16_f32 v200, v104, v105
    s_waitcnt lgkmcnt(0)
    v_mfma_f32_16x16x32_bf16 a[32:35], a[208:211], v[160:163], a[32:35]
    ds_read_b64_tr_b16 a[192:193], v21 offset:512
    v_cvt_pk_bf16_f32 v201, v106, v107
    v_mfma_f32_16x16x32_bf16 a[32:35], a[212:215], v[176:179], a[32:35]
    ds_read_b64_tr_b16 a[194:195], v21 offset:4640
    v_cvt_pk_bf16_f32 v204, v108, v109
    v_mfma_f32_16x16x32_bf16 a[36:39], a[208:211], v[164:167], a[36:39]
    ds_read_b64_tr_b16 a[196:197], v21 offset:8768
    v_cvt_pk_bf16_f32 v205, v110, v111
    v_mfma_f32_16x16x32_bf16 a[36:39], a[212:215], v[180:183], a[36:39]
    ds_read_b64_tr_b16 a[198:199], v21 offset:12896
    v_cvt_pk_bf16_f32 v194, v112, v113
    v_mfma_f32_16x16x32_bf16 a[40:43], a[208:211], v[168:171], a[40:43]
    ds_read_b64_tr_b16 a[200:201], v21 offset:520
    v_cvt_pk_bf16_f32 v195, v114, v115
    v_mfma_f32_16x16x32_bf16 a[40:43], a[212:215], v[184:187], a[40:43]
    ds_read_b64_tr_b16 a[202:203], v21 offset:4648
    ds_read_b64_tr_b16 a[204:205], v21 offset:8776
    v_mfma_f32_16x16x32_bf16 a[44:47], a[208:211], v[172:175], a[44:47]
    ds_read_b64_tr_b16 a[206:207], v21 offset:12904
    v_mfma_f32_16x16x32_bf16 a[44:47], a[212:215], v[188:191], a[44:47]
    v_exp_f32 v116, v116
    v_mfma_f32_16x16x32_bf16 a[48:51], a[216:219], v[160:163], a[48:51]
    v_exp_f32 v117, v117
    v_mfma_f32_16x16x32_bf16 a[48:51], a[220:223], v[176:179], a[48:51]
    v_exp_f32 v118, v118
    v_mfma_f32_16x16x32_bf16 a[52:55], a[216:219], v[164:167], a[52:55]
    v_exp_f32 v119, v119
    v_mfma_f32_16x16x32_bf16 a[52:55], a[220:223], v[180:183], a[52:55]
    v_exp_f32 v120, v120
    v_mfma_f32_16x16x32_bf16 a[56:59], a[216:219], v[168:171], a[56:59]
    v_exp_f32 v121, v121
    v_mfma_f32_16x16x32_bf16 a[56:59], a[220:223], v[184:187], a[56:59]
    v_exp_f32 v122, v122
    v_mfma_f32_16x16x32_bf16 a[60:63], a[216:219], v[172:175], a[60:63]
    v_exp_f32 v123, v123
    v_mfma_f32_16x16x32_bf16 a[60:63], a[220:223], v[188:191], a[60:63]
    v_cvt_pk_bf16_f32 v198, v116, v117
    s_waitcnt lgkmcnt(0)
    v_mfma_f32_16x16x32_bf16 a[64:67], a[192:195], v[160:163], a[64:67]
    ds_read_b64_tr_b16 a[208:209], v21 offset:768
    v_cvt_pk_bf16_f32 v199, v118, v119
    v_mfma_f32_16x16x32_bf16 a[64:67], a[196:199], v[176:179], a[64:67]
    ds_read_b64_tr_b16 a[210:211], v21 offset:4896
    v_cvt_pk_bf16_f32 v202, v120, v121
    v_mfma_f32_16x16x32_bf16 a[68:71], a[192:195], v[164:167], a[68:71]
    ds_read_b64_tr_b16 a[212:213], v21 offset:9024
    v_cvt_pk_bf16_f32 v203, v122, v123
    v_mfma_f32_16x16x32_bf16 a[68:71], a[196:199], v[180:183], a[68:71]
    ds_read_b64_tr_b16 a[214:215], v21 offset:13152
    ds_read_b64_tr_b16 a[216:217], v21 offset:776
    v_mfma_f32_16x16x32_bf16 a[72:75], a[192:195], v[168:171], a[72:75]
    ds_read_b64_tr_b16 a[218:219], v21 offset:4904
    ds_read_b64_tr_b16 a[220:221], v21 offset:9032
    v_mfma_f32_16x16x32_bf16 a[72:75], a[196:199], v[184:187], a[72:75]
    ds_read_b64_tr_b16 a[222:223], v21 offset:13160
    v_mfma_f32_16x16x32_bf16 a[76:79], a[192:195], v[172:175], a[76:79]
    v_exp_f32 v124, v124
    v_mfma_f32_16x16x32_bf16 a[76:79], a[196:199], v[188:191], a[76:79]
    v_exp_f32 v125, v125
    v_mfma_f32_16x16x32_bf16 a[80:83], a[200:203], v[160:163], a[80:83]
    v_exp_f32 v126, v126
    v_mfma_f32_16x16x32_bf16 a[80:83], a[204:207], v[176:179], a[80:83]
    v_exp_f32 v127, v127
    v_mfma_f32_16x16x32_bf16 a[84:87], a[200:203], v[164:167], a[84:87]
    v_exp_f32 v128, v128
    v_mfma_f32_16x16x32_bf16 a[84:87], a[204:207], v[180:183], a[84:87]
    v_exp_f32 v129, v129
    v_mfma_f32_16x16x32_bf16 a[88:91], a[200:203], v[168:171], a[88:91]
    v_exp_f32 v130, v130
    v_mfma_f32_16x16x32_bf16 a[88:91], a[204:207], v[184:187], a[88:91]
    v_exp_f32 v131, v131
    v_mfma_f32_16x16x32_bf16 a[92:95], a[200:203], v[172:175], a[92:95]
    v_exp_f32 v132, v132
    v_mfma_f32_16x16x32_bf16 a[92:95], a[204:207], v[188:191], a[92:95]
    v_cvt_pk_bf16_f32 v206, v124, v125
    s_waitcnt lgkmcnt(0)
    v_mfma_f32_16x16x32_bf16 a[96:99], a[208:211], v[160:163], a[96:99]
    v_exp_f32 v133, v133
    v_mfma_f32_16x16x32_bf16 a[96:99], a[212:215], v[176:179], a[96:99]
    s_waitcnt vmcnt(11)
    s_barrier
    v_cvt_pk_bf16_f32 v207, v126, v127
    v_mfma_f32_16x16x32_bf16 a[100:103], a[208:211], v[164:167], a[100:103]
    ds_read_b64_tr_b16 a[192:193], v21 offset:16512
    v_cvt_pk_bf16_f32 v208, v128, v129
    v_mfma_f32_16x16x32_bf16 a[100:103], a[212:215], v[180:183], a[100:103]
    ds_read_b64_tr_b16 a[194:195], v21 offset:20640
    v_cvt_pk_bf16_f32 v209, v130, v131
    v_mfma_f32_16x16x32_bf16 a[104:107], a[208:211], v[168:171], a[104:107]
    ds_read_b64_tr_b16 a[196:197], v21 offset:24768
    ds_read_b64_tr_b16 a[198:199], v21 offset:28896
    v_mfma_f32_16x16x32_bf16 a[104:107], a[212:215], v[184:187], a[104:107]
    ds_read_b64_tr_b16 a[200:201], v21 offset:16520
    ds_read_b64_tr_b16 a[202:203], v21 offset:20648
    v_mfma_f32_16x16x32_bf16 a[108:111], a[208:211], v[172:175], a[108:111]
    ds_read_b64_tr_b16 a[204:205], v21 offset:24776
    ds_read_b64_tr_b16 a[206:207], v21 offset:28904
    v_mfma_f32_16x16x32_bf16 a[108:111], a[212:215], v[188:191], a[108:111]
    v_exp_f32 v134, v134
    v_mfma_f32_16x16x32_bf16 a[112:115], a[216:219], v[160:163], a[112:115]
    v_exp_f32 v135, v135
    v_mfma_f32_16x16x32_bf16 a[112:115], a[220:223], v[176:179], a[112:115]
    v_cvt_pk_bf16_f32 v212, v132, v133
    v_cvt_pk_bf16_f32 v213, v134, v135
    v_mfma_f32_16x16x32_bf16 a[116:119], a[216:219], v[164:167], a[116:119]
    v_exp_f32 v136, v136
    v_mfma_f32_16x16x32_bf16 a[116:119], a[220:223], v[180:183], a[116:119]
    v_exp_f32 v137, v137
    v_mfma_f32_16x16x32_bf16 a[120:123], a[216:219], v[168:171], a[120:123]
    v_exp_f32 v138, v138
    v_mfma_f32_16x16x32_bf16 a[120:123], a[220:223], v[184:187], a[120:123]
    v_exp_f32 v139, v139
    v_mfma_f32_16x16x32_bf16 a[124:127], a[216:219], v[172:175], a[124:127]
    v_cvt_pk_bf16_f32 v216, v136, v137
    v_cvt_pk_bf16_f32 v217, v138, v139
    v_exp_f32 v140, v140
    v_exp_f32 v141, v141
    v_exp_f32 v142, v142
    v_exp_f32 v143, v143
    v_cvt_pk_bf16_f32 v220, v140, v141
    v_cvt_pk_bf16_f32 v221, v142, v143
    v_exp_f32 v144, v144
    v_exp_f32 v145, v145
    v_exp_f32 v146, v146
    v_exp_f32 v147, v147
    v_cvt_pk_bf16_f32 v210, v144, v145
    v_cvt_pk_bf16_f32 v211, v146, v147
    v_exp_f32 v148, v148
    v_exp_f32 v149, v149
    v_exp_f32 v150, v150
    v_exp_f32 v151, v151
    v_cvt_pk_bf16_f32 v214, v148, v149
    v_cvt_pk_bf16_f32 v215, v150, v151
    v_exp_f32 v152, v152
    v_exp_f32 v153, v153
    v_exp_f32 v154, v154
    v_exp_f32 v155, v155
    v_cvt_pk_bf16_f32 v218, v152, v153
    v_cvt_pk_bf16_f32 v219, v154, v155
    v_exp_f32 v156, v156
    v_exp_f32 v157, v157
    v_exp_f32 v158, v158
    v_exp_f32 v159, v159
    v_cvt_pk_bf16_f32 v222, v156, v157
    v_cvt_pk_bf16_f32 v223, v158, v159
    v_mfma_f32_16x16x32_bf16 a[124:127], a[220:223], v[188:191], a[124:127]
    v_mfma_f32_16x16x32_bf16 a[224:227], a[240:243], v[192:195], a[224:227]
    v_mfma_f32_16x16x32_bf16 a[224:227], a[240:243], v[208:211], a[224:227]
    ds_read_b64_tr_b16 v[128:129], v10 offset:8256
    v_mfma_f32_16x16x32_bf16 a[228:231], a[240:243], v[196:199], a[228:231]
    ds_read_b64_tr_b16 v[130:131], v10 offset:8512
    v_mfma_f32_16x16x32_bf16 a[228:231], a[240:243], v[212:215], a[228:231]
    ds_read_b64_tr_b16 v[132:133], v10 offset:10320
    v_mfma_f32_16x16x32_bf16 a[232:235], a[240:243], v[200:203], a[232:235]
    ds_read_b64_tr_b16 v[134:135], v10 offset:10576
    v_mfma_f32_16x16x32_bf16 a[232:235], a[240:243], v[216:219], a[232:235]
    ds_read_b64_tr_b16 v[136:137], v10 offset:8264
    v_mfma_f32_16x16x32_bf16 a[236:239], a[240:243], v[204:207], a[236:239]
    ds_read_b64_tr_b16 v[138:139], v10 offset:8520
    v_mfma_f32_16x16x32_bf16 a[236:239], a[240:243], v[220:223], a[236:239]
    ds_read_b64_tr_b16 v[140:141], v10 offset:10328
    s_waitcnt lgkmcnt(7)
    v_mfma_f32_16x16x32_bf16 a[0:3], a[192:195], v[192:195], a[0:3]
    ds_read_b64_tr_b16 a[208:209], v21 offset:16768
    v_mfma_f32_16x16x32_bf16 a[0:3], a[196:199], v[208:211], a[0:3]
    ds_read_b64_tr_b16 a[210:211], v21 offset:20896
    v_mfma_f32_16x16x32_bf16 a[4:7], a[192:195], v[196:199], a[4:7]
    ds_read_b64_tr_b16 a[212:213], v21 offset:25024
    v_mfma_f32_16x16x32_bf16 a[4:7], a[196:199], v[212:215], a[4:7]
    ds_read_b64_tr_b16 a[214:215], v21 offset:29152
    v_mfma_f32_16x16x32_bf16 a[8:11], a[192:195], v[200:203], a[8:11]
    ds_read_b64_tr_b16 a[216:217], v21 offset:16776
    v_accvgpr_read_b32 v240, a224
    v_mfma_f32_16x16x32_bf16 a[8:11], a[196:199], v[216:219], a[8:11]
    ds_read_b64_tr_b16 a[218:219], v21 offset:20904
    v_accvgpr_read_b32 v241, a228
    v_mfma_f32_16x16x32_bf16 a[12:15], a[192:195], v[204:207], a[12:15]
    ds_read_b64_tr_b16 a[220:221], v21 offset:25032
    v_accvgpr_read_b32 v242, a232
    v_mfma_f32_16x16x32_bf16 a[12:15], a[196:199], v[220:223], a[12:15]
    ds_read_b64_tr_b16 a[222:223], v21 offset:29160
    v_accvgpr_read_b32 v243, a236
    v_mfma_f32_16x16x32_bf16 a[16:19], a[200:203], v[192:195], a[16:19]
    ds_read_b64_tr_b16 v[142:143], v10 offset:10584
    v_mfma_f32_16x16x32_bf16 a[16:19], a[204:207], v[208:211], a[16:19]
    ds_read_b64_tr_b16 v[144:145], v10 offset:12384
    v_mfma_f32_16x16x32_bf16 a[20:23], a[200:203], v[196:199], a[20:23]
    ds_read_b64_tr_b16 v[146:147], v10 offset:12640
    v_mfma_f32_16x16x32_bf16 a[20:23], a[204:207], v[212:215], a[20:23]
    ds_read_b64_tr_b16 v[148:149], v10 offset:14448
    s_add_u32 m0, s63, 8256
    v_mfma_f32_16x16x32_bf16 a[24:27], a[200:203], v[200:203], a[24:27]
    ds_read_b64_tr_b16 v[150:151], v10 offset:14704
    s_add_u32 s60, s92, s94
    v_mfma_f32_16x16x32_bf16 a[24:27], a[204:207], v[216:219], a[24:27]
    ds_read_b64_tr_b16 v[152:153], v10 offset:12392
    v_mfma_f32_16x16x32_bf16 a[28:31], a[200:203], v[204:207], a[28:31]
    s_waitcnt lgkmcnt(5)
    buffer_load_dwordx4 v11, s[36:39], s60 offen offset:0 lds
    v_mfma_f32_16x16x32_bf16 a[28:31], a[204:207], v[220:223], a[28:31]
    ds_read_b64_tr_b16 v[154:155], v10 offset:12648
    v_mfma_f32_16x16x32_bf16 a[32:35], a[208:211], v[192:195], a[32:35]
    v_rcp_f32 v244, v240
    v_rcp_f32 v246, v241
    v_rcp_f32 v248, v242
    v_rcp_f32 v250, v243
    v_mfma_f32_16x16x32_bf16 a[32:35], a[212:215], v[208:211], a[32:35]
    ds_read_b64_tr_b16 a[192:193], v21 offset:17024
    v_add_f32 v252, v240, v241
    v_mfma_f32_16x16x32_bf16 a[36:39], a[208:211], v[196:199], a[36:39]
    ds_read_b64_tr_b16 a[194:195], v21 offset:21152
    v_add_f32 v254, v242, v243
    v_mfma_f32_16x16x32_bf16 a[36:39], a[212:215], v[212:215], a[36:39]
    ds_read_b64_tr_b16 a[196:197], v21 offset:25280
    v_add_f32 v252, v252, v254
    v_mfma_f32_16x16x32_bf16 a[40:43], a[208:211], v[200:203], a[40:43]
    ds_read_b64_tr_b16 a[198:199], v21 offset:29408
    v_cmp_nge_f32 vcc, 1350565888, v252
    s_nop 0
    s_cmp_lg_u64 vcc, 0
    s_cselect_b32 s3, 1, 0
    v_mfma_f32_16x16x32_bf16 a[40:43], a[212:215], v[216:219], a[40:43]
    ds_read_b64_tr_b16 a[200:201], v21 offset:17032
    buffer_load_dwordx4 v12, s[36:39], s60 offen offset:1032 lds
    v_mfma_f32_16x16x32_bf16 a[44:47], a[208:211], v[204:207], a[44:47]
    ds_read_b64_tr_b16 a[202:203], v21 offset:21160
    v_mov_b32 v254, s3
    v_mfma_f32_16x16x32_bf16 a[44:47], a[212:215], v[220:223], a[44:47]
    ds_read_b64_tr_b16 a[204:205], v21 offset:25288
    ds_read_b64_tr_b16 v[156:157], v10 offset:14456
    v_mfma_f32_16x16x32_bf16 a[48:51], a[216:219], v[192:195], a[48:51]
    ds_read_b64_tr_b16 a[206:207], v21 offset:29416
    ds_read_b64_tr_b16 v[158:159], v10 offset:14712
    v_mfma_f32_16x16x32_bf16 a[48:51], a[220:223], v[208:211], a[48:51]
    v_and_b32 v253, 3, v1
    v_lshlrev_b32 v253, 2, v253
    v_mfma_f32_16x16x32_bf16 a[52:55], a[216:219], v[196:199], a[52:55]
    v_add_u32 v253, 161168, v253
    v_accvgpr_read_b32 v160, a0
    v_mfma_f32_16x16x32_bf16 a[52:55], a[220:223], v[212:215], a[52:55]
    buffer_load_dwordx4 v13, s[36:39], s60 offen offset:2064 lds
    v_accvgpr_read_b32 v161, a1
    v_mfma_f32_16x16x32_bf16 a[56:59], a[216:219], v[200:203], a[56:59]
    v_accvgpr_read_b32 v162, a2
    v_accvgpr_read_b32 v163, a3
    v_mfma_f32_16x16x32_bf16 a[56:59], a[220:223], v[216:219], a[56:59]
    v_accvgpr_read_b32 v164, a16
    v_accvgpr_read_b32 v165, a17
    v_mfma_f32_16x16x32_bf16 a[60:63], a[216:219], v[204:207], a[60:63]
    v_accvgpr_read_b32 v166, a18
    v_accvgpr_read_b32 v167, a19
    v_mfma_f32_16x16x32_bf16 a[60:63], a[220:223], v[220:223], a[60:63]
    v_mul_f32 v160, v244, v160
    s_waitcnt lgkmcnt(1)
    v_mfma_f32_16x16x32_bf16 a[64:67], a[192:195], v[192:195], a[64:67]
    ds_read_b64_tr_b16 a[208:209], v21 offset:17280
    v_mul_f32 v161, v244, v161
    v_mfma_f32_16x16x32_bf16 a[64:67], a[196:199], v[208:211], a[64:67]
    buffer_load_dwordx4 v14, s[36:39], s60 offen offset:3096 lds
    s_add_u32 s94, s94, 0x20000
    v_mfma_f32_16x16x32_bf16 a[68:71], a[192:195], v[196:199], a[68:71]
    ds_read_b64_tr_b16 a[210:211], v21 offset:21408
    s_and_b32 s94, s94, 0x7ffff
    v_mfma_f32_16x16x32_bf16 a[68:71], a[196:199], v[212:215], a[68:71]
    ds_read_b64_tr_b16 a[212:213], v21 offset:25536
    s_add_u32 m0, s63, 12384
    v_mfma_f32_16x16x32_bf16 a[72:75], a[192:195], v[200:203], a[72:75]
    ds_read_b64_tr_b16 a[214:215], v21 offset:29664
    s_add_u32 s60, s92, s94
    v_mfma_f32_16x16x32_bf16 a[72:75], a[196:199], v[216:219], a[72:75]
    ds_read_b64_tr_b16 a[216:217], v21 offset:17288
    v_mul_f32 v162, v244, v162
    v_mfma_f32_16x16x32_bf16 a[76:79], a[192:195], v[204:207], a[76:79]
    ds_read_b64_tr_b16 a[218:219], v21 offset:21416
    v_mul_f32 v163, v244, v163
    v_mfma_f32_16x16x32_bf16 a[76:79], a[196:199], v[220:223], a[76:79]
    ds_read_b64_tr_b16 a[220:221], v21 offset:25544
    s_waitcnt lgkmcnt(6)
    buffer_load_dwordx4 v11, s[36:39], s60 offen offset:0 lds
    v_mfma_f32_16x16x32_bf16 a[80:83], a[200:203], v[192:195], a[80:83]
    ds_read_b64_tr_b16 a[222:223], v21 offset:29672
    v_mul_f32 v164, v244, v164
    v_mfma_f32_16x16x32_bf16 a[80:83], a[204:207], v[208:211], a[80:83]
    v_mul_f32 v165, v244, v165
    v_mul_f32 v166, v244, v166
    v_mfma_f32_16x16x32_bf16 a[84:87], a[200:203], v[196:199], a[84:87]
    v_mul_f32 v167, v244, v167
    v_cvt_pk_bf16_f32 v224, v160, v161
    v_mfma_f32_16x16x32_bf16 a[84:87], a[204:207], v[212:215], a[84:87]
    v_cvt_pk_bf16_f32 v225, v162, v163
    v_cvt_pk_bf16_f32 v226, v164, v165
    v_mfma_f32_16x16x32_bf16 a[88:91], a[200:203], v[200:203], a[88:91]
    buffer_load_dwordx4 v12, s[36:39], s60 offen offset:1032 lds
    v_cvt_pk_bf16_f32 v227, v166, v167
    v_mfma_f32_16x16x32_bf16 a[88:91], a[204:207], v[216:219], a[88:91]
    ds_write_b128 v30, v[224:227] offset:0
    v_accvgpr_read_b32 v168, a4
    v_mfma_f32_16x16x32_bf16 a[92:95], a[200:203], v[204:207], a[92:95]
    v_accvgpr_read_b32 v169, a5
    v_accvgpr_read_b32 v170, a6
    v_mfma_f32_16x16x32_bf16 a[92:95], a[204:207], v[220:223], a[92:95]
    v_accvgpr_read_b32 v171, a7
    s_waitcnt lgkmcnt(1)
    v_mfma_f32_16x16x32_bf16 a[96:99], a[208:211], v[192:195], a[96:99]
    v_accvgpr_read_b32 v172, a20
    v_accvgpr_read_b32 v173, a21
    v_mfma_f32_16x16x32_bf16 a[96:99], a[212:215], v[208:211], a[96:99]
    v_accvgpr_read_b32 v174, a22
    v_accvgpr_read_b32 v175, a23
    v_mfma_f32_16x16x32_bf16 a[100:103], a[208:211], v[196:199], a[100:103]
    buffer_load_dwordx4 v13, s[36:39], s60 offen offset:2064 lds
    v_mul_f32 v168, v246, v168
    v_mfma_f32_16x16x32_bf16 a[100:103], a[212:215], v[212:215], a[100:103]
    v_mul_f32 v169, v246, v169
    v_mul_f32 v170, v246, v170
    v_mfma_f32_16x16x32_bf16 a[104:107], a[208:211], v[200:203], a[104:107]
    v_mul_f32 v171, v246, v171
    v_mul_f32 v172, v246, v172
    v_mfma_f32_16x16x32_bf16 a[104:107], a[212:215], v[216:219], a[104:107]
    v_mul_f32 v173, v246, v173
    v_mul_f32 v174, v246, v174
    v_mfma_f32_16x16x32_bf16 a[108:111], a[208:211], v[204:207], a[108:111]
    v_mul_f32 v175, v246, v175
    v_cvt_pk_bf16_f32 v228, v168, v169
    v_mfma_f32_16x16x32_bf16 a[108:111], a[212:215], v[220:223], a[108:111]
    v_cvt_pk_bf16_f32 v229, v170, v171
    v_cvt_pk_bf16_f32 v230, v172, v173
    v_mfma_f32_16x16x32_bf16 a[112:115], a[216:219], v[192:195], a[112:115]
    buffer_load_dwordx4 v14, s[36:39], s60 offen offset:3096 lds
    s_add_u32 s94, s94, 0x20000
    v_mfma_f32_16x16x32_bf16 a[112:115], a[220:223], v[208:211], a[112:115]
    s_and_b32 s94, s94, 0x7ffff
    v_cvt_pk_bf16_f32 v231, v174, v175
    v_mfma_f32_16x16x32_bf16 a[116:119], a[216:219], v[196:199], a[116:119]
    ds_write_b128 v30, v[228:231] offset:1024
    v_accvgpr_read_b32 v176, a8
    v_mfma_f32_16x16x32_bf16 a[116:119], a[220:223], v[212:215], a[116:119]
    v_accvgpr_read_b32 v177, a9
    v_accvgpr_read_b32 v178, a10
    v_mfma_f32_16x16x32_bf16 a[120:123], a[216:219], v[200:203], a[120:123]
    v_accvgpr_read_b32 v179, a11
    v_accvgpr_read_b32 v180, a24
    v_mfma_f32_16x16x32_bf16 a[120:123], a[220:223], v[216:219], a[120:123]
    v_accvgpr_read_b32 v181, a25
    v_accvgpr_read_b32 v182, a26
    v_mfma_f32_16x16x32_bf16 a[124:127], a[216:219], v[204:207], a[124:127]
    v_accvgpr_read_b32 v183, a27
    v_mul_f32 v176, v248, v176
    v_mfma_f32_16x16x32_bf16 a[124:127], a[220:223], v[220:223], a[124:127]
    v_mul_f32 v177, v248, v177
    v_mul_f32 v178, v248, v178
    v_mul_f32 v179, v248, v179
    v_mul_f32 v180, v248, v180
    v_mul_f32 v181, v248, v181
    v_mul_f32 v182, v248, v182
    v_mul_f32 v183, v248, v183
    v_cvt_pk_bf16_f32 v232, v176, v177
    v_cvt_pk_bf16_f32 v233, v178, v179
    v_cvt_pk_bf16_f32 v234, v180, v181
    v_cvt_pk_bf16_f32 v235, v182, v183
    ds_write_b128 v30, v[232:235] offset:2048
    v_accvgpr_read_b32 v184, a12
    v_accvgpr_read_b32 v185, a13
    v_accvgpr_read_b32 v186, a14
    v_accvgpr_read_b32 v187, a15
    v_accvgpr_read_b32 v188, a28
    v_accvgpr_read_b32 v189, a29
    v_accvgpr_read_b32 v190, a30
    v_accvgpr_read_b32 v191, a31
    v_mul_f32 v184, v250, v184
    v_mul_f32 v185, v250, v185
    v_mul_f32 v186, v250, v186
    v_mul_f32 v187, v250, v187
    v_mul_f32 v188, v250, v188
    v_mul_f32 v189, v250, v189
    v_mul_f32 v190, v250, v190
    v_mul_f32 v191, v250, v191
    v_cvt_pk_bf16_f32 v236, v184, v185
    v_cvt_pk_bf16_f32 v237, v186, v187
    v_cvt_pk_bf16_f32 v238, v188, v189
    v_cvt_pk_bf16_f32 v239, v190, v191
    ds_write_b128 v30, v[236:239] offset:3072
    ds_write_b32 v31, v254
    ds_read_b64_tr_b16 v[192:193], v10 offset:0
    ds_read_b64_tr_b16 v[194:195], v10 offset:256
    ds_read_b64_tr_b16 v[196:197], v10 offset:2064
    ds_read_b64_tr_b16 v[198:199], v10 offset:2320
    ds_read_b64_tr_b16 v[200:201], v10 offset:8
    ds_read_b64_tr_b16 v[202:203], v10 offset:264
    ds_read_b64_tr_b16 v[204:205], v10 offset:2072
    ds_read_b64_tr_b16 v[206:207], v10 offset:2328
    s_waitcnt vmcnt(15)
    ds_read_b64_tr_b16 v[208:209], v10 offset:4128
    ds_read_b64_tr_b16 v[210:211], v10 offset:4384
    ds_read_b64_tr_b16 v[212:213], v10 offset:6192
    ds_read_b64_tr_b16 v[214:215], v10 offset:6448
    ds_read_b64_tr_b16 v[216:217], v10 offset:4136
    ds_read_b64_tr_b16 v[218:219], v10 offset:4392
    ds_read_b64_tr_b16 v[220:221], v10 offset:6200
    ds_read_b64_tr_b16 v[222:223], v10 offset:6456
    v_accvgpr_read_b32 v160, a32
    v_accvgpr_read_b32 v161, a33
    v_accvgpr_read_b32 v162, a34
    v_accvgpr_read_b32 v163, a35
    v_accvgpr_read_b32 v164, a48
    v_accvgpr_read_b32 v165, a49
    v_accvgpr_read_b32 v166, a50
    v_accvgpr_read_b32 v167, a51
    v_pk_mul_f32 v[160:161], v[160:161], v[244:245] op_sel_hi:[1,0]
    v_pk_mul_f32 v[162:163], v[162:163], v[244:245] op_sel_hi:[1,0]
    v_pk_mul_f32 v[164:165], v[164:165], v[244:245] op_sel_hi:[1,0]
    v_pk_mul_f32 v[166:167], v[166:167], v[244:245] op_sel_hi:[1,0]
    v_cvt_pk_bf16_f32 v224, v160, v161
    v_cvt_pk_bf16_f32 v225, v162, v163
    v_cvt_pk_bf16_f32 v226, v164, v165
    v_cvt_pk_bf16_f32 v227, v166, v167
    ds_write_b128 v30, v[224:227] offset:4096
    v_accvgpr_read_b32 v168, a36
    v_accvgpr_read_b32 v169, a37
    v_accvgpr_read_b32 v170, a38
    v_accvgpr_read_b32 v171, a39
    v_accvgpr_read_b32 v172, a52
    v_accvgpr_read_b32 v173, a53
    v_accvgpr_read_b32 v174, a54
    v_accvgpr_read_b32 v175, a55
    v_pk_mul_f32 v[168:169], v[168:169], v[246:247] op_sel_hi:[1,0]
    v_pk_mul_f32 v[170:171], v[170:171], v[246:247] op_sel_hi:[1,0]
    v_pk_mul_f32 v[172:173], v[172:173], v[246:247] op_sel_hi:[1,0]
    v_pk_mul_f32 v[174:175], v[174:175], v[246:247] op_sel_hi:[1,0]
    v_cvt_pk_bf16_f32 v228, v168, v169
    v_cvt_pk_bf16_f32 v229, v170, v171
    v_cvt_pk_bf16_f32 v230, v172, v173
    v_cvt_pk_bf16_f32 v231, v174, v175
    ds_write_b128 v30, v[228:231] offset:5120
    v_accvgpr_read_b32 v176, a40
    v_accvgpr_read_b32 v177, a41
    v_accvgpr_read_b32 v178, a42
    v_accvgpr_read_b32 v179, a43
    v_accvgpr_read_b32 v180, a56
    v_accvgpr_read_b32 v181, a57
    v_accvgpr_read_b32 v182, a58
    v_accvgpr_read_b32 v183, a59
    v_pk_mul_f32 v[176:177], v[176:177], v[248:249] op_sel_hi:[1,0]
    v_pk_mul_f32 v[178:179], v[178:179], v[248:249] op_sel_hi:[1,0]
    v_pk_mul_f32 v[180:181], v[180:181], v[248:249] op_sel_hi:[1,0]
    v_pk_mul_f32 v[182:183], v[182:183], v[248:249] op_sel_hi:[1,0]
    v_cvt_pk_bf16_f32 v232, v176, v177
    v_cvt_pk_bf16_f32 v233, v178, v179
    v_cvt_pk_bf16_f32 v234, v180, v181
    v_cvt_pk_bf16_f32 v235, v182, v183
    ds_write_b128 v30, v[232:235] offset:6144
    v_accvgpr_read_b32 v184, a44
    v_accvgpr_read_b32 v185, a45
    v_accvgpr_read_b32 v186, a46
    v_accvgpr_read_b32 v187, a47
    v_accvgpr_read_b32 v188, a60
    v_accvgpr_read_b32 v189, a61
    v_accvgpr_read_b32 v190, a62
    v_accvgpr_read_b32 v191, a63
    v_pk_mul_f32 v[184:185], v[184:185], v[250:251] op_sel_hi:[1,0]
    v_pk_mul_f32 v[186:187], v[186:187], v[250:251] op_sel_hi:[1,0]
    v_pk_mul_f32 v[188:189], v[188:189], v[250:251] op_sel_hi:[1,0]
    v_pk_mul_f32 v[190:191], v[190:191], v[250:251] op_sel_hi:[1,0]
    v_cvt_pk_bf16_f32 v236, v184, v185
    v_cvt_pk_bf16_f32 v237, v186, v187
    v_cvt_pk_bf16_f32 v238, v188, v189
    v_cvt_pk_bf16_f32 v239, v190, v191
    ds_write_b128 v30, v[236:239] offset:7168
    s_waitcnt vmcnt(8) lgkmcnt(0)
    s_barrier
    ds_read_b32 v252, v253
    ds_read_b128 a[0:3], v2 offset:0
    ds_read_b128 a[4:7], v2 offset:1024
    ds_read_b128 a[8:11], v2 offset:2048
    ds_read_b128 a[12:15], v2 offset:3072
    ds_read_b128 a[16:19], v2 offset:4096
    ds_read_b128 a[20:23], v2 offset:5120
    ds_read_b128 a[24:27], v2 offset:6144
    ds_read_b128 a[28:31], v2 offset:7168
    s_waitcnt lgkmcnt(7)
    v_mfma_f32_16x16x32_bf16 v[96:99], a[128:131], a[0:3], 0
    v_accvgpr_read_b32 v160, a64
    v_accvgpr_read_b32 v161, a65
    v_accvgpr_read_b32 v162, a66
    v_accvgpr_read_b32 v163, a67
    v_accvgpr_read_b32 v164, a80
    v_accvgpr_read_b32 v165, a81
    v_accvgpr_read_b32 v166, a82
    v_accvgpr_read_b32 v167, a83
    v_pk_mul_f32 v[160:161], v[160:161], v[244:245] op_sel_hi:[1,0]
    v_pk_mul_f32 v[162:163], v[162:163], v[244:245] op_sel_hi:[1,0]
    v_pk_mul_f32 v[164:165], v[164:165], v[244:245] op_sel_hi:[1,0]
    v_pk_mul_f32 v[166:167], v[166:167], v[244:245] op_sel_hi:[1,0]
    v_cvt_pk_bf16_f32 v224, v160, v161
    v_cvt_pk_bf16_f32 v225, v162, v163
    v_cvt_pk_bf16_f32 v226, v164, v165
    v_cvt_pk_bf16_f32 v227, v166, v167
    s_add_u32 m0, s63, 0
    s_waitcnt lgkmcnt(3)
    v_mfma_f32_16x16x32_bf16 v[96:99], a[132:135], a[16:19], v[96:99]
    ds_read_b128 a[32:35], v3 offset:0
    ds_write_b128 v30, v[224:227] offset:8192
    s_add_u32 s60, s92, s94
    v_mfma_f32_16x16x32_bf16 v[100:103], a[128:131], a[4:7], 0
    ds_read_b128 a[36:39], v3 offset:1024
    buffer_load_dwordx4 v11, s[36:39], s60 offen offset:0 lds
    v_cmp_lt_u32 vcc, s95, v252
    s_cbranch_vccnz L_redo
    s_waitcnt lgkmcnt(3)
    v_mfma_f32_16x16x32_bf16 v[100:103], a[132:135], a[20:23], v[100:103]
    ds_read_b128 a[40:43], v3 offset:2048
    v_mfma_f32_16x16x32_bf16 v[104:107], a[128:131], a[8:11], 0
    ds_read_b128 a[44:47], v3 offset:3072
    v_accvgpr_read_b32 v168, a68
    v_accvgpr_read_b32 v169, a69
    v_accvgpr_read_b32 v170, a70
    v_accvgpr_read_b32 v171, a71
    v_accvgpr_read_b32 v172, a84
    v_accvgpr_read_b32 v173, a85
    v_accvgpr_read_b32 v174, a86
    v_accvgpr_read_b32 v175, a87
    v_pk_mul_f32 v[168:169], v[168:169], v[246:247] op_sel_hi:[1,0]
    v_pk_mul_f32 v[170:171], v[170:171], v[246:247] op_sel_hi:[1,0]
    v_pk_mul_f32 v[172:173], v[172:173], v[246:247] op_sel_hi:[1,0]
    v_pk_mul_f32 v[174:175], v[174:175], v[246:247] op_sel_hi:[1,0]
    v_cvt_pk_bf16_f32 v228, v168, v169
    v_cvt_pk_bf16_f32 v229, v170, v171
    v_cvt_pk_bf16_f32 v230, v172, v173
    v_cvt_pk_bf16_f32 v231, v174, v175
    v_mfma_f32_16x16x32_bf16 v[104:107], a[132:135], a[24:27], v[104:107]
    ds_read_b128 a[48:51], v3 offset:4096
    ds_write_b128 v30, v[228:231] offset:9216
    v_mfma_f32_16x16x32_bf16 v[108:111], a[128:131], a[12:15], 0
    ds_read_b128 a[52:55], v3 offset:5120
    v_mfma_f32_16x16x32_bf16 v[108:111], a[132:135], a[28:31], v[108:111]
    ds_read_b128 a[56:59], v3 offset:6144
    buffer_load_dwordx4 v12, s[36:39], s60 offen offset:1032 lds
    v_mfma_f32_16x16x32_bf16 v[112:115], a[136:139], a[0:3], 0
    ds_read_b128 a[60:63], v3 offset:7168
    v_mfma_f32_16x16x32_bf16 v[112:115], a[140:143], a[16:19], v[112:115]
    ds_read_b128 v[32:35], v4 offset:0
    v_accvgpr_read_b32 v176, a72
    v_accvgpr_read_b32 v177, a73
    v_accvgpr_read_b32 v178, a74
    v_accvgpr_read_b32 v179, a75
    v_accvgpr_read_b32 v180, a88
    v_accvgpr_read_b32 v181, a89
    v_accvgpr_read_b32 v182, a90
    v_accvgpr_read_b32 v183, a91
L_stub9:
    s_cbranch_execz L_stub13
    v_pk_mul_f32 v[176:177], v[176:177], v[248:249] op_sel_hi:[1,0]
    v_pk_mul_f32 v[178:179], v[178:179], v[248:249] op_sel_hi:[1,0]
    v_pk_mul_f32 v[180:181], v[180:181], v[248:249] op_sel_hi:[1,0]
    v_pk_mul_f32 v[182:183], v[182:183], v[248:249] op_sel_hi:[1,0]
    v_cvt_pk_bf16_f32 v232, v176, v177
    v_cvt_pk_bf16_f32 v233, v178, v179
    v_cvt_pk_bf16_f32 v234, v180, v181
    v_cvt_pk_bf16_f32 v235, v182, v183
    v_mfma_f32_16x16x32_bf16 v[116:119], a[136:139], a[4:7], 0
    ds_read_b128 v[36:39], v4 offset:1024
    ds_write_b128 v30, v[232:235] offset:10240
    v_mfma_f32_16x16x32_bf16 v[116:119], a[140:143], a[20:23], v[116:119]
    ds_read_b128 v[40:43], v4 offset:2048
    v_mfma_f32_16x16x32_bf16 v[120:123], a[136:139], a[8:11], 0
    ds_read_b128 v[44:47], v4 offset:3072
    buffer_load_dwordx4 v13, s[36:39], s60 offen offset:2064 lds
    v_mfma_f32_16x16x32_bf16 v[120:123], a[140:143], a[24:27], v[120:123]
    ds_read_b128 v[48:51], v4 offset:4096
    v_accvgpr_read_b32 v184, a76
    v_accvgpr_read_b32 v185, a77
    v_accvgpr_read_b32 v186, a78
    v_accvgpr_read_b32 v187, a79
    v_accvgpr_read_b32 v188, a92
    v_accvgpr_read_b32 v189, a93
    v_accvgpr_read_b32 v190, a94
    v_accvgpr_read_b32 v191, a95
    v_pk_mul_f32 v[184:185], v[184:185], v[250:251] op_sel_hi:[1,0]
    v_pk_mul_f32 v[186:187], v[186:187], v[250:251] op_sel_hi:[1,0]
    v_pk_mul_f32 v[188:189], v[188:189], v[250:251] op_sel_hi:[1,0]
    v_pk_mul_f32 v[190:191], v[190:191], v[250:251] op_sel_hi:[1,0]
    v_cvt_pk_bf16_f32 v236, v184, v185
    v_cvt_pk_bf16_f32 v237, v186, v187
    v_cvt_pk_bf16_f32 v238, v188, v189
    v_cvt_pk_bf16_f32 v239, v190, v191
    v_mfma_f32_16x16x32_bf16 v[124:127], a[136:139], a[12:15], 0
    ds_read_b128 v[52:55], v4 offset:5120
    ds_write_b128 v30, v[236:239] offset:11264
    v_mfma_f32_16x16x32_bf16 v[124:127], a[140:143], a[28:31], v[124:127]
    ds_read_b128 v[56:59], v4 offset:6144
    s_waitcnt lgkmcnt(5)
    v_mfma_f32_16x16x32_bf16 v[96:99], a[144:147], a[32:35], v[96:99]
    ds_read_b128 v[60:63], v4 offset:7168
    v_mfma_f32_16x16x32_bf16 v[96:99], a[148:151], a[48:51], v[96:99]
    ds_read_b128 v[64:67], v5 offset:0
    buffer_load_dwordx4 v14, s[36:39], s60 offen offset:3096 lds
    v_mfma_f32_16x16x32_bf16 v[100:103], a[144:147], a[36:39], v[100:103]
    ds_read_b128 v[68:71], v5 offset:1024
    v_accvgpr_read_b32 v160, a96
    v_accvgpr_read_b32 v161, a97
    v_accvgpr_read_b32 v162, a98
    v_accvgpr_read_b32 v163, a99
    v_accvgpr_read_b32 v164, a112
    v_accvgpr_read_b32 v165, a113
    v_accvgpr_read_b32 v166, a114
    v_accvgpr_read_b32 v167, a115
    v_pk_mul_f32 v[160:161], v[160:161], v[244:245] op_sel_hi:[1,0]
    v_pk_mul_f32 v[162:163], v[162:163], v[244:245] op_sel_hi:[1,0]
    v_pk_mul_f32 v[164:165], v[164:165], v[244:245] op_sel_hi:[1,0]
    v_pk_mul_f32 v[166:167], v[166:167], v[244:245] op_sel_hi:[1,0]
    v_cvt_pk_bf16_f32 v224, v160, v161
    v_cvt_pk_bf16_f32 v225, v162, v163
    v_cvt_pk_bf16_f32 v226, v164, v165
    v_cvt_pk_bf16_f32 v227, v166, v167
    s_add_u32 s94, s94, 0x20000
    s_and_b32 s94, s94, 0x7ffff
    v_mfma_f32_16x16x32_bf16 v[100:103], a[148:151], a[52:55], v[100:103]
    ds_read_b128 v[72:75], v5 offset:2048
    ds_write_b128 v30, v[224:227] offset:12288
    v_mfma_f32_16x16x32_bf16 v[104:107], a[144:147], a[40:43], v[104:107]
    ds_read_b128 v[76:79], v5 offset:3072
    s_add_u32 m0, s63, 4128
    v_mfma_f32_16x16x32_bf16 v[104:107], a[148:151], a[56:59], v[104:107]
    ds_read_b128 v[80:83], v5 offset:4096
    s_add_u32 s60, s92, s94
    v_mfma_f32_16x16x32_bf16 v[108:111], a[144:147], a[44:47], v[108:111]
    ds_read_b128 v[84:87], v5 offset:5120
    buffer_load_dwordx4 v11, s[36:39], s60 offen offset:0 lds
    v_accvgpr_read_b32 v168, a100
    v_accvgpr_read_b32 v169, a101
    v_accvgpr_read_b32 v170, a102
    v_accvgpr_read_b32 v171, a103
    v_accvgpr_read_b32 v172, a116
    v_accvgpr_read_b32 v173, a117
    v_accvgpr_read_b32 v174, a118
    v_accvgpr_read_b32 v175, a119
    v_pk_mul_f32 v[168:169], v[168:169], v[246:247] op_sel_hi:[1,0]
    v_pk_mul_f32 v[170:171], v[170:171], v[246:247] op_sel_hi:[1,0]
    v_pk_mul_f32 v[172:173], v[172:173], v[246:247] op_sel_hi:[1,0]
    v_pk_mul_f32 v[174:175], v[174:175], v[246:247] op_sel_hi:[1,0]
    v_cvt_pk_bf16_f32 v228, v168, v169
    v_cvt_pk_bf16_f32 v229, v170, v171
    v_cvt_pk_bf16_f32 v230, v172, v173
    v_cvt_pk_bf16_f32 v231, v174, v175
    v_mfma_f32_16x16x32_bf16 v[108:111], a[148:151], a[60:63], v[108:111]
    ds_read_b128 v[88:91], v5 offset:6144
    ds_write_b128 v30, v[228:231] offset:13312
    v_mfma_f32_16x16x32_bf16 v[112:115], a[152:155], a[32:35], v[112:115]
    ds_read_b128 v[92:95], v5 offset:7168
    v_mfma_f32_16x16x32_bf16 v[112:115], a[156:159], a[48:51], v[112:115]
    v_mfma_f32_16x16x32_bf16 v[116:119], a[152:155], a[36:39], v[116:119]
    buffer_load_dwordx4 v12, s[36:39], s60 offen offset:1032 lds
    v_mfma_f32_16x16x32_bf16 v[116:119], a[156:159], a[52:55], v[116:119]
    v_accvgpr_read_b32 v176, a104
    v_accvgpr_read_b32 v177, a105
    v_accvgpr_read_b32 v178, a106
    v_accvgpr_read_b32 v179, a107
    v_accvgpr_read_b32 v180, a120
    v_accvgpr_read_b32 v181, a121
    v_accvgpr_read_b32 v182, a122
    v_accvgpr_read_b32 v183, a123
    v_pk_mul_f32 v[176:177], v[176:177], v[248:249] op_sel_hi:[1,0]
    v_pk_mul_f32 v[178:179], v[178:179], v[248:249] op_sel_hi:[1,0]
    v_pk_mul_f32 v[180:181], v[180:181], v[248:249] op_sel_hi:[1,0]
    v_pk_mul_f32 v[182:183], v[182:183], v[248:249] op_sel_hi:[1,0]
    v_cvt_pk_bf16_f32 v232, v176, v177
    v_cvt_pk_bf16_f32 v233, v178, v179
    v_cvt_pk_bf16_f32 v234, v180, v181
    v_cvt_pk_bf16_f32 v235, v182, v183
    v_mfma_f32_16x16x32_bf16 v[120:123], a[152:155], a[40:43], v[120:123]
    ds_write_b128 v30, v[232:235] offset:14336
    v_mfma_f32_16x16x32_bf16 v[120:123], a[156:159], a[56:59], v[120:123]
    v_mfma_f32_16x16x32_bf16 v[124:127], a[152:155], a[44:47], v[124:127]
    v_mfma_f32_16x16x32_bf16 v[124:127], a[156:159], a[60:63], v[124:127]
    v_accvgpr_read_b32 v184, a108
    v_accvgpr_read_b32 v185, a109
    v_accvgpr_read_b32 v186, a110
    v_accvgpr_read_b32 v187, a111
    v_accvgpr_read_b32 v188, a124
    v_accvgpr_read_b32 v189, a125
    v_accvgpr_read_b32 v190, a126
    v_accvgpr_read_b32 v191, a127
    v_pk_mul_f32 v[184:185], v[184:185], v[250:251] op_sel_hi:[1,0]
    v_pk_mul_f32 v[186:187], v[186:187], v[250:251] op_sel_hi:[1,0]
    v_pk_mul_f32 v[188:189], v[188:189], v[250:251] op_sel_hi:[1,0]
    v_pk_mul_f32 v[190:191], v[190:191], v[250:251] op_sel_hi:[1,0]
    v_cvt_pk_bf16_f32 v236, v184, v185
    v_cvt_pk_bf16_f32 v237, v186, v187
    v_cvt_pk_bf16_f32 v238, v188, v189
    v_cvt_pk_bf16_f32 v239, v190, v191
    v_mfma_f32_16x16x32_bf16 v[96:99], a[160:163], v[32:35], v[96:99]
    ds_write_b128 v30, v[236:239] offset:15360
    buffer_load_dwordx4 v13, s[36:39], s60 offen offset:2064 lds
    s_mul_i32 s6, s35, 4128
    s_waitcnt lgkmcnt(1)
    v_mfma_f32_16x16x32_bf16 v[96:99], a[164:167], v[48:51], v[96:99]
    s_add_u32 s6, s6, 49408
    s_sub_u32 s100, s6, s63
    v_mfma_f32_16x16x32_bf16 v[100:103], a[160:163], v[36:39], v[100:103]
    v_add_u32 v20, s100, v10
    s_mul_i32 s7, s35, 8256
    v_mfma_f32_16x16x32_bf16 v[100:103], a[164:167], v[52:55], v[100:103]
    s_sub_u32 s100, s7, s63
    v_add_u32 v21, s100, v10
    v_mfma_f32_16x16x32_bf16 v[104:107], a[160:163], v[40:43], v[104:107]
    buffer_load_dwordx4 v14, s[36:39], s60 offen offset:3096 lds
    s_mul_i32 s62, s35, 4128
    v_mfma_f32_16x16x32_bf16 v[104:107], a[164:167], v[56:59], v[104:107]
    s_add_u32 s94, s94, 0x20000
    s_and_b32 s94, s94, 0x7ffff
    v_mfma_f32_16x16x32_bf16 v[108:111], a[160:163], v[44:47], v[108:111]
    s_add_u32 s62, s62, 33024
    s_cmp_eq_u32 s35, 3
    s_cselect_b32 s62, 156544, s62
    v_mfma_f32_16x16x32_bf16 v[108:111], a[164:167], v[60:63], v[108:111]
    s_sub_u32 s100, s62, s63
    v_add_u32 v15, s100, v10
    v_mfma_f32_16x16x32_bf16 v[112:115], a[168:171], v[32:35], v[112:115]
    s_waitcnt lgkmcnt(0)
    s_barrier
    v_and_b32 v6, 15, v1
    v_mfma_f32_16x16x32_bf16 v[112:115], a[172:175], v[48:51], v[112:115]
    ds_read_b128 a[64:67], v2 offset:8192
    v_lshrrev_b32 v7, 1, v6
    v_mfma_f32_16x16x32_bf16 v[116:119], a[168:171], v[36:39], v[116:119]
    ds_read_b128 a[68:71], v2 offset:9216
    s_mov_b32 m0, s6
    v_mfma_f32_16x16x32_bf16 v[116:119], a[172:175], v[52:55], v[116:119]
    ds_read_b128 a[72:75], v2 offset:10240
    s_add_u32 s60, s92, s94
    s_add_u32 s60, s60, 0x10000
    v_mfma_f32_16x16x32_bf16 v[120:123], a[168:171], v[40:43], v[120:123]
    ds_read_b128 a[76:79], v2 offset:11264
    v_and_b32 v6, 1, v1
    v_mfma_f32_16x16x32_bf16 v[120:123], a[172:175], v[56:59], v[120:123]
    buffer_load_dwordx4 v11, s[36:39], s60 offen offset:0 lds
    v_lshrrev_b32 v8, 4, v1
    v_mfma_f32_16x16x32_bf16 v[124:127], a[168:171], v[44:47], v[124:127]
    ds_read_b128 a[80:83], v2 offset:12288
    v_lshlrev_b32 v31, 11, v7
    v_mfma_f32_16x16x32_bf16 v[124:127], a[172:175], v[60:63], v[124:127]
    ds_read_b128 a[84:87], v2 offset:13312
    v_lshl_add_u32 v31, v6, 4, v31
    v_mfma_f32_16x16x32_bf16 v[96:99], a[176:179], v[64:67], v[96:99]
    ds_read_b128 a[88:91], v2 offset:14336
    v_lshl_add_u32 v31, v8, 5, v31
    v_mfma_f32_16x16x32_bf16 v[96:99], a[180:183], v[80:83], v[96:99]
    ds_read_b128 a[92:95], v2 offset:15360
    buffer_load_dwordx4 v12, s[36:39], s60 offen offset:1032 lds
    v_lshrrev_b32 v7, 3, v1
    v_mfma_f32_16x16x32_bf16 v[100:103], a[176:179], v[68:71], v[100:103]
    ds_read_b128 a[96:99], v3 offset:8192
    v_and_b32 v8, 7, v1
    v_mfma_f32_16x16x32_bf16 v[100:103], a[180:183], v[84:87], v[100:103]
    ds_read_b128 a[100:103], v3 offset:9216
    v_lshlrev_b32 v23, 7, v8
    v_and_b32 v7, 1, v7
    v_mfma_f32_16x16x32_bf16 v[104:107], a[176:179], v[72:75], v[104:107]
    ds_read_b128 a[104:107], v3 offset:10240
    v_mul_u32_u24 v7, 917504, v7
    v_mfma_f32_16x16x32_bf16 v[104:107], a[180:183], v[88:91], v[104:107]
    ds_read_b128 a[108:111], v3 offset:11264
    buffer_load_dwordx4 v13, s[36:39], s60 offen offset:2064 lds
    v_add_u32 v23, v23, v7
    v_mfma_f32_16x16x32_bf16 v[108:111], a[176:179], v[76:79], v[108:111]
    ds_read_b128 a[112:115], v3 offset:12288
    v_lshlrev_b32 v19, 16, v8
    v_mfma_f32_16x16x32_bf16 v[108:111], a[180:183], v[92:95], v[108:111]
    ds_read_b128 a[116:119], v3 offset:13312
    v_mov_b32 v7, 268435456
    v_mfma_f32_16x16x32_bf16 v[112:115], a[184:187], v[64:67], v[112:115]
    ds_read_b128 a[120:123], v3 offset:14336
    v_cmp_le_u32 vcc, 8, v1
    s_nop 1
    v_cndmask_b32 v19, v19, v7, vcc
    v_mfma_f32_16x16x32_bf16 v[112:115], a[188:191], v[80:83], v[112:115]
    ds_read_b128 a[124:127], v3 offset:15360
    buffer_load_dwordx4 v14, s[36:39], s60 offen offset:3096 lds
    v_and_b32 v24, 31, v1
    v_mfma_f32_16x16x32_bf16 v[116:119], a[184:187], v[68:71], v[116:119]
    ds_read_b128 a[128:131], v4 offset:8192
    v_lshlrev_b32 v24, 4, v24
    s_lshl_b32 s100, s57, 3
    s_add_u32 s94, s94, 0x20000
    s_and_b32 s94, s94, 0x7ffff
    v_mfma_f32_16x16x32_bf16 v[116:119], a[188:191], v[84:87], v[116:119]
    ds_read_b128 a[132:135], v4 offset:9216
    s_add_u32 s100, s100, s56
    v_mfma_f32_16x16x32_bf16 v[120:123], a[184:187], v[72:75], v[120:123]
    ds_read_b128 a[136:139], v4 offset:10240
    s_lshl_b32 s100, s100, 7
    v_mfma_f32_16x16x32_bf16 v[120:123], a[188:191], v[88:91], v[120:123]
    ds_read_b128 a[140:143], v4 offset:11264
    s_add_u32 s100, s100, 1048576
    v_mfma_f32_16x16x32_bf16 v[124:127], a[184:187], v[76:79], v[124:127]
    ds_read_b128 a[144:147], v4 offset:12288
    s_lshl_b32 s101, s58, 3
    v_mfma_f32_16x16x32_bf16 v[124:127], a[188:191], v[92:95], v[124:127]
    ds_read_b128 a[148:151], v4 offset:13312
    s_add_u32 s101, s101, s59
    s_waitcnt lgkmcnt(6)
    v_mfma_f32_16x16x32_bf16 v[96:99], v[128:131], a[64:67], v[96:99]
    ds_read_b128 a[152:155], v4 offset:14336
    s_lshl_b32 s101, s101, 7
    v_mfma_f32_16x16x32_bf16 v[96:99], v[132:135], a[80:83], v[96:99]
    ds_read_b128 a[156:159], v4 offset:15360
    s_add_u32 s101, s101, 130944
    v_lshlrev_b32 v8, 2, v1
    v_mfma_f32_16x16x32_bf16 v[100:103], v[128:131], a[68:71], v[100:103]
    ds_read_b128 a[160:163], v5 offset:8192
    v_add_u32 v22, s100, v8
    v_mfma_f32_16x16x32_bf16 v[100:103], v[132:135], a[84:87], v[100:103]
    ds_read_b128 a[164:167], v5 offset:9216
    v_add_u32 v8, s101, v8
    v_mfma_f32_16x16x32_bf16 v[104:107], v[128:131], a[72:75], v[104:107]
    ds_read_b128 a[168:171], v5 offset:10240
    v_cmp_le_u32 vcc, 32, v1
    s_nop 1
    v_cndmask_b32 v22, v22, v8, vcc
    v_mfma_f32_16x16x32_bf16 v[104:107], v[132:135], a[88:91], v[104:107]
    ds_read_b128 a[172:175], v5 offset:11264
    v_lshrrev_b32 v8, 5, v1
    v_mfma_f32_16x16x32_bf16 v[108:111], v[128:131], a[76:79], v[108:111]
    ds_read_b128 a[176:179], v5 offset:12288
    v_lshl_add_u32 v24, v8, 16, v24
    v_mfma_f32_16x16x32_bf16 v[108:111], v[132:135], a[92:95], v[108:111]
    ds_read_b128 a[180:183], v5 offset:13312
    v_mov_b32 v25, s34
    s_lshl_b32 s101, s57, 3
    v_mfma_f32_16x16x32_bf16 v[112:115], v[136:139], a[64:67], v[112:115]
    ds_read_b128 a[184:187], v5 offset:14336
    s_add_u32 s101, s101, s56
    v_mfma_f32_16x16x32_bf16 v[112:115], v[140:143], a[80:83], v[112:115]
    ds_read_b128 a[188:191], v5 offset:15360
    s_lshl_b32 s93, s101, 16
    v_mfma_f32_16x16x32_bf16 v[116:119], v[136:139], a[68:71], v[116:119]
    s_lshl_b32 s100, s35, 7
    s_add_u32 s93, s93, s100
    v_mfma_f32_16x16x32_bf16 v[116:119], v[140:143], a[84:87], v[116:119]
    s_add_u32 s93, s93, 16777216
    s_lshl_b32 s8, s14, 9
    v_mfma_f32_16x16x32_bf16 v[120:123], v[136:139], a[72:75], v[120:123]
    s_cmp_lg_u32 s35, 0
    s_cselect_b32 s9, 268435456, 0
    s_lshl_b32 s0, s58, 10
    v_mfma_f32_16x16x32_bf16 v[120:123], v[140:143], a[88:91], v[120:123]
    s_add_u32 s0, s0, 131072
    s_lshl_b32 s1, s58, 19
    v_mfma_f32_16x16x32_bf16 v[124:127], v[136:139], a[76:79], v[124:127]
    s_waitcnt lgkmcnt(0)
    s_barrier
    s_mov_b32 m0, s7
    v_mfma_f32_16x16x32_bf16 v[124:127], v[140:143], a[92:95], v[124:127]
    s_add_u32 s60, s92, s94
    s_add_u32 s60, s60, 0x10000
    v_mfma_f32_16x16x32_bf16 v[96:99], v[144:147], a[96:99], v[96:99]
    buffer_load_dwordx4 v11, s[36:39], s60 offen offset:0 lds
    s_lshl_b32 s100, s59, 13
    v_mfma_f32_16x16x32_bf16 v[96:99], v[148:151], a[112:115], v[96:99]
    s_add_u32 s1, s1, s100
    s_lshl_b32 s100, s35, 11
    v_mfma_f32_16x16x32_bf16 v[100:103], v[144:147], a[100:103], v[100:103]
    s_add_u32 s1, s1, s100
    s_add_u32 s1, s1, 16777216
    v_mfma_f32_16x16x32_bf16 v[100:103], v[148:151], a[116:119], v[100:103]
    s_and_b32 s12, s58, 3
    s_lshl_b32 s12, s12, 9
    v_mfma_f32_16x16x32_bf16 v[104:107], v[144:147], a[104:107], v[104:107]
    buffer_load_dwordx4 v12, s[36:39], s60 offen offset:1032 lds
    s_mov_b32 s15, 0
    v_mfma_f32_16x16x32_bf16 v[104:107], v[148:151], a[120:123], v[104:107]
    v_lshrrev_b32 v6, 5, v1
    s_and_b32 s100, s58, 3
    v_mfma_f32_16x16x32_bf16 v[108:111], v[144:147], a[108:111], v[108:111]
    v_add_u32 v6, s100, v6
    v_add_u32 v7, 2, v6
    v_mfma_f32_16x16x32_bf16 v[108:111], v[148:151], a[124:127], v[108:111]
    v_and_b32 v6, 3, v6
    v_and_b32 v7, 3, v7
    v_mfma_f32_16x16x32_bf16 v[112:115], v[152:155], a[96:99], v[112:115]
    buffer_load_dwordx4 v13, s[36:39], s60 offen offset:2064 lds
    v_and_b32 v8, 30, v1
    v_mfma_f32_16x16x32_bf16 v[112:115], v[156:159], a[112:115], v[112:115]
    v_lshlrev_b32 v8, 3, v8
    v_lshl_add_u32 v6, v6, 8, v8
    v_mfma_f32_16x16x32_bf16 v[116:119], v[152:155], a[100:103], v[116:119]
    v_lshl_add_u32 v7, v7, 8, v8
    v_lshlrev_b32 v240, 1, v6
    v_mfma_f32_16x16x32_bf16 v[116:119], v[156:159], a[116:119], v[116:119]
    v_lshlrev_b32 v241, 1, v7
    v_add_u32 v242, 148352, v240
    v_mfma_f32_16x16x32_bf16 v[120:123], v[152:155], a[104:107], v[120:123]
    buffer_load_dwordx4 v14, s[36:39], s60 offen offset:3096 lds
    s_add_u32 s94, s94, 0x20000
    v_mfma_f32_16x16x32_bf16 v[120:123], v[156:159], a[120:123], v[120:123]
    s_and_b32 s94, s94, 0x7ffff
    s_add_u32 m0, s7, 4128
    v_mfma_f32_16x16x32_bf16 v[124:127], v[152:155], a[108:111], v[124:127]
    s_add_u32 s60, s92, s94
    s_add_u32 s60, s60, 0x10000
    v_add_u32 v243, 148352, v241
    v_mfma_f32_16x16x32_bf16 v[124:127], v[156:159], a[124:127], v[124:127]
    buffer_load_dwordx4 v11, s[36:39], s60 offen offset:0 lds
    v_mfma_f32_16x16x32_bf16 v[96:99], v[192:195], a[128:131], v[96:99]
    v_and_b32 v241, 3, v1
    v_lshlrev_b32 v241, 2, v241
    v_mfma_f32_16x16x32_bf16 v[96:99], v[196:199], a[144:147], v[96:99]
    v_add_u32 v241, 161152, v241
    v_not_b32 v240, v25
    v_mfma_f32_16x16x32_bf16 v[100:103], v[192:195], a[132:135], v[100:103]
    buffer_load_dwordx4 v12, s[36:39], s60 offen offset:1032 lds
    v_mfma_f32_16x16x32_bf16 v[100:103], v[196:199], a[148:151], v[100:103]
    ds_write_b32 v241, v240
    v_mov_b32 v241, 161152
    v_mfma_f32_16x16x32_bf16 v[104:107], v[192:195], a[136:139], v[104:107]
    v_and_b32 v8, 1, v1
    v_lshl_add_u32 v6, v8, 10, v6
    v_mfma_f32_16x16x32_bf16 v[104:107], v[196:199], a[152:155], v[104:107]
    v_lshl_add_u32 v7, v8, 10, v7
    v_lshlrev_b32 v8, 4, v0
    v_mfma_f32_16x16x32_bf16 v[108:111], v[192:195], a[140:143], v[108:111]
    buffer_load_dwordx4 v13, s[36:39], s60 offen offset:2064 lds
    v_add_u32 v8, 20480, v8
    v_mfma_f32_16x16x32_bf16 v[108:111], v[196:199], a[156:159], v[108:111]
    s_lshl_b32 s10, s58, 16
    s_lshl_b32 s100, s59, 13
    v_mfma_f32_16x16x32_bf16 v[112:115], v[200:203], a[128:131], v[112:115]
    s_add_u32 s10, s10, s100
    s_lshl_b32 s100, s35, 11
    v_mfma_f32_16x16x32_bf16 v[112:115], v[204:207], a[144:147], v[112:115]
    s_add_u32 s10, s10, s100
    s_mov_b32 s52, s4
    v_mfma_f32_16x16x32_bf16 v[116:119], v[200:203], a[132:135], v[116:119]
    buffer_load_dwordx4 v14, s[36:39], s60 offen offset:3096 lds
    s_add_u32 s94, s94, 0x20000
    v_mfma_f32_16x16x32_bf16 v[116:119], v[204:207], a[148:151], v[116:119]
    s_and_b32 s94, s94, 0x7ffff
    s_mov_b32 m0, s62
    v_mfma_f32_16x16x32_bf16 v[120:123], v[200:203], a[136:139], v[120:123]
    s_add_u32 s60, s92, s94
    s_add_u32 s60, s60, 0x10000
    s_mov_b32 s53, s5
    v_mfma_f32_16x16x32_bf16 v[120:123], v[204:207], a[152:155], v[120:123]
    buffer_load_dwordx4 v11, s[36:39], s60 offen offset:0 lds
    s_mov_b32 s54, 2097152
    v_mfma_f32_16x16x32_bf16 v[124:127], v[200:203], a[140:143], v[124:127]
    s_mov_b32 s55, 0x20000
    s_movk_i32 s11, 4096
    v_mfma_f32_16x16x32_bf16 v[124:127], v[204:207], a[156:159], v[124:127]
    v_mfma_f32_16x16x32_bf16 v[96:99], v[208:211], a[160:163], v[96:99]
    s_waitcnt vmcnt(25)
    ds_read_b64_tr_b16 a[192:193], v10 offset:8256
    v_mfma_f32_16x16x32_bf16 v[96:99], v[212:215], a[176:179], v[96:99]
    buffer_load_dwordx4 v12, s[36:39], s60 offen offset:1032 lds
    v_mfma_f32_16x16x32_bf16 v[100:103], v[208:211], a[164:167], v[100:103]
    ds_read_b64_tr_b16 a[194:195], v10 offset:8512
    v_mfma_f32_16x16x32_bf16 v[100:103], v[212:215], a[180:183], v[100:103]
    ds_read_b64_tr_b16 a[196:197], v10 offset:10320
    v_mfma_f32_16x16x32_bf16 v[104:107], v[208:211], a[168:171], v[104:107]
    ds_read_b64_tr_b16 a[198:199], v10 offset:10576
    v_mfma_f32_16x16x32_bf16 v[104:107], v[212:215], a[184:187], v[104:107]
    ds_read_b64_tr_b16 a[200:201], v10 offset:8264
    buffer_load_dwordx4 v13, s[36:39], s60 offen offset:2064 lds
    v_mfma_f32_16x16x32_bf16 v[108:111], v[208:211], a[172:175], v[108:111]
    ds_read_b64_tr_b16 a[202:203], v10 offset:8520
    v_mfma_f32_16x16x32_bf16 v[108:111], v[212:215], a[188:191], v[108:111]
    ds_read_b64_tr_b16 a[204:205], v10 offset:10328
    v_mfma_f32_16x16x32_bf16 v[112:115], v[216:219], a[160:163], v[112:115]
    ds_read_b64_tr_b16 a[206:207], v10 offset:10584
    v_mfma_f32_16x16x32_bf16 v[112:115], v[220:223], a[176:179], v[112:115]
    buffer_load_dwordx4 v14, s[36:39], s60 offen offset:3096 lds
    s_add_u32 s94, s94, 0x20000
    v_mfma_f32_16x16x32_bf16 v[116:119], v[216:219], a[164:167], v[116:119]
    s_and_b32 s94, s94, 0x7ffff
    s_add_u32 s92, s92, 256
    s_and_b32 s92, s92, 1023
    v_mfma_f32_16x16x32_bf16 v[116:119], v[220:223], a[180:183], v[116:119]
    s_add_u32 m0, s63, 8256
    s_add_u32 s60, s92, s94
    v_mfma_f32_16x16x32_bf16 v[120:123], v[216:219], a[168:171], v[120:123]
    s_waitcnt lgkmcnt(0)
    buffer_load_dwordx4 v11, s[36:39], s60 offen offset:0 lds
    v_mfma_f32_16x16x32_bf16 v[120:123], v[220:223], a[184:187], v[120:123]
    v_mfma_f32_16x16x32_bf16 v[124:127], v[216:219], a[172:175], v[124:127]
    v_mfma_f32_16x16x32_bf16 v[124:127], v[220:223], a[188:191], v[124:127]
    buffer_load_dwordx4 v12, s[36:39], s60 offen offset:1032 lds
    v_mfma_f32_16x16x32_bf16 v[128:131], a[192:195], a[0:3], 0
    s_waitcnt vmcnt(26)
    ds_read_b64_tr_b16 a[208:209], v10 offset:12384
    v_mfma_f32_16x16x32_bf16 v[128:131], a[196:199], a[16:19], v[128:131]
    ds_read_b64_tr_b16 a[210:211], v10 offset:12640
    v_mfma_f32_16x16x32_bf16 v[132:135], a[192:195], a[4:7], 0
    ds_read_b64_tr_b16 a[212:213], v10 offset:14448
    s_add_u32 s61, s93, s8
    v_mfma_f32_16x16x32_bf16 v[132:135], a[196:199], a[20:23], v[132:135]
    ds_read_b64_tr_b16 a[214:215], v10 offset:14704
    v_cvt_pk_bf16_f32 v224, v96, v97
    v_mfma_f32_16x16x32_bf16 v[136:139], a[192:195], a[8:11], 0
    buffer_load_dwordx4 v13, s[36:39], s60 offen offset:2064 lds
    v_cvt_pk_bf16_f32 v225, v98, v99
    v_mfma_f32_16x16x32_bf16 v[136:139], a[196:199], a[24:27], v[136:139]
    ds_read_b64_tr_b16 a[216:217], v10 offset:12392
    v_cvt_pk_bf16_f32 v226, v112, v113
    v_mfma_f32_16x16x32_bf16 v[140:143], a[192:195], a[12:15], 0
    ds_read_b64_tr_b16 a[218:219], v10 offset:12648
    v_cvt_pk_bf16_f32 v227, v114, v115
    v_mfma_f32_16x16x32_bf16 v[140:143], a[196:199], a[28:31], v[140:143]
    ds_read_b64_tr_b16 a[220:221], v10 offset:14456
    v_mfma_f32_16x16x32_bf16 v[144:147], a[200:203], a[0:3], 0
    ds_read_b64_tr_b16 a[222:223], v10 offset:14712
    buffer_load_dwordx4 v14, s[36:39], s60 offen offset:3096 lds
    v_mfma_f32_16x16x32_bf16 v[144:147], a[204:207], a[16:19], v[144:147]
    s_add_u32 s94, s94, 0x20000
    s_and_b32 s94, s94, 0x7ffff
    v_mfma_f32_16x16x32_bf16 v[148:151], a[200:203], a[4:7], 0
    buffer_store_dwordx4 v[224:227], v31, s[48:51], s61 offen sc1
    s_add_u32 m0, s63, 12384
    v_mfma_f32_16x16x32_bf16 v[148:151], a[204:207], a[20:23], v[148:151]
    s_add_u32 s60, s92, s94
    s_add_u32 s61, s61, 16384
    v_mfma_f32_16x16x32_bf16 v[152:155], a[200:203], a[8:11], 0
    s_waitcnt lgkmcnt(0)
    buffer_load_dwordx4 v11, s[36:39], s60 offen offset:0 lds
    v_cvt_pk_bf16_f32 v228, v100, v101
    v_mfma_f32_16x16x32_bf16 v[152:155], a[204:207], a[24:27], v[152:155]
    v_cvt_pk_bf16_f32 v229, v102, v103
    v_cvt_pk_bf16_f32 v230, v116, v117
    v_cvt_pk_bf16_f32 v231, v118, v119
    v_mfma_f32_16x16x32_bf16 v[156:159], a[200:203], a[12:15], 0
    buffer_store_dwordx4 v[228:231], v31, s[48:51], s61 offen sc1
    s_add_u32 s61, s61, 16384
    v_mfma_f32_16x16x32_bf16 v[156:159], a[204:207], a[28:31], v[156:159]
    buffer_load_dwordx4 v12, s[36:39], s60 offen offset:1032 lds
    v_mfma_f32_16x16x32_bf16 v[128:131], a[208:211], a[32:35], v[128:131]
    s_waitcnt vmcnt(28)
    ds_read_b64_tr_b16 a[192:193], v10 offset:0
    v_cvt_pk_bf16_f32 v232, v104, v105
    v_mfma_f32_16x16x32_bf16 v[128:131], a[212:215], a[48:51], v[128:131]
    v_cvt_pk_bf16_f32 v233, v106, v107
    v_cvt_pk_bf16_f32 v234, v120, v121
    v_cvt_pk_bf16_f32 v235, v122, v123
    v_mfma_f32_16x16x32_bf16 v[132:135], a[208:211], a[36:39], v[132:135]
    ds_read_b64_tr_b16 a[194:195], v10 offset:256
    buffer_store_dwordx4 v[232:235], v31, s[48:51], s61 offen sc1
    v_mfma_f32_16x16x32_bf16 v[132:135], a[212:215], a[52:55], v[132:135]
    ds_read_b64_tr_b16 a[196:197], v10 offset:2064
    s_add_u32 s61, s61, 16384
    v_mfma_f32_16x16x32_bf16 v[136:139], a[208:211], a[40:43], v[136:139]
    ds_read_b64_tr_b16 a[198:199], v10 offset:2320
    buffer_load_dwordx4 v13, s[36:39], s60 offen offset:2064 lds
    v_mfma_f32_16x16x32_bf16 v[136:139], a[212:215], a[56:59], v[136:139]
    ds_read_b64_tr_b16 a[200:201], v10 offset:8
    v_cvt_pk_bf16_f32 v236, v108, v109
    v_cvt_pk_bf16_f32 v237, v110, v111
    v_cvt_pk_bf16_f32 v238, v124, v125
    v_cvt_pk_bf16_f32 v239, v126, v127
    v_mfma_f32_16x16x32_bf16 v[140:143], a[208:211], a[44:47], v[140:143]
    ds_read_b64_tr_b16 a[202:203], v10 offset:264
    buffer_store_dwordx4 v[236:239], v31, s[48:51], s61 offen sc1
    v_mfma_f32_16x16x32_bf16 v[140:143], a[212:215], a[60:63], v[140:143]
    ds_read_b64_tr_b16 a[204:205], v10 offset:2072
    s_add_u32 s8, s8, 512
    v_mfma_f32_16x16x32_bf16 v[144:147], a[216:219], a[32:35], v[144:147]
    ds_read_b64_tr_b16 a[206:207], v10 offset:2328
    buffer_load_dwordx4 v14, s[36:39], s60 offen offset:3096 lds
    v_mfma_f32_16x16x32_bf16 v[144:147], a[220:223], a[48:51], v[144:147]
    s_add_u32 s94, s94, 0x20000
    s_and_b32 s94, s94, 0x7ffff
    v_mfma_f32_16x16x32_bf16 v[148:151], a[216:219], a[36:39], v[148:151]
    s_and_b32 s8, s8, 2047
    s_add_u32 m0, s63, 0
    v_mfma_f32_16x16x32_bf16 v[148:151], a[220:223], a[52:55], v[148:151]
    s_add_u32 s60, s92, s94
    v_mfma_f32_16x16x32_bf16 v[152:155], a[216:219], a[40:43], v[152:155]
    s_waitcnt lgkmcnt(0)
    buffer_load_dwordx4 v11, s[36:39], s60 offen offset:0 lds
    v_mfma_f32_16x16x32_bf16 v[152:155], a[220:223], a[56:59], v[152:155]
    v_mfma_f32_16x16x32_bf16 v[156:159], a[216:219], a[44:47], v[156:159]
    v_mfma_f32_16x16x32_bf16 v[156:159], a[220:223], a[60:63], v[156:159]
    buffer_load_dwordx4 v12, s[36:39], s60 offen offset:1032 lds
    v_mfma_f32_16x16x32_bf16 v[128:131], a[192:195], v[32:35], v[128:131]
    s_waitcnt vmcnt(30)
    ds_read_b64_tr_b16 a[208:209], v10 offset:4128
    v_mfma_f32_16x16x32_bf16 v[128:131], a[196:199], v[48:51], v[128:131]
    ds_read_b64_tr_b16 a[210:211], v10 offset:4384
    v_mfma_f32_16x16x32_bf16 v[132:135], a[192:195], v[36:39], v[132:135]
    ds_read_b64_tr_b16 a[212:213], v10 offset:6192
    v_mfma_f32_16x16x32_bf16 v[132:135], a[196:199], v[52:55], v[132:135]
    ds_read_b64_tr_b16 a[214:215], v10 offset:6448
    v_mfma_f32_16x16x32_bf16 v[136:139], a[192:195], v[40:43], v[136:139]
    buffer_load_dwordx4 v13, s[36:39], s60 offen offset:2064 lds
    v_mfma_f32_16x16x32_bf16 v[136:139], a[196:199], v[56:59], v[136:139]
    ds_read_b64_tr_b16 a[216:217], v10 offset:4136
    v_mfma_f32_16x16x32_bf16 v[140:143], a[192:195], v[44:47], v[140:143]
    ds_read_b64_tr_b16 a[218:219], v10 offset:4392
    v_mfma_f32_16x16x32_bf16 v[140:143], a[196:199], v[60:63], v[140:143]
    ds_read_b64_tr_b16 a[220:221], v10 offset:6200
    v_mfma_f32_16x16x32_bf16 v[144:147], a[200:203], v[32:35], v[144:147]
    ds_read_b64_tr_b16 a[222:223], v10 offset:6456
    buffer_load_dwordx4 v14, s[36:39], s60 offen offset:3096 lds
    v_mfma_f32_16x16x32_bf16 v[144:147], a[204:207], v[48:51], v[144:147]
    s_add_u32 s94, s94, 0x20000
    s_and_b32 s94, s94, 0x7ffff
    v_mfma_f32_16x16x32_bf16 v[148:151], a[200:203], v[36:39], v[148:151]
    s_add_u32 m0, s63, 4128
    s_add_u32 s60, s92, s94
    v_mfma_f32_16x16x32_bf16 v[148:151], a[204:207], v[52:55], v[148:151]
    s_waitcnt lgkmcnt(0)
    buffer_load_dwordx4 v11, s[36:39], s60 offen offset:0 lds
    v_mfma_f32_16x16x32_bf16 v[152:155], a[200:203], v[40:43], v[152:155]
    v_mfma_f32_16x16x32_bf16 v[152:155], a[204:207], v[56:59], v[152:155]
    v_mfma_f32_16x16x32_bf16 v[156:159], a[200:203], v[44:47], v[156:159]
    v_mfma_f32_16x16x32_bf16 v[156:159], a[204:207], v[60:63], v[156:159]
    buffer_load_dwordx4 v12, s[36:39], s60 offen offset:1032 lds
    v_mfma_f32_16x16x32_bf16 v[128:131], a[208:211], v[64:67], v[128:131]
L_stub10:
    s_cbranch_execz L_stub14
    s_waitcnt vmcnt(30)
    ds_read_b64_tr_b16 a[192:193], v20 offset:0
    v_mfma_f32_16x16x32_bf16 v[128:131], a[212:215], v[80:83], v[128:131]
    ds_read_b64_tr_b16 a[194:195], v20 offset:256
    v_mfma_f32_16x16x32_bf16 v[132:135], a[208:211], v[68:71], v[132:135]
    ds_read_b64_tr_b16 a[196:197], v20 offset:2064
    v_mfma_f32_16x16x32_bf16 v[132:135], a[212:215], v[84:87], v[132:135]
    ds_read_b64_tr_b16 a[198:199], v20 offset:2320
    v_mfma_f32_16x16x32_bf16 v[136:139], a[208:211], v[72:75], v[136:139]
    buffer_load_dwordx4 v13, s[36:39], s60 offen offset:2064 lds
    v_mfma_f32_16x16x32_bf16 v[136:139], a[212:215], v[88:91], v[136:139]
    ds_read_b64_tr_b16 a[200:201], v20 offset:8
    v_mfma_f32_16x16x32_bf16 v[140:143], a[208:211], v[76:79], v[140:143]
    ds_read_b64_tr_b16 a[202:203], v20 offset:264
    v_mfma_f32_16x16x32_bf16 v[140:143], a[212:215], v[92:95], v[140:143]
    ds_read_b64_tr_b16 a[204:205], v20 offset:2072
    v_mfma_f32_16x16x32_bf16 v[144:147], a[216:219], v[64:67], v[144:147]
    ds_read_b64_tr_b16 a[206:207], v20 offset:2328
    buffer_load_dwordx4 v14, s[36:39], s60 offen offset:3096 lds
    v_mfma_f32_16x16x32_bf16 v[144:147], a[220:223], v[80:83], v[144:147]
    s_add_u32 s94, s94, 0x20000
    s_and_b32 s94, s94, 0x7ffff
    v_mfma_f32_16x16x32_bf16 v[148:151], a[216:219], v[68:71], v[148:151]
    s_mov_b32 m0, s6
    s_add_u32 s60, s92, s94
    s_add_u32 s60, s60, 0x10000
    v_mfma_f32_16x16x32_bf16 v[148:151], a[220:223], v[84:87], v[148:151]
    s_waitcnt lgkmcnt(0)
    buffer_load_dwordx4 v11, s[36:39], s60 offen offset:0 lds
    v_mfma_f32_16x16x32_bf16 v[152:155], a[216:219], v[72:75], v[152:155]
    v_mfma_f32_16x16x32_bf16 v[152:155], a[220:223], v[88:91], v[152:155]
    v_mfma_f32_16x16x32_bf16 v[156:159], a[216:219], v[76:79], v[156:159]
    v_mfma_f32_16x16x32_bf16 v[156:159], a[220:223], v[92:95], v[156:159]
    buffer_load_dwordx4 v12, s[36:39], s60 offen offset:1032 lds
    v_mfma_f32_16x16x32_bf16 v[128:131], a[192:195], a[64:67], v[128:131]
    s_waitcnt vmcnt(30)
    ds_read_b64_tr_b16 a[208:209], v21 offset:0
    v_mfma_f32_16x16x32_bf16 v[128:131], a[196:199], a[80:83], v[128:131]
    ds_read_b64_tr_b16 a[210:211], v21 offset:256
    v_mfma_f32_16x16x32_bf16 v[132:135], a[192:195], a[68:71], v[132:135]
    ds_read_b64_tr_b16 a[212:213], v21 offset:2064
    v_mfma_f32_16x16x32_bf16 v[132:135], a[196:199], a[84:87], v[132:135]
    ds_read_b64_tr_b16 a[214:215], v21 offset:2320
    v_mfma_f32_16x16x32_bf16 v[136:139], a[192:195], a[72:75], v[136:139]
    buffer_load_dwordx4 v13, s[36:39], s60 offen offset:2064 lds
    v_mfma_f32_16x16x32_bf16 v[136:139], a[196:199], a[88:91], v[136:139]
    ds_read_b64_tr_b16 a[216:217], v21 offset:8
    v_mfma_f32_16x16x32_bf16 v[140:143], a[192:195], a[76:79], v[140:143]
    ds_read_b64_tr_b16 a[218:219], v21 offset:264
    v_mfma_f32_16x16x32_bf16 v[140:143], a[196:199], a[92:95], v[140:143]
    ds_read_b64_tr_b16 a[220:221], v21 offset:2072
    v_mfma_f32_16x16x32_bf16 v[144:147], a[200:203], a[64:67], v[144:147]
    ds_read_b64_tr_b16 a[222:223], v21 offset:2328
    buffer_load_dwordx4 v14, s[36:39], s60 offen offset:3096 lds
    v_mfma_f32_16x16x32_bf16 v[144:147], a[204:207], a[80:83], v[144:147]
    s_add_u32 s94, s94, 0x20000
    s_and_b32 s94, s94, 0x7ffff
    v_mfma_f32_16x16x32_bf16 v[148:151], a[200:203], a[68:71], v[148:151]
    s_mov_b32 m0, s7
    s_add_u32 s60, s92, s94
    s_add_u32 s60, s60, 0x10000
    v_mfma_f32_16x16x32_bf16 v[148:151], a[204:207], a[84:87], v[148:151]
    s_waitcnt lgkmcnt(0)
    buffer_load_dwordx4 v11, s[36:39], s60 offen offset:0 lds
    v_mfma_f32_16x16x32_bf16 v[152:155], a[200:203], a[72:75], v[152:155]
    v_mfma_f32_16x16x32_bf16 v[152:155], a[204:207], a[88:91], v[152:155]
    v_mfma_f32_16x16x32_bf16 v[156:159], a[200:203], a[76:79], v[156:159]
    v_mfma_f32_16x16x32_bf16 v[156:159], a[204:207], a[92:95], v[156:159]
    buffer_load_dwordx4 v12, s[36:39], s60 offen offset:1032 lds
    v_mfma_f32_16x16x32_bf16 v[128:131], a[208:211], a[96:99], v[128:131]
    s_waitcnt vmcnt(30)
    ds_read_b64_tr_b16 a[192:193], v21 offset:4128
    v_mfma_f32_16x16x32_bf16 v[128:131], a[212:215], a[112:115], v[128:131]
    ds_read_b64_tr_b16 a[194:195], v21 offset:4384
    v_mfma_f32_16x16x32_bf16 v[132:135], a[208:211], a[100:103], v[132:135]
    ds_read_b64_tr_b16 a[196:197], v21 offset:6192
    v_mfma_f32_16x16x32_bf16 v[132:135], a[212:215], a[116:119], v[132:135]
    ds_read_b64_tr_b16 a[198:199], v21 offset:6448
    v_mfma_f32_16x16x32_bf16 v[136:139], a[208:211], a[104:107], v[136:139]
    buffer_load_dwordx4 v13, s[36:39], s60 offen offset:2064 lds
    v_mfma_f32_16x16x32_bf16 v[136:139], a[212:215], a[120:123], v[136:139]
    ds_read_b64_tr_b16 a[200:201], v21 offset:4136
    v_mfma_f32_16x16x32_bf16 v[140:143], a[208:211], a[108:111], v[140:143]
    ds_read_b64_tr_b16 a[202:203], v21 offset:4392
    v_mfma_f32_16x16x32_bf16 v[140:143], a[212:215], a[124:127], v[140:143]
    ds_read_b64_tr_b16 a[204:205], v21 offset:6200
    v_mfma_f32_16x16x32_bf16 v[144:147], a[216:219], a[96:99], v[144:147]
    ds_read_b64_tr_b16 a[206:207], v21 offset:6456
    buffer_load_dwordx4 v14, s[36:39], s60 offen offset:3096 lds
    v_mfma_f32_16x16x32_bf16 v[144:147], a[220:223], a[112:115], v[144:147]
    s_add_u32 s94, s94, 0x20000
    s_and_b32 s94, s94, 0x7ffff
    v_mfma_f32_16x16x32_bf16 v[148:151], a[216:219], a[100:103], v[148:151]
    s_add_u32 m0, s7, 4128
    s_add_u32 s60, s92, s94
    s_add_u32 s60, s60, 0x10000
    v_mfma_f32_16x16x32_bf16 v[148:151], a[220:223], a[116:119], v[148:151]
    s_waitcnt lgkmcnt(0)
    buffer_load_dwordx4 v11, s[36:39], s60 offen offset:0 lds
    v_mfma_f32_16x16x32_bf16 v[152:155], a[216:219], a[104:107], v[152:155]
    v_mfma_f32_16x16x32_bf16 v[152:155], a[220:223], a[120:123], v[152:155]
    v_mfma_f32_16x16x32_bf16 v[156:159], a[216:219], a[108:111], v[156:159]
    v_mfma_f32_16x16x32_bf16 v[156:159], a[220:223], a[124:127], v[156:159]
    buffer_load_dwordx4 v12, s[36:39], s60 offen offset:1032 lds
    v_mfma_f32_16x16x32_bf16 v[128:131], a[192:195], a[128:131], v[128:131]
    s_waitcnt vmcnt(30)
    ds_read_b64_tr_b16 a[208:209], v15 offset:0
    v_mfma_f32_16x16x32_bf16 v[128:131], a[196:199], a[144:147], v[128:131]
    ds_read_b64_tr_b16 a[210:211], v15 offset:256
    v_mfma_f32_16x16x32_bf16 v[132:135], a[192:195], a[132:135], v[132:135]
    ds_read_b64_tr_b16 a[212:213], v15 offset:2064
    v_mfma_f32_16x16x32_bf16 v[132:135], a[196:199], a[148:151], v[132:135]
    ds_read_b64_tr_b16 a[214:215], v15 offset:2320
    v_mfma_f32_16x16x32_bf16 v[136:139], a[192:195], a[136:139], v[136:139]
    buffer_load_dwordx4 v13, s[36:39], s60 offen offset:2064 lds
    v_mfma_f32_16x16x32_bf16 v[136:139], a[196:199], a[152:155], v[136:139]
    ds_read_b64_tr_b16 a[216:217], v15 offset:8
    v_mfma_f32_16x16x32_bf16 v[140:143], a[192:195], a[140:143], v[140:143]
    ds_read_b64_tr_b16 a[218:219], v15 offset:264
    v_mfma_f32_16x16x32_bf16 v[140:143], a[196:199], a[156:159], v[140:143]
    ds_read_b64_tr_b16 a[220:221], v15 offset:2072
    v_mfma_f32_16x16x32_bf16 v[144:147], a[200:203], a[128:131], v[144:147]
    ds_read_b64_tr_b16 a[222:223], v15 offset:2328
    buffer_load_dwordx4 v14, s[36:39], s60 offen offset:3096 lds
    v_mfma_f32_16x16x32_bf16 v[144:147], a[204:207], a[144:147], v[144:147]
    s_add_u32 s94, s94, 0x20000
    s_and_b32 s94, s94, 0x7ffff
    v_mfma_f32_16x16x32_bf16 v[148:151], a[200:203], a[132:135], v[148:151]
    s_mov_b32 m0, s62
    s_add_u32 s60, s92, s94
    s_add_u32 s60, s60, 0x10000
    v_mfma_f32_16x16x32_bf16 v[148:151], a[204:207], a[148:151], v[148:151]
    s_waitcnt lgkmcnt(0)
    buffer_load_dwordx4 v11, s[36:39], s60 offen offset:0 lds
    v_mfma_f32_16x16x32_bf16 v[152:155], a[200:203], a[136:139], v[152:155]
    v_mfma_f32_16x16x32_bf16 v[152:155], a[204:207], a[152:155], v[152:155]
    v_mfma_f32_16x16x32_bf16 v[156:159], a[200:203], a[140:143], v[156:159]
    v_mfma_f32_16x16x32_bf16 v[156:159], a[204:207], a[156:159], v[156:159]
    buffer_load_dwordx4 v12, s[36:39], s60 offen offset:1032 lds
    v_mfma_f32_16x16x32_bf16 v[128:131], a[208:211], a[160:163], v[128:131]
    s_waitcnt vmcnt(30)
    ds_read_b64_tr_b16 a[192:193], v10 offset:8256
    v_mfma_f32_16x16x32_bf16 v[128:131], a[212:215], a[176:179], v[128:131]
    ds_read_b64_tr_b16 a[194:195], v10 offset:8512
    v_mfma_f32_16x16x32_bf16 v[132:135], a[208:211], a[164:167], v[132:135]
    ds_read_b64_tr_b16 a[196:197], v10 offset:10320
    v_mfma_f32_16x16x32_bf16 v[132:135], a[212:215], a[180:183], v[132:135]
    ds_read_b64_tr_b16 a[198:199], v10 offset:10576
    v_mfma_f32_16x16x32_bf16 v[136:139], a[208:211], a[168:171], v[136:139]
    buffer_load_dwordx4 v13, s[36:39], s60 offen offset:2064 lds
    v_mfma_f32_16x16x32_bf16 v[136:139], a[212:215], a[184:187], v[136:139]
    ds_read_b64_tr_b16 a[200:201], v10 offset:8264
    v_mfma_f32_16x16x32_bf16 v[140:143], a[208:211], a[172:175], v[140:143]
    ds_read_b64_tr_b16 a[202:203], v10 offset:8520
    v_mfma_f32_16x16x32_bf16 v[140:143], a[212:215], a[188:191], v[140:143]
    ds_read_b64_tr_b16 a[204:205], v10 offset:10328
    v_mfma_f32_16x16x32_bf16 v[144:147], a[216:219], a[160:163], v[144:147]
    ds_read_b64_tr_b16 a[206:207], v10 offset:10584
    buffer_load_dwordx4 v14, s[36:39], s60 offen offset:3096 lds
    v_mfma_f32_16x16x32_bf16 v[144:147], a[220:223], a[176:179], v[144:147]
    s_add_u32 s94, s94, 0x20000
    s_and_b32 s94, s94, 0x7ffff
    s_add_u32 s92, s92, 256
    s_and_b32 s92, s92, 1023
    v_mfma_f32_16x16x32_bf16 v[148:151], a[216:219], a[164:167], v[148:151]
    s_add_u32 m0, s63, 8256
    s_add_u32 s60, s92, s94
    v_mfma_f32_16x16x32_bf16 v[148:151], a[220:223], a[180:183], v[148:151]
    s_waitcnt lgkmcnt(0)
    buffer_load_dwordx4 v11, s[36:39], s60 offen offset:0 lds
    v_mfma_f32_16x16x32_bf16 v[152:155], a[216:219], a[168:171], v[152:155]
    v_mfma_f32_16x16x32_bf16 v[152:155], a[220:223], a[184:187], v[152:155]
    v_mfma_f32_16x16x32_bf16 v[156:159], a[216:219], a[172:175], v[156:159]
    v_mfma_f32_16x16x32_bf16 v[156:159], a[220:223], a[188:191], v[156:159]
    buffer_load_dwordx4 v12, s[36:39], s60 offen offset:1032 lds
    v_mfma_f32_16x16x32_bf16 v[96:99], a[192:195], a[0:3], 0
    s_waitcnt vmcnt(26)
    ds_read_b64_tr_b16 a[208:209], v10 offset:12384
    v_mfma_f32_16x16x32_bf16 v[96:99], a[196:199], a[16:19], v[96:99]
    ds_read_b64_tr_b16 a[210:211], v10 offset:12640
    v_mfma_f32_16x16x32_bf16 v[100:103], a[192:195], a[4:7], 0
    ds_read_b64_tr_b16 a[212:213], v10 offset:14448
    s_add_u32 s61, s93, s8
    v_mfma_f32_16x16x32_bf16 v[100:103], a[196:199], a[20:23], v[100:103]
    ds_read_b64_tr_b16 a[214:215], v10 offset:14704
    v_cvt_pk_bf16_f32 v224, v128, v129
    v_mfma_f32_16x16x32_bf16 v[104:107], a[192:195], a[8:11], 0
    buffer_load_dwordx4 v13, s[36:39], s60 offen offset:2064 lds
    v_cvt_pk_bf16_f32 v225, v130, v131
    v_mfma_f32_16x16x32_bf16 v[104:107], a[196:199], a[24:27], v[104:107]
    ds_read_b64_tr_b16 a[216:217], v10 offset:12392
    v_cvt_pk_bf16_f32 v226, v144, v145
    v_mfma_f32_16x16x32_bf16 v[108:111], a[192:195], a[12:15], 0
    ds_read_b64_tr_b16 a[218:219], v10 offset:12648
    v_cvt_pk_bf16_f32 v227, v146, v147
    v_mfma_f32_16x16x32_bf16 v[108:111], a[196:199], a[28:31], v[108:111]
    ds_read_b64_tr_b16 a[220:221], v10 offset:14456
    v_mfma_f32_16x16x32_bf16 v[112:115], a[200:203], a[0:3], 0
    ds_read_b64_tr_b16 a[222:223], v10 offset:14712
    buffer_load_dwordx4 v14, s[36:39], s60 offen offset:3096 lds
    v_mfma_f32_16x16x32_bf16 v[112:115], a[204:207], a[16:19], v[112:115]
    s_add_u32 s94, s94, 0x20000
    s_and_b32 s94, s94, 0x7ffff
    v_mfma_f32_16x16x32_bf16 v[116:119], a[200:203], a[4:7], 0
    buffer_store_dwordx4 v[224:227], v31, s[48:51], s61 offen sc1
    s_add_u32 m0, s63, 12384
    v_mfma_f32_16x16x32_bf16 v[116:119], a[204:207], a[20:23], v[116:119]
    s_add_u32 s60, s92, s94
    s_add_u32 s61, s61, 16384
    v_mfma_f32_16x16x32_bf16 v[120:123], a[200:203], a[8:11], 0
    s_waitcnt lgkmcnt(0)
    buffer_load_dwordx4 v11, s[36:39], s60 offen offset:0 lds
    v_cvt_pk_bf16_f32 v228, v132, v133
    v_mfma_f32_16x16x32_bf16 v[120:123], a[204:207], a[24:27], v[120:123]
    v_cvt_pk_bf16_f32 v229, v134, v135
    v_cvt_pk_bf16_f32 v230, v148, v149
    v_cvt_pk_bf16_f32 v231, v150, v151
    v_mfma_f32_16x16x32_bf16 v[124:127], a[200:203], a[12:15], 0
    buffer_store_dwordx4 v[228:231], v31, s[48:51], s61 offen sc1
    s_add_u32 s61, s61, 16384
    v_mfma_f32_16x16x32_bf16 v[124:127], a[204:207], a[28:31], v[124:127]
    buffer_load_dwordx4 v12, s[36:39], s60 offen offset:1032 lds
    v_mfma_f32_16x16x32_bf16 v[96:99], a[208:211], a[32:35], v[96:99]
    s_waitcnt vmcnt(28)
    ds_read_b64_tr_b16 a[192:193], v10 offset:0
    v_cvt_pk_bf16_f32 v232, v136, v137
    v_mfma_f32_16x16x32_bf16 v[96:99], a[212:215], a[48:51], v[96:99]
    v_cvt_pk_bf16_f32 v233, v138, v139
    v_cvt_pk_bf16_f32 v234, v152, v153
    v_cvt_pk_bf16_f32 v235, v154, v155
    v_mfma_f32_16x16x32_bf16 v[100:103], a[208:211], a[36:39], v[100:103]
    ds_read_b64_tr_b16 a[194:195], v10 offset:256
    buffer_store_dwordx4 v[232:235], v31, s[48:51], s61 offen sc1
    v_mfma_f32_16x16x32_bf16 v[100:103], a[212:215], a[52:55], v[100:103]
    ds_read_b64_tr_b16 a[196:197], v10 offset:2064
    s_add_u32 s61, s61, 16384
    v_mfma_f32_16x16x32_bf16 v[104:107], a[208:211], a[40:43], v[104:107]
    ds_read_b64_tr_b16 a[198:199], v10 offset:2320
    buffer_load_dwordx4 v13, s[36:39], s60 offen offset:2064 lds
    v_mfma_f32_16x16x32_bf16 v[104:107], a[212:215], a[56:59], v[104:107]
    ds_read_b64_tr_b16 a[200:201], v10 offset:8
    v_cvt_pk_bf16_f32 v236, v140, v141
    v_cvt_pk_bf16_f32 v237, v142, v143
    v_cvt_pk_bf16_f32 v238, v156, v157
    v_cvt_pk_bf16_f32 v239, v158, v159
    v_mfma_f32_16x16x32_bf16 v[108:111], a[208:211], a[44:47], v[108:111]
    ds_read_b64_tr_b16 a[202:203], v10 offset:264
    buffer_store_dwordx4 v[236:239], v31, s[48:51], s61 offen sc1
    v_mfma_f32_16x16x32_bf16 v[108:111], a[212:215], a[60:63], v[108:111]
    ds_read_b64_tr_b16 a[204:205], v10 offset:2072
    s_add_u32 s8, s8, 512
    v_mfma_f32_16x16x32_bf16 v[112:115], a[216:219], a[32:35], v[112:115]
    ds_read_b64_tr_b16 a[206:207], v10 offset:2328
    buffer_load_dwordx4 v14, s[36:39], s60 offen offset:3096 lds
    v_mfma_f32_16x16x32_bf16 v[112:115], a[220:223], a[48:51], v[112:115]
    s_add_u32 s94, s94, 0x20000
    s_and_b32 s94, s94, 0x7ffff
    v_mfma_f32_16x16x32_bf16 v[116:119], a[216:219], a[36:39], v[116:119]
    s_and_b32 s8, s8, 2047
    s_add_u32 m0, s63, 0
    v_mfma_f32_16x16x32_bf16 v[116:119], a[220:223], a[52:55], v[116:119]
    s_add_u32 s60, s92, s94
    v_mfma_f32_16x16x32_bf16 v[120:123], a[216:219], a[40:43], v[120:123]
    s_waitcnt lgkmcnt(0)
    buffer_load_dwordx4 v11, s[36:39], s60 offen offset:0 lds
    v_mfma_f32_16x16x32_bf16 v[120:123], a[220:223], a[56:59], v[120:123]
    v_mfma_f32_16x16x32_bf16 v[124:127], a[216:219], a[44:47], v[124:127]
    v_mfma_f32_16x16x32_bf16 v[124:127], a[220:223], a[60:63], v[124:127]
    buffer_load_dwordx4 v12, s[36:39], s60 offen offset:1032 lds
    v_mfma_f32_16x16x32_bf16 v[96:99], a[192:195], v[32:35], v[96:99]
    s_waitcnt vmcnt(30)
    ds_read_b64_tr_b16 a[208:209], v10 offset:4128
    v_mfma_f32_16x16x32_bf16 v[96:99], a[196:199], v[48:51], v[96:99]
    ds_read_b64_tr_b16 a[210:211], v10 offset:4384
    v_mfma_f32_16x16x32_bf16 v[100:103], a[192:195], v[36:39], v[100:103]
    ds_read_b64_tr_b16 a[212:213], v10 offset:6192
    v_mfma_f32_16x16x32_bf16 v[100:103], a[196:199], v[52:55], v[100:103]
    ds_read_b64_tr_b16 a[214:215], v10 offset:6448
    v_mfma_f32_16x16x32_bf16 v[104:107], a[192:195], v[40:43], v[104:107]
    buffer_load_dwordx4 v13, s[36:39], s60 offen offset:2064 lds
    v_mfma_f32_16x16x32_bf16 v[104:107], a[196:199], v[56:59], v[104:107]
    ds_read_b64_tr_b16 a[216:217], v10 offset:4136
    v_mfma_f32_16x16x32_bf16 v[108:111], a[192:195], v[44:47], v[108:111]
    ds_read_b64_tr_b16 a[218:219], v10 offset:4392
    v_mfma_f32_16x16x32_bf16 v[108:111], a[196:199], v[60:63], v[108:111]
    ds_read_b64_tr_b16 a[220:221], v10 offset:6200
    v_mfma_f32_16x16x32_bf16 v[112:115], a[200:203], v[32:35], v[112:115]
    ds_read_b64_tr_b16 a[222:223], v10 offset:6456
    buffer_load_dwordx4 v14, s[36:39], s60 offen offset:3096 lds
    v_mfma_f32_16x16x32_bf16 v[112:115], a[204:207], v[48:51], v[112:115]
    s_add_u32 s94, s94, 0x20000
    s_and_b32 s94, s94, 0x7ffff
    v_mfma_f32_16x16x32_bf16 v[116:119], a[200:203], v[36:39], v[116:119]
    s_add_u32 m0, s63, 4128
    s_add_u32 s60, s92, s94
    v_mfma_f32_16x16x32_bf16 v[116:119], a[204:207], v[52:55], v[116:119]
    s_waitcnt lgkmcnt(0)
    buffer_load_dwordx4 v11, s[36:39], s60 offen offset:0 lds
    v_mfma_f32_16x16x32_bf16 v[120:123], a[200:203], v[40:43], v[120:123]
    v_mfma_f32_16x16x32_bf16 v[120:123], a[204:207], v[56:59], v[120:123]
    v_mfma_f32_16x16x32_bf16 v[124:127], a[200:203], v[44:47], v[124:127]
    v_mfma_f32_16x16x32_bf16 v[124:127], a[204:207], v[60:63], v[124:127]
    buffer_load_dwordx4 v12, s[36:39], s60 offen offset:1032 lds
    v_mfma_f32_16x16x32_bf16 v[96:99], a[208:211], v[64:67], v[96:99]
    s_waitcnt vmcnt(30)
    ds_read_b64_tr_b16 a[192:193], v20 offset:0
    v_mfma_f32_16x16x32_bf16 v[96:99], a[212:215], v[80:83], v[96:99]
    ds_read_b64_tr_b16 a[194:195], v20 offset:256
    v_mfma_f32_16x16x32_bf16 v[100:103], a[208:211], v[68:71], v[100:103]
    ds_read_b64_tr_b16 a[196:197], v20 offset:2064
    v_mfma_f32_16x16x32_bf16 v[100:103], a[212:215], v[84:87], v[100:103]
    ds_read_b64_tr_b16 a[198:199], v20 offset:2320
    v_mfma_f32_16x16x32_bf16 v[104:107], a[208:211], v[72:75], v[104:107]
    buffer_load_dwordx4 v13, s[36:39], s60 offen offset:2064 lds
    v_mfma_f32_16x16x32_bf16 v[104:107], a[212:215], v[88:91], v[104:107]
    ds_read_b64_tr_b16 a[200:201], v20 offset:8
    v_mfma_f32_16x16x32_bf16 v[108:111], a[208:211], v[76:79], v[108:111]
    ds_read_b64_tr_b16 a[202:203], v20 offset:264
    v_mfma_f32_16x16x32_bf16 v[108:111], a[212:215], v[92:95], v[108:111]
    ds_read_b64_tr_b16 a[204:205], v20 offset:2072
    v_mfma_f32_16x16x32_bf16 v[112:115], a[216:219], v[64:67], v[112:115]
    ds_read_b64_tr_b16 a[206:207], v20 offset:2328
    buffer_load_dwordx4 v14, s[36:39], s60 offen offset:3096 lds
    v_mfma_f32_16x16x32_bf16 v[112:115], a[220:223], v[80:83], v[112:115]
    s_add_u32 s94, s94, 0x20000
    s_and_b32 s94, s94, 0x7ffff
    v_mfma_f32_16x16x32_bf16 v[116:119], a[216:219], v[68:71], v[116:119]
    s_mov_b32 m0, s6
    s_add_u32 s60, s92, s94
    s_add_u32 s60, s60, 0x10000
    v_mfma_f32_16x16x32_bf16 v[116:119], a[220:223], v[84:87], v[116:119]
    s_waitcnt lgkmcnt(0)
    buffer_load_dwordx4 v11, s[36:39], s60 offen offset:0 lds
    v_mfma_f32_16x16x32_bf16 v[120:123], a[216:219], v[72:75], v[120:123]
    v_mfma_f32_16x16x32_bf16 v[120:123], a[220:223], v[88:91], v[120:123]
    v_mfma_f32_16x16x32_bf16 v[124:127], a[216:219], v[76:79], v[124:127]
    v_mfma_f32_16x16x32_bf16 v[124:127], a[220:223], v[92:95], v[124:127]
    buffer_load_dwordx4 v12, s[36:39], s60 offen offset:1032 lds
    v_mfma_f32_16x16x32_bf16 v[96:99], a[192:195], a[64:67], v[96:99]
    s_waitcnt vmcnt(30)
    ds_read_b64_tr_b16 a[208:209], v21 offset:0
    v_mfma_f32_16x16x32_bf16 v[96:99], a[196:199], a[80:83], v[96:99]
    ds_read_b64_tr_b16 a[210:211], v21 offset:256
    v_mfma_f32_16x16x32_bf16 v[100:103], a[192:195], a[68:71], v[100:103]
    ds_read_b64_tr_b16 a[212:213], v21 offset:2064
    v_mfma_f32_16x16x32_bf16 v[100:103], a[196:199], a[84:87], v[100:103]
    ds_read_b64_tr_b16 a[214:215], v21 offset:2320
    v_mfma_f32_16x16x32_bf16 v[104:107], a[192:195], a[72:75], v[104:107]
    buffer_load_dwordx4 v13, s[36:39], s60 offen offset:2064 lds
    v_mfma_f32_16x16x32_bf16 v[104:107], a[196:199], a[88:91], v[104:107]
    ds_read_b64_tr_b16 a[216:217], v21 offset:8
    v_mfma_f32_16x16x32_bf16 v[108:111], a[192:195], a[76:79], v[108:111]
    ds_read_b64_tr_b16 a[218:219], v21 offset:264
    v_mfma_f32_16x16x32_bf16 v[108:111], a[196:199], a[92:95], v[108:111]
    ds_read_b64_tr_b16 a[220:221], v21 offset:2072
    v_mfma_f32_16x16x32_bf16 v[112:115], a[200:203], a[64:67], v[112:115]
    ds_read_b64_tr_b16 a[222:223], v21 offset:2328
    buffer_load_dwordx4 v14, s[36:39], s60 offen offset:3096 lds
    v_mfma_f32_16x16x32_bf16 v[112:115], a[204:207], a[80:83], v[112:115]
    s_add_u32 s94, s94, 0x20000
    s_and_b32 s94, s94, 0x7ffff
    v_mfma_f32_16x16x32_bf16 v[116:119], a[200:203], a[68:71], v[116:119]
    s_mov_b32 m0, s7
    s_add_u32 s60, s92, s94
    s_add_u32 s60, s60, 0x10000
    v_mfma_f32_16x16x32_bf16 v[116:119], a[204:207], a[84:87], v[116:119]
    s_waitcnt lgkmcnt(0)
    buffer_load_dwordx4 v11, s[36:39], s60 offen offset:0 lds
    v_mfma_f32_16x16x32_bf16 v[120:123], a[200:203], a[72:75], v[120:123]
    v_mfma_f32_16x16x32_bf16 v[120:123], a[204:207], a[88:91], v[120:123]
    v_mfma_f32_16x16x32_bf16 v[124:127], a[200:203], a[76:79], v[124:127]
    v_mfma_f32_16x16x32_bf16 v[124:127], a[204:207], a[92:95], v[124:127]
    buffer_load_dwordx4 v12, s[36:39], s60 offen offset:1032 lds
    v_mfma_f32_16x16x32_bf16 v[96:99], a[208:211], a[96:99], v[96:99]
    s_waitcnt vmcnt(30)
    ds_read_b64_tr_b16 a[192:193], v21 offset:4128
    v_mfma_f32_16x16x32_bf16 v[96:99], a[212:215], a[112:115], v[96:99]
    ds_read_b64_tr_b16 a[194:195], v21 offset:4384
    v_mfma_f32_16x16x32_bf16 v[100:103], a[208:211], a[100:103], v[100:103]
    ds_read_b64_tr_b16 a[196:197], v21 offset:6192
    v_mfma_f32_16x16x32_bf16 v[100:103], a[212:215], a[116:119], v[100:103]
    ds_read_b64_tr_b16 a[198:199], v21 offset:6448
    v_mfma_f32_16x16x32_bf16 v[104:107], a[208:211], a[104:107], v[104:107]
    buffer_load_dwordx4 v13, s[36:39], s60 offen offset:2064 lds
    v_mfma_f32_16x16x32_bf16 v[104:107], a[212:215], a[120:123], v[104:107]
    ds_read_b64_tr_b16 a[200:201], v21 offset:4136
    v_mfma_f32_16x16x32_bf16 v[108:111], a[208:211], a[108:111], v[108:111]
    ds_read_b64_tr_b16 a[202:203], v21 offset:4392
    v_mfma_f32_16x16x32_bf16 v[108:111], a[212:215], a[124:127], v[108:111]
    ds_read_b64_tr_b16 a[204:205], v21 offset:6200
    v_mfma_f32_16x16x32_bf16 v[112:115], a[216:219], a[96:99], v[112:115]
    ds_read_b64_tr_b16 a[206:207], v21 offset:6456
    buffer_load_dwordx4 v14, s[36:39], s60 offen offset:3096 lds
    v_mfma_f32_16x16x32_bf16 v[112:115], a[220:223], a[112:115], v[112:115]
    s_add_u32 s94, s94, 0x20000
    s_and_b32 s94, s94, 0x7ffff
    v_mfma_f32_16x16x32_bf16 v[116:119], a[216:219], a[100:103], v[116:119]
    s_add_u32 m0, s7, 4128
    s_add_u32 s60, s92, s94
    s_add_u32 s60, s60, 0x10000
    v_mfma_f32_16x16x32_bf16 v[116:119], a[220:223], a[116:119], v[116:119]
    s_waitcnt lgkmcnt(0)
    buffer_load_dwordx4 v11, s[36:39], s60 offen offset:0 lds
    v_mfma_f32_16x16x32_bf16 v[120:123], a[216:219], a[104:107], v[120:123]
    v_mfma_f32_16x16x32_bf16 v[120:123], a[220:223], a[120:123], v[120:123]
    v_mfma_f32_16x16x32_bf16 v[124:127], a[216:219], a[108:111], v[124:127]
    v_mfma_f32_16x16x32_bf16 v[124:127], a[220:223], a[124:127], v[124:127]
    buffer_load_dwordx4 v12, s[36:39], s60 offen offset:1032 lds
    v_mfma_f32_16x16x32_bf16 v[96:99], a[192:195], a[128:131], v[96:99]
    s_waitcnt vmcnt(30)
    ds_read_b64_tr_b16 a[208:209], v15 offset:0
    v_mfma_f32_16x16x32_bf16 v[96:99], a[196:199], a[144:147], v[96:99]
    ds_read_b64_tr_b16 a[210:211], v15 offset:256
    v_mfma_f32_16x16x32_bf16 v[100:103], a[192:195], a[132:135], v[100:103]
    ds_read_b64_tr_b16 a[212:213], v15 offset:2064
    v_mfma_f32_16x16x32_bf16 v[100:103], a[196:199], a[148:151], v[100:103]
    ds_read_b64_tr_b16 a[214:215], v15 offset:2320
    v_mfma_f32_16x16x32_bf16 v[104:107], a[192:195], a[136:139], v[104:107]
    buffer_load_dwordx4 v13, s[36:39], s60 offen offset:2064 lds
    v_mfma_f32_16x16x32_bf16 v[104:107], a[196:199], a[152:155], v[104:107]
    ds_read_b64_tr_b16 a[216:217], v15 offset:8
    v_mfma_f32_16x16x32_bf16 v[108:111], a[192:195], a[140:143], v[108:111]
    ds_read_b64_tr_b16 a[218:219], v15 offset:264
    v_mfma_f32_16x16x32_bf16 v[108:111], a[196:199], a[156:159], v[108:111]
    ds_read_b64_tr_b16 a[220:221], v15 offset:2072
    v_mfma_f32_16x16x32_bf16 v[112:115], a[200:203], a[128:131], v[112:115]
    ds_read_b64_tr_b16 a[222:223], v15 offset:2328
    buffer_load_dwordx4 v14, s[36:39], s60 offen offset:3096 lds
    v_mfma_f32_16x16x32_bf16 v[112:115], a[204:207], a[144:147], v[112:115]
    s_add_u32 s94, s94, 0x20000
    s_and_b32 s94, s94, 0x7ffff
    s_waitcnt vmcnt(21)
    s_barrier
    v_mfma_f32_16x16x32_bf16 v[116:119], a[200:203], a[132:135], v[116:119]
    buffer_store_dword v25, v22, s[48:51], s9 offen sc1
    s_mov_b32 m0, s62
    v_mfma_f32_16x16x32_bf16 v[116:119], a[204:207], a[148:151], v[116:119]
    s_add_u32 s60, s92, s94
    s_add_u32 s60, s60, 0x10000
    v_mfma_f32_16x16x32_bf16 v[120:123], a[200:203], a[136:139], v[120:123]
    s_waitcnt lgkmcnt(0)
    buffer_load_dwordx4 v11, s[36:39], s60 offen offset:0 lds
    v_mfma_f32_16x16x32_bf16 v[120:123], a[204:207], a[152:155], v[120:123]
    v_mfma_f32_16x16x32_bf16 v[124:127], a[200:203], a[140:143], v[124:127]
    v_mfma_f32_16x16x32_bf16 v[124:127], a[204:207], a[156:159], v[124:127]
    buffer_load_dwordx4 v12, s[36:39], s60 offen offset:1032 lds
    v_mfma_f32_16x16x32_bf16 v[96:99], a[208:211], a[160:163], v[96:99]
    ds_read_b64_tr_b16 a[192:193], v10 offset:8256
    v_mfma_f32_16x16x32_bf16 v[96:99], a[212:215], a[176:179], v[96:99]
    ds_read_b64_tr_b16 a[194:195], v10 offset:8512
    v_mfma_f32_16x16x32_bf16 v[100:103], a[208:211], a[164:167], v[100:103]
    ds_read_b64_tr_b16 a[196:197], v10 offset:10320
    v_mfma_f32_16x16x32_bf16 v[100:103], a[212:215], a[180:183], v[100:103]
    ds_read_b64_tr_b16 a[198:199], v10 offset:10576
    v_mfma_f32_16x16x32_bf16 v[104:107], a[208:211], a[168:171], v[104:107]
    buffer_load_dwordx4 v13, s[36:39], s60 offen offset:2064 lds
    v_mfma_f32_16x16x32_bf16 v[104:107], a[212:215], a[184:187], v[104:107]
    ds_read_b64_tr_b16 a[200:201], v10 offset:8264
    v_mfma_f32_16x16x32_bf16 v[108:111], a[208:211], a[172:175], v[108:111]
    ds_read_b64_tr_b16 a[202:203], v10 offset:8520
    v_mfma_f32_16x16x32_bf16 v[108:111], a[212:215], a[188:191], v[108:111]
    ds_read_b64_tr_b16 a[204:205], v10 offset:10328
    v_mfma_f32_16x16x32_bf16 v[112:115], a[216:219], a[160:163], v[112:115]
    ds_read_b64_tr_b16 a[206:207], v10 offset:10584
    buffer_load_dwordx4 v14, s[36:39], s60 offen offset:3096 lds
    v_mfma_f32_16x16x32_bf16 v[112:115], a[220:223], a[176:179], v[112:115]
    s_add_u32 s94, s94, 0x20000
    s_and_b32 s94, s94, 0x7ffff
    s_add_u32 s92, s92, 256
    s_and_b32 s92, s92, 1023
    v_mfma_f32_16x16x32_bf16 v[116:119], a[216:219], a[164:167], v[116:119]
    v_mfma_f32_16x16x32_bf16 v[116:119], a[220:223], a[180:183], v[116:119]
    v_mfma_f32_16x16x32_bf16 v[120:123], a[216:219], a[168:171], v[120:123]
    s_min_u32 s62, s59, 6
    s_lshl_b32 s62, s62, 9
    v_mfma_f32_16x16x32_bf16 v[120:123], a[220:223], a[184:187], v[120:123]
    s_lshl_b32 s60, s35, 7
    s_add_u32 s62, s62, s60
    v_mfma_f32_16x16x32_bf16 v[124:127], a[216:219], a[172:175], v[124:127]
    buffer_load_dwordx4 v[244:247], v6, s[52:55], s10 offen
    s_add_u32 s36, s16, s62
    s_addc_u32 s37, s17, 0
    v_mfma_f32_16x16x32_bf16 v[124:127], a[220:223], a[188:191], v[124:127]
    s_sub_u32 s38, 1835008, s62
    s_waitcnt lgkmcnt(0)
    v_mfma_f32_16x16x32_bf16 v[128:131], a[192:195], a[0:3], 0
    s_waitcnt vmcnt(26)
    ds_read_b64_tr_b16 a[208:209], v10 offset:12384
    s_cmp_eq_u32 s59, 9
    s_cselect_b32 s38, 0, s38
    v_mfma_f32_16x16x32_bf16 v[128:131], a[196:199], a[16:19], v[128:131]
    ds_read_b64_tr_b16 a[210:211], v10 offset:12640
    s_lshl_b32 s14, s58, 1
    v_mfma_f32_16x16x32_bf16 v[132:135], a[192:195], a[4:7], 0
    ds_read_b64_tr_b16 a[212:213], v10 offset:14448
    s_add_u32 s61, s93, s8
    v_mfma_f32_16x16x32_bf16 v[132:135], a[196:199], a[20:23], v[132:135]
    ds_read_b64_tr_b16 a[214:215], v10 offset:14704
    v_cvt_pk_bf16_f32 v224, v96, v97
    v_mfma_f32_16x16x32_bf16 v[136:139], a[192:195], a[8:11], 0
    ds_read_b64_tr_b16 a[216:217], v10 offset:12392
    v_cvt_pk_bf16_f32 v225, v98, v99
    v_mfma_f32_16x16x32_bf16 v[136:139], a[196:199], a[24:27], v[136:139]
    ds_read_b64_tr_b16 a[218:219], v10 offset:12648
    v_cvt_pk_bf16_f32 v226, v112, v113
    v_mfma_f32_16x16x32_bf16 v[140:143], a[192:195], a[12:15], 0
    ds_read_b64_tr_b16 a[220:221], v10 offset:14456
    v_cvt_pk_bf16_f32 v227, v114, v115
    v_mfma_f32_16x16x32_bf16 v[140:143], a[196:199], a[28:31], v[140:143]
    ds_read_b64_tr_b16 a[222:223], v10 offset:14712
    v_min_u32 v224, -2, v224
    v_mfma_f32_16x16x32_bf16 v[144:147], a[200:203], a[0:3], 0
    s_and_b32 s14, s14, 6
    s_add_u32 s14, s14, s59
    v_mfma_f32_16x16x32_bf16 v[144:147], a[204:207], a[16:19], v[144:147]
    buffer_store_dwordx4 v[224:227], v31, s[48:51], s61 offen sc1
    s_and_b32 s92, s14, 7
    v_mfma_f32_16x16x32_bf16 v[148:151], a[200:203], a[4:7], 0
    s_mul_i32 s92, s92, 229376
    v_bfe_u32 v2, v1, 2, 3
    v_mul_u32_u24 v2, 3584, v2
    v_lshrrev_b32 v3, 5, v1
    v_lshl_add_u32 v2, v3, 6, v2
    v_and_b32 v3, 3, v1
    v_lshl_add_u32 v11, v3, 4, v2
    v_add_u32 v12, 27640, v11
    v_add_u32 v13, 55280, v11
    v_add_u32 v14, 82920, v11
    v_mfma_f32_16x16x32_bf16 v[148:151], a[204:207], a[20:23], v[148:151]
    s_add_u32 s61, s61, 16384
    s_add_u32 m0, s63, 8256
    v_mfma_f32_16x16x32_bf16 v[152:155], a[200:203], a[8:11], 0
    s_mov_b32 s60, s92
    v_cvt_pk_bf16_f32 v228, v100, v101
    v_mfma_f32_16x16x32_bf16 v[152:155], a[204:207], a[24:27], v[152:155]
    buffer_load_dwordx4 v11, s[36:39], s60 offen offset:0 lds
    v_cvt_pk_bf16_f32 v229, v102, v103
    v_cvt_pk_bf16_f32 v230, v116, v117
    v_cvt_pk_bf16_f32 v231, v118, v119
    v_min_u32 v228, -2, v228
    v_mfma_f32_16x16x32_bf16 v[156:159], a[200:203], a[12:15], 0
    buffer_store_dwordx4 v[228:231], v31, s[48:51], s61 offen sc1
    s_add_u32 s61, s61, 16384
    v_mfma_f32_16x16x32_bf16 v[156:159], a[204:207], a[28:31], v[156:159]
    buffer_load_dwordx4 v12, s[36:39], s60 offen offset:1032 lds
L_stub11:
    s_cbranch_execz L_stub15
    s_waitcnt lgkmcnt(0)
    v_mfma_f32_16x16x32_bf16 v[128:131], a[208:211], a[32:35], v[128:131]
    s_waitcnt vmcnt(26)
    ds_read_b64_tr_b16 a[192:193], v10 offset:0
    v_cvt_pk_bf16_f32 v232, v104, v105
    v_mfma_f32_16x16x32_bf16 v[128:131], a[212:215], a[48:51], v[128:131]
    v_cvt_pk_bf16_f32 v233, v106, v107
    v_cvt_pk_bf16_f32 v234, v120, v121
    v_cvt_pk_bf16_f32 v235, v122, v123
    v_min_u32 v232, -2, v232
    v_mfma_f32_16x16x32_bf16 v[132:135], a[208:211], a[36:39], v[132:135]
    ds_read_b64_tr_b16 a[194:195], v10 offset:256
    buffer_store_dwordx4 v[232:235], v31, s[48:51], s61 offen sc1
    buffer_load_dwordx4 v[248:251], v7, s[52:55], s10 offen
    v_mfma_f32_16x16x32_bf16 v[132:135], a[212:215], a[52:55], v[132:135]
    ds_read_b64_tr_b16 a[196:197], v10 offset:2064
    buffer_load_dwordx4 v13, s[36:39], s60 offen offset:2064 lds
    v_mfma_f32_16x16x32_bf16 v[136:139], a[208:211], a[40:43], v[136:139]
    ds_read_b64_tr_b16 a[198:199], v10 offset:2320
    s_add_u32 s61, s61, 16384
    v_mfma_f32_16x16x32_bf16 v[136:139], a[212:215], a[56:59], v[136:139]
    ds_read_b64_tr_b16 a[200:201], v10 offset:8
    v_cvt_pk_bf16_f32 v236, v108, v109
    v_cvt_pk_bf16_f32 v237, v110, v111
    v_cvt_pk_bf16_f32 v238, v124, v125
    v_cvt_pk_bf16_f32 v239, v126, v127
    v_min_u32 v236, -2, v236
    v_mfma_f32_16x16x32_bf16 v[140:143], a[208:211], a[44:47], v[140:143]
    ds_read_b64_tr_b16 a[202:203], v10 offset:264
    buffer_store_dwordx4 v[236:239], v31, s[48:51], s61 offen sc1
    buffer_load_dwordx4 v14, s[36:39], s60 offen offset:3096 lds
    v_mfma_f32_16x16x32_bf16 v[140:143], a[212:215], a[60:63], v[140:143]
    ds_read_b64_tr_b16 a[204:205], v10 offset:2072
    s_add_u32 s92, s92, 114688
    s_cmp_eq_u32 s92, 1835008
    s_cselect_b32 s92, 0, s92
    v_mfma_f32_16x16x32_bf16 v[144:147], a[216:219], a[32:35], v[144:147]
    ds_read_b64_tr_b16 a[206:207], v10 offset:2328
    s_add_u32 s8, s8, 512
    v_mfma_f32_16x16x32_bf16 v[144:147], a[220:223], a[48:51], v[144:147]
    s_and_b32 s8, s8, 2047
    s_add_u32 m0, s63, 12384
    v_mfma_f32_16x16x32_bf16 v[148:151], a[216:219], a[36:39], v[148:151]
    s_mov_b32 s60, s92
    v_mfma_f32_16x16x32_bf16 v[148:151], a[220:223], a[52:55], v[148:151]
    v_mfma_f32_16x16x32_bf16 v[152:155], a[216:219], a[40:43], v[152:155]
    buffer_load_dwordx4 v11, s[36:39], s60 offen offset:0 lds
    v_mfma_f32_16x16x32_bf16 v[152:155], a[220:223], a[56:59], v[152:155]
    v_mfma_f32_16x16x32_bf16 v[156:159], a[216:219], a[44:47], v[156:159]
    buffer_load_dwordx4 v[252:255], v8, s[48:51], 0 offen sc1
    v_mfma_f32_16x16x32_bf16 v[156:159], a[220:223], a[60:63], v[156:159]
    buffer_load_dwordx4 v12, s[36:39], s60 offen offset:1032 lds
    s_waitcnt lgkmcnt(0)
    v_mfma_f32_16x16x32_bf16 v[128:131], a[192:195], v[32:35], v[128:131]
    s_waitcnt vmcnt(30)
    ds_read_b64_tr_b16 a[208:209], v10 offset:4128
    v_mfma_f32_16x16x32_bf16 v[128:131], a[196:199], v[48:51], v[128:131]
    ds_read_b64_tr_b16 a[210:211], v10 offset:4384
    v_mfma_f32_16x16x32_bf16 v[132:135], a[192:195], v[36:39], v[132:135]
    ds_read_b64_tr_b16 a[212:213], v10 offset:6192
    v_mfma_f32_16x16x32_bf16 v[132:135], a[196:199], v[52:55], v[132:135]
    buffer_load_dwordx4 v13, s[36:39], s60 offen offset:2064 lds
    v_mfma_f32_16x16x32_bf16 v[136:139], a[192:195], v[40:43], v[136:139]
    ds_read_b64_tr_b16 a[214:215], v10 offset:6448
    v_mfma_f32_16x16x32_bf16 v[136:139], a[196:199], v[56:59], v[136:139]
    ds_read_b64_tr_b16 a[216:217], v10 offset:4136
    v_mfma_f32_16x16x32_bf16 v[140:143], a[192:195], v[44:47], v[140:143]
    ds_read_b64_tr_b16 a[218:219], v10 offset:4392
    buffer_load_dwordx4 v14, s[36:39], s60 offen offset:3096 lds
    v_mfma_f32_16x16x32_bf16 v[140:143], a[196:199], v[60:63], v[140:143]
    ds_read_b64_tr_b16 a[220:221], v10 offset:6200
    s_add_u32 s92, s92, 114688
    s_cmp_eq_u32 s92, 1835008
    s_cselect_b32 s92, 0, s92
    v_mfma_f32_16x16x32_bf16 v[144:147], a[200:203], v[32:35], v[144:147]
    ds_read_b64_tr_b16 a[222:223], v10 offset:6456
    s_add_u32 m0, s63, 0
    v_mfma_f32_16x16x32_bf16 v[144:147], a[204:207], v[48:51], v[144:147]
    s_mov_b32 s60, s92
    v_mfma_f32_16x16x32_bf16 v[148:151], a[200:203], v[36:39], v[148:151]
    buffer_load_dwordx4 v11, s[36:39], s60 offen offset:0 lds
    v_mfma_f32_16x16x32_bf16 v[148:151], a[204:207], v[52:55], v[148:151]
    v_mfma_f32_16x16x32_bf16 v[152:155], a[200:203], v[40:43], v[152:155]
    buffer_load_dwordx4 v12, s[36:39], s60 offen offset:1032 lds
    v_mfma_f32_16x16x32_bf16 v[152:155], a[204:207], v[56:59], v[152:155]
    v_mfma_f32_16x16x32_bf16 v[156:159], a[200:203], v[44:47], v[156:159]
    buffer_load_dwordx4 v[26:29], v8, s[48:51], s11 offen sc1
    v_mfma_f32_16x16x32_bf16 v[156:159], a[204:207], v[60:63], v[156:159]
    buffer_load_dwordx4 v13, s[36:39], s60 offen offset:2064 lds
    s_waitcnt lgkmcnt(0)
    v_mfma_f32_16x16x32_bf16 v[128:131], a[208:211], v[64:67], v[128:131]
    s_waitcnt vmcnt(32)
    ds_read_b64_tr_b16 a[192:193], v20 offset:0
    v_mfma_f32_16x16x32_bf16 v[128:131], a[212:215], v[80:83], v[128:131]
    ds_read_b64_tr_b16 a[194:195], v20 offset:256
    v_mfma_f32_16x16x32_bf16 v[132:135], a[208:211], v[68:71], v[132:135]
    ds_read_b64_tr_b16 a[196:197], v20 offset:2064
    v_mfma_f32_16x16x32_bf16 v[132:135], a[212:215], v[84:87], v[132:135]
    buffer_load_dwordx4 v14, s[36:39], s60 offen offset:3096 lds
    s_add_u32 s92, s92, 114688
    v_mfma_f32_16x16x32_bf16 v[136:139], a[208:211], v[72:75], v[136:139]
    ds_read_b64_tr_b16 a[198:199], v20 offset:2320
    s_cmp_eq_u32 s92, 1835008
    s_cselect_b32 s92, 0, s92
    v_mfma_f32_16x16x32_bf16 v[136:139], a[212:215], v[88:91], v[136:139]
    ds_read_b64_tr_b16 a[200:201], v20 offset:8
    v_mfma_f32_16x16x32_bf16 v[140:143], a[208:211], v[76:79], v[140:143]
    ds_read_b64_tr_b16 a[202:203], v20 offset:264
    s_add_u32 m0, s63, 4128
    v_mfma_f32_16x16x32_bf16 v[140:143], a[212:215], v[92:95], v[140:143]
    ds_read_b64_tr_b16 a[204:205], v20 offset:2072
    s_mov_b32 s60, s92
    v_mfma_f32_16x16x32_bf16 v[144:147], a[216:219], v[64:67], v[144:147]
    ds_read_b64_tr_b16 a[206:207], v20 offset:2328
    v_mfma_f32_16x16x32_bf16 v[144:147], a[220:223], v[80:83], v[144:147]
    buffer_load_dwordx4 v11, s[36:39], s60 offen offset:0 lds
    v_mfma_f32_16x16x32_bf16 v[148:151], a[216:219], v[68:71], v[148:151]
    v_mfma_f32_16x16x32_bf16 v[148:151], a[220:223], v[84:87], v[148:151]
    v_mfma_f32_16x16x32_bf16 v[152:155], a[216:219], v[72:75], v[152:155]
    buffer_load_dwordx4 v12, s[36:39], s60 offen offset:1032 lds
    v_mfma_f32_16x16x32_bf16 v[152:155], a[220:223], v[88:91], v[152:155]
    v_mfma_f32_16x16x32_bf16 v[156:159], a[216:219], v[76:79], v[156:159]
    v_mfma_f32_16x16x32_bf16 v[156:159], a[220:223], v[92:95], v[156:159]
    buffer_load_dwordx4 v13, s[36:39], s60 offen offset:2064 lds
    s_waitcnt lgkmcnt(0)
    v_mfma_f32_16x16x32_bf16 v[128:131], a[192:195], a[64:67], v[128:131]
    s_waitcnt vmcnt(32)
    ds_read_b64_tr_b16 a[208:209], v21 offset:0
    v_mfma_f32_16x16x32_bf16 v[128:131], a[196:199], a[80:83], v[128:131]
    ds_read_b64_tr_b16 a[210:211], v21 offset:256
    v_mfma_f32_16x16x32_bf16 v[132:135], a[192:195], a[68:71], v[132:135]
    ds_read_b64_tr_b16 a[212:213], v21 offset:2064
    v_mfma_f32_16x16x32_bf16 v[132:135], a[196:199], a[84:87], v[132:135]
    buffer_load_dwordx4 v14, s[36:39], s60 offen offset:3096 lds
    s_add_u32 s92, s92, 114688
    v_mfma_f32_16x16x32_bf16 v[136:139], a[192:195], a[72:75], v[136:139]
    ds_read_b64_tr_b16 a[214:215], v21 offset:2320
    s_cmp_eq_u32 s92, 1835008
    s_cselect_b32 s92, 0, s92
    v_mfma_f32_16x16x32_bf16 v[136:139], a[196:199], a[88:91], v[136:139]
    ds_read_b64_tr_b16 a[216:217], v21 offset:8
    s_mov_b32 m0, s6
    v_mfma_f32_16x16x32_bf16 v[140:143], a[192:195], a[76:79], v[140:143]
    ds_read_b64_tr_b16 a[218:219], v21 offset:264
    s_mov_b32 s60, s92
    v_mfma_f32_16x16x32_bf16 v[140:143], a[196:199], a[92:95], v[140:143]
    ds_read_b64_tr_b16 a[220:221], v21 offset:2072
    buffer_load_dwordx4 v11, s[36:39], s60 offen offset:0 lds
    v_mfma_f32_16x16x32_bf16 v[144:147], a[200:203], a[64:67], v[144:147]
    ds_read_b64_tr_b16 a[222:223], v21 offset:2328
    v_mfma_f32_16x16x32_bf16 v[144:147], a[204:207], a[80:83], v[144:147]
    buffer_load_dwordx4 v12, s[36:39], s60 offen offset:1032 lds
    v_mfma_f32_16x16x32_bf16 v[148:151], a[200:203], a[68:71], v[148:151]
    v_mfma_f32_16x16x32_bf16 v[148:151], a[204:207], a[84:87], v[148:151]
    v_mfma_f32_16x16x32_bf16 v[152:155], a[200:203], a[72:75], v[152:155]
    buffer_load_dwordx4 v13, s[36:39], s60 offen offset:2064 lds
    v_mfma_f32_16x16x32_bf16 v[152:155], a[204:207], a[88:91], v[152:155]
    v_mfma_f32_16x16x32_bf16 v[156:159], a[200:203], a[76:79], v[156:159]
    v_mfma_f32_16x16x32_bf16 v[156:159], a[204:207], a[92:95], v[156:159]
    buffer_load_dwordx4 v14, s[36:39], s60 offen offset:3096 lds
    s_waitcnt lgkmcnt(0)
    v_mfma_f32_16x16x32_bf16 v[128:131], a[208:211], a[96:99], v[128:131]
    s_waitcnt vmcnt(33)
    ds_read_b64_tr_b16 a[192:193], v21 offset:4128
    s_add_u32 s92, s92, 114688
    v_mfma_f32_16x16x32_bf16 v[128:131], a[212:215], a[112:115], v[128:131]
    s_cmp_eq_u32 s92, 1835008
    s_cselect_b32 s92, 0, s92
    v_mfma_f32_16x16x32_bf16 v[132:135], a[208:211], a[100:103], v[132:135]
    ds_read_b64_tr_b16 a[194:195], v21 offset:4384
    v_mfma_f32_16x16x32_bf16 v[132:135], a[212:215], a[116:119], v[132:135]
    ds_read_b64_tr_b16 a[196:197], v21 offset:6192
    s_mov_b32 m0, s7
    v_mfma_f32_16x16x32_bf16 v[136:139], a[208:211], a[104:107], v[136:139]
    ds_read_b64_tr_b16 a[198:199], v21 offset:6448
    s_mov_b32 s60, s92
    v_mfma_f32_16x16x32_bf16 v[136:139], a[212:215], a[120:123], v[136:139]
    ds_read_b64_tr_b16 a[200:201], v21 offset:4136
    v_mfma_f32_16x16x32_bf16 v[140:143], a[208:211], a[108:111], v[140:143]
    ds_read_b64_tr_b16 a[202:203], v21 offset:4392
    v_mfma_f32_16x16x32_bf16 v[140:143], a[212:215], a[124:127], v[140:143]
    ds_read_b64_tr_b16 a[204:205], v21 offset:6200
    buffer_load_dwordx4 v11, s[36:39], s60 offen offset:0 lds
    v_mfma_f32_16x16x32_bf16 v[144:147], a[216:219], a[96:99], v[144:147]
    ds_read_b64_tr_b16 a[206:207], v21 offset:6456
    v_mfma_f32_16x16x32_bf16 v[144:147], a[220:223], a[112:115], v[144:147]
    buffer_load_dwordx4 v12, s[36:39], s60 offen offset:1032 lds
    v_mfma_f32_16x16x32_bf16 v[148:151], a[216:219], a[100:103], v[148:151]
    v_mfma_f32_16x16x32_bf16 v[148:151], a[220:223], a[116:119], v[148:151]
    v_mfma_f32_16x16x32_bf16 v[152:155], a[216:219], a[104:107], v[152:155]
    buffer_load_dwordx4 v13, s[36:39], s60 offen offset:2064 lds
    v_mfma_f32_16x16x32_bf16 v[152:155], a[220:223], a[120:123], v[152:155]
    v_mfma_f32_16x16x32_bf16 v[156:159], a[216:219], a[108:111], v[156:159]
    v_mfma_f32_16x16x32_bf16 v[156:159], a[220:223], a[124:127], v[156:159]
    buffer_load_dwordx4 v14, s[36:39], s60 offen offset:3096 lds
    s_waitcnt lgkmcnt(0)
    v_mfma_f32_16x16x32_bf16 v[128:131], a[192:195], a[128:131], v[128:131]
    s_waitcnt vmcnt(32)
    ds_read_b64_tr_b16 a[208:209], v15 offset:0
    s_add_u32 s92, s92, 114688
    v_mfma_f32_16x16x32_bf16 v[128:131], a[196:199], a[144:147], v[128:131]
    s_cmp_eq_u32 s92, 1835008
    s_cselect_b32 s92, 0, s92
    s_add_u32 m0, s7, 4128
    v_mfma_f32_16x16x32_bf16 v[132:135], a[192:195], a[132:135], v[132:135]
    ds_read_b64_tr_b16 a[210:211], v15 offset:256
    s_mov_b32 s60, s92
    v_mfma_f32_16x16x32_bf16 v[132:135], a[196:199], a[148:151], v[132:135]
    ds_read_b64_tr_b16 a[212:213], v15 offset:2064
    v_mfma_f32_16x16x32_bf16 v[136:139], a[192:195], a[136:139], v[136:139]
    ds_read_b64_tr_b16 a[214:215], v15 offset:2320
    buffer_load_dwordx4 v11, s[36:39], s60 offen offset:0 lds
    v_mfma_f32_16x16x32_bf16 v[136:139], a[196:199], a[152:155], v[136:139]
    ds_read_b64_tr_b16 a[216:217], v15 offset:8
    v_mfma_f32_16x16x32_bf16 v[140:143], a[192:195], a[140:143], v[140:143]
    ds_read_b64_tr_b16 a[218:219], v15 offset:264
    v_mfma_f32_16x16x32_bf16 v[140:143], a[196:199], a[156:159], v[140:143]
    ds_read_b64_tr_b16 a[220:221], v15 offset:2072
    buffer_load_dwordx4 v12, s[36:39], s60 offen offset:1032 lds
    v_mfma_f32_16x16x32_bf16 v[144:147], a[200:203], a[128:131], v[144:147]
    ds_read_b64_tr_b16 a[222:223], v15 offset:2328
    v_mfma_f32_16x16x32_bf16 v[144:147], a[204:207], a[144:147], v[144:147]
    s_waitcnt vmcnt(22)
    v_cmp_ne_u32 vcc, s34, v253
    v_cmp_ne_u32 s[100:101], s34, v255
    s_nop 0
    s_or_b64 vcc, vcc, s[100:101]
    s_waitcnt vmcnt(16)
    v_cmp_ne_u32 s[100:101], s34, v27
    s_nop 0
    s_or_b64 vcc, vcc, s[100:101]
    v_cmp_ne_u32 s[100:101], s34, v29
    s_nop 0
    s_or_b64 vcc, vcc, s[100:101]
    s_cbranch_vccz L_pm2_x
    s_mov_b32 s3, 262144
L_pm2:
    s_sleep 8
    buffer_load_dwordx4 v[252:255], v8, s[48:51], 0 offen sc1
    buffer_load_dwordx4 v[26:29], v8, s[48:51], s11 offen sc1
    s_sub_u32 s3, s3, 1
    s_waitcnt vmcnt(0)
    v_cmp_ne_u32 vcc, s34, v253
    v_cmp_ne_u32 s[100:101], s34, v255
    s_nop 0
    s_or_b64 vcc, vcc, s[100:101]
    v_cmp_ne_u32 s[100:101], s34, v27
    s_nop 0
    s_or_b64 vcc, vcc, s[100:101]
    v_cmp_ne_u32 s[100:101], s34, v29
    s_nop 0
    s_or_b64 vcc, vcc, s[100:101]
    s_cmp_eq_u32 s3, 0
    s_cbranch_scc1 L_pm2_x
    s_cbranch_vccnz L_pm2
L_pm2_x:
    v_mfma_f32_16x16x32_bf16 v[148:151], a[200:203], a[132:135], v[148:151]
    buffer_load_dwordx4 v13, s[36:39], s60 offen offset:2064 lds
    s_cmp_lt_u32 s35, 2
    s_cselect_b32 s100, 1.0, 0
    v_mfma_f32_16x16x32_bf16 v[148:151], a[204:207], a[148:151], v[148:151]
    v_lshlrev_b32 v160, 16, v252
    v_and_b32 v161, 0xffff0000, v252
    v_mfma_f32_16x16x32_bf16 v[152:155], a[200:203], a[136:139], v[152:155]
    buffer_load_dword v240, v23, s[48:51], s0 offen sc1
    v_lshlrev_b32 v162, 16, v254
    v_mfma_f32_16x16x32_bf16 v[152:155], a[204:207], a[152:155], v[152:155]
    buffer_load_dwordx4 v14, s[36:39], s60 offen offset:3096 lds
    s_add_u32 s92, s92, 114688
    v_mfma_f32_16x16x32_bf16 v[156:159], a[200:203], a[140:143], v[156:159]
    s_cmp_eq_u32 s92, 1835008
    s_cselect_b32 s92, 0, s92
    v_and_b32 v163, 0xffff0000, v254
    v_lshlrev_b32 v164, 16, v26
    v_mfma_f32_16x16x32_bf16 v[156:159], a[204:207], a[156:159], v[156:159]
    v_and_b32 v165, 0xffff0000, v26
    s_waitcnt lgkmcnt(0)
    v_mfma_f32_16x16x32_bf16 v[128:131], a[208:211], a[160:163], v[128:131]
    v_lshlrev_b32 v166, 16, v28
    v_and_b32 v167, 0xffff0000, v28
    v_mfma_f32_16x16x32_bf16 v[128:131], a[212:215], a[176:179], v[128:131]
    v_add_f32 v164, s100, v164
    v_add_f32 v165, s100, v165
    v_mfma_f32_16x16x32_bf16 v[132:135], a[208:211], a[164:167], v[132:135]
    v_add_f32 v166, s100, v166
    v_add_f32 v167, s100, v167
    v_mfma_f32_16x16x32_bf16 v[132:135], a[212:215], a[180:183], v[132:135]
    v_lshlrev_b32 v8, 4, v0
    v_add_u32 v8, 148352, v8
    v_mfma_f32_16x16x32_bf16 v[136:139], a[208:211], a[168:171], v[136:139]
    ds_write_b128 v8, v[160:163]
    v_mfma_f32_16x16x32_bf16 v[136:139], a[212:215], a[184:187], v[136:139]
    ds_write_b128 v8, v[164:167] offset:4096
    v_mfma_f32_16x16x32_bf16 v[140:143], a[208:211], a[172:175], v[140:143]
    v_mfma_f32_16x16x32_bf16 v[140:143], a[212:215], a[188:191], v[140:143]
    v_mfma_f32_16x16x32_bf16 v[144:147], a[216:219], a[160:163], v[144:147]
    v_mfma_f32_16x16x32_bf16 v[144:147], a[220:223], a[176:179], v[144:147]
    v_mfma_f32_16x16x32_bf16 v[148:151], a[216:219], a[164:167], v[148:151]
    v_mfma_f32_16x16x32_bf16 v[148:151], a[220:223], a[180:183], v[148:151]
    v_mfma_f32_16x16x32_bf16 v[152:155], a[216:219], a[168:171], v[152:155]
    v_mfma_f32_16x16x32_bf16 v[152:155], a[220:223], a[184:187], v[152:155]
    v_mfma_f32_16x16x32_bf16 v[156:159], a[216:219], a[172:175], v[156:159]
    v_mfma_f32_16x16x32_bf16 v[156:159], a[220:223], a[188:191], v[156:159]
    v_cvt_pk_bf16_f32 v224, v128, v129
    v_cvt_pk_bf16_f32 v225, v130, v131
    v_cvt_pk_bf16_f32 v226, v144, v145
    v_cvt_pk_bf16_f32 v227, v146, v147
    v_min_u32 v224, -2, v224
    v_cvt_pk_bf16_f32 v228, v132, v133
    v_cvt_pk_bf16_f32 v229, v134, v135
    v_cvt_pk_bf16_f32 v230, v148, v149
    v_cvt_pk_bf16_f32 v231, v150, v151
    v_min_u32 v228, -2, v228
    v_cvt_pk_bf16_f32 v232, v136, v137
    v_cvt_pk_bf16_f32 v233, v138, v139
    v_cvt_pk_bf16_f32 v234, v152, v153
    v_cvt_pk_bf16_f32 v235, v154, v155
    v_min_u32 v232, -2, v232
    v_cvt_pk_bf16_f32 v236, v140, v141
    v_cvt_pk_bf16_f32 v237, v142, v143
    v_cvt_pk_bf16_f32 v238, v156, v157
    v_cvt_pk_bf16_f32 v239, v158, v159
    v_min_u32 v236, -2, v236
    s_add_u32 s61, s93, s8
    buffer_store_dwordx4 v[224:227], v31, s[48:51], s61 offen sc1
    s_add_u32 s61, s61, 16384
    buffer_store_dwordx4 v[228:231], v31, s[48:51], s61 offen sc1
    s_add_u32 s61, s61, 16384
    buffer_store_dwordx4 v[232:235], v31, s[48:51], s61 offen sc1
    s_add_u32 s61, s61, 16384
    buffer_store_dwordx4 v[236:239], v31, s[48:51], s61 offen sc1
    s_mov_b32 s52, s18
    s_mov_b32 s53, s19
    s_mov_b32 s54, 3584
    s_mov_b32 s55, 0x20000
    v_lshrrev_b32 v2, 4, v1
    v_lshlrev_b32 v2, 4, v2
    buffer_load_dwordx4 v[80:83], v2, s[52:55], s62 offen
    buffer_load_dwordx4 v[84:87], v2, s[52:55], s62 offen offset:64
    v_subrev_u32 v2, v10, v9
    v_add_u32 v20, v2, v20
    v_add_u32 v21, v2, v21
    s_waitcnt vmcnt(7)
    v_cmp_ne_u32 vcc, s34, v240
    s_cmp_eq_u32 s35, 0
    s_cbranch_scc1 L_rdy_0
    s_cbranch_vccz L_rdy_e
    s_mov_b32 s3, 2097152
L_rdy_l:
    ds_read_b32 v240, v241 offset:0
    s_sub_u32 s3, s3, 1
    s_waitcnt lgkmcnt(0)
    v_cmp_ne_u32 vcc, s34, v240
    s_cmp_eq_u32 s3, 0
    s_cbranch_scc1 L_rdy_e
    s_cbranch_vccz L_rdy_e
    s_sleep 1
    s_branch L_rdy_l
L_rdy_0:
    s_cbranch_vccz L_rdy_x
    s_mov_b64 exec, 0xffff
    s_mov_b32 s3, 262144
L_rdy:
    v_mov_b32 v240, 0
    buffer_atomic_add v240, v23, s[48:51], s0 offen sc0 sc1
    s_sub_u32 s3, s3, 1
    s_waitcnt vmcnt(0)
    v_cmp_ne_u32 vcc, s34, v240
    s_cmp_eq_u32 s3, 0
    s_cbranch_scc1 L_rdy_x
    s_cbranch_vccnz L_rdy
L_rdy_x:
    s_mov_b64 exec, -1
    ds_write_b32 v241, v25 offset:0
L_rdy_e:
    s_add_u32 s13, s12, 0
    s_and_b32 s13, s13, 2047
    s_add_u32 s13, s13, s1
    buffer_load_dwordx4 v[160:163], v24, s[48:51], s13 offen sc1 nt
    s_add_u32 s13, s13, 0x20000
    buffer_load_dwordx4 v[164:167], v24, s[48:51], s13 offen sc1 nt
    s_add_u32 s13, s13, 0x20000
    buffer_load_dwordx4 v[168:171], v24, s[48:51], s13 offen sc1 nt
    s_add_u32 s13, s13, 0x20000
    buffer_load_dwordx4 v[172:175], v24, s[48:51], s13 offen sc1 nt
    s_add_u32 s13, s12, 512
    s_and_b32 s13, s13, 2047
    s_add_u32 s13, s13, s1
    buffer_load_dwordx4 v[176:179], v24, s[48:51], s13 offen sc1 nt
    s_add_u32 s13, s13, 0x20000
    buffer_load_dwordx4 v[180:183], v24, s[48:51], s13 offen sc1 nt
    s_add_u32 s13, s13, 0x20000
    buffer_load_dwordx4 v[184:187], v24, s[48:51], s13 offen sc1 nt
    s_add_u32 s13, s13, 0x20000
    buffer_load_dwordx4 v[188:191], v24, s[48:51], s13 offen sc1 nt
    s_add_u32 s15, s12, 1536
    s_and_b32 s15, s15, 2047
    s_add_u32 s15, s15, s1
    v_mov_b32 v240, 0
    buffer_atomic_add v240, v19, s[48:51], s15 offen offset:384 sc0 sc1
    ds_read_b64_tr_b16 a[0:1], v9 offset:8256
    ds_read_b64_tr_b16 a[2:3], v9 offset:8512
    ds_read_b64_tr_b16 a[4:5], v9 offset:8264
    ds_read_b64_tr_b16 a[6:7], v9 offset:8520
    ds_read_b64_tr_b16 a[128:129], v9 offset:8768
    ds_read_b64_tr_b16 a[130:131], v9 offset:9024
    ds_read_b64_tr_b16 a[132:133], v9 offset:8776
    ds_read_b64_tr_b16 a[134:135], v9 offset:9032
    ds_read_b64_tr_b16 a[8:9], v9 offset:12384
    ds_read_b64_tr_b16 a[10:11], v9 offset:12640
    ds_read_b64_tr_b16 a[12:13], v9 offset:12392
    ds_read_b64_tr_b16 a[14:15], v9 offset:12648
    ds_read_b64_tr_b16 a[136:137], v9 offset:12896
    ds_read_b64_tr_b16 a[138:139], v9 offset:13152
    ds_read_b64_tr_b16 a[140:141], v9 offset:12904
    ds_read_b64_tr_b16 a[142:143], v9 offset:13160
    ds_read_b64_tr_b16 a[16:17], v9 offset:0
    ds_read_b64_tr_b16 a[18:19], v9 offset:256
    ds_read_b64_tr_b16 a[20:21], v9 offset:8
    ds_read_b64_tr_b16 a[22:23], v9 offset:264
    ds_read_b64_tr_b16 a[144:145], v9 offset:512
    ds_read_b64_tr_b16 a[146:147], v9 offset:768
    ds_read_b64_tr_b16 a[148:149], v9 offset:520
    ds_read_b64_tr_b16 a[150:151], v9 offset:776
    ds_read_b64_tr_b16 a[24:25], v9 offset:4128
    ds_read_b64_tr_b16 a[26:27], v9 offset:4384
    ds_read_b64_tr_b16 a[28:29], v9 offset:4136
    ds_read_b64_tr_b16 a[30:31], v9 offset:4392
    ds_read_b64_tr_b16 a[152:153], v9 offset:4640
    ds_read_b64_tr_b16 a[154:155], v9 offset:4896
    ds_read_b64_tr_b16 a[156:157], v9 offset:4648
    ds_read_b64_tr_b16 a[158:159], v9 offset:4904
    ds_read_b64_tr_b16 a[32:33], v20 offset:0
    ds_read_b64_tr_b16 a[34:35], v20 offset:256
    ds_read_b64_tr_b16 a[36:37], v20 offset:8
    ds_read_b64_tr_b16 a[38:39], v20 offset:264
    ds_read_b64_tr_b16 a[160:161], v20 offset:512
    ds_read_b64_tr_b16 a[162:163], v20 offset:768
    ds_read_b64_tr_b16 a[164:165], v20 offset:520
    ds_read_b64_tr_b16 a[166:167], v20 offset:776
    ds_read_b64_tr_b16 a[40:41], v21 offset:0
    ds_read_b64_tr_b16 a[42:43], v21 offset:256
    ds_read_b64_tr_b16 a[44:45], v21 offset:8
    ds_read_b64_tr_b16 a[46:47], v21 offset:264
    ds_read_b64_tr_b16 a[168:169], v21 offset:512
    ds_read_b64_tr_b16 a[170:171], v21 offset:768
    ds_read_b64_tr_b16 a[172:173], v21 offset:520
    ds_read_b64_tr_b16 a[174:175], v21 offset:776
    s_waitcnt vmcnt(15)
    ds_read_b64_tr_b16 a[48:49], v21 offset:4128
    ds_read_b64_tr_b16 a[50:51], v21 offset:4384
    ds_read_b64_tr_b16 a[52:53], v21 offset:4136
    ds_read_b64_tr_b16 a[54:55], v21 offset:4392
    ds_read_b64_tr_b16 a[176:177], v21 offset:4640
    ds_read_b64_tr_b16 a[178:179], v21 offset:4896
    ds_read_b64_tr_b16 a[180:181], v21 offset:4648
    ds_read_b64_tr_b16 a[182:183], v21 offset:4904
    v_mov_b32 v2, 0x3f80
    v_mov_b32 v3, 0x3f800000
    s_mul_i32 s6, s35, 4128
    s_add_u32 s6, s6, 65536
    s_sub_u32 s60, s6, s63
    s_waitcnt lgkmcnt(0)
    v_add_u32 v20, s60, v9
    s_barrier
    ds_read_b128 v[32:35], v242 offset:0
    ds_read_b128 v[36:39], v242 offset:16
    ds_read_b128 v[40:43], v243 offset:0
    ds_read_b128 v[44:47], v243 offset:16
    ds_read_b128 v[48:51], v242 offset:4096
    ds_read_b128 v[52:55], v242 offset:4112
    ds_read_b128 v[56:59], v243 offset:4096
    ds_read_b128 v[60:63], v243 offset:4112
    ds_read_b128 v[64:67], v242 offset:2048
    ds_read_b128 v[68:71], v242 offset:2064
    ds_read_b128 v[72:75], v243 offset:2048
    ds_read_b128 v[76:79], v243 offset:2064
    s_waitcnt vmcnt(0)
    v_cmp_eq_u32 vcc, -1, v240
    s_cmp_eq_u32 s35, 0
    s_cbranch_scc1 L_hp_0
    s_cbranch_vccz L_hp_e
    s_mov_b32 s3, 2097152
L_hp_l:
    ds_read_b32 v240, v241 offset:4
    s_sub_u32 s3, s3, 1
    s_waitcnt lgkmcnt(0)
    v_cmp_ne_u32 vcc, s34, v240
    s_cmp_eq_u32 s3, 0
    s_cbranch_scc1 L_hp_e
    s_cbranch_vccz L_hp_e
    s_sleep 1
    s_branch L_hp_l
L_hp_0:
    s_cbranch_vccz L_hp_x
    s_mov_b32 s3, 262144
L_hp:
    v_mov_b32 v240, 0
    buffer_atomic_add v240, v19, s[48:51], s15 offen offset:384 sc0 sc1
    s_sub_u32 s3, s3, 1
    s_waitcnt vmcnt(0)
    v_cmp_eq_u32 vcc, -1, v240
    s_cmp_eq_u32 s3, 0
    s_cbranch_scc1 L_hp_x
    s_cbranch_vccnz L_hp
L_hp_x:
    ds_write_b32 v241, v25 offset:4
L_hp_e:
    s_add_u32 s13, s12, 1024
    s_and_b32 s13, s13, 2047
    s_add_u32 s13, s13, s1
    buffer_load_dwordx4 v[192:195], v24, s[48:51], s13 offen sc1 nt
    s_add_u32 s13, s13, 0x20000
    buffer_load_dwordx4 v[196:199], v24, s[48:51], s13 offen sc1 nt
    s_add_u32 s13, s13, 0x20000
    buffer_load_dwordx4 v[200:203], v24, s[48:51], s13 offen sc1 nt
    s_add_u32 s13, s13, 0x20000
    buffer_load_dwordx4 v[204:207], v24, s[48:51], s13 offen sc1 nt
    s_add_u32 s13, s12, 1536
    s_and_b32 s13, s13, 2047
    s_add_u32 s13, s13, s1
    buffer_load_dwordx4 v[208:211], v24, s[48:51], s13 offen sc1 nt
    s_add_u32 s13, s13, 0x20000
    buffer_load_dwordx4 v[212:215], v24, s[48:51], s13 offen sc1 nt
    s_add_u32 s13, s13, 0x20000
    buffer_load_dwordx4 v[216:219], v24, s[48:51], s13 offen sc1 nt
    s_add_u32 s13, s13, 0x20000
    buffer_load_dwordx4 v[220:223], v24, s[48:51], s13 offen sc1 nt
    s_mov_b32 m0, s7
    s_mov_b32 s60, s92
    s_add_u32 s92, s92, 114688
    s_cmp_eq_u32 s92, 1835008
    s_cselect_b32 s92, 0, s92
    buffer_load_dwordx4 v11, s[36:39], s60 offen offset:0 lds
    buffer_load_dwordx4 v12, s[36:39], s60 offen offset:1032 lds
    buffer_load_dwordx4 v13, s[36:39], s60 offen offset:2064 lds
    buffer_load_dwordx4 v14, s[36:39], s60 offen offset:3096 lds
    s_add_u32 m0, s7, 4128
    s_mov_b32 s60, s92
    s_add_u32 s92, s92, 114688
    s_cmp_eq_u32 s92, 1835008
    s_cselect_b32 s92, 0, s92
    buffer_load_dwordx4 v11, s[36:39], s60 offen offset:0 lds
    buffer_load_dwordx4 v12, s[36:39], s60 offen offset:1032 lds
    buffer_load_dwordx4 v13, s[36:39], s60 offen offset:2064 lds
    buffer_load_dwordx4 v14, s[36:39], s60 offen offset:3096 lds
    s_add_u32 m0, s63, 0
    s_mov_b32 s60, s92
    s_add_u32 s92, s92, 114688
    s_cmp_eq_u32 s92, 1835008
    s_cselect_b32 s92, 0, s92
    buffer_load_dwordx4 v11, s[36:39], s60 offen offset:0 lds
    buffer_load_dwordx4 v12, s[36:39], s60 offen offset:1032 lds
    buffer_load_dwordx4 v13, s[36:39], s60 offen offset:2064 lds
    buffer_load_dwordx4 v14, s[36:39], s60 offen offset:3096 lds
    s_add_u32 m0, s63, 4128
    s_mov_b32 s60, s92
    s_add_u32 s92, s92, 114688
    s_cmp_eq_u32 s92, 1835008
    s_cselect_b32 s92, 0, s92
    buffer_load_dwordx4 v11, s[36:39], s60 offen offset:0 lds
    buffer_load_dwordx4 v12, s[36:39], s60 offen offset:1032 lds
    buffer_load_dwordx4 v13, s[36:39], s60 offen offset:2064 lds
    buffer_load_dwordx4 v14, s[36:39], s60 offen offset:3096 lds
    v_lshlrev_b32 v144, 16, v244
    v_and_b32 v145, 0xffff0000, v244
    v_lshlrev_b32 v146, 16, v245
    v_and_b32 v147, 0xffff0000, v245
    v_lshlrev_b32 v148, 16, v246
    v_and_b32 v149, 0xffff0000, v246
    v_lshlrev_b32 v150, 16, v247
    v_and_b32 v151, 0xffff0000, v247
    v_lshlrev_b32 v152, 16, v248
    v_and_b32 v153, 0xffff0000, v248
    v_lshlrev_b32 v154, 16, v249
    v_and_b32 v155, 0xffff0000, v249
    v_lshlrev_b32 v156, 16, v250
    v_and_b32 v157, 0xffff0000, v250
    v_lshlrev_b32 v158, 16, v251
    v_and_b32 v159, 0xffff0000, v251
    v_lshlrev_b32 v96, 16, v160
    v_and_b32 v97, 0xffff0000, v160
    v_lshlrev_b32 v98, 16, v161
    v_and_b32 v99, 0xffff0000, v161
    v_lshlrev_b32 v100, 16, v162
    v_and_b32 v101, 0xffff0000, v162
    v_lshlrev_b32 v102, 16, v163
    v_and_b32 v103, 0xffff0000, v163
    v_dot2c_f32_bf16 v96, v164, v2
    v_dot2c_f32_bf16 v97, v164, v3
    v_dot2c_f32_bf16 v98, v165, v2
    v_dot2c_f32_bf16 v99, v165, v3
    v_dot2c_f32_bf16 v100, v166, v2
    v_dot2c_f32_bf16 v101, v166, v3
    v_dot2c_f32_bf16 v102, v167, v2
    v_dot2c_f32_bf16 v103, v167, v3
    v_dot2c_f32_bf16 v96, v168, v2
    v_dot2c_f32_bf16 v97, v168, v3
    v_dot2c_f32_bf16 v98, v169, v2
    v_dot2c_f32_bf16 v99, v169, v3
    v_dot2c_f32_bf16 v100, v170, v2
    v_dot2c_f32_bf16 v101, v170, v3
    v_dot2c_f32_bf16 v102, v171, v2
    v_dot2c_f32_bf16 v103, v171, v3
    v_dot2c_f32_bf16 v96, v172, v2
    v_dot2c_f32_bf16 v97, v172, v3
    v_dot2c_f32_bf16 v98, v173, v2
    v_dot2c_f32_bf16 v99, v173, v3
    v_dot2c_f32_bf16 v100, v174, v2
    v_dot2c_f32_bf16 v101, v174, v3
    v_dot2c_f32_bf16 v102, v175, v2
    v_dot2c_f32_bf16 v103, v175, v3
    v_lshlrev_b32 v104, 16, v176
L_stub12:
    s_cbranch_execz L_stub16
    v_and_b32 v105, 0xffff0000, v176
    v_lshlrev_b32 v106, 16, v177
    v_and_b32 v107, 0xffff0000, v177
    v_lshlrev_b32 v108, 16, v178
    v_and_b32 v109, 0xffff0000, v178
    v_lshlrev_b32 v110, 16, v179
    v_and_b32 v111, 0xffff0000, v179
    v_dot2c_f32_bf16 v104, v180, v2
    v_dot2c_f32_bf16 v105, v180, v3
    v_dot2c_f32_bf16 v106, v181, v2
    v_dot2c_f32_bf16 v107, v181, v3
    v_dot2c_f32_bf16 v108, v182, v2
    v_dot2c_f32_bf16 v109, v182, v3
    v_dot2c_f32_bf16 v110, v183, v2
    v_dot2c_f32_bf16 v111, v183, v3
    v_dot2c_f32_bf16 v104, v184, v2
    v_dot2c_f32_bf16 v105, v184, v3
    v_dot2c_f32_bf16 v106, v185, v2
    v_dot2c_f32_bf16 v107, v185, v3
    v_dot2c_f32_bf16 v108, v186, v2
    v_dot2c_f32_bf16 v109, v186, v3
    v_dot2c_f32_bf16 v110, v187, v2
    v_dot2c_f32_bf16 v111, v187, v3
    v_dot2c_f32_bf16 v104, v188, v2
    v_dot2c_f32_bf16 v105, v188, v3
    v_dot2c_f32_bf16 v106, v189, v2
    v_dot2c_f32_bf16 v107, v189, v3
    v_dot2c_f32_bf16 v108, v190, v2
    v_dot2c_f32_bf16 v109, v190, v3
    v_dot2c_f32_bf16 v110, v191, v2
    v_dot2c_f32_bf16 v111, v191, v3
    s_waitcnt vmcnt(16)
    v_max3_u32 v240, v192, v196, v200
    v_max3_u32 v240, v240, v204, v208
    v_max3_u32 v240, v240, v212, v216
    v_max_u32 v240, v240, v220
    v_cmp_eq_u32 vcc, -1, v240
    s_cbranch_vccz L_p23_x
    s_mov_b32 s3, 262144
L_p23:
    s_sleep 2
    s_add_u32 s13, s12, 1024
    s_and_b32 s13, s13, 2047
    s_add_u32 s13, s13, s1
    buffer_load_dwordx4 v[192:195], v24, s[48:51], s13 offen sc1 nt
    s_add_u32 s13, s13, 0x20000
    buffer_load_dwordx4 v[196:199], v24, s[48:51], s13 offen sc1 nt
    s_add_u32 s13, s13, 0x20000
    buffer_load_dwordx4 v[200:203], v24, s[48:51], s13 offen sc1 nt
    s_add_u32 s13, s13, 0x20000
    buffer_load_dwordx4 v[204:207], v24, s[48:51], s13 offen sc1 nt
    s_add_u32 s13, s12, 1536
    s_and_b32 s13, s13, 2047
    s_add_u32 s13, s13, s1
    buffer_load_dwordx4 v[208:211], v24, s[48:51], s13 offen sc1 nt
    s_add_u32 s13, s13, 0x20000
    buffer_load_dwordx4 v[212:215], v24, s[48:51], s13 offen sc1 nt
    s_add_u32 s13, s13, 0x20000
    buffer_load_dwordx4 v[216:219], v24, s[48:51], s13 offen sc1 nt
    s_add_u32 s13, s13, 0x20000
    buffer_load_dwordx4 v[220:223], v24, s[48:51], s13 offen sc1 nt
    s_sub_u32 s3, s3, 1
    s_waitcnt vmcnt(0)
    v_max3_u32 v240, v192, v196, v200
    v_max3_u32 v240, v240, v204, v208
    v_max3_u32 v240, v240, v212, v216
    v_max_u32 v240, v240, v220
    v_cmp_eq_u32 vcc, -1, v240
    s_cmp_eq_u32 s3, 0
    s_cbranch_scc1 L_p23_x
    s_cbranch_vccnz L_p23
L_p23_x:
    v_lshlrev_b32 v112, 16, v192
    v_and_b32 v113, 0xffff0000, v192
    v_lshlrev_b32 v114, 16, v193
    v_and_b32 v115, 0xffff0000, v193
    v_lshlrev_b32 v116, 16, v194
    v_and_b32 v117, 0xffff0000, v194
    v_lshlrev_b32 v118, 16, v195
    v_and_b32 v119, 0xffff0000, v195
    v_dot2c_f32_bf16 v112, v196, v2
    v_dot2c_f32_bf16 v113, v196, v3
    v_dot2c_f32_bf16 v114, v197, v2
    v_dot2c_f32_bf16 v115, v197, v3
    v_dot2c_f32_bf16 v116, v198, v2
    v_dot2c_f32_bf16 v117, v198, v3
    v_dot2c_f32_bf16 v118, v199, v2
    v_dot2c_f32_bf16 v119, v199, v3
    v_dot2c_f32_bf16 v112, v200, v2
    v_dot2c_f32_bf16 v113, v200, v3
    v_dot2c_f32_bf16 v114, v201, v2
    v_dot2c_f32_bf16 v115, v201, v3
    v_dot2c_f32_bf16 v116, v202, v2
    v_dot2c_f32_bf16 v117, v202, v3
    v_dot2c_f32_bf16 v118, v203, v2
    v_dot2c_f32_bf16 v119, v203, v3
    v_dot2c_f32_bf16 v112, v204, v2
    v_dot2c_f32_bf16 v113, v204, v3
    v_dot2c_f32_bf16 v114, v205, v2
    v_dot2c_f32_bf16 v115, v205, v3
    v_dot2c_f32_bf16 v116, v206, v2
    v_dot2c_f32_bf16 v117, v206, v3
    v_dot2c_f32_bf16 v118, v207, v2
    v_dot2c_f32_bf16 v119, v207, v3
    v_lshlrev_b32 v120, 16, v208
    v_and_b32 v121, 0xffff0000, v208
    v_lshlrev_b32 v122, 16, v209
    v_and_b32 v123, 0xffff0000, v209
    v_lshlrev_b32 v124, 16, v210
    v_and_b32 v125, 0xffff0000, v210
    v_lshlrev_b32 v126, 16, v211
    v_and_b32 v127, 0xffff0000, v211
    v_dot2c_f32_bf16 v120, v212, v2
    v_dot2c_f32_bf16 v121, v212, v3
    v_dot2c_f32_bf16 v122, v213, v2
    v_dot2c_f32_bf16 v123, v213, v3
    v_dot2c_f32_bf16 v124, v214, v2
    v_dot2c_f32_bf16 v125, v214, v3
    v_dot2c_f32_bf16 v126, v215, v2
    v_dot2c_f32_bf16 v127, v215, v3
    v_dot2c_f32_bf16 v120, v216, v2
    v_dot2c_f32_bf16 v121, v216, v3
    v_dot2c_f32_bf16 v122, v217, v2
    v_dot2c_f32_bf16 v123, v217, v3
    v_dot2c_f32_bf16 v124, v218, v2
    v_dot2c_f32_bf16 v125, v218, v3
    v_dot2c_f32_bf16 v126, v219, v2
    v_dot2c_f32_bf16 v127, v219, v3
    v_dot2c_f32_bf16 v120, v220, v2
    v_dot2c_f32_bf16 v121, v220, v3
    v_dot2c_f32_bf16 v122, v221, v2
    v_dot2c_f32_bf16 v123, v221, v3
    v_dot2c_f32_bf16 v124, v222, v2
    v_dot2c_f32_bf16 v125, v222, v3
    v_dot2c_f32_bf16 v126, v223, v2
    v_dot2c_f32_bf16 v127, v223, v3
    v_permlane32_swap_b32 v96, v104
    v_permlane32_swap_b32 v97, v105
    v_permlane32_swap_b32 v98, v106
    v_permlane32_swap_b32 v99, v107
    v_permlane32_swap_b32 v100, v108
    v_permlane32_swap_b32 v101, v109
    v_permlane32_swap_b32 v102, v110
    v_permlane32_swap_b32 v103, v111
    v_permlane32_swap_b32 v112, v120
    v_permlane32_swap_b32 v113, v121
    v_permlane32_swap_b32 v114, v122
    v_permlane32_swap_b32 v115, v123
    v_permlane32_swap_b32 v116, v124
    v_permlane32_swap_b32 v117, v125
    v_permlane32_swap_b32 v118, v126
    v_permlane32_swap_b32 v119, v127
    v_pk_add_f32 v[128:129], v[96:97], v[104:105]
    v_pk_add_f32 v[130:131], v[98:99], v[106:107]
    v_pk_add_f32 v[132:133], v[100:101], v[108:109]
    v_pk_add_f32 v[134:135], v[102:103], v[110:111]
    v_pk_add_f32 v[136:137], v[112:113], v[120:121]
    v_pk_add_f32 v[138:139], v[114:115], v[122:123]
    v_pk_add_f32 v[140:141], v[116:117], v[124:125]
    v_pk_add_f32 v[142:143], v[118:119], v[126:127]
    s_waitcnt lgkmcnt(0)
    v_pk_fma_f32 v[128:129], v[128:129], v[32:33], v[144:145]
    v_pk_fma_f32 v[130:131], v[130:131], v[34:35], v[146:147]
    v_pk_fma_f32 v[132:133], v[132:133], v[36:37], v[148:149]
    v_pk_fma_f32 v[134:135], v[134:135], v[38:39], v[150:151]
    v_pk_fma_f32 v[136:137], v[136:137], v[40:41], v[152:153]
    v_pk_fma_f32 v[138:139], v[138:139], v[42:43], v[154:155]
    v_pk_fma_f32 v[140:141], v[140:141], v[44:45], v[156:157]
    v_pk_fma_f32 v[142:143], v[142:143], v[46:47], v[158:159]
    v_cvt_pk_bf16_f32 v144, v128, v129
    v_cvt_pk_bf16_f32 v145, v130, v131
    v_cvt_pk_bf16_f32 v146, v132, v133
    v_cvt_pk_bf16_f32 v147, v134, v135
    v_cvt_pk_bf16_f32 v148, v136, v137
    v_cvt_pk_bf16_f32 v149, v138, v139
    v_cvt_pk_bf16_f32 v150, v140, v141
    v_cvt_pk_bf16_f32 v151, v142, v143
    v_pk_add_f32 v[96:97], v[128:129], v[130:131]
    v_pk_mul_f32 v[98:99], v[128:129], v[128:129]
    v_pk_fma_f32 v[98:99], v[130:131], v[130:131], v[98:99]
    v_pk_add_f32 v[96:97], v[96:97], v[132:133]
    v_pk_fma_f32 v[98:99], v[132:133], v[132:133], v[98:99]
    v_pk_add_f32 v[96:97], v[96:97], v[134:135]
    v_pk_fma_f32 v[98:99], v[134:135], v[134:135], v[98:99]
    v_pk_add_f32 v[96:97], v[96:97], v[136:137]
    v_pk_fma_f32 v[98:99], v[136:137], v[136:137], v[98:99]
    v_pk_add_f32 v[96:97], v[96:97], v[138:139]
    v_pk_fma_f32 v[98:99], v[138:139], v[138:139], v[98:99]
    v_pk_add_f32 v[96:97], v[96:97], v[140:141]
    v_pk_fma_f32 v[98:99], v[140:141], v[140:141], v[98:99]
    v_pk_add_f32 v[96:97], v[96:97], v[142:143]
    v_pk_fma_f32 v[98:99], v[142:143], v[142:143], v[98:99]
    v_add_f32 v96, v96, v97
    v_add_f32 v98, v98, v99
    s_nop 0
    v_add_f32_dpp v96, v96, v96 quad_perm:[2,3,0,1] row_mask:0xf bank_mask:0xf
    v_add_f32_dpp v98, v98, v98 quad_perm:[2,3,0,1] row_mask:0xf bank_mask:0xf
    s_nop 0
    v_add_f32_dpp v96, v96, v96 row_ror:4 row_mask:0xf bank_mask:0xf
    v_add_f32_dpp v98, v98, v98 row_ror:4 row_mask:0xf bank_mask:0xf
    s_nop 0
    v_add_f32_dpp v96, v96, v96 row_ror:8 row_mask:0xf bank_mask:0xf
    v_add_f32_dpp v98, v98, v98 row_ror:8 row_mask:0xf bank_mask:0xf
    v_mov_b32 v97, v96
    v_mov_b32 v99, v98
    s_nop 0
    v_permlane16_swap_b32 v96, v97
    v_permlane16_swap_b32 v98, v99
    v_add_f32 v96, v96, v97
    v_add_f32 v98, v98, v99
    v_mov_b32 v97, v96
    v_mov_b32 v99, v98
    s_nop 0
    v_permlane32_swap_b32 v96, v97
    v_permlane32_swap_b32 v98, v99
    v_add_f32 v96, v96, v97
    v_add_f32 v98, v98, v99
    v_mul_f32 v97, 989855744, v96
    v_mul_f32 v98, 989855744, v98
    v_fma_f32 v98, -v97, v97, v98
    v_max_f32 v98, 0, v98
    v_add_f32 v98, 925353388, v98
    v_rsq_f32 v96, v98
    s_nop 0
    v_mul_f32_e64 v98, -v97, v96
    v_pk_fma_f32 v[128:129], v[128:129], v[96:97], v[98:99] op_sel_hi:[1,0,0]
    v_pk_fma_f32 v[130:131], v[130:131], v[96:97], v[98:99] op_sel_hi:[1,0,0]
    v_pk_fma_f32 v[132:133], v[132:133], v[96:97], v[98:99] op_sel_hi:[1,0,0]
    v_pk_fma_f32 v[134:135], v[134:135], v[96:97], v[98:99] op_sel_hi:[1,0,0]
    v_pk_fma_f32 v[136:137], v[136:137], v[96:97], v[98:99] op_sel_hi:[1,0,0]
    v_pk_fma_f32 v[138:139], v[138:139], v[96:97], v[98:99] op_sel_hi:[1,0,0]
    v_pk_fma_f32 v[140:141], v[140:141], v[96:97], v[98:99] op_sel_hi:[1,0,0]
    v_pk_fma_f32 v[142:143], v[142:143], v[96:97], v[98:99] op_sel_hi:[1,0,0]
    v_pk_fma_f32 v[128:129], v[128:129], v[48:49], v[64:65]
    v_pk_fma_f32 v[130:131], v[130:131], v[50:51], v[66:67]
    v_pk_fma_f32 v[132:133], v[132:133], v[52:53], v[68:69]
    v_pk_fma_f32 v[134:135], v[134:135], v[54:55], v[70:71]
    v_pk_fma_f32 v[136:137], v[136:137], v[56:57], v[72:73]
    v_pk_fma_f32 v[138:139], v[138:139], v[58:59], v[74:75]
    v_pk_fma_f32 v[140:141], v[140:141], v[60:61], v[76:77]
    v_pk_fma_f32 v[142:143], v[142:143], v[62:63], v[78:79]
    v_pk_add_f32 v[96:97], v[128:129], v[130:131]
    v_pk_mul_f32 v[98:99], v[128:129], v[128:129]
    v_pk_fma_f32 v[98:99], v[130:131], v[130:131], v[98:99]
    v_pk_add_f32 v[96:97], v[96:97], v[132:133]
    v_pk_fma_f32 v[98:99], v[132:133], v[132:133], v[98:99]
    v_pk_add_f32 v[96:97], v[96:97], v[134:135]
    v_pk_fma_f32 v[98:99], v[134:135], v[134:135], v[98:99]
    v_pk_add_f32 v[96:97], v[96:97], v[136:137]
    v_pk_fma_f32 v[98:99], v[136:137], v[136:137], v[98:99]
    v_pk_add_f32 v[96:97], v[96:97], v[138:139]
    v_pk_fma_f32 v[98:99], v[138:139], v[138:139], v[98:99]
    v_pk_add_f32 v[96:97], v[96:97], v[140:141]
    v_pk_fma_f32 v[98:99], v[140:141], v[140:141], v[98:99]
    v_pk_add_f32 v[96:97], v[96:97], v[142:143]
    v_pk_fma_f32 v[98:99], v[142:143], v[142:143], v[98:99]
    v_add_f32 v96, v96, v97
    v_add_f32 v98, v98, v99
    s_nop 0
    v_add_f32_dpp v96, v96, v96 quad_perm:[2,3,0,1] row_mask:0xf bank_mask:0xf
    v_add_f32_dpp v98, v98, v98 quad_perm:[2,3,0,1] row_mask:0xf bank_mask:0xf
    s_nop 0
    v_add_f32_dpp v96, v96, v96 row_ror:4 row_mask:0xf bank_mask:0xf
    v_add_f32_dpp v98, v98, v98 row_ror:4 row_mask:0xf bank_mask:0xf
    s_nop 0
    v_add_f32_dpp v96, v96, v96 row_ror:8 row_mask:0xf bank_mask:0xf
    v_add_f32_dpp v98, v98, v98 row_ror:8 row_mask:0xf bank_mask:0xf
    v_mov_b32 v97, v96
    v_mov_b32 v99, v98
    s_nop 0
    v_permlane16_swap_b32 v96, v97
    v_permlane16_swap_b32 v98, v99
    v_add_f32 v96, v96, v97
    v_add_f32 v98, v98, v99
    v_mov_b32 v97, v96
    v_mov_b32 v99, v98
    s_nop 0
    v_permlane32_swap_b32 v96, v97
    v_permlane32_swap_b32 v98, v99
    v_add_f32 v96, v96, v97
    v_add_f32 v98, v98, v99
    v_mul_f32 v97, 989855744, v96
    v_mul_f32 v98, 989855744, v98
    v_fma_f32 v98, -v97, v97, v98
    v_max_f32 v98, 0, v98
    v_add_f32 v98, 925353388, v98
    v_mul_f32 v98, 1083289508, v98
    v_rsq_f32 v96, v98
    s_nop 0
    v_mul_f32_e64 v98, -v97, v96
    v_pk_fma_f32 v[128:129], v[128:129], v[96:97], v[98:99] op_sel_hi:[1,0,0]
    v_pk_fma_f32 v[130:131], v[130:131], v[96:97], v[98:99] op_sel_hi:[1,0,0]
    v_pk_fma_f32 v[132:133], v[132:133], v[96:97], v[98:99] op_sel_hi:[1,0,0]
    v_pk_fma_f32 v[134:135], v[134:135], v[96:97], v[98:99] op_sel_hi:[1,0,0]
    v_pk_fma_f32 v[136:137], v[136:137], v[96:97], v[98:99] op_sel_hi:[1,0,0]
    v_pk_fma_f32 v[138:139], v[138:139], v[96:97], v[98:99] op_sel_hi:[1,0,0]
    v_pk_fma_f32 v[140:141], v[140:141], v[96:97], v[98:99] op_sel_hi:[1,0,0]
    v_pk_fma_f32 v[142:143], v[142:143], v[96:97], v[98:99] op_sel_hi:[1,0,0]
    v_cvt_pk_bf16_f32 v152, v128, v129
    v_cvt_pk_bf16_f32 v153, v130, v131
    v_cvt_pk_bf16_f32 v154, v132, v133
    v_cvt_pk_bf16_f32 v155, v134, v135
    v_cvt_pk_bf16_f32 v156, v136, v137
    v_cvt_pk_bf16_f32 v157, v138, v139
    v_cvt_pk_bf16_f32 v158, v140, v141
    v_cvt_pk_bf16_f32 v159, v142, v143
    s_add_u32 s61, s10, 2097152
    buffer_store_dwordx4 v[152:155], v6, s[48:51], s61 offen sc1
    buffer_store_dwordx4 v[156:159], v7, s[48:51], s61 offen sc1
    s_add_u32 s61, s10, 4194304
    buffer_store_dwordx4 v[144:147], v6, s[48:51], s61 offen sc1
    buffer_store_dwordx4 v[148:151], v7, s[48:51], s61 offen sc1
    s_waitcnt vmcnt(16)
    ds_read_b64_tr_b16 a[56:57], v21 offset:0
    ds_read_b64_tr_b16 a[58:59], v21 offset:256
    ds_read_b64_tr_b16 a[60:61], v21 offset:8
    ds_read_b64_tr_b16 a[62:63], v21 offset:264
    ds_read_b64_tr_b16 a[184:185], v21 offset:512
    ds_read_b64_tr_b16 a[186:187], v21 offset:768
    ds_read_b64_tr_b16 a[188:189], v21 offset:520
    ds_read_b64_tr_b16 a[190:191], v21 offset:776
    s_waitcnt vmcnt(12)
    ds_read_b64_tr_b16 a[64:65], v21 offset:4128
    ds_read_b64_tr_b16 a[66:67], v21 offset:4384
    ds_read_b64_tr_b16 a[68:69], v21 offset:4136
    ds_read_b64_tr_b16 a[70:71], v21 offset:4392
    ds_read_b64_tr_b16 a[192:193], v21 offset:4640
    ds_read_b64_tr_b16 a[194:195], v21 offset:4896
    ds_read_b64_tr_b16 a[196:197], v21 offset:4648
    ds_read_b64_tr_b16 a[198:199], v21 offset:4904
    s_waitcnt vmcnt(8)
    ds_read_b64_tr_b16 a[72:73], v9 offset:0
    ds_read_b64_tr_b16 a[74:75], v9 offset:256
    ds_read_b64_tr_b16 a[76:77], v9 offset:8
    ds_read_b64_tr_b16 a[78:79], v9 offset:264
    ds_read_b64_tr_b16 a[200:201], v9 offset:512
    ds_read_b64_tr_b16 a[202:203], v9 offset:768
    ds_read_b64_tr_b16 a[204:205], v9 offset:520
    ds_read_b64_tr_b16 a[206:207], v9 offset:776
    s_waitcnt vmcnt(4)
    ds_read_b64_tr_b16 a[80:81], v9 offset:4128
    ds_read_b64_tr_b16 a[82:83], v9 offset:4384
    ds_read_b64_tr_b16 a[84:85], v9 offset:4136
    ds_read_b64_tr_b16 a[86:87], v9 offset:4392
    ds_read_b64_tr_b16 a[208:209], v9 offset:4640
    ds_read_b64_tr_b16 a[210:211], v9 offset:4896
    ds_read_b64_tr_b16 a[212:213], v9 offset:4648
    ds_read_b64_tr_b16 a[214:215], v9 offset:4904
    s_add_u32 m0, s63, 0
    s_mov_b32 s60, s92
    s_add_u32 s92, s92, 114688
    s_cmp_eq_u32 s92, 1835008
    s_cselect_b32 s92, 0, s92
    s_waitcnt lgkmcnt(8)
    buffer_load_dwordx4 v11, s[36:39], s60 offen offset:0 lds
    buffer_load_dwordx4 v12, s[36:39], s60 offen offset:1032 lds
    buffer_load_dwordx4 v13, s[36:39], s60 offen offset:2064 lds
    buffer_load_dwordx4 v14, s[36:39], s60 offen offset:3096 lds
    s_add_u32 m0, s63, 4128
    s_mov_b32 s60, s92
    s_add_u32 s92, s92, 114688
    s_cmp_eq_u32 s92, 1835008
    s_cselect_b32 s92, 0, s92
    s_waitcnt lgkmcnt(0)
    buffer_load_dwordx4 v11, s[36:39], s60 offen offset:0 lds
    buffer_load_dwordx4 v12, s[36:39], s60 offen offset:1032 lds
    buffer_load_dwordx4 v13, s[36:39], s60 offen offset:2064 lds
    buffer_load_dwordx4 v14, s[36:39], s60 offen offset:3096 lds
    s_add_u32 m0, s63, 8256
    s_mov_b32 s60, s92
    s_add_u32 s92, s92, 114688
    s_cmp_eq_u32 s92, 1835008
    s_cselect_b32 s92, 0, s92
    buffer_load_dwordx4 v11, s[36:39], s60 offen offset:0 lds
    buffer_load_dwordx4 v12, s[36:39], s60 offen offset:1032 lds
    buffer_load_dwordx4 v13, s[36:39], s60 offen offset:2064 lds
    buffer_load_dwordx4 v14, s[36:39], s60 offen offset:3096 lds
    v_lshrrev_b32 v2, 4, v1
    s_lshl_b32 s12, s58, 16
    s_and_b32 s11, s35, 1
    s_lshl_b32 s11, s11, 14
    s_add_u32 s12, s12, s11
    s_add_u32 s12, s12, 2097152
    s_lshr_b32 s15, s35, 1
    s_lshl_b32 s61, s15, 13
    s_add_u32 s11, s11, s61
    s_mul_i32 s15, s15, 0x2040
    s_lshl_b32 s61, s58, 3
    s_add_u32 s61, s61, s59
    s_lshl_b32 s9, s61, 7
    s_add_u32 s9, s9, 262144
    s_cmp_lg_u32 s35, 0
    s_cselect_b32 s9, 268435456, s9
    s_lshl_b32 s0, s58, 2
    s_add_u32 s0, s0, s35
    s_lshl_b32 s0, s0, 8
    s_add_u32 s0, s0, 262144
    v_min_u32 v23, 2, v1
    v_lshrrev_b32 v22, 1, v23
    v_lshlrev_b32 v23, 7, v23
    v_lshl_add_u32 v23, v22, 28, v23
    v_and_b32 v22, 31, v1
    v_lshlrev_b32 v22, 2, v22
    v_lshrrev_b32 v4, 3, v1
    v_lshrrev_b32 v5, 1, v4
    v_xor_b32 v5, v5, v1
    v_and_b32 v5, 7, v5
    v_lshlrev_b32 v5, 4, v5
    v_lshl_add_u32 v4, v4, 10, v5
    v_xor_b32 v4, s15, v4
    v_bfe_u32 v15, v1, 1, 3
    v_xor_b32 v15, v15, v2
    v_lshlrev_b32 v15, 4, v15
    v_and_b32 v17, 7, v1
    v_lshl_add_u32 v15, v17, 7, v15
    v_bfe_u32 v17, v1, 3, 1
    v_lshl_add_u32 v15, v17, 13, v15
    v_xor_b32 v17, 64, v15
    v_lshlrev_b32 v224, 16, v80
    v_and_b32 v225, 0xffff0000, v80
    v_lshlrev_b32 v226, 16, v81
    v_and_b32 v227, 0xffff0000, v81
    v_lshlrev_b32 v228, 16, v82
    v_and_b32 v229, 0xffff0000, v82
    v_lshlrev_b32 v230, 16, v83
    v_and_b32 v231, 0xffff0000, v83
    v_lshlrev_b32 v232, 16, v84
    v_and_b32 v233, 0xffff0000, v84
    v_lshlrev_b32 v234, 16, v85
    v_and_b32 v235, 0xffff0000, v85
    v_lshlrev_b32 v236, 16, v86
    v_and_b32 v237, 0xffff0000, v86
    v_lshlrev_b32 v238, 16, v87
    v_and_b32 v239, 0xffff0000, v87
    v_mul_f32 v224, 1055913304, v224
    v_mul_f32 v225, 1055913304, v225
    v_mul_f32 v226, 1055913304, v226
    v_mul_f32 v227, 1055913304, v227
    v_mul_f32 v228, 1055913304, v228
    v_mul_f32 v229, 1055913304, v229
    v_mul_f32 v230, 1055913304, v230
    v_mul_f32 v231, 1055913304, v231
    v_mul_f32 v232, 1055913304, v232
    v_mul_f32 v233, 1055913304, v233
    v_mul_f32 v234, 1055913304, v234
    v_mul_f32 v235, 1055913304, v235
    v_mul_f32 v236, 1055913304, v236
    v_mul_f32 v237, 1055913304, v237
    v_mul_f32 v238, 1055913304, v238
    v_mul_f32 v239, 1055913304, v239
    s_waitcnt vmcnt(12)
    s_barrier
    buffer_store_dword v25, v22, s[48:51], s9 offen sc1
    s_waitcnt vmcnt(9)
    ds_read_b64_tr_b16 a[88:89], v9 offset:0
    ds_read_b64_tr_b16 a[90:91], v9 offset:256
    ds_read_b64_tr_b16 a[92:93], v9 offset:8
    ds_read_b64_tr_b16 a[94:95], v9 offset:264
    ds_read_b64_tr_b16 a[216:217], v9 offset:512
    ds_read_b64_tr_b16 a[218:219], v9 offset:768
    ds_read_b64_tr_b16 a[220:221], v9 offset:520
    ds_read_b64_tr_b16 a[222:223], v9 offset:776
    s_waitcnt vmcnt(5)
    ds_read_b64_tr_b16 a[96:97], v9 offset:4128
    ds_read_b64_tr_b16 a[98:99], v9 offset:4384
    ds_read_b64_tr_b16 a[100:101], v9 offset:4136
    ds_read_b64_tr_b16 a[102:103], v9 offset:4392
    ds_read_b64_tr_b16 a[224:225], v9 offset:4640
    ds_read_b64_tr_b16 a[226:227], v9 offset:4896
    ds_read_b64_tr_b16 a[228:229], v9 offset:4648
    ds_read_b64_tr_b16 a[230:231], v9 offset:4904
    s_waitcnt vmcnt(1)
    ds_read_b64_tr_b16 a[104:105], v9 offset:8256
    ds_read_b64_tr_b16 a[106:107], v9 offset:8512
    ds_read_b64_tr_b16 a[108:109], v9 offset:8264
    ds_read_b64_tr_b16 a[110:111], v9 offset:8520
    ds_read_b64_tr_b16 a[232:233], v9 offset:8768
    ds_read_b64_tr_b16 a[234:235], v9 offset:9024
    ds_read_b64_tr_b16 a[236:237], v9 offset:8776
    ds_read_b64_tr_b16 a[238:239], v9 offset:9032
    s_add_u32 m0, s63, 0
    s_mov_b32 s60, s92
    s_add_u32 s92, s92, 114688
    s_cmp_eq_u32 s92, 1835008
    s_cselect_b32 s92, 0, s92
    s_waitcnt lgkmcnt(15)
    buffer_load_dwordx4 v11, s[36:39], s60 offen offset:0 lds
    buffer_load_dwordx4 v12, s[36:39], s60 offen offset:1032 lds
    buffer_load_dwordx4 v13, s[36:39], s60 offen offset:2064 lds
    buffer_load_dwordx4 v14, s[36:39], s60 offen offset:3096 lds
    s_add_u32 m0, s63, 4128
    s_mov_b32 s60, s92
    s_add_u32 s92, s92, 114688
    s_cmp_eq_u32 s92, 1835008
    s_cselect_b32 s92, 0, s92
    s_waitcnt lgkmcnt(8)
    buffer_load_dwordx4 v11, s[36:39], s60 offen offset:0 lds
    buffer_load_dwordx4 v12, s[36:39], s60 offen offset:1032 lds
    buffer_load_dwordx4 v13, s[36:39], s60 offen offset:2064 lds
    buffer_load_dwordx4 v14, s[36:39], s60 offen offset:3096 lds
    v_mov_b32 v240, 0
    buffer_atomic_add v240, v23, s[48:51], s0 offen sc0 sc1
    s_add_u32 m0, s63, 8256
    v_bfe_u32 v2, v1, 2, 3
    v_mul_u32_u24 v2, 1024, v2
    v_lshrrev_b32 v3, 5, v1
    v_lshl_add_u32 v2, v3, 6, v2
    v_and_b32 v3, 3, v1
    v_lshl_add_u32 v11, v3, 4, v2
    v_add_u32 v12, 7160, v11
    v_add_u32 v13, 14320, v11
    v_add_u32 v14, 21480, v11
    s_lshl_b32 s60, s35, 16
    s_lshl_b32 s61, s59, 7
    s_add_u32 s60, s60, s61
    s_add_u32 s36, s20, s60
    s_addc_u32 s37, s21, 0
    s_sub_u32 s38, 1835008, s60
    s_sub_u32 s7, s14, 7
    s_cselect_b32 s7, s14, s7
    s_mul_i32 s8, s7, 40960
    s_lshl_b32 s7, s7, 18
    s_add_u32 s60, s7, 0
    s_add_u32 s7, s7, 0x40000
    s_cmp_eq_u32 s7, 1835008
    s_cselect_b32 s7, 0, s7
    s_waitcnt lgkmcnt(0)
    buffer_load_dwordx4 v11, s[36:39], s60 offen offset:0 lds
    buffer_load_dwordx4 v12, s[36:39], s60 offen offset:1032 lds
    buffer_load_dwordx4 v13, s[36:39], s60 offen offset:2064 lds
    buffer_load_dwordx4 v14, s[36:39], s60 offen offset:3096 lds
    s_add_u32 m0, s63, 12384
    s_add_u32 s60, s7, 0
    s_add_u32 s7, s7, 0x40000
    s_cmp_eq_u32 s7, 1835008
    s_cselect_b32 s7, 0, s7
    buffer_load_dwordx4 v11, s[36:39], s60 offen offset:0 lds
    buffer_load_dwordx4 v12, s[36:39], s60 offen offset:1032 lds
    buffer_load_dwordx4 v13, s[36:39], s60 offen offset:2064 lds
    buffer_load_dwordx4 v14, s[36:39], s60 offen offset:3096 lds
    s_waitcnt vmcnt(8)
    v_cmp_ne_u32 vcc, s34, v240
    s_nop 0
    s_and_b64 vcc, vcc, 3
    s_cbranch_vccz L_pf2_x
    s_mov_b32 s3, 262144
L_pf2:
    v_mov_b32 v240, 0
    buffer_atomic_add v240, v23, s[48:51], s0 offen sc0 sc1
    s_sub_u32 s3, s3, 1
    s_waitcnt vmcnt(0)
    v_cmp_ne_u32 vcc, s34, v240
    s_nop 0
    s_and_b64 vcc, vcc, 3
    s_cmp_eq_u32 s3, 0
    s_cbranch_scc1 L_pf2_x
    s_cbranch_vccnz L_pf2
L_pf2_x:
    s_waitcnt lgkmcnt(0)
    s_barrier
    s_and_b32 s13, s14, 7
    s_lshl_b32 s13, s13, 7
    v_add_u32 v4, s12, v4
    s_add_u32 m0, s11, 0
    s_nop 0
    buffer_load_dwordx4 v4, s[48:51], s13 offen sc1 lds
    s_add_u32 s13, s13, 128
    s_and_b32 s13, s13, 1023
    s_add_u32 m0, s11, 1024
    s_nop 0
    buffer_load_dwordx4 v4, s[48:51], s13 offen sc1 lds
    s_add_u32 s13, s13, 128
    s_and_b32 s13, s13, 1023
    s_add_u32 m0, s11, 2048
    s_nop 0
    buffer_load_dwordx4 v4, s[48:51], s13 offen sc1 lds
    s_add_u32 s13, s13, 128
    s_and_b32 s13, s13, 1023
    s_add_u32 m0, s11, 3072
    s_nop 0
    buffer_load_dwordx4 v4, s[48:51], s13 offen sc1 lds
    s_add_u32 s13, s13, 128
    s_and_b32 s13, s13, 1023
    s_add_u32 m0, s11, 4096
    s_nop 0
    buffer_load_dwordx4 v4, s[48:51], s13 offen sc1 lds
    s_add_u32 s13, s13, 128
    s_and_b32 s13, s13, 1023
    s_add_u32 m0, s11, 5120
    s_nop 0
    buffer_load_dwordx4 v4, s[48:51], s13 offen sc1 lds
    s_add_u32 s13, s13, 128
    s_and_b32 s13, s13, 1023
    s_add_u32 m0, s11, 6144
    s_nop 0
    buffer_load_dwordx4 v4, s[48:51], s13 offen sc1 lds
    s_add_u32 s13, s13, 128
    s_and_b32 s13, s13, 1023
    s_add_u32 m0, s11, 7168
    s_nop 0
    buffer_load_dwordx4 v4, s[48:51], s13 offen sc1 lds
    s_add_u32 s13, s13, 128
    s_and_b32 s13, s13, 1023
    s_mov_b64 exec, 0
    s_cmp_eq_u32 s35, 0
    s_cbranch_scc0 L_w2_0
    s_call_b64 s[100:101], L_stub13
    s_branch L_w2_ret
L_w2_0:
    s_cmp_eq_u32 s35, 1
    s_cbranch_scc0 L_w2_1
    s_call_b64 s[100:101], L_stub14
    s_branch L_w2_ret
L_w2_1:
    s_cmp_eq_u32 s35, 2
    s_cbranch_scc0 L_w2_2
    s_call_b64 s[100:101], L_stub15
    s_branch L_w2_ret
L_w2_2:
    s_call_b64 s[100:101], L_stub16
L_w2_ret:
    s_mov_b64 exec, -1
    s_lshl_b32 s60, s2, 2
    s_add_u32 s60, s60, s35
    s_cmp_lg_u32 s60, 1
    s_cbranch_scc1 L_noep
    v_lshlrev_b32 v2, 7, v1
    v_add_u32 v2, 1048576, v2
    s_mov_b32 s60, 0x2000
    s_mov_b32 s61, 0x4000
    s_mov_b32 s15, 0x6000
    s_mov_b32 s3, 262144
L_ep:
    buffer_load_dword v40, v2, s[48:51], 0 offen sc1
    buffer_load_dword v41, v2, s[48:51], s60 offen sc1
    buffer_load_dword v42, v2, s[48:51], s61 offen sc1
    buffer_load_dword v43, v2, s[48:51], s15 offen sc1
    s_sub_u32 s3, s3, 1
    s_waitcnt vmcnt(0)
    v_cmp_ne_u32 vcc, s34, v40
    v_cmp_ne_u32 s[100:101], s34, v41
    s_nop 0
    s_or_b64 vcc, vcc, s[100:101]
    v_cmp_ne_u32 s[100:101], s34, v42
    s_nop 0
    s_or_b64 vcc, vcc, s[100:101]
    v_cmp_ne_u32 s[100:101], s34, v43
    s_nop 0
    s_or_b64 vcc, vcc, s[100:101]
    s_cmp_eq_u32 s3, 0
    s_cbranch_scc1 L_ep_x
    s_cbranch_vccnz L_ep
L_ep_x:
    v_mov_b32 v2, 0
    buffer_store_dword v25, v2, s[48:51], 0 offen sc1
L_noep:
    s_waitcnt vmcnt(4)
    s_barrier
    ds_read_b128 v[96:99], v15 offset:0
    ds_read_b128 v[104:107], v17 offset:0
    ds_read_b128 v[112:115], v15 offset:1024
    ds_read_b128 v[120:123], v17 offset:1024
    ds_read_b128 v[100:103], v15 offset:16384
    ds_read_b128 v[108:111], v17 offset:16384
    ds_read_b128 v[116:119], v15 offset:17408
    ds_read_b128 v[124:127], v17 offset:17408
    s_mov_b32 s92, 1055913304
    v_mov_b32 v26, 1084043516
    s_lshl_b32 s60, s58, 3
    s_add_u32 s60, s60, s59
    s_mul_i32 s94, s60, 40960
    s_mul_i32 s61, s35, 5120
    s_add_u32 s94, s94, s61
    s_add_u32 s94, s94, 6291456
L_stub13:
    s_cbranch_execz L_stub17
    s_cmp_eq_u32 s59, 9
    s_cselect_b32 s94, 268435456, s94
    s_add_u32 s95, s94, 20480
    s_mul_i32 s1, s58, 327680
    s_add_u32 s1, s1, s61
    s_add_u32 s1, s1, 6291456
    v_add_u32 v18, 20480, v16
    s_mov_b32 s9, s8
    s_waitcnt lgkmcnt(7)
    v_mfma_f32_16x16x32_bf16 v[32:35], a[0:3], v[96:99], v[224:227]
    ds_read_b64_tr_b16 a[112:113], v9 offset:0
    ds_read_b64_tr_b16 a[114:115], v9 offset:256
    v_add_u32 v4, 32768, v4
    s_add_u32 m0, s11, 32768
    s_nop 0
    buffer_load_dwordx4 v4, s[48:51], s13 offen sc1 lds
    s_waitcnt lgkmcnt(5)
    v_mfma_f32_16x16x32_bf16 v[32:35], a[8:11], v[104:107], v[32:35]
    ds_read_b64_tr_b16 a[116:117], v9 offset:8
    ds_read_b128 v[128:131], v15 offset:2048
    v_mfma_f32_16x16x32_bf16 v[32:35], a[16:19], v[112:115], v[32:35]
    ds_read_b64_tr_b16 a[118:119], v9 offset:264
    ds_read_b128 v[136:139], v17 offset:2048
    v_mfma_f32_16x16x32_bf16 v[32:35], a[24:27], v[120:123], v[32:35]
    ds_read_b64_tr_b16 a[240:241], v9 offset:512
    ds_read_b64_tr_b16 a[242:243], v9 offset:768
    ds_read_b128 v[144:147], v15 offset:3072
    s_add_u32 s13, s13, 128
    s_and_b32 s13, s13, 1023
    s_add_u32 m0, s11, 33792
    s_nop 0
    buffer_load_dwordx4 v4, s[48:51], s13 offen sc1 lds
    v_mfma_f32_16x16x32_bf16 v[36:39], a[0:3], v[100:103], v[224:227]
    ds_read_b64_tr_b16 a[244:245], v9 offset:520
    ds_read_b128 v[152:155], v17 offset:3072
    s_waitcnt lgkmcnt(10)
    v_mfma_f32_16x16x32_bf16 v[36:39], a[8:11], v[108:111], v[36:39]
    ds_read_b64_tr_b16 a[246:247], v9 offset:776
    ds_read_b128 v[132:135], v15 offset:18432
    v_mfma_f32_16x16x32_bf16 v[36:39], a[16:19], v[116:119], v[36:39]
    ds_read_b64_tr_b16 a[120:121], v9 offset:4128
    ds_read_b64_tr_b16 a[122:123], v9 offset:4384
    ds_read_b128 v[140:143], v17 offset:18432
    s_add_u32 s13, s13, 128
    s_and_b32 s13, s13, 1023
    s_add_u32 m0, s11, 34816
    s_nop 0
    buffer_load_dwordx4 v4, s[48:51], s13 offen sc1 lds
    v_mfma_f32_16x16x32_bf16 v[36:39], a[24:27], v[124:127], v[36:39]
    ds_read_b64_tr_b16 a[124:125], v9 offset:4136
    ds_read_b128 v[148:151], v15 offset:19456
    v_mfma_f32_16x16x32_bf16 v[48:51], a[4:7], v[96:99], v[228:231]
    ds_read_b64_tr_b16 a[126:127], v9 offset:4392
    ds_read_b128 v[156:159], v17 offset:19456
    v_mfma_f32_16x16x32_bf16 v[48:51], a[12:15], v[104:107], v[48:51]
    ds_read_b64_tr_b16 a[248:249], v9 offset:4640
    ds_read_b64_tr_b16 a[250:251], v9 offset:4896
    s_add_u32 s13, s13, 128
    s_and_b32 s13, s13, 1023
    s_add_u32 m0, s11, 35840
    s_nop 0
    buffer_load_dwordx4 v4, s[48:51], s13 offen sc1 lds
    v_mfma_f32_16x16x32_bf16 v[48:51], a[20:23], v[112:115], v[48:51]
    ds_read_b64_tr_b16 a[252:253], v9 offset:4648
    s_add_u32 s13, s13, 128
    v_mfma_f32_16x16x32_bf16 v[48:51], a[28:31], v[120:123], v[48:51]
    ds_read_b64_tr_b16 a[254:255], v9 offset:4904
    s_and_b32 s13, s13, 1023
    v_mfma_f32_16x16x32_bf16 v[52:55], a[4:7], v[100:103], v[228:231]
    ds_read_b64_tr_b16 v[160:161], v9 offset:8256
    ds_read_b64_tr_b16 v[162:163], v9 offset:8512
    s_add_u32 m0, s11, 36864
    s_nop 0
    buffer_load_dwordx4 v4, s[48:51], s13 offen sc1 lds
    v_mfma_f32_16x16x32_bf16 v[52:55], a[12:15], v[108:111], v[52:55]
    ds_read_b64_tr_b16 v[164:165], v9 offset:8264
    s_add_u32 s13, s13, 128
    v_mfma_f32_16x16x32_bf16 v[52:55], a[20:23], v[116:119], v[52:55]
    ds_read_b64_tr_b16 v[166:167], v9 offset:8520
    s_and_b32 s13, s13, 1023
    v_mfma_f32_16x16x32_bf16 v[52:55], a[28:31], v[124:127], v[52:55]
    ds_read_b64_tr_b16 v[168:169], v9 offset:8768
    ds_read_b64_tr_b16 v[170:171], v9 offset:9024
    s_add_u32 m0, s11, 37888
    s_nop 0
    buffer_load_dwordx4 v4, s[48:51], s13 offen sc1 lds
    s_waitcnt lgkmcnt(8)
    v_mfma_f32_16x16x32_bf16 v[32:35], a[32:35], v[128:131], v[32:35]
    ds_read_b64_tr_b16 v[172:173], v9 offset:8776
    s_waitcnt vmcnt(6)
    s_barrier
    v_mfma_f32_16x16x32_bf16 v[32:35], a[40:43], v[136:139], v[32:35]
    ds_read_b64_tr_b16 v[174:175], v9 offset:9032
    ds_read_b128 v[96:99], v15 offset:4096
    v_mfma_f32_16x16x32_bf16 v[32:35], a[48:51], v[144:147], v[32:35]
    ds_read_b64_tr_b16 v[176:177], v9 offset:12384
    ds_read_b64_tr_b16 v[178:179], v9 offset:12640
    ds_read_b128 v[104:107], v17 offset:4096
    s_add_u32 s13, s13, 128
    s_and_b32 s13, s13, 1023
    s_add_u32 m0, s11, 38912
    s_nop 0
    buffer_load_dwordx4 v4, s[48:51], s13 offen sc1 lds
    v_mfma_f32_16x16x32_bf16 v[32:35], a[56:59], v[152:155], v[32:35]
    ds_read_b64_tr_b16 v[180:181], v9 offset:12392
    ds_read_b128 v[112:115], v15 offset:5120
    v_mfma_f32_16x16x32_bf16 v[36:39], a[32:35], v[132:135], v[36:39]
    ds_read_b64_tr_b16 v[182:183], v9 offset:12648
    ds_read_b128 v[120:123], v17 offset:5120
    v_mfma_f32_16x16x32_bf16 v[36:39], a[40:43], v[140:143], v[36:39]
    ds_read_b64_tr_b16 v[184:185], v9 offset:12896
    ds_read_b64_tr_b16 v[186:187], v9 offset:13152
    ds_read_b128 v[100:103], v15 offset:20480
    s_add_u32 s13, s13, 128
    s_and_b32 s13, s13, 1023
    s_add_u32 m0, s11, 39936
    s_nop 0
    buffer_load_dwordx4 v4, s[48:51], s13 offen sc1 lds
    v_mfma_f32_16x16x32_bf16 v[36:39], a[48:51], v[148:151], v[36:39]
    ds_read_b64_tr_b16 v[188:189], v9 offset:12904
    ds_read_b128 v[108:111], v17 offset:20480
    v_mfma_f32_16x16x32_bf16 v[36:39], a[56:59], v[156:159], v[36:39]
    ds_read_b64_tr_b16 v[190:191], v9 offset:13160
    ds_read_b128 v[116:119], v15 offset:21504
    v_mfma_f32_16x16x32_bf16 v[48:51], a[36:39], v[128:131], v[48:51]
    ds_read_b128 v[124:127], v17 offset:21504
    s_add_u32 s13, s13, 128
    s_and_b32 s13, s13, 1023
    v_mfma_f32_16x16x32_bf16 v[48:51], a[44:47], v[136:139], v[48:51]
    s_mov_b32 m0, s6
    s_add_u32 s60, s7, 0
    v_mfma_f32_16x16x32_bf16 v[48:51], a[52:55], v[144:147], v[48:51]
    buffer_load_dwordx4 v11, s[36:39], s60 offen offset:0 lds
    v_mfma_f32_16x16x32_bf16 v[48:51], a[60:63], v[152:155], v[48:51]
    v_mfma_f32_16x16x32_bf16 v[52:55], a[36:39], v[132:135], v[52:55]
    v_mfma_f32_16x16x32_bf16 v[52:55], a[44:47], v[140:143], v[52:55]
    buffer_load_dwordx4 v12, s[36:39], s60 offen offset:1032 lds
    v_mfma_f32_16x16x32_bf16 v[52:55], a[52:55], v[148:151], v[52:55]
    v_mfma_f32_16x16x32_bf16 v[52:55], a[60:63], v[156:159], v[52:55]
    s_waitcnt lgkmcnt(0)
    v_mfma_f32_16x16x32_bf16 v[32:35], a[64:67], v[96:99], v[32:35]
    ds_read_b128 v[128:131], v15 offset:6144
    buffer_load_dwordx4 v13, s[36:39], s60 offen offset:2064 lds
    v_mfma_f32_16x16x32_bf16 v[32:35], a[72:75], v[104:107], v[32:35]
    ds_read_b128 v[136:139], v17 offset:6144
    v_mfma_f32_16x16x32_bf16 v[32:35], a[80:83], v[112:115], v[32:35]
    ds_read_b128 v[144:147], v15 offset:7168
    v_mfma_f32_16x16x32_bf16 v[32:35], a[88:91], v[120:123], v[32:35]
    ds_read_b128 v[152:155], v17 offset:7168
    buffer_load_dwordx4 v14, s[36:39], s60 offen offset:3096 lds
    v_mfma_f32_16x16x32_bf16 v[36:39], a[64:67], v[100:103], v[36:39]
    ds_read_b128 v[132:135], v15 offset:22528
    s_add_u32 s7, s7, 0x40000
    v_mfma_f32_16x16x32_bf16 v[36:39], a[72:75], v[108:111], v[36:39]
    s_cmp_eq_u32 s7, 1835008
    s_cselect_b32 s7, 0, s7
    s_add_u32 m0, s63, 0
    v_mfma_f32_16x16x32_bf16 v[36:39], a[80:83], v[116:119], v[36:39]
    ds_read_b128 v[140:143], v17 offset:22528
    s_add_u32 s60, s7, 0
    v_mfma_f32_16x16x32_bf16 v[36:39], a[88:91], v[124:127], v[36:39]
    ds_read_b128 v[148:151], v15 offset:23552
    ds_read_b128 v[156:159], v17 offset:23552
    v_mfma_f32_16x16x32_bf16 v[48:51], a[68:71], v[96:99], v[48:51]
    buffer_load_dwordx4 v11, s[36:39], s60 offen offset:0 lds
    v_mfma_f32_16x16x32_bf16 v[48:51], a[76:79], v[104:107], v[48:51]
    v_mfma_f32_16x16x32_bf16 v[48:51], a[84:87], v[112:115], v[48:51]
    v_mfma_f32_16x16x32_bf16 v[48:51], a[92:95], v[120:123], v[48:51]
    buffer_load_dwordx4 v12, s[36:39], s60 offen offset:1032 lds
    v_mfma_f32_16x16x32_bf16 v[52:55], a[68:71], v[100:103], v[52:55]
    v_mfma_f32_16x16x32_bf16 v[52:55], a[76:79], v[108:111], v[52:55]
    v_mfma_f32_16x16x32_bf16 v[52:55], a[84:87], v[116:119], v[52:55]
    buffer_load_dwordx4 v13, s[36:39], s60 offen offset:2064 lds
    v_mfma_f32_16x16x32_bf16 v[52:55], a[92:95], v[124:127], v[52:55]
    s_waitcnt lgkmcnt(0)
    v_mfma_f32_16x16x32_bf16 v[32:35], a[96:99], v[128:131], v[32:35]
    s_waitcnt vmcnt(7)
    s_barrier
    ds_read_b128 v[96:99], v15 offset:32768
    v_mfma_f32_16x16x32_bf16 v[32:35], a[104:107], v[136:139], v[32:35]
    ds_read_b128 v[104:107], v17 offset:32768
    buffer_load_dwordx4 v14, s[36:39], s60 offen offset:3096 lds
    v_mfma_f32_16x16x32_bf16 v[32:35], a[112:115], v[144:147], v[32:35]
    ds_read_b128 v[112:115], v15 offset:33792
    s_add_u32 s7, s7, 0x40000
    v_mfma_f32_16x16x32_bf16 v[32:35], a[120:123], v[152:155], v[32:35]
    s_cmp_eq_u32 s7, 1835008
    s_cselect_b32 s7, 0, s7
    s_add_u32 m0, s63, 4128
    v_mfma_f32_16x16x32_bf16 v[36:39], a[96:99], v[132:135], v[36:39]
    ds_read_b128 v[120:123], v17 offset:33792
    s_add_u32 s60, s7, 0
    v_mfma_f32_16x16x32_bf16 v[36:39], a[104:107], v[140:143], v[36:39]
    ds_read_b128 v[100:103], v15 offset:49152
    ds_read_b128 v[108:111], v17 offset:49152
    v_mfma_f32_16x16x32_bf16 v[36:39], a[112:115], v[148:151], v[36:39]
    ds_read_b128 v[116:119], v15 offset:50176
    buffer_load_dwordx4 v11, s[36:39], s60 offen offset:0 lds
    v_mfma_f32_16x16x32_bf16 v[36:39], a[120:123], v[156:159], v[36:39]
    ds_read_b128 v[124:127], v17 offset:50176
    v_mfma_f32_16x16x32_bf16 v[48:51], a[100:103], v[128:131], v[48:51]
    v_mfma_f32_16x16x32_bf16 v[48:51], a[108:111], v[136:139], v[48:51]
    buffer_load_dwordx4 v12, s[36:39], s60 offen offset:1032 lds
    v_mfma_f32_16x16x32_bf16 v[48:51], a[116:119], v[144:147], v[48:51]
    v_mfma_f32_16x16x32_bf16 v[48:51], a[124:127], v[152:155], v[48:51]
    v_mfma_f32_16x16x32_bf16 v[52:55], a[100:103], v[132:135], v[52:55]
    buffer_load_dwordx4 v13, s[36:39], s60 offen offset:2064 lds
    v_mfma_f32_16x16x32_bf16 v[52:55], a[108:111], v[140:143], v[52:55]
    v_mfma_f32_16x16x32_bf16 v[52:55], a[116:119], v[148:151], v[52:55]
    v_mfma_f32_16x16x32_bf16 v[52:55], a[124:127], v[156:159], v[52:55]
    buffer_load_dwordx4 v14, s[36:39], s60 offen offset:3096 lds
    s_waitcnt lgkmcnt(0)
    v_mfma_f32_16x16x32_bf16 v[40:43], a[0:3], v[96:99], v[224:227]
    ds_read_b128 v[128:131], v15 offset:34816
    s_add_u32 s7, s7, 0x40000
    v_mfma_f32_16x16x32_bf16 v[40:43], a[8:11], v[104:107], v[40:43]
    s_cmp_eq_u32 s7, 1835008
    s_cselect_b32 s7, 0, s7
    s_add_u32 m0, s63, 8256
    v_mfma_f32_16x16x32_bf16 v[40:43], a[16:19], v[112:115], v[40:43]
    ds_read_b128 v[136:139], v17 offset:34816
    s_add_u32 s60, s7, 0
    v_mfma_f32_16x16x32_bf16 v[40:43], a[24:27], v[120:123], v[40:43]
    ds_read_b128 v[144:147], v15 offset:35840
    ds_read_b128 v[152:155], v17 offset:35840
    v_mfma_f32_16x16x32_bf16 v[44:47], a[0:3], v[100:103], v[224:227]
    ds_read_b128 v[132:135], v15 offset:51200
    v_pk_fma_f32 v[240:241], v[32:33], v[32:33], v[26:27] op_sel_hi:[1,1,0]
    v_pk_fma_f32 v[242:243], v[34:35], v[34:35], v[26:27] op_sel_hi:[1,1,0]
    v_pk_fma_f32 v[244:245], v[48:49], v[48:49], v[26:27] op_sel_hi:[1,1,0]
    v_pk_fma_f32 v[246:247], v[50:51], v[50:51], v[26:27] op_sel_hi:[1,1,0]
    v_pk_fma_f32 v[248:249], v[36:37], v[36:37], v[26:27] op_sel_hi:[1,1,0]
    v_pk_fma_f32 v[250:251], v[38:39], v[38:39], v[26:27] op_sel_hi:[1,1,0]
    v_pk_fma_f32 v[252:253], v[52:53], v[52:53], v[26:27] op_sel_hi:[1,1,0]
    v_pk_fma_f32 v[254:255], v[54:55], v[54:55], v[26:27] op_sel_hi:[1,1,0]
    v_pk_mul_f32 v[240:241], v[32:33], v[240:241] neg_lo:[1,0] neg_hi:[1,0]
    v_pk_mul_f32 v[242:243], v[34:35], v[242:243] neg_lo:[1,0] neg_hi:[1,0]
    v_pk_mul_f32 v[244:245], v[48:49], v[244:245] neg_lo:[1,0] neg_hi:[1,0]
    v_pk_mul_f32 v[246:247], v[50:51], v[246:247] neg_lo:[1,0] neg_hi:[1,0]
    v_pk_mul_f32 v[248:249], v[36:37], v[248:249] neg_lo:[1,0] neg_hi:[1,0]
    v_pk_mul_f32 v[250:251], v[38:39], v[250:251] neg_lo:[1,0] neg_hi:[1,0]
    v_pk_mul_f32 v[252:253], v[52:53], v[252:253] neg_lo:[1,0] neg_hi:[1,0]
    v_pk_mul_f32 v[254:255], v[54:55], v[254:255] neg_lo:[1,0] neg_hi:[1,0]
    v_mfma_f32_16x16x32_bf16 v[44:47], a[8:11], v[108:111], v[44:47]
    buffer_load_dwordx4 v11, s[36:39], s60 offen offset:0 lds
    v_exp_f32 v240, v240
    v_mfma_f32_16x16x32_bf16 v[44:47], a[16:19], v[116:119], v[44:47]
    ds_read_b128 v[140:143], v17 offset:51200
    s_waitcnt vmcnt(9)
    ds_read_b64_tr_b16 v[192:193], v20 offset:0
    v_exp_f32 v241, v241
    v_mfma_f32_16x16x32_bf16 v[44:47], a[24:27], v[124:127], v[44:47]
    ds_read_b128 v[148:151], v15 offset:52224
    ds_read_b64_tr_b16 v[194:195], v20 offset:256
    ds_read_b64_tr_b16 v[196:197], v20 offset:8
    v_exp_f32 v242, v242
    v_mfma_f32_16x16x32_bf16 v[56:59], a[4:7], v[96:99], v[228:231]
    ds_read_b128 v[156:159], v17 offset:52224
    buffer_load_dwordx4 v12, s[36:39], s60 offen offset:1032 lds
    ds_read_b64_tr_b16 v[198:199], v20 offset:264
    ds_read_b64_tr_b16 v[200:201], v20 offset:512
    v_exp_f32 v243, v243
    v_mfma_f32_16x16x32_bf16 v[56:59], a[12:15], v[104:107], v[56:59]
    ds_read_b64_tr_b16 v[202:203], v20 offset:768
    ds_read_b64_tr_b16 v[204:205], v20 offset:520
    v_exp_f32 v244, v244
    v_mfma_f32_16x16x32_bf16 v[56:59], a[20:23], v[112:115], v[56:59]
    ds_read_b64_tr_b16 v[206:207], v20 offset:776
    v_exp_f32 v245, v245
    v_mfma_f32_16x16x32_bf16 v[56:59], a[28:31], v[120:123], v[56:59]
    buffer_load_dwordx4 v13, s[36:39], s60 offen offset:2064 lds
    v_exp_f32 v246, v246
    v_mfma_f32_16x16x32_bf16 v[60:63], a[4:7], v[100:103], v[228:231]
    v_exp_f32 v247, v247
    v_mfma_f32_16x16x32_bf16 v[60:63], a[12:15], v[108:111], v[60:63]
    buffer_load_dwordx4 v14, s[36:39], s60 offen offset:3096 lds
    v_exp_f32 v248, v248
    v_mfma_f32_16x16x32_bf16 v[60:63], a[20:23], v[116:119], v[60:63]
    v_exp_f32 v249, v249
    s_add_u32 s7, s7, 0x40000
    v_mfma_f32_16x16x32_bf16 v[60:63], a[28:31], v[124:127], v[60:63]
    s_cmp_eq_u32 s7, 1835008
    s_cselect_b32 s7, 0, s7
    v_exp_f32 v250, v250
    s_waitcnt lgkmcnt(1)
    v_mfma_f32_16x16x32_bf16 v[40:43], a[32:35], v[128:131], v[40:43]
    v_exp_f32 v251, v251
    s_add_u32 m0, s63, 12384
    v_mfma_f32_16x16x32_bf16 v[40:43], a[40:43], v[136:139], v[40:43]
    ds_read_b128 v[96:99], v15 offset:36864
    v_exp_f32 v252, v252
    v_mfma_f32_16x16x32_bf16 v[40:43], a[48:51], v[144:147], v[40:43]
    ds_read_b128 v[104:107], v17 offset:36864
    s_add_u32 s60, s7, 0
    v_exp_f32 v253, v253
    v_mfma_f32_16x16x32_bf16 v[40:43], a[56:59], v[152:155], v[40:43]
    ds_read_b128 v[112:115], v15 offset:37888
    buffer_load_dwordx4 v11, s[36:39], s60 offen offset:0 lds
    v_exp_f32 v254, v254
    v_mfma_f32_16x16x32_bf16 v[44:47], a[32:35], v[132:135], v[44:47]
    ds_read_b128 v[120:123], v17 offset:37888
    s_waitcnt vmcnt(9)
    ds_read_b64_tr_b16 v[208:209], v9 offset:0
    v_exp_f32 v255, v255
    v_mfma_f32_16x16x32_bf16 v[44:47], a[40:43], v[140:143], v[44:47]
    ds_read_b128 v[100:103], v15 offset:53248
    ds_read_b64_tr_b16 v[210:211], v9 offset:256
    ds_read_b64_tr_b16 v[212:213], v9 offset:8
    v_mfma_f32_16x16x32_bf16 v[44:47], a[48:51], v[148:151], v[44:47]
    ds_read_b128 v[108:111], v17 offset:53248
    buffer_load_dwordx4 v12, s[36:39], s60 offen offset:1032 lds
    ds_read_b64_tr_b16 v[214:215], v9 offset:264
    ds_read_b64_tr_b16 v[216:217], v9 offset:512
    v_pk_fma_f32 v[240:241], v[240:241], s[92:93], s[92:93] op_sel_hi:[1,0,0]
    v_pk_fma_f32 v[242:243], v[242:243], s[92:93], s[92:93] op_sel_hi:[1,0,0]
    v_pk_fma_f32 v[244:245], v[244:245], s[92:93], s[92:93] op_sel_hi:[1,0,0]
    v_pk_fma_f32 v[246:247], v[246:247], s[92:93], s[92:93] op_sel_hi:[1,0,0]
    v_pk_fma_f32 v[248:249], v[248:249], s[92:93], s[92:93] op_sel_hi:[1,0,0]
    v_pk_fma_f32 v[250:251], v[250:251], s[92:93], s[92:93] op_sel_hi:[1,0,0]
    v_pk_fma_f32 v[252:253], v[252:253], s[92:93], s[92:93] op_sel_hi:[1,0,0]
    v_pk_fma_f32 v[254:255], v[254:255], s[92:93], s[92:93] op_sel_hi:[1,0,0]
    v_mfma_f32_16x16x32_bf16 v[44:47], a[56:59], v[156:159], v[44:47]
    ds_read_b128 v[116:119], v15 offset:54272
    ds_read_b64_tr_b16 v[218:219], v9 offset:768
    ds_read_b64_tr_b16 v[220:221], v9 offset:520
    v_rcp_f32 v240, v240
    v_mfma_f32_16x16x32_bf16 v[56:59], a[36:39], v[128:131], v[56:59]
    ds_read_b128 v[124:127], v17 offset:54272
    ds_read_b64_tr_b16 v[222:223], v9 offset:776
    v_rcp_f32 v241, v241
    v_mfma_f32_16x16x32_bf16 v[56:59], a[44:47], v[136:139], v[56:59]
    buffer_load_dwordx4 v13, s[36:39], s60 offen offset:2064 lds
    v_rcp_f32 v242, v242
    v_mfma_f32_16x16x32_bf16 v[56:59], a[52:55], v[144:147], v[56:59]
    v_rcp_f32 v243, v243
    v_mfma_f32_16x16x32_bf16 v[56:59], a[60:63], v[152:155], v[56:59]
    buffer_load_dwordx4 v14, s[36:39], s60 offen offset:3096 lds
    v_rcp_f32 v244, v244
    v_mfma_f32_16x16x32_bf16 v[60:63], a[36:39], v[132:135], v[60:63]
    v_rcp_f32 v245, v245
    s_add_u32 s7, s7, 0x40000
    v_mfma_f32_16x16x32_bf16 v[60:63], a[44:47], v[140:143], v[60:63]
    s_cmp_eq_u32 s7, 1835008
    s_cselect_b32 s7, 0, s7
    v_rcp_f32 v246, v246
    v_mfma_f32_16x16x32_bf16 v[60:63], a[52:55], v[148:151], v[60:63]
    v_rcp_f32 v247, v247
    s_mov_b32 m0, s6
    v_mfma_f32_16x16x32_bf16 v[60:63], a[60:63], v[156:159], v[60:63]
    v_rcp_f32 v248, v248
    s_waitcnt lgkmcnt(0)
    v_mfma_f32_16x16x32_bf16 v[40:43], a[64:67], v[96:99], v[40:43]
    s_add_u32 s60, s7, 32768
    v_rcp_f32 v249, v249
    v_mfma_f32_16x16x32_bf16 v[40:43], a[72:75], v[104:107], v[40:43]
    ds_read_b128 v[128:131], v15 offset:38912
    buffer_load_dwordx4 v11, s[36:39], s60 offen offset:0 lds
    v_rcp_f32 v250, v250
    v_mfma_f32_16x16x32_bf16 v[40:43], a[80:83], v[112:115], v[40:43]
    ds_read_b128 v[136:139], v17 offset:38912
    s_waitcnt vmcnt(9)
    ds_read_b64_tr_b16 a[0:1], v9 offset:4128
    v_rcp_f32 v251, v251
    v_mfma_f32_16x16x32_bf16 v[40:43], a[88:91], v[120:123], v[40:43]
    ds_read_b128 v[144:147], v15 offset:39936
    ds_read_b64_tr_b16 a[2:3], v9 offset:4384
    ds_read_b64_tr_b16 a[4:5], v9 offset:4136
    v_rcp_f32 v252, v252
    v_mfma_f32_16x16x32_bf16 v[44:47], a[64:67], v[100:103], v[44:47]
    ds_read_b128 v[152:155], v17 offset:39936
    buffer_load_dwordx4 v12, s[36:39], s60 offen offset:1032 lds
    ds_read_b64_tr_b16 a[6:7], v9 offset:4392
    ds_read_b64_tr_b16 a[8:9], v9 offset:4640
    v_rcp_f32 v253, v253
    v_mfma_f32_16x16x32_bf16 v[44:47], a[72:75], v[108:111], v[44:47]
    ds_read_b128 v[132:135], v15 offset:55296
    ds_read_b64_tr_b16 a[10:11], v9 offset:4896
    ds_read_b64_tr_b16 a[12:13], v9 offset:4648
    v_rcp_f32 v254, v254
    v_mfma_f32_16x16x32_bf16 v[44:47], a[80:83], v[116:119], v[44:47]
    ds_read_b128 v[140:143], v17 offset:55296
    ds_read_b64_tr_b16 a[14:15], v9 offset:4904
    v_rcp_f32 v255, v255
    v_mfma_f32_16x16x32_bf16 v[44:47], a[88:91], v[124:127], v[44:47]
    ds_read_b128 v[148:151], v15 offset:56320
    buffer_load_dwordx4 v13, s[36:39], s60 offen offset:2064 lds
    v_mfma_f32_16x16x32_bf16 v[56:59], a[68:71], v[96:99], v[56:59]
    ds_read_b128 v[156:159], v17 offset:56320
    v_pk_mul_f32 v[32:33], v[32:33], v[240:241]
    v_pk_mul_f32 v[34:35], v[34:35], v[242:243]
    v_pk_mul_f32 v[48:49], v[48:49], v[244:245]
    v_pk_mul_f32 v[50:51], v[50:51], v[246:247]
    v_pk_mul_f32 v[36:37], v[36:37], v[248:249]
    v_pk_mul_f32 v[38:39], v[38:39], v[250:251]
    v_pk_mul_f32 v[52:53], v[52:53], v[252:253]
    v_pk_mul_f32 v[54:55], v[54:55], v[254:255]
    v_cvt_pk_bf16_f32 v32, v32, v33
    v_cvt_pk_bf16_f32 v33, v34, v35
    v_cvt_pk_bf16_f32 v34, v48, v49
    v_cvt_pk_bf16_f32 v35, v50, v51
    v_min_u32 v32, -2, v32
    v_cvt_pk_bf16_f32 v36, v36, v37
    v_cvt_pk_bf16_f32 v37, v38, v39
    v_cvt_pk_bf16_f32 v38, v52, v53
    v_cvt_pk_bf16_f32 v39, v54, v55
    v_min_u32 v36, -2, v36
    v_mfma_f32_16x16x32_bf16 v[56:59], a[76:79], v[104:107], v[56:59]
    buffer_store_dwordx4 v[32:35], v16, s[48:51], s94 offen offset:0 sc1
    buffer_load_dwordx4 v14, s[36:39], s60 offen offset:3096 lds
    v_mfma_f32_16x16x32_bf16 v[56:59], a[84:87], v[112:115], v[56:59]
    s_add_u32 s7, s7, 0x40000
    s_cmp_eq_u32 s7, 1835008
    s_cselect_b32 s7, 0, s7
    v_mfma_f32_16x16x32_bf16 v[56:59], a[92:95], v[120:123], v[56:59]
    buffer_store_dwordx4 v[36:39], v16, s[48:51], s94 offen offset:1024 sc1
    s_add_u32 m0, s63, 0
    v_mfma_f32_16x16x32_bf16 v[60:63], a[68:71], v[100:103], v[60:63]
    s_add_u32 s60, s7, 32768
    v_mfma_f32_16x16x32_bf16 v[60:63], a[76:79], v[108:111], v[60:63]
    v_mfma_f32_16x16x32_bf16 v[60:63], a[84:87], v[116:119], v[60:63]
    buffer_load_dwordx4 v11, s[36:39], s60 offen offset:0 lds
    v_mfma_f32_16x16x32_bf16 v[60:63], a[92:95], v[124:127], v[60:63]
    s_waitcnt lgkmcnt(0)
    v_mfma_f32_16x16x32_bf16 v[40:43], a[96:99], v[128:131], v[40:43]
    s_waitcnt vmcnt(11)
    ds_read_b64_tr_b16 a[16:17], v9 offset:8256
    ds_read_b128 v[96:99], v15 offset:0
    v_mfma_f32_16x16x32_bf16 v[40:43], a[104:107], v[136:139], v[40:43]
    ds_read_b64_tr_b16 a[18:19], v9 offset:8512
    ds_read_b64_tr_b16 a[20:21], v9 offset:8264
    v_mfma_f32_16x16x32_bf16 v[40:43], a[112:115], v[144:147], v[40:43]
    ds_read_b128 v[104:107], v17 offset:0
    buffer_load_dwordx4 v12, s[36:39], s60 offen offset:1032 lds
    ds_read_b64_tr_b16 a[22:23], v9 offset:8520
    ds_read_b64_tr_b16 a[24:25], v9 offset:8768
    v_mfma_f32_16x16x32_bf16 v[40:43], a[120:123], v[152:155], v[40:43]
    ds_read_b128 v[112:115], v15 offset:1024
    ds_read_b64_tr_b16 a[26:27], v9 offset:9024
    ds_read_b64_tr_b16 a[28:29], v9 offset:8776
    v_mfma_f32_16x16x32_bf16 v[44:47], a[96:99], v[132:135], v[44:47]
    ds_read_b128 v[120:123], v17 offset:1024
    ds_read_b64_tr_b16 a[30:31], v9 offset:9032
    v_mfma_f32_16x16x32_bf16 v[44:47], a[104:107], v[140:143], v[44:47]
    ds_read_b128 v[100:103], v15 offset:16384
    buffer_load_dwordx4 v13, s[36:39], s60 offen offset:2064 lds
    v_mfma_f32_16x16x32_bf16 v[44:47], a[112:115], v[148:151], v[44:47]
    ds_read_b128 v[108:111], v17 offset:16384
    ds_read_b128 v[116:119], v15 offset:17408
    v_mfma_f32_16x16x32_bf16 v[44:47], a[120:123], v[156:159], v[44:47]
    ds_read_b128 v[124:127], v17 offset:17408
    buffer_load_dwordx4 v14, s[36:39], s60 offen offset:3096 lds
    v_mfma_f32_16x16x32_bf16 v[56:59], a[100:103], v[128:131], v[56:59]
    s_add_u32 s7, s7, 0x40000
    s_cmp_eq_u32 s7, 1835008
    s_cselect_b32 s7, 0, s7
    v_mfma_f32_16x16x32_bf16 v[56:59], a[108:111], v[136:139], v[56:59]
    s_add_u32 m0, s63, 4128
    s_add_u32 s60, s7, 32768
    v_mfma_f32_16x16x32_bf16 v[56:59], a[116:119], v[144:147], v[56:59]
    v_mfma_f32_16x16x32_bf16 v[56:59], a[124:127], v[152:155], v[56:59]
    v_mfma_f32_16x16x32_bf16 v[60:63], a[100:103], v[132:135], v[60:63]
    buffer_load_dwordx4 v11, s[36:39], s60 offen offset:0 lds
    v_mfma_f32_16x16x32_bf16 v[60:63], a[108:111], v[140:143], v[60:63]
    v_mfma_f32_16x16x32_bf16 v[60:63], a[116:119], v[148:151], v[60:63]
    s_waitcnt vmcnt(11)
    ds_read_b64_tr_b16 a[32:33], v9 offset:12384
    ds_read_b64_tr_b16 a[34:35], v9 offset:12640
    v_mfma_f32_16x16x32_bf16 v[60:63], a[124:127], v[156:159], v[60:63]
    ds_read_b64_tr_b16 a[36:37], v9 offset:12392
    s_waitcnt lgkmcnt(3)
    v_mfma_f32_16x16x32_bf16 v[64:67], a[128:131], v[96:99], v[232:235]
    buffer_load_dwordx4 v12, s[36:39], s60 offen offset:1032 lds
    ds_read_b64_tr_b16 a[38:39], v9 offset:12648
    ds_read_b64_tr_b16 a[40:41], v9 offset:12896
    v_mfma_f32_16x16x32_bf16 v[64:67], a[136:139], v[104:107], v[64:67]
    ds_read_b128 v[128:131], v15 offset:2048
    ds_read_b64_tr_b16 a[42:43], v9 offset:13152
    ds_read_b64_tr_b16 a[44:45], v9 offset:12904
    v_mfma_f32_16x16x32_bf16 v[64:67], a[144:147], v[112:115], v[64:67]
    ds_read_b128 v[136:139], v17 offset:2048
    ds_read_b64_tr_b16 a[46:47], v9 offset:13160
    v_mfma_f32_16x16x32_bf16 v[64:67], a[152:155], v[120:123], v[64:67]
    ds_read_b128 v[144:147], v15 offset:3072
    buffer_load_dwordx4 v13, s[36:39], s60 offen offset:2064 lds
    v_mfma_f32_16x16x32_bf16 v[68:71], a[128:131], v[100:103], v[232:235]
    ds_read_b128 v[152:155], v17 offset:3072
    v_pk_fma_f32 v[240:241], v[40:41], v[40:41], v[26:27] op_sel_hi:[1,1,0]
    v_pk_fma_f32 v[242:243], v[42:43], v[42:43], v[26:27] op_sel_hi:[1,1,0]
    v_pk_fma_f32 v[244:245], v[56:57], v[56:57], v[26:27] op_sel_hi:[1,1,0]
    v_pk_fma_f32 v[246:247], v[58:59], v[58:59], v[26:27] op_sel_hi:[1,1,0]
    v_pk_fma_f32 v[248:249], v[44:45], v[44:45], v[26:27] op_sel_hi:[1,1,0]
    v_pk_fma_f32 v[250:251], v[46:47], v[46:47], v[26:27] op_sel_hi:[1,1,0]
    v_pk_fma_f32 v[252:253], v[60:61], v[60:61], v[26:27] op_sel_hi:[1,1,0]
    v_pk_fma_f32 v[254:255], v[62:63], v[62:63], v[26:27] op_sel_hi:[1,1,0]
    v_pk_mul_f32 v[240:241], v[40:41], v[240:241] neg_lo:[1,0] neg_hi:[1,0]
    v_pk_mul_f32 v[242:243], v[42:43], v[242:243] neg_lo:[1,0] neg_hi:[1,0]
    v_pk_mul_f32 v[244:245], v[56:57], v[244:245] neg_lo:[1,0] neg_hi:[1,0]
    v_pk_mul_f32 v[246:247], v[58:59], v[246:247] neg_lo:[1,0] neg_hi:[1,0]
    v_pk_mul_f32 v[248:249], v[44:45], v[248:249] neg_lo:[1,0] neg_hi:[1,0]
    v_pk_mul_f32 v[250:251], v[46:47], v[250:251] neg_lo:[1,0] neg_hi:[1,0]
    v_pk_mul_f32 v[252:253], v[60:61], v[252:253] neg_lo:[1,0] neg_hi:[1,0]
    v_pk_mul_f32 v[254:255], v[62:63], v[254:255] neg_lo:[1,0] neg_hi:[1,0]
    v_mfma_f32_16x16x32_bf16 v[68:71], a[136:139], v[108:111], v[68:71]
    ds_read_b128 v[132:135], v15 offset:18432
    v_exp_f32 v240, v240
    v_mfma_f32_16x16x32_bf16 v[68:71], a[144:147], v[116:119], v[68:71]
    ds_read_b128 v[140:143], v17 offset:18432
    buffer_load_dwordx4 v14, s[36:39], s60 offen offset:3096 lds
    v_exp_f32 v241, v241
    v_mfma_f32_16x16x32_bf16 v[68:71], a[152:155], v[124:127], v[68:71]
    ds_read_b128 v[148:151], v15 offset:19456
    s_add_u32 s7, s7, 0x40000
    s_cmp_eq_u32 s7, 1835008
    s_cselect_b32 s7, 0, s7
    v_exp_f32 v242, v242
    v_mfma_f32_16x16x32_bf16 v[80:83], a[132:135], v[96:99], v[236:239]
    ds_read_b128 v[156:159], v17 offset:19456
    v_exp_f32 v243, v243
    v_mfma_f32_16x16x32_bf16 v[80:83], a[140:143], v[104:107], v[80:83]
    v_exp_f32 v244, v244
    s_add_u32 m0, s63, 8256
    v_mfma_f32_16x16x32_bf16 v[80:83], a[148:151], v[112:115], v[80:83]
    s_add_u32 s60, s7, 32768
    v_exp_f32 v245, v245
    v_mfma_f32_16x16x32_bf16 v[80:83], a[156:159], v[120:123], v[80:83]
    buffer_load_dwordx4 v11, s[36:39], s60 offen offset:0 lds
    v_exp_f32 v246, v246
    v_mfma_f32_16x16x32_bf16 v[84:87], a[132:135], v[100:103], v[236:239]
    s_waitcnt vmcnt(10)
    ds_read_b64_tr_b16 a[48:49], v20 offset:0
    v_exp_f32 v247, v247
    v_mfma_f32_16x16x32_bf16 v[84:87], a[140:143], v[108:111], v[84:87]
    ds_read_b64_tr_b16 a[50:51], v20 offset:256
    ds_read_b64_tr_b16 a[52:53], v20 offset:8
    v_exp_f32 v248, v248
    v_mfma_f32_16x16x32_bf16 v[84:87], a[148:151], v[116:119], v[84:87]
    buffer_load_dwordx4 v12, s[36:39], s60 offen offset:1032 lds
    ds_read_b64_tr_b16 a[54:55], v20 offset:264
    ds_read_b64_tr_b16 a[56:57], v20 offset:512
    v_exp_f32 v249, v249
    v_mfma_f32_16x16x32_bf16 v[84:87], a[156:159], v[124:127], v[84:87]
    ds_read_b64_tr_b16 a[58:59], v20 offset:768
    ds_read_b64_tr_b16 a[60:61], v20 offset:520
    v_exp_f32 v250, v250
    s_waitcnt lgkmcnt(7)
    v_mfma_f32_16x16x32_bf16 v[64:67], a[160:163], v[128:131], v[64:67]
    ds_read_b64_tr_b16 a[62:63], v20 offset:776
    v_exp_f32 v251, v251
    v_mfma_f32_16x16x32_bf16 v[64:67], a[168:171], v[136:139], v[64:67]
    ds_read_b128 v[96:99], v15 offset:4096
    buffer_load_dwordx4 v13, s[36:39], s60 offen offset:2064 lds
    v_exp_f32 v252, v252
    v_mfma_f32_16x16x32_bf16 v[64:67], a[176:179], v[144:147], v[64:67]
    ds_read_b128 v[104:107], v17 offset:4096
    v_exp_f32 v253, v253
    v_mfma_f32_16x16x32_bf16 v[64:67], a[184:187], v[152:155], v[64:67]
    ds_read_b128 v[112:115], v15 offset:5120
    v_exp_f32 v254, v254
    v_mfma_f32_16x16x32_bf16 v[68:71], a[160:163], v[132:135], v[68:71]
    ds_read_b128 v[120:123], v17 offset:5120
    buffer_load_dwordx4 v14, s[36:39], s60 offen offset:3096 lds
L_stub14:
    s_cbranch_execz L_stub18
    v_exp_f32 v255, v255
    v_mfma_f32_16x16x32_bf16 v[68:71], a[168:171], v[140:143], v[68:71]
    ds_read_b128 v[100:103], v15 offset:20480
    s_add_u32 s7, s7, 0x40000
    s_cmp_eq_u32 s7, 1835008
    s_cselect_b32 s7, 0, s7
    v_mfma_f32_16x16x32_bf16 v[68:71], a[176:179], v[148:151], v[68:71]
    ds_read_b128 v[108:111], v17 offset:20480
    v_pk_fma_f32 v[240:241], v[240:241], s[92:93], s[92:93] op_sel_hi:[1,0,0]
    v_pk_fma_f32 v[242:243], v[242:243], s[92:93], s[92:93] op_sel_hi:[1,0,0]
    v_pk_fma_f32 v[244:245], v[244:245], s[92:93], s[92:93] op_sel_hi:[1,0,0]
    v_pk_fma_f32 v[246:247], v[246:247], s[92:93], s[92:93] op_sel_hi:[1,0,0]
    v_pk_fma_f32 v[248:249], v[248:249], s[92:93], s[92:93] op_sel_hi:[1,0,0]
    v_pk_fma_f32 v[250:251], v[250:251], s[92:93], s[92:93] op_sel_hi:[1,0,0]
    v_pk_fma_f32 v[252:253], v[252:253], s[92:93], s[92:93] op_sel_hi:[1,0,0]
    v_pk_fma_f32 v[254:255], v[254:255], s[92:93], s[92:93] op_sel_hi:[1,0,0]
    s_add_u32 m0, s63, 12384
    v_mfma_f32_16x16x32_bf16 v[68:71], a[184:187], v[156:159], v[68:71]
    ds_read_b128 v[116:119], v15 offset:21504
    v_rcp_f32 v240, v240
    v_mfma_f32_16x16x32_bf16 v[80:83], a[164:167], v[128:131], v[80:83]
    ds_read_b128 v[124:127], v17 offset:21504
    s_add_u32 s60, s7, 32768
    v_rcp_f32 v241, v241
    v_mfma_f32_16x16x32_bf16 v[80:83], a[172:175], v[136:139], v[80:83]
    buffer_load_dwordx4 v11, s[36:39], s60 offen offset:0 lds
    v_rcp_f32 v242, v242
    v_mfma_f32_16x16x32_bf16 v[80:83], a[180:183], v[144:147], v[80:83]
    s_waitcnt vmcnt(9)
    ds_read_b64_tr_b16 a[64:65], v9 offset:0
    v_rcp_f32 v243, v243
    v_mfma_f32_16x16x32_bf16 v[80:83], a[188:191], v[152:155], v[80:83]
    ds_read_b64_tr_b16 a[66:67], v9 offset:256
    ds_read_b64_tr_b16 a[68:69], v9 offset:8
    v_rcp_f32 v244, v244
    v_mfma_f32_16x16x32_bf16 v[84:87], a[164:167], v[132:135], v[84:87]
    buffer_load_dwordx4 v12, s[36:39], s60 offen offset:1032 lds
    ds_read_b64_tr_b16 a[70:71], v9 offset:264
    ds_read_b64_tr_b16 a[72:73], v9 offset:512
    v_rcp_f32 v245, v245
    v_mfma_f32_16x16x32_bf16 v[84:87], a[172:175], v[140:143], v[84:87]
    ds_read_b64_tr_b16 a[74:75], v9 offset:768
    ds_read_b64_tr_b16 a[76:77], v9 offset:520
    v_rcp_f32 v246, v246
    v_mfma_f32_16x16x32_bf16 v[84:87], a[180:183], v[148:151], v[84:87]
    ds_read_b64_tr_b16 a[78:79], v9 offset:776
    v_rcp_f32 v247, v247
    v_mfma_f32_16x16x32_bf16 v[84:87], a[188:191], v[156:159], v[84:87]
    buffer_load_dwordx4 v13, s[36:39], s60 offen offset:2064 lds
    v_rcp_f32 v248, v248
    s_waitcnt lgkmcnt(7)
    v_mfma_f32_16x16x32_bf16 v[64:67], a[192:195], v[96:99], v[64:67]
    ds_read_b128 v[128:131], v15 offset:6144
    v_rcp_f32 v249, v249
    v_mfma_f32_16x16x32_bf16 v[64:67], a[200:203], v[104:107], v[64:67]
    ds_read_b128 v[136:139], v17 offset:6144
    v_rcp_f32 v250, v250
    v_mfma_f32_16x16x32_bf16 v[64:67], a[208:211], v[112:115], v[64:67]
    buffer_load_dwordx4 v14, s[36:39], s60 offen offset:3096 lds
    v_rcp_f32 v251, v251
    v_mfma_f32_16x16x32_bf16 v[64:67], a[216:219], v[120:123], v[64:67]
    ds_read_b128 v[144:147], v15 offset:7168
    s_add_u32 s7, s7, 0x40000
    s_cmp_eq_u32 s7, 1835008
    s_cselect_b32 s7, 0, s7
    v_rcp_f32 v252, v252
    v_mfma_f32_16x16x32_bf16 v[68:71], a[192:195], v[100:103], v[68:71]
    ds_read_b128 v[152:155], v17 offset:7168
    v_rcp_f32 v253, v253
    v_mfma_f32_16x16x32_bf16 v[68:71], a[200:203], v[108:111], v[68:71]
    ds_read_b128 v[132:135], v15 offset:22528
    v_rcp_f32 v254, v254
    v_mfma_f32_16x16x32_bf16 v[68:71], a[208:211], v[116:119], v[68:71]
    ds_read_b128 v[140:143], v17 offset:22528
    s_mov_b32 m0, s6
    s_add_u32 s60, s7, 32768
    v_rcp_f32 v255, v255
    v_mfma_f32_16x16x32_bf16 v[68:71], a[216:219], v[124:127], v[68:71]
    ds_read_b128 v[148:151], v15 offset:23552
    buffer_load_dwordx4 v11, s[36:39], s60 offen offset:0 lds
    v_mfma_f32_16x16x32_bf16 v[80:83], a[196:199], v[96:99], v[80:83]
    ds_read_b128 v[156:159], v17 offset:23552
    v_pk_mul_f32 v[40:41], v[40:41], v[240:241]
    v_pk_mul_f32 v[42:43], v[42:43], v[242:243]
    v_pk_mul_f32 v[56:57], v[56:57], v[244:245]
    v_pk_mul_f32 v[58:59], v[58:59], v[246:247]
    v_pk_mul_f32 v[44:45], v[44:45], v[248:249]
    v_pk_mul_f32 v[46:47], v[46:47], v[250:251]
    v_pk_mul_f32 v[60:61], v[60:61], v[252:253]
    v_pk_mul_f32 v[62:63], v[62:63], v[254:255]
    v_cvt_pk_bf16_f32 v40, v40, v41
    v_cvt_pk_bf16_f32 v41, v42, v43
    v_cvt_pk_bf16_f32 v42, v56, v57
    v_cvt_pk_bf16_f32 v43, v58, v59
    v_min_u32 v40, -2, v40
    v_cvt_pk_bf16_f32 v44, v44, v45
    v_cvt_pk_bf16_f32 v45, v46, v47
    v_cvt_pk_bf16_f32 v46, v60, v61
    v_cvt_pk_bf16_f32 v47, v62, v63
    v_min_u32 v44, -2, v44
    v_mfma_f32_16x16x32_bf16 v[80:83], a[204:207], v[104:107], v[80:83]
    buffer_store_dwordx4 v[40:43], v16, s[48:51], s94 offen offset:2048 sc1
    buffer_load_dwordx4 v12, s[36:39], s60 offen offset:1032 lds
    v_mfma_f32_16x16x32_bf16 v[80:83], a[212:215], v[112:115], v[80:83]
    v_mfma_f32_16x16x32_bf16 v[80:83], a[220:223], v[120:123], v[80:83]
    buffer_store_dwordx4 v[44:47], v16, s[48:51], s94 offen offset:3072 sc1
    v_mfma_f32_16x16x32_bf16 v[84:87], a[196:199], v[100:103], v[84:87]
    buffer_load_dwordx4 v13, s[36:39], s60 offen offset:2064 lds
    v_mfma_f32_16x16x32_bf16 v[84:87], a[204:207], v[108:111], v[84:87]
    v_mfma_f32_16x16x32_bf16 v[84:87], a[212:215], v[116:119], v[84:87]
    s_add_u32 s10, s1, s8
    buffer_load_dwordx4 a[80:83], v16, s[48:51], s10 offen offset:0 sc1
    v_mfma_f32_16x16x32_bf16 v[84:87], a[220:223], v[124:127], v[84:87]
    buffer_load_dwordx4 v14, s[36:39], s60 offen offset:3096 lds
    s_waitcnt lgkmcnt(0)
    v_mfma_f32_16x16x32_bf16 v[64:67], a[224:227], v[128:131], v[64:67]
    ds_read_b128 v[96:99], v15 offset:32768
    s_add_u32 s7, s7, 0x40000
    v_mfma_f32_16x16x32_bf16 v[64:67], a[232:235], v[136:139], v[64:67]
    s_cmp_eq_u32 s7, 1835008
    s_cselect_b32 s7, 0, s7
    s_add_u32 m0, s63, 0
    v_mfma_f32_16x16x32_bf16 v[64:67], a[240:243], v[144:147], v[64:67]
    ds_read_b128 v[104:107], v17 offset:32768
    s_add_u32 s60, s7, 32768
    v_mfma_f32_16x16x32_bf16 v[64:67], a[248:251], v[152:155], v[64:67]
    ds_read_b128 v[112:115], v15 offset:33792
    ds_read_b128 v[120:123], v17 offset:33792
    v_mfma_f32_16x16x32_bf16 v[68:71], a[224:227], v[132:135], v[68:71]
    ds_read_b128 v[100:103], v15 offset:49152
    buffer_load_dwordx4 v11, s[36:39], s60 offen offset:0 lds
    v_mfma_f32_16x16x32_bf16 v[68:71], a[232:235], v[140:143], v[68:71]
    buffer_load_dwordx4 a[84:87], v16, s[48:51], s10 offen offset:1024 sc1
    ds_read_b128 v[108:111], v17 offset:49152
    v_mfma_f32_16x16x32_bf16 v[68:71], a[240:243], v[148:151], v[68:71]
    ds_read_b128 v[116:119], v15 offset:50176
    s_add_u32 s8, s8, 40960
    v_mfma_f32_16x16x32_bf16 v[68:71], a[248:251], v[156:159], v[68:71]
    ds_read_b128 v[124:127], v17 offset:50176
    s_cmp_eq_u32 s8, 286720
    s_cselect_b32 s8, 0, s8
    v_mfma_f32_16x16x32_bf16 v[80:83], a[228:231], v[128:131], v[80:83]
    buffer_load_dwordx4 v12, s[36:39], s60 offen offset:1032 lds
    s_add_u32 s10, s1, s8
    v_mfma_f32_16x16x32_bf16 v[80:83], a[236:239], v[136:139], v[80:83]
    buffer_load_dwordx4 a[88:91], v16, s[48:51], s10 offen offset:0 sc1
    v_mfma_f32_16x16x32_bf16 v[80:83], a[244:247], v[144:147], v[80:83]
    buffer_load_dwordx4 v13, s[36:39], s60 offen offset:2064 lds
    buffer_load_dwordx4 a[92:95], v16, s[48:51], s10 offen offset:1024 sc1
    v_mfma_f32_16x16x32_bf16 v[80:83], a[252:255], v[152:155], v[80:83]
    v_mfma_f32_16x16x32_bf16 v[84:87], a[228:231], v[132:135], v[84:87]
    v_mfma_f32_16x16x32_bf16 v[84:87], a[236:239], v[140:143], v[84:87]
    buffer_load_dwordx4 v14, s[36:39], s60 offen offset:3096 lds
    s_add_u32 s7, s7, 0x40000
    v_mfma_f32_16x16x32_bf16 v[84:87], a[244:247], v[148:151], v[84:87]
    s_cmp_eq_u32 s7, 1835008
    s_cselect_b32 s7, 0, s7
    s_add_u32 s8, s8, 40960
    v_mfma_f32_16x16x32_bf16 v[84:87], a[252:255], v[156:159], v[84:87]
    s_cmp_eq_u32 s8, 286720
    s_cselect_b32 s8, 0, s8
    s_waitcnt lgkmcnt(0)
    v_mfma_f32_16x16x32_bf16 v[72:75], a[128:131], v[96:99], v[232:235]
    ds_read_b128 v[128:131], v15 offset:34816
    s_add_u32 s10, s1, s8
    v_mfma_f32_16x16x32_bf16 v[72:75], a[136:139], v[104:107], v[72:75]
    buffer_load_dwordx4 a[96:99], v16, s[48:51], s10 offen offset:0 sc1
    ds_read_b128 v[136:139], v17 offset:34816
    v_mfma_f32_16x16x32_bf16 v[72:75], a[144:147], v[112:115], v[72:75]
    ds_read_b128 v[144:147], v15 offset:35840
    buffer_load_dwordx4 a[100:103], v16, s[48:51], s10 offen offset:1024 sc1
    v_mfma_f32_16x16x32_bf16 v[72:75], a[152:155], v[120:123], v[72:75]
    ds_read_b128 v[152:155], v17 offset:35840
    v_mfma_f32_16x16x32_bf16 v[76:79], a[128:131], v[100:103], v[232:235]
    ds_read_b128 v[132:135], v15 offset:51200
    v_pk_fma_f32 v[240:241], v[64:65], v[64:65], v[26:27] op_sel_hi:[1,1,0]
    v_pk_fma_f32 v[242:243], v[66:67], v[66:67], v[26:27] op_sel_hi:[1,1,0]
    v_pk_fma_f32 v[244:245], v[80:81], v[80:81], v[26:27] op_sel_hi:[1,1,0]
    v_pk_fma_f32 v[246:247], v[82:83], v[82:83], v[26:27] op_sel_hi:[1,1,0]
    v_pk_fma_f32 v[248:249], v[68:69], v[68:69], v[26:27] op_sel_hi:[1,1,0]
    v_pk_fma_f32 v[250:251], v[70:71], v[70:71], v[26:27] op_sel_hi:[1,1,0]
    v_pk_fma_f32 v[252:253], v[84:85], v[84:85], v[26:27] op_sel_hi:[1,1,0]
    v_pk_fma_f32 v[254:255], v[86:87], v[86:87], v[26:27] op_sel_hi:[1,1,0]
    v_pk_mul_f32 v[240:241], v[64:65], v[240:241] neg_lo:[1,0] neg_hi:[1,0]
    v_pk_mul_f32 v[242:243], v[66:67], v[242:243] neg_lo:[1,0] neg_hi:[1,0]
    v_pk_mul_f32 v[244:245], v[80:81], v[244:245] neg_lo:[1,0] neg_hi:[1,0]
    v_pk_mul_f32 v[246:247], v[82:83], v[246:247] neg_lo:[1,0] neg_hi:[1,0]
    v_pk_mul_f32 v[248:249], v[68:69], v[248:249] neg_lo:[1,0] neg_hi:[1,0]
    v_pk_mul_f32 v[250:251], v[70:71], v[250:251] neg_lo:[1,0] neg_hi:[1,0]
    v_pk_mul_f32 v[252:253], v[84:85], v[252:253] neg_lo:[1,0] neg_hi:[1,0]
    v_pk_mul_f32 v[254:255], v[86:87], v[254:255] neg_lo:[1,0] neg_hi:[1,0]
    v_mfma_f32_16x16x32_bf16 v[76:79], a[136:139], v[108:111], v[76:79]
    ds_read_b128 v[140:143], v17 offset:51200
    v_exp_f32 v240, v240
    v_mfma_f32_16x16x32_bf16 v[76:79], a[144:147], v[116:119], v[76:79]
    v_exp_f32 v241, v241
    s_add_u32 s8, s8, 40960
    v_mfma_f32_16x16x32_bf16 v[76:79], a[152:155], v[124:127], v[76:79]
    ds_read_b128 v[148:151], v15 offset:52224
    v_exp_f32 v242, v242
    v_mfma_f32_16x16x32_bf16 v[88:91], a[132:135], v[96:99], v[236:239]
    ds_read_b128 v[156:159], v17 offset:52224
    v_exp_f32 v243, v243
    v_mfma_f32_16x16x32_bf16 v[88:91], a[140:143], v[104:107], v[88:91]
    v_exp_f32 v244, v244
    s_cmp_eq_u32 s8, 286720
    s_cselect_b32 s8, 0, s8
    s_add_u32 s10, s1, s8
    buffer_load_dwordx4 a[104:107], v16, s[48:51], s10 offen offset:0 sc1
    v_mfma_f32_16x16x32_bf16 v[88:91], a[148:151], v[112:115], v[88:91]
    buffer_load_dwordx4 a[108:111], v16, s[48:51], s10 offen offset:1024 sc1
    v_exp_f32 v245, v245
    v_mfma_f32_16x16x32_bf16 v[88:91], a[156:159], v[120:123], v[88:91]
    v_exp_f32 v246, v246
    v_mfma_f32_16x16x32_bf16 v[92:95], a[132:135], v[100:103], v[236:239]
    v_exp_f32 v247, v247
    v_mfma_f32_16x16x32_bf16 v[92:95], a[140:143], v[108:111], v[92:95]
    v_exp_f32 v248, v248
    v_mfma_f32_16x16x32_bf16 v[92:95], a[148:151], v[116:119], v[92:95]
    v_exp_f32 v249, v249
    s_add_u32 s8, s8, 40960
    v_mfma_f32_16x16x32_bf16 v[92:95], a[156:159], v[124:127], v[92:95]
    v_exp_f32 v250, v250
    s_waitcnt lgkmcnt(0)
    v_mfma_f32_16x16x32_bf16 v[72:75], a[160:163], v[128:131], v[72:75]
    v_exp_f32 v251, v251
    s_cmp_eq_u32 s8, 286720
    s_cselect_b32 s8, 0, s8
    v_mfma_f32_16x16x32_bf16 v[72:75], a[168:171], v[136:139], v[72:75]
    ds_read_b128 v[96:99], v15 offset:36864
    v_exp_f32 v252, v252
    s_add_u32 s10, s1, s8
    buffer_load_dwordx4 a[112:115], v16, s[48:51], s10 offen offset:0 sc1
    v_mfma_f32_16x16x32_bf16 v[72:75], a[176:179], v[144:147], v[72:75]
    ds_read_b128 v[104:107], v17 offset:36864
    v_exp_f32 v253, v253
    v_mfma_f32_16x16x32_bf16 v[72:75], a[184:187], v[152:155], v[72:75]
    ds_read_b128 v[112:115], v15 offset:37888
    v_exp_f32 v254, v254
    v_mfma_f32_16x16x32_bf16 v[76:79], a[160:163], v[132:135], v[76:79]
    ds_read_b128 v[120:123], v17 offset:37888
    v_exp_f32 v255, v255
    v_mfma_f32_16x16x32_bf16 v[76:79], a[168:171], v[140:143], v[76:79]
    ds_read_b128 v[100:103], v15 offset:53248
    buffer_load_dwordx4 a[116:119], v16, s[48:51], s10 offen offset:1024 sc1
    ds_read_b128 v[108:111], v17 offset:53248
    v_mfma_f32_16x16x32_bf16 v[76:79], a[176:179], v[148:151], v[76:79]
    v_pk_fma_f32 v[240:241], v[240:241], s[92:93], s[92:93] op_sel_hi:[1,0,0]
    v_pk_fma_f32 v[242:243], v[242:243], s[92:93], s[92:93] op_sel_hi:[1,0,0]
    v_pk_fma_f32 v[244:245], v[244:245], s[92:93], s[92:93] op_sel_hi:[1,0,0]
    v_pk_fma_f32 v[246:247], v[246:247], s[92:93], s[92:93] op_sel_hi:[1,0,0]
    v_pk_fma_f32 v[248:249], v[248:249], s[92:93], s[92:93] op_sel_hi:[1,0,0]
    v_pk_fma_f32 v[250:251], v[250:251], s[92:93], s[92:93] op_sel_hi:[1,0,0]
    v_pk_fma_f32 v[252:253], v[252:253], s[92:93], s[92:93] op_sel_hi:[1,0,0]
    v_pk_fma_f32 v[254:255], v[254:255], s[92:93], s[92:93] op_sel_hi:[1,0,0]
    s_add_u32 s8, s8, 40960
    s_cmp_eq_u32 s8, 286720
    s_cselect_b32 s8, 0, s8
    v_mfma_f32_16x16x32_bf16 v[76:79], a[184:187], v[156:159], v[76:79]
    ds_read_b128 v[116:119], v15 offset:54272
    v_rcp_f32 v240, v240
    v_mfma_f32_16x16x32_bf16 v[88:91], a[164:167], v[128:131], v[88:91]
    ds_read_b128 v[124:127], v17 offset:54272
    v_rcp_f32 v241, v241
    v_mfma_f32_16x16x32_bf16 v[88:91], a[172:175], v[136:139], v[88:91]
    v_rcp_f32 v242, v242
    s_add_u32 s10, s1, s8
    buffer_load_dwordx4 a[120:123], v16, s[48:51], s10 offen offset:0 sc1
    v_mfma_f32_16x16x32_bf16 v[88:91], a[180:183], v[144:147], v[88:91]
    buffer_load_dwordx4 a[124:127], v16, s[48:51], s10 offen offset:1024 sc1
    v_rcp_f32 v243, v243
    v_mfma_f32_16x16x32_bf16 v[88:91], a[188:191], v[152:155], v[88:91]
    v_rcp_f32 v244, v244
    v_mfma_f32_16x16x32_bf16 v[92:95], a[164:167], v[132:135], v[92:95]
    v_rcp_f32 v245, v245
    v_mfma_f32_16x16x32_bf16 v[92:95], a[172:175], v[140:143], v[92:95]
    v_rcp_f32 v246, v246
    v_mfma_f32_16x16x32_bf16 v[92:95], a[180:183], v[148:151], v[92:95]
    v_rcp_f32 v247, v247
    s_add_u32 s8, s8, 40960
    v_mfma_f32_16x16x32_bf16 v[92:95], a[188:191], v[156:159], v[92:95]
    v_rcp_f32 v248, v248
    s_waitcnt lgkmcnt(0)
    v_mfma_f32_16x16x32_bf16 v[72:75], a[192:195], v[96:99], v[72:75]
    v_rcp_f32 v249, v249
    s_cmp_eq_u32 s8, 286720
    s_cselect_b32 s8, 0, s8
    v_mfma_f32_16x16x32_bf16 v[72:75], a[200:203], v[104:107], v[72:75]
    ds_read_b128 v[128:131], v15 offset:38912
    v_rcp_f32 v250, v250
    s_add_u32 s10, s1, s8
    buffer_load_dwordx4 v[224:227], v16, s[48:51], s10 offen offset:0 sc1
    v_mfma_f32_16x16x32_bf16 v[72:75], a[208:211], v[112:115], v[72:75]
    ds_read_b128 v[136:139], v17 offset:38912
    v_rcp_f32 v251, v251
    v_mfma_f32_16x16x32_bf16 v[72:75], a[216:219], v[120:123], v[72:75]
    ds_read_b128 v[144:147], v15 offset:39936
    v_rcp_f32 v252, v252
    v_mfma_f32_16x16x32_bf16 v[76:79], a[192:195], v[100:103], v[76:79]
    ds_read_b128 v[152:155], v17 offset:39936
    v_rcp_f32 v253, v253
    v_mfma_f32_16x16x32_bf16 v[76:79], a[200:203], v[108:111], v[76:79]
    ds_read_b128 v[132:135], v15 offset:55296
    buffer_load_dwordx4 v[228:231], v16, s[48:51], s10 offen offset:1024 sc1
    v_rcp_f32 v254, v254
    v_mfma_f32_16x16x32_bf16 v[76:79], a[208:211], v[116:119], v[76:79]
    ds_read_b128 v[140:143], v17 offset:55296
    v_rcp_f32 v255, v255
    v_mfma_f32_16x16x32_bf16 v[76:79], a[216:219], v[124:127], v[76:79]
    ds_read_b128 v[148:151], v15 offset:56320
    s_add_u32 s8, s8, 40960
    v_mfma_f32_16x16x32_bf16 v[88:91], a[196:199], v[96:99], v[88:91]
    ds_read_b128 v[156:159], v17 offset:56320
    v_pk_mul_f32 v[64:65], v[64:65], v[240:241]
    v_pk_mul_f32 v[66:67], v[66:67], v[242:243]
    v_pk_mul_f32 v[80:81], v[80:81], v[244:245]
    v_pk_mul_f32 v[82:83], v[82:83], v[246:247]
    v_pk_mul_f32 v[68:69], v[68:69], v[248:249]
    v_pk_mul_f32 v[70:71], v[70:71], v[250:251]
    v_pk_mul_f32 v[84:85], v[84:85], v[252:253]
    v_pk_mul_f32 v[86:87], v[86:87], v[254:255]
    v_cvt_pk_bf16_f32 v64, v64, v65
    v_cvt_pk_bf16_f32 v65, v66, v67
    v_cvt_pk_bf16_f32 v66, v80, v81
    v_cvt_pk_bf16_f32 v67, v82, v83
    v_min_u32 v64, -2, v64
    v_cvt_pk_bf16_f32 v68, v68, v69
    v_cvt_pk_bf16_f32 v69, v70, v71
    v_cvt_pk_bf16_f32 v70, v84, v85
    v_cvt_pk_bf16_f32 v71, v86, v87
    v_min_u32 v68, -2, v68
    v_mfma_f32_16x16x32_bf16 v[88:91], a[204:207], v[104:107], v[88:91]
    buffer_store_dwordx4 v[64:67], v16, s[48:51], s95 offen offset:0 sc1
    s_cmp_eq_u32 s8, 286720
    s_cselect_b32 s8, 0, s8
    v_mfma_f32_16x16x32_bf16 v[88:91], a[212:215], v[112:115], v[88:91]
    s_add_u32 s10, s1, s8
    buffer_load_dwordx4 a[136:139], v16, s[48:51], s10 offen offset:2048 sc1
    v_mfma_f32_16x16x32_bf16 v[88:91], a[220:223], v[120:123], v[88:91]
    buffer_store_dwordx4 v[68:71], v16, s[48:51], s95 offen offset:1024 sc1
    v_mfma_f32_16x16x32_bf16 v[92:95], a[196:199], v[100:103], v[92:95]
    buffer_load_dwordx4 a[140:143], v16, s[48:51], s10 offen offset:3072 sc1
    v_mfma_f32_16x16x32_bf16 v[92:95], a[204:207], v[108:111], v[92:95]
    v_mfma_f32_16x16x32_bf16 v[92:95], a[212:215], v[116:119], v[92:95]
    v_mfma_f32_16x16x32_bf16 v[92:95], a[220:223], v[124:127], v[92:95]
    s_waitcnt lgkmcnt(0)
    v_mfma_f32_16x16x32_bf16 v[72:75], a[224:227], v[128:131], v[72:75]
    s_add_u32 s8, s8, 40960
    s_cmp_eq_u32 s8, 286720
    s_cselect_b32 s8, 0, s8
    v_mfma_f32_16x16x32_bf16 v[72:75], a[232:235], v[136:139], v[72:75]
    s_add_u32 s10, s1, s8
    s_waitcnt vmcnt(4)
    v_accvgpr_read_b32 v29, a80
    v_mfma_f32_16x16x32_bf16 v[72:75], a[240:243], v[144:147], v[72:75]
    buffer_load_dwordx4 a[144:147], v16, s[48:51], s10 offen offset:2048 sc1
    v_mov_b32 v28, v29
    v_mfma_f32_16x16x32_bf16 v[72:75], a[248:251], v[152:155], v[72:75]
    v_accvgpr_read_b32 v29, a84
    v_max_u32 v28, v28, v29
    v_mfma_f32_16x16x32_bf16 v[76:79], a[224:227], v[132:135], v[76:79]
    buffer_load_dwordx4 a[148:151], v16, s[48:51], s10 offen offset:3072 sc1
    v_accvgpr_read_b32 v29, a88
    v_mfma_f32_16x16x32_bf16 v[76:79], a[232:235], v[140:143], v[76:79]
    v_max_u32 v28, v28, v29
    v_accvgpr_read_b32 v29, a92
    v_mfma_f32_16x16x32_bf16 v[76:79], a[240:243], v[148:151], v[76:79]
    v_max_u32 v28, v28, v29
    v_accvgpr_read_b32 v29, a96
    v_mfma_f32_16x16x32_bf16 v[76:79], a[248:251], v[156:159], v[76:79]
    v_max_u32 v28, v28, v29
    v_accvgpr_read_b32 v29, a100
    v_mfma_f32_16x16x32_bf16 v[88:91], a[228:231], v[128:131], v[88:91]
    s_add_u32 s8, s8, 40960
    s_cmp_eq_u32 s8, 286720
    s_cselect_b32 s8, 0, s8
    v_mfma_f32_16x16x32_bf16 v[88:91], a[236:239], v[136:139], v[88:91]
    s_add_u32 s10, s1, s8
    v_max_u32 v28, v28, v29
    v_mfma_f32_16x16x32_bf16 v[88:91], a[244:247], v[144:147], v[88:91]
    buffer_load_dwordx4 a[152:155], v16, s[48:51], s10 offen offset:2048 sc1
    v_accvgpr_read_b32 v29, a104
    v_mfma_f32_16x16x32_bf16 v[88:91], a[252:255], v[152:155], v[88:91]
    v_max_u32 v28, v28, v29
    v_accvgpr_read_b32 v29, a108
    v_mfma_f32_16x16x32_bf16 v[92:95], a[228:231], v[132:135], v[92:95]
    buffer_load_dwordx4 a[156:159], v16, s[48:51], s10 offen offset:3072 sc1
    v_max_u32 v28, v28, v29
    v_mfma_f32_16x16x32_bf16 v[92:95], a[236:239], v[140:143], v[92:95]
    v_accvgpr_read_b32 v29, a112
    v_max_u32 v28, v28, v29
    v_mfma_f32_16x16x32_bf16 v[92:95], a[244:247], v[148:151], v[92:95]
    v_accvgpr_read_b32 v29, a116
    v_max_u32 v28, v28, v29
    v_mfma_f32_16x16x32_bf16 v[92:95], a[252:255], v[156:159], v[92:95]
    s_add_u32 s8, s8, 40960
    s_cmp_eq_u32 s8, 286720
    s_cselect_b32 s8, 0, s8
    v_accvgpr_read_b32 v29, a120
    v_max_u32 v28, v28, v29
    v_accvgpr_read_b32 v29, a124
    v_max_u32 v28, v28, v29
    v_max_u32 v28, v28, v224
    v_max_u32 v28, v28, v228
    v_pk_fma_f32 v[240:241], v[72:73], v[72:73], v[26:27] op_sel_hi:[1,1,0]
    v_pk_fma_f32 v[242:243], v[74:75], v[74:75], v[26:27] op_sel_hi:[1,1,0]
    v_pk_fma_f32 v[244:245], v[88:89], v[88:89], v[26:27] op_sel_hi:[1,1,0]
    v_pk_fma_f32 v[246:247], v[90:91], v[90:91], v[26:27] op_sel_hi:[1,1,0]
    v_pk_fma_f32 v[248:249], v[76:77], v[76:77], v[26:27] op_sel_hi:[1,1,0]
    v_pk_fma_f32 v[250:251], v[78:79], v[78:79], v[26:27] op_sel_hi:[1,1,0]
    v_pk_fma_f32 v[252:253], v[92:93], v[92:93], v[26:27] op_sel_hi:[1,1,0]
    v_pk_fma_f32 v[254:255], v[94:95], v[94:95], v[26:27] op_sel_hi:[1,1,0]
    v_pk_mul_f32 v[240:241], v[72:73], v[240:241] neg_lo:[1,0] neg_hi:[1,0]
    s_add_u32 s10, s1, s8
    buffer_load_dwordx4 a[160:163], v16, s[48:51], s10 offen offset:2048 sc1
    v_pk_mul_f32 v[242:243], v[74:75], v[242:243] neg_lo:[1,0] neg_hi:[1,0]
    v_pk_mul_f32 v[244:245], v[88:89], v[244:245] neg_lo:[1,0] neg_hi:[1,0]
    v_pk_mul_f32 v[246:247], v[90:91], v[246:247] neg_lo:[1,0] neg_hi:[1,0]
    v_pk_mul_f32 v[248:249], v[76:77], v[248:249] neg_lo:[1,0] neg_hi:[1,0]
    v_pk_mul_f32 v[250:251], v[78:79], v[250:251] neg_lo:[1,0] neg_hi:[1,0]
    v_pk_mul_f32 v[252:253], v[92:93], v[252:253] neg_lo:[1,0] neg_hi:[1,0]
    v_pk_mul_f32 v[254:255], v[94:95], v[254:255] neg_lo:[1,0] neg_hi:[1,0]
    v_exp_f32 v240, v240
    v_exp_f32 v241, v241
    buffer_load_dwordx4 a[164:167], v16, s[48:51], s10 offen offset:3072 sc1
    v_exp_f32 v242, v242
    v_exp_f32 v243, v243
    v_exp_f32 v244, v244
    v_exp_f32 v245, v245
    v_exp_f32 v246, v246
    v_exp_f32 v247, v247
    v_exp_f32 v248, v248
    v_exp_f32 v249, v249
    v_exp_f32 v250, v250
    s_add_u32 s8, s8, 40960
    s_cmp_eq_u32 s8, 286720
    s_cselect_b32 s8, 0, s8
    s_add_u32 s10, s1, s8
    buffer_load_dwordx4 a[168:171], v16, s[48:51], s10 offen offset:2048 sc1
    v_exp_f32 v251, v251
    v_exp_f32 v252, v252
    v_exp_f32 v253, v253
    v_exp_f32 v254, v254
    v_exp_f32 v255, v255
    v_pk_fma_f32 v[240:241], v[240:241], s[92:93], s[92:93] op_sel_hi:[1,0,0]
    v_pk_fma_f32 v[242:243], v[242:243], s[92:93], s[92:93] op_sel_hi:[1,0,0]
    v_pk_fma_f32 v[244:245], v[244:245], s[92:93], s[92:93] op_sel_hi:[1,0,0]
    v_pk_fma_f32 v[246:247], v[246:247], s[92:93], s[92:93] op_sel_hi:[1,0,0]
    buffer_load_dwordx4 a[172:175], v16, s[48:51], s10 offen offset:3072 sc1
    v_pk_fma_f32 v[248:249], v[248:249], s[92:93], s[92:93] op_sel_hi:[1,0,0]
    v_pk_fma_f32 v[250:251], v[250:251], s[92:93], s[92:93] op_sel_hi:[1,0,0]
    v_pk_fma_f32 v[252:253], v[252:253], s[92:93], s[92:93] op_sel_hi:[1,0,0]
    v_pk_fma_f32 v[254:255], v[254:255], s[92:93], s[92:93] op_sel_hi:[1,0,0]
    v_rcp_f32 v240, v240
    v_rcp_f32 v241, v241
    v_rcp_f32 v242, v242
    v_rcp_f32 v243, v243
    v_rcp_f32 v244, v244
    s_add_u32 s8, s8, 40960
    s_cmp_eq_u32 s8, 286720
    s_cselect_b32 s8, 0, s8
    s_add_u32 s10, s1, s8
    buffer_load_dwordx4 a[176:179], v16, s[48:51], s10 offen offset:2048 sc1
    v_rcp_f32 v245, v245
    v_rcp_f32 v246, v246
    v_rcp_f32 v247, v247
    v_rcp_f32 v248, v248
    v_rcp_f32 v249, v249
    v_rcp_f32 v250, v250
    v_rcp_f32 v251, v251
    v_rcp_f32 v252, v252
    v_rcp_f32 v253, v253
    buffer_load_dwordx4 a[180:183], v16, s[48:51], s10 offen offset:3072 sc1
    v_rcp_f32 v254, v254
    v_rcp_f32 v255, v255
    v_pk_mul_f32 v[72:73], v[72:73], v[240:241]
    v_pk_mul_f32 v[74:75], v[74:75], v[242:243]
    v_pk_mul_f32 v[88:89], v[88:89], v[244:245]
    v_pk_mul_f32 v[90:91], v[90:91], v[246:247]
    v_pk_mul_f32 v[76:77], v[76:77], v[248:249]
    v_pk_mul_f32 v[78:79], v[78:79], v[250:251]
    v_pk_mul_f32 v[92:93], v[92:93], v[252:253]
    s_add_u32 s8, s8, 40960
    s_cmp_eq_u32 s8, 286720
    s_cselect_b32 s8, 0, s8
    s_add_u32 s10, s1, s8
    buffer_load_dwordx4 a[184:187], v16, s[48:51], s10 offen offset:2048 sc1
    v_pk_mul_f32 v[94:95], v[94:95], v[254:255]
    v_cvt_pk_bf16_f32 v72, v72, v73
    v_cvt_pk_bf16_f32 v73, v74, v75
    v_cvt_pk_bf16_f32 v74, v88, v89
    v_cvt_pk_bf16_f32 v75, v90, v91
    v_min_u32 v72, -2, v72
    v_cvt_pk_bf16_f32 v76, v76, v77
    v_cvt_pk_bf16_f32 v77, v78, v79
    v_cvt_pk_bf16_f32 v78, v92, v93
    buffer_load_dwordx4 a[188:191], v16, s[48:51], s10 offen offset:3072 sc1
    v_cvt_pk_bf16_f32 v79, v94, v95
    v_min_u32 v76, -2, v76
    buffer_store_dwordx4 v[72:75], v16, s[48:51], s95 offen offset:2048 sc1
    buffer_store_dwordx4 v[76:79], v16, s[48:51], s95 offen offset:3072 sc1
    v_cmp_eq_u32 vcc, -1, v28
    s_cbranch_vccz L_h0_x
    s_mov_b32 s3, 262144
L_h0:
    s_sleep 4
    s_add_u32 s13, s1, s9
    buffer_load_dwordx4 a[80:83], v16, s[48:51], s13 offen offset:0 sc1
    buffer_load_dwordx4 a[84:87], v16, s[48:51], s13 offen offset:1024 sc1
    s_add_u32 s9, s9, 40960
    s_cmp_eq_u32 s9, 286720
    s_cselect_b32 s9, 0, s9
    s_add_u32 s13, s1, s9
    buffer_load_dwordx4 a[88:91], v16, s[48:51], s13 offen offset:0 sc1
    buffer_load_dwordx4 a[92:95], v16, s[48:51], s13 offen offset:1024 sc1
    s_add_u32 s9, s9, 40960
    s_cmp_eq_u32 s9, 286720
    s_cselect_b32 s9, 0, s9
    s_add_u32 s13, s1, s9
    buffer_load_dwordx4 a[96:99], v16, s[48:51], s13 offen offset:0 sc1
    buffer_load_dwordx4 a[100:103], v16, s[48:51], s13 offen offset:1024 sc1
    s_add_u32 s9, s9, 40960
    s_cmp_eq_u32 s9, 286720
    s_cselect_b32 s9, 0, s9
    s_add_u32 s13, s1, s9
    buffer_load_dwordx4 a[104:107], v16, s[48:51], s13 offen offset:0 sc1
    buffer_load_dwordx4 a[108:111], v16, s[48:51], s13 offen offset:1024 sc1
    s_add_u32 s9, s9, 40960
    s_cmp_eq_u32 s9, 286720
    s_cselect_b32 s9, 0, s9
    s_add_u32 s13, s1, s9
    buffer_load_dwordx4 a[112:115], v16, s[48:51], s13 offen offset:0 sc1
    buffer_load_dwordx4 a[116:119], v16, s[48:51], s13 offen offset:1024 sc1
    s_add_u32 s9, s9, 40960
    s_cmp_eq_u32 s9, 286720
    s_cselect_b32 s9, 0, s9
    s_add_u32 s13, s1, s9
    buffer_load_dwordx4 a[120:123], v16, s[48:51], s13 offen offset:0 sc1
    buffer_load_dwordx4 a[124:127], v16, s[48:51], s13 offen offset:1024 sc1
    s_add_u32 s9, s9, 40960
    s_cmp_eq_u32 s9, 286720
    s_cselect_b32 s9, 0, s9
    s_add_u32 s13, s1, s9
    buffer_load_dwordx4 v[224:227], v16, s[48:51], s13 offen offset:0 sc1
    buffer_load_dwordx4 v[228:231], v16, s[48:51], s13 offen offset:1024 sc1
    s_add_u32 s9, s9, 40960
    s_cmp_eq_u32 s9, 286720
    s_cselect_b32 s9, 0, s9
    s_sub_u32 s3, s3, 1
    s_waitcnt vmcnt(0)
    v_accvgpr_read_b32 v29, a80
    v_mov_b32 v28, v29
    v_accvgpr_read_b32 v29, a84
    v_max_u32 v28, v28, v29
    v_accvgpr_read_b32 v29, a88
    v_max_u32 v28, v28, v29
    v_accvgpr_read_b32 v29, a92
    v_max_u32 v28, v28, v29
    v_accvgpr_read_b32 v29, a96
    v_max_u32 v28, v28, v29
    v_accvgpr_read_b32 v29, a100
    v_max_u32 v28, v28, v29
    v_accvgpr_read_b32 v29, a104
    v_max_u32 v28, v28, v29
    v_accvgpr_read_b32 v29, a108
    v_max_u32 v28, v28, v29
    v_accvgpr_read_b32 v29, a112
    v_max_u32 v28, v28, v29
    v_accvgpr_read_b32 v29, a116
    v_max_u32 v28, v28, v29
    v_accvgpr_read_b32 v29, a120
    v_max_u32 v28, v28, v29
    v_accvgpr_read_b32 v29, a124
    v_max_u32 v28, v28, v29
    v_max_u32 v28, v28, v224
    v_max_u32 v28, v28, v228
    v_cmp_eq_u32 vcc, -1, v28
    s_cmp_eq_u32 s3, 0
    s_cbranch_scc1 L_h0_x
    s_cbranch_vccnz L_h0
L_h0_x:
    v_mfma_f32_16x16x32_bf16 v[96:99], v[160:163], a[80:83], 0
    ds_read_b64_tr_b16 a[192:193], v9 offset:4128
    s_add_u32 s8, s8, 40960
    v_mfma_f32_16x16x32_bf16 v[96:99], v[176:179], a[88:91], v[96:99]
    s_cmp_eq_u32 s8, 286720
    s_cselect_b32 s8, 0, s8
    v_mfma_f32_16x16x32_bf16 v[100:103], v[160:163], a[84:87], 0
    ds_read_b64_tr_b16 a[194:195], v9 offset:4384
    v_mfma_f32_16x16x32_bf16 v[100:103], v[176:179], a[92:95], v[100:103]
    ds_read_b64_tr_b16 a[196:197], v9 offset:4136
    v_mfma_f32_16x16x32_bf16 v[112:115], v[164:167], a[80:83], 0
    ds_read_b64_tr_b16 a[198:199], v9 offset:4392
    v_mfma_f32_16x16x32_bf16 v[112:115], v[180:183], a[88:91], v[112:115]
    ds_read_b64_tr_b16 a[200:201], v9 offset:4640
    v_mfma_f32_16x16x32_bf16 v[116:119], v[164:167], a[84:87], 0
    ds_read_b64_tr_b16 a[202:203], v9 offset:4896
    v_mfma_f32_16x16x32_bf16 v[116:119], v[180:183], a[92:95], v[116:119]
    ds_read_b64_tr_b16 a[204:205], v9 offset:4648
    v_mfma_f32_16x16x32_bf16 v[128:131], v[168:171], a[80:83], 0
    ds_read_b64_tr_b16 a[206:207], v9 offset:4904
    s_add_u32 s10, s1, s8
    v_mfma_f32_16x16x32_bf16 v[128:131], v[184:187], a[88:91], v[128:131]
    ds_read_b64_tr_b16 a[208:209], v9 offset:8256
L_stub15:
    s_cbranch_execz L_stub19
    v_mfma_f32_16x16x32_bf16 v[132:135], v[168:171], a[84:87], 0
    ds_read_b64_tr_b16 a[210:211], v9 offset:8512
    v_mfma_f32_16x16x32_bf16 v[132:135], v[184:187], a[92:95], v[132:135]
    ds_read_b64_tr_b16 a[212:213], v9 offset:8264
    buffer_load_dwordx4 v[32:35], v18, s[48:51], s10 offen offset:0 sc1
    v_mfma_f32_16x16x32_bf16 v[144:147], v[172:175], a[80:83], 0
    ds_read_b64_tr_b16 a[214:215], v9 offset:8520
    v_mfma_f32_16x16x32_bf16 v[144:147], v[188:191], a[88:91], v[144:147]
    ds_read_b64_tr_b16 a[216:217], v9 offset:8768
    v_mfma_f32_16x16x32_bf16 v[148:151], v[172:175], a[84:87], 0
    ds_read_b64_tr_b16 a[218:219], v9 offset:9024
    buffer_load_dwordx4 v[36:39], v18, s[48:51], s10 offen offset:1024 sc1
    v_mfma_f32_16x16x32_bf16 v[148:151], v[188:191], a[92:95], v[148:151]
    ds_read_b64_tr_b16 a[220:221], v9 offset:8776
    s_add_u32 s8, s8, 40960
    v_mfma_f32_16x16x32_bf16 v[96:99], v[192:195], a[96:99], v[96:99]
    ds_read_b64_tr_b16 a[222:223], v9 offset:9032
    s_cmp_eq_u32 s8, 286720
    s_cselect_b32 s8, 0, s8
    v_mfma_f32_16x16x32_bf16 v[96:99], v[208:211], a[104:107], v[96:99]
    ds_read_b64_tr_b16 a[224:225], v9 offset:12384
    s_add_u32 s10, s1, s8
    buffer_load_dwordx4 v[40:43], v18, s[48:51], s10 offen offset:0 sc1
    v_mfma_f32_16x16x32_bf16 v[100:103], v[192:195], a[100:103], v[100:103]
    ds_read_b64_tr_b16 a[226:227], v9 offset:12640
    v_mfma_f32_16x16x32_bf16 v[100:103], v[208:211], a[108:111], v[100:103]
    ds_read_b64_tr_b16 a[228:229], v9 offset:12392
    v_mfma_f32_16x16x32_bf16 v[112:115], v[196:199], a[96:99], v[112:115]
    ds_read_b64_tr_b16 a[230:231], v9 offset:12648
    buffer_load_dwordx4 v[44:47], v18, s[48:51], s10 offen offset:1024 sc1
    v_mfma_f32_16x16x32_bf16 v[112:115], v[212:215], a[104:107], v[112:115]
    ds_read_b64_tr_b16 a[232:233], v9 offset:12896
    s_add_u32 s8, s8, 40960
    v_mfma_f32_16x16x32_bf16 v[116:119], v[196:199], a[100:103], v[116:119]
    ds_read_b64_tr_b16 a[234:235], v9 offset:13152
    s_cmp_eq_u32 s8, 286720
    s_cselect_b32 s8, 0, s8
    v_mfma_f32_16x16x32_bf16 v[116:119], v[212:215], a[108:111], v[116:119]
    ds_read_b64_tr_b16 a[236:237], v9 offset:12904
    s_add_u32 s10, s1, s8
    buffer_load_dwordx4 v[48:51], v18, s[48:51], s10 offen offset:0 sc1
    v_mfma_f32_16x16x32_bf16 v[128:131], v[200:203], a[96:99], v[128:131]
    ds_read_b64_tr_b16 a[238:239], v9 offset:13160
    v_mfma_f32_16x16x32_bf16 v[128:131], v[216:219], a[104:107], v[128:131]
    ds_read_b64_tr_b16 a[240:241], v20 offset:0
    v_mfma_f32_16x16x32_bf16 v[132:135], v[200:203], a[100:103], v[132:135]
    ds_read_b64_tr_b16 a[242:243], v20 offset:256
    buffer_load_dwordx4 v[52:55], v18, s[48:51], s10 offen offset:1024 sc1
    v_mfma_f32_16x16x32_bf16 v[132:135], v[216:219], a[108:111], v[132:135]
    ds_read_b64_tr_b16 a[244:245], v20 offset:8
    s_add_u32 s8, s8, 40960
    v_mfma_f32_16x16x32_bf16 v[144:147], v[204:207], a[96:99], v[144:147]
    ds_read_b64_tr_b16 a[246:247], v20 offset:264
    s_cmp_eq_u32 s8, 286720
    s_cselect_b32 s8, 0, s8
    v_mfma_f32_16x16x32_bf16 v[144:147], v[220:223], a[104:107], v[144:147]
    ds_read_b64_tr_b16 a[248:249], v20 offset:512
    s_add_u32 s10, s1, s8
    buffer_load_dwordx4 v[56:59], v18, s[48:51], s10 offen offset:0 sc1
    v_mfma_f32_16x16x32_bf16 v[148:151], v[204:207], a[100:103], v[148:151]
    ds_read_b64_tr_b16 a[250:251], v20 offset:768
    v_mfma_f32_16x16x32_bf16 v[148:151], v[220:223], a[108:111], v[148:151]
    ds_read_b64_tr_b16 a[252:253], v20 offset:520
    v_mfma_f32_16x16x32_bf16 v[96:99], a[0:3], a[112:115], v[96:99]
    ds_read_b64_tr_b16 a[254:255], v20 offset:776
    buffer_load_dwordx4 v[60:63], v18, s[48:51], s10 offen offset:1024 sc1
    v_mfma_f32_16x16x32_bf16 v[96:99], a[16:19], a[120:123], v[96:99]
    s_add_u32 s8, s8, 40960
    s_cmp_eq_u32 s8, 286720
    s_cselect_b32 s8, 0, s8
    v_mfma_f32_16x16x32_bf16 v[96:99], a[32:35], v[224:227], v[96:99]
    s_add_u32 s10, s1, s8
    v_mfma_f32_16x16x32_bf16 v[100:103], a[0:3], a[116:119], v[100:103]
    buffer_load_dwordx4 v[64:67], v18, s[48:51], s10 offen offset:0 sc1
    v_mfma_f32_16x16x32_bf16 v[100:103], a[16:19], a[124:127], v[100:103]
    buffer_load_dwordx4 v[68:71], v18, s[48:51], s10 offen offset:1024 sc1
    v_mfma_f32_16x16x32_bf16 v[100:103], a[32:35], v[228:231], v[100:103]
    v_mfma_f32_16x16x32_bf16 v[112:115], a[4:7], a[112:115], v[112:115]
    s_add_u32 s8, s8, 40960
    s_cmp_eq_u32 s8, 286720
    s_cselect_b32 s8, 0, s8
    v_mfma_f32_16x16x32_bf16 v[112:115], a[20:23], a[120:123], v[112:115]
    s_add_u32 s10, s1, s8
    v_mfma_f32_16x16x32_bf16 v[112:115], a[36:39], v[224:227], v[112:115]
    buffer_load_dwordx4 v[80:83], v18, s[48:51], s10 offen offset:0 sc1
    v_mfma_f32_16x16x32_bf16 v[116:119], a[4:7], a[116:119], v[116:119]
    buffer_load_dwordx4 v[84:87], v18, s[48:51], s10 offen offset:1024 sc1
    s_waitcnt vmcnt(14)
    v_accvgpr_read_b32 v29, a136
    v_mfma_f32_16x16x32_bf16 v[116:119], a[20:23], a[124:127], v[116:119]
    v_mov_b32 v28, v29
    v_accvgpr_read_b32 v29, a140
    v_mfma_f32_16x16x32_bf16 v[116:119], a[36:39], v[228:231], v[116:119]
    v_max_u32 v28, v28, v29
    v_accvgpr_read_b32 v29, a144
    v_mfma_f32_16x16x32_bf16 v[128:131], a[8:11], a[112:115], v[128:131]
    s_add_u32 s8, s8, 40960
    s_cmp_eq_u32 s8, 286720
    s_cselect_b32 s8, 0, s8
    v_mfma_f32_16x16x32_bf16 v[128:131], a[24:27], a[120:123], v[128:131]
    s_add_u32 s10, s1, s8
    v_max_u32 v28, v28, v29
    v_mfma_f32_16x16x32_bf16 v[128:131], a[40:43], v[224:227], v[128:131]
    buffer_load_dwordx4 v[232:235], v18, s[48:51], s10 offen offset:0 sc1
    v_accvgpr_read_b32 v29, a148
    v_mfma_f32_16x16x32_bf16 v[132:135], a[8:11], a[116:119], v[132:135]
    buffer_load_dwordx4 v[236:239], v18, s[48:51], s10 offen offset:1024 sc1
    v_max_u32 v28, v28, v29
    v_mfma_f32_16x16x32_bf16 v[132:135], a[24:27], a[124:127], v[132:135]
    v_accvgpr_read_b32 v29, a152
    v_max_u32 v28, v28, v29
    v_mfma_f32_16x16x32_bf16 v[132:135], a[40:43], v[228:231], v[132:135]
    v_accvgpr_read_b32 v29, a156
    v_max_u32 v28, v28, v29
    v_mfma_f32_16x16x32_bf16 v[144:147], a[12:15], a[112:115], v[144:147]
    s_add_u32 s8, s8, 40960
    s_cmp_eq_u32 s8, 286720
    s_cselect_b32 s8, 0, s8
    v_mfma_f32_16x16x32_bf16 v[144:147], a[28:31], a[120:123], v[144:147]
    v_accvgpr_read_b32 v29, a160
    v_max_u32 v28, v28, v29
    v_mfma_f32_16x16x32_bf16 v[144:147], a[44:47], v[224:227], v[144:147]
    v_accvgpr_read_b32 v29, a164
    v_max_u32 v28, v28, v29
    v_mfma_f32_16x16x32_bf16 v[148:151], a[12:15], a[116:119], v[148:151]
    v_accvgpr_read_b32 v29, a168
    v_max_u32 v28, v28, v29
    v_mfma_f32_16x16x32_bf16 v[148:151], a[28:31], a[124:127], v[148:151]
    v_accvgpr_read_b32 v29, a172
    v_max_u32 v28, v28, v29
    v_mfma_f32_16x16x32_bf16 v[148:151], a[44:47], v[228:231], v[148:151]
    v_accvgpr_read_b32 v29, a176
    v_max_u32 v28, v28, v29
    v_accvgpr_read_b32 v29, a180
    v_max_u32 v28, v28, v29
    v_accvgpr_read_b32 v29, a184
    v_max_u32 v28, v28, v29
    v_accvgpr_read_b32 v29, a188
    v_max_u32 v28, v28, v29
    v_cmp_eq_u32 vcc, -1, v28
    s_cbranch_vccz L_h1_x
    s_mov_b32 s3, 262144
L_h1:
    s_sleep 4
    s_add_u32 s13, s1, s9
    buffer_load_dwordx4 a[136:139], v16, s[48:51], s13 offen offset:2048 sc1
    buffer_load_dwordx4 a[140:143], v16, s[48:51], s13 offen offset:3072 sc1
    s_add_u32 s9, s9, 40960
    s_cmp_eq_u32 s9, 286720
    s_cselect_b32 s9, 0, s9
    s_add_u32 s13, s1, s9
    buffer_load_dwordx4 a[144:147], v16, s[48:51], s13 offen offset:2048 sc1
    buffer_load_dwordx4 a[148:151], v16, s[48:51], s13 offen offset:3072 sc1
    s_add_u32 s9, s9, 40960
    s_cmp_eq_u32 s9, 286720
    s_cselect_b32 s9, 0, s9
    s_add_u32 s13, s1, s9
    buffer_load_dwordx4 a[152:155], v16, s[48:51], s13 offen offset:2048 sc1
    buffer_load_dwordx4 a[156:159], v16, s[48:51], s13 offen offset:3072 sc1
    s_add_u32 s9, s9, 40960
    s_cmp_eq_u32 s9, 286720
    s_cselect_b32 s9, 0, s9
    s_add_u32 s13, s1, s9
    buffer_load_dwordx4 a[160:163], v16, s[48:51], s13 offen offset:2048 sc1
    buffer_load_dwordx4 a[164:167], v16, s[48:51], s13 offen offset:3072 sc1
    s_add_u32 s9, s9, 40960
    s_cmp_eq_u32 s9, 286720
    s_cselect_b32 s9, 0, s9
    s_add_u32 s13, s1, s9
    buffer_load_dwordx4 a[168:171], v16, s[48:51], s13 offen offset:2048 sc1
    buffer_load_dwordx4 a[172:175], v16, s[48:51], s13 offen offset:3072 sc1
    s_add_u32 s9, s9, 40960
    s_cmp_eq_u32 s9, 286720
    s_cselect_b32 s9, 0, s9
    s_add_u32 s13, s1, s9
    buffer_load_dwordx4 a[176:179], v16, s[48:51], s13 offen offset:2048 sc1
    buffer_load_dwordx4 a[180:183], v16, s[48:51], s13 offen offset:3072 sc1
    s_add_u32 s9, s9, 40960
    s_cmp_eq_u32 s9, 286720
    s_cselect_b32 s9, 0, s9
    s_add_u32 s13, s1, s9
    buffer_load_dwordx4 a[184:187], v16, s[48:51], s13 offen offset:2048 sc1
    buffer_load_dwordx4 a[188:191], v16, s[48:51], s13 offen offset:3072 sc1
    s_add_u32 s9, s9, 40960
    s_cmp_eq_u32 s9, 286720
    s_cselect_b32 s9, 0, s9
    s_sub_u32 s3, s3, 1
    s_waitcnt vmcnt(0)
    v_accvgpr_read_b32 v29, a136
    v_mov_b32 v28, v29
    v_accvgpr_read_b32 v29, a140
    v_max_u32 v28, v28, v29
    v_accvgpr_read_b32 v29, a144
    v_max_u32 v28, v28, v29
    v_accvgpr_read_b32 v29, a148
    v_max_u32 v28, v28, v29
    v_accvgpr_read_b32 v29, a152
    v_max_u32 v28, v28, v29
    v_accvgpr_read_b32 v29, a156
    v_max_u32 v28, v28, v29
    v_accvgpr_read_b32 v29, a160
    v_max_u32 v28, v28, v29
    v_accvgpr_read_b32 v29, a164
    v_max_u32 v28, v28, v29
    v_accvgpr_read_b32 v29, a168
    v_max_u32 v28, v28, v29
    v_accvgpr_read_b32 v29, a172
    v_max_u32 v28, v28, v29
    v_accvgpr_read_b32 v29, a176
    v_max_u32 v28, v28, v29
    v_accvgpr_read_b32 v29, a180
    v_max_u32 v28, v28, v29
    v_accvgpr_read_b32 v29, a184
    v_max_u32 v28, v28, v29
    v_accvgpr_read_b32 v29, a188
    v_max_u32 v28, v28, v29
    v_cmp_eq_u32 vcc, -1, v28
    s_cmp_eq_u32 s3, 0
    s_cbranch_scc1 L_h1_x
    s_cbranch_vccnz L_h1
L_h1_x:
    v_mfma_f32_16x16x32_bf16 v[104:107], v[160:163], a[136:139], 0
    v_and_b32 v2, 15, v1
    v_lshlrev_b32 v2, 10, v2
    v_mfma_f32_16x16x32_bf16 v[104:107], v[176:179], a[144:147], v[104:107]
    v_lshrrev_b32 v3, 4, v1
    v_lshl_add_u32 v2, v3, 4, v2
    v_mfma_f32_16x16x32_bf16 v[108:111], v[160:163], a[140:143], 0
    v_lshlrev_b32 v4, 4, v3
    s_lshl_b32 s92, s58, 16
    v_mfma_f32_16x16x32_bf16 v[108:111], v[176:179], a[148:151], v[108:111]
    s_lshl_b32 s60, s35, 14
    s_add_u32 s92, s92, s60
    v_mfma_f32_16x16x32_bf16 v[120:123], v[164:167], a[136:139], 0
    s_lshl_b32 s95, s59, 7
    s_add_u32 s92, s92, s95
    v_mfma_f32_16x16x32_bf16 v[120:123], v[180:183], a[144:147], v[120:123]
    s_add_u32 s60, s92, 4194304
    s_mov_b32 s52, s22
    v_mfma_f32_16x16x32_bf16 v[124:127], v[164:167], a[140:143], 0
    s_add_u32 s10, s1, s8
    s_mov_b32 s53, s23
    v_mfma_f32_16x16x32_bf16 v[124:127], v[180:183], a[148:151], v[124:127]
    buffer_load_dwordx4 a[80:83], v18, s[48:51], s10 offen offset:2048 sc1
    s_mov_b32 s54, 1024
    v_mfma_f32_16x16x32_bf16 v[136:139], v[168:171], a[136:139], 0
    s_mov_b32 s55, 0x20000
    v_mfma_f32_16x16x32_bf16 v[136:139], v[184:187], a[144:147], v[136:139]
    buffer_load_dwordx4 a[84:87], v18, s[48:51], s10 offen offset:3072 sc1
    v_mfma_f32_16x16x32_bf16 v[140:143], v[168:171], a[140:143], 0
    v_mfma_f32_16x16x32_bf16 v[140:143], v[184:187], a[148:151], v[140:143]
    v_mfma_f32_16x16x32_bf16 v[152:155], v[172:175], a[136:139], 0
    s_add_u32 s8, s8, 40960
    s_cmp_eq_u32 s8, 286720
    s_cselect_b32 s8, 0, s8
    v_mfma_f32_16x16x32_bf16 v[152:155], v[188:191], a[144:147], v[152:155]
    s_add_u32 s10, s1, s8
    v_mfma_f32_16x16x32_bf16 v[156:159], v[172:175], a[140:143], 0
    buffer_load_dwordx4 a[88:91], v18, s[48:51], s10 offen offset:2048 sc1
    v_mfma_f32_16x16x32_bf16 v[156:159], v[188:191], a[148:151], v[156:159]
    buffer_load_dwordx4 a[92:95], v18, s[48:51], s10 offen offset:3072 sc1
    v_mfma_f32_16x16x32_bf16 v[104:107], v[192:195], a[152:155], v[104:107]
    v_mfma_f32_16x16x32_bf16 v[104:107], v[208:211], a[160:163], v[104:107]
    v_mfma_f32_16x16x32_bf16 v[108:111], v[192:195], a[156:159], v[108:111]
    s_add_u32 s8, s8, 40960
    s_cmp_eq_u32 s8, 286720
    s_cselect_b32 s8, 0, s8
    v_mfma_f32_16x16x32_bf16 v[108:111], v[208:211], a[164:167], v[108:111]
    s_add_u32 s10, s1, s8
    v_mfma_f32_16x16x32_bf16 v[120:123], v[196:199], a[152:155], v[120:123]
    buffer_load_dwordx4 a[96:99], v18, s[48:51], s10 offen offset:2048 sc1
    v_mfma_f32_16x16x32_bf16 v[120:123], v[212:215], a[160:163], v[120:123]
    buffer_load_dwordx4 a[100:103], v18, s[48:51], s10 offen offset:3072 sc1
    v_mfma_f32_16x16x32_bf16 v[124:127], v[196:199], a[156:159], v[124:127]
    v_mfma_f32_16x16x32_bf16 v[124:127], v[212:215], a[164:167], v[124:127]
    v_mfma_f32_16x16x32_bf16 v[136:139], v[200:203], a[152:155], v[136:139]
    s_add_u32 s8, s8, 40960
    s_cmp_eq_u32 s8, 286720
    s_cselect_b32 s8, 0, s8
    v_mfma_f32_16x16x32_bf16 v[136:139], v[216:219], a[160:163], v[136:139]
    s_add_u32 s10, s1, s8
    v_mfma_f32_16x16x32_bf16 v[140:143], v[200:203], a[156:159], v[140:143]
    buffer_load_dwordx4 a[104:107], v18, s[48:51], s10 offen offset:2048 sc1
    v_mfma_f32_16x16x32_bf16 v[140:143], v[216:219], a[164:167], v[140:143]
    buffer_load_dwordx4 a[108:111], v18, s[48:51], s10 offen offset:3072 sc1
    v_mfma_f32_16x16x32_bf16 v[152:155], v[204:207], a[152:155], v[152:155]
    v_mfma_f32_16x16x32_bf16 v[152:155], v[220:223], a[160:163], v[152:155]
    v_mfma_f32_16x16x32_bf16 v[156:159], v[204:207], a[156:159], v[156:159]
    s_add_u32 s8, s8, 40960
    s_cmp_eq_u32 s8, 286720
    s_cselect_b32 s8, 0, s8
    v_mfma_f32_16x16x32_bf16 v[156:159], v[220:223], a[164:167], v[156:159]
    s_add_u32 s10, s1, s8
    v_mfma_f32_16x16x32_bf16 v[104:107], a[0:3], a[168:171], v[104:107]
    ds_read_b64_tr_b16 v[208:209], v9 offset:0
    v_mfma_f32_16x16x32_bf16 v[104:107], a[16:19], a[176:179], v[104:107]
    buffer_load_dwordx4 a[112:115], v18, s[48:51], s10 offen offset:2048 sc1
    v_mfma_f32_16x16x32_bf16 v[104:107], a[32:35], a[184:187], v[104:107]
    ds_read_b64_tr_b16 v[210:211], v9 offset:256
    v_mfma_f32_16x16x32_bf16 v[108:111], a[0:3], a[172:175], v[108:111]
    ds_read_b64_tr_b16 v[212:213], v9 offset:8
    v_mfma_f32_16x16x32_bf16 v[108:111], a[16:19], a[180:183], v[108:111]
    ds_read_b64_tr_b16 v[214:215], v9 offset:264
    buffer_load_dwordx4 a[116:119], v18, s[48:51], s10 offen offset:3072 sc1
    v_mfma_f32_16x16x32_bf16 v[108:111], a[32:35], a[188:191], v[108:111]
    ds_read_b64_tr_b16 v[216:217], v9 offset:512
    s_add_u32 s8, s8, 40960
    v_mfma_f32_16x16x32_bf16 v[120:123], a[4:7], a[168:171], v[120:123]
    ds_read_b64_tr_b16 v[218:219], v9 offset:768
    s_cmp_eq_u32 s8, 286720
    s_cselect_b32 s8, 0, s8
    v_mfma_f32_16x16x32_bf16 v[120:123], a[20:23], a[176:179], v[120:123]
    ds_read_b64_tr_b16 v[220:221], v9 offset:520
    s_add_u32 s10, s1, s8
    buffer_load_dwordx4 a[120:123], v18, s[48:51], s10 offen offset:2048 sc1
    v_mfma_f32_16x16x32_bf16 v[120:123], a[36:39], a[184:187], v[120:123]
    ds_read_b64_tr_b16 v[222:223], v9 offset:776
    v_mfma_f32_16x16x32_bf16 v[124:127], a[4:7], a[172:175], v[124:127]
    buffer_load_dwordx4 a[124:127], v18, s[48:51], s10 offen offset:3072 sc1
    v_mfma_f32_16x16x32_bf16 v[124:127], a[20:23], a[180:183], v[124:127]
    s_add_u32 s8, s8, 40960
    s_cmp_eq_u32 s8, 286720
    s_cselect_b32 s8, 0, s8
    v_mfma_f32_16x16x32_bf16 v[124:127], a[36:39], a[188:191], v[124:127]
    s_add_u32 s10, s1, s8
    v_mfma_f32_16x16x32_bf16 v[136:139], a[8:11], a[168:171], v[136:139]
    buffer_load_dwordx4 a[128:131], v18, s[48:51], s10 offen offset:2048 sc1
    v_mfma_f32_16x16x32_bf16 v[136:139], a[24:27], a[176:179], v[136:139]
    buffer_load_dwordx4 a[132:135], v18, s[48:51], s10 offen offset:3072 sc1
    v_mfma_f32_16x16x32_bf16 v[136:139], a[40:43], a[184:187], v[136:139]
    s_waitcnt vmcnt(14)
    v_mov_b32 v28, v32
    v_max_u32 v28, v28, v36
    v_mfma_f32_16x16x32_bf16 v[140:143], a[8:11], a[172:175], v[140:143]
    v_max_u32 v28, v28, v40
    v_max_u32 v28, v28, v44
    v_mfma_f32_16x16x32_bf16 v[140:143], a[24:27], a[180:183], v[140:143]
    s_add_u32 s8, s8, 40960
    s_cmp_eq_u32 s8, 286720
    s_cselect_b32 s8, 0, s8
    v_mfma_f32_16x16x32_bf16 v[140:143], a[40:43], a[188:191], v[140:143]
    v_max_u32 v28, v28, v48
    v_max_u32 v28, v28, v52
    v_mfma_f32_16x16x32_bf16 v[152:155], a[12:15], a[168:171], v[152:155]
    v_max_u32 v28, v28, v56
    v_max_u32 v28, v28, v60
    v_mfma_f32_16x16x32_bf16 v[152:155], a[28:31], a[176:179], v[152:155]
    v_max_u32 v28, v28, v64
    v_max_u32 v28, v28, v68
    v_mfma_f32_16x16x32_bf16 v[152:155], a[44:47], a[184:187], v[152:155]
    v_max_u32 v28, v28, v80
    v_max_u32 v28, v28, v84
    v_mfma_f32_16x16x32_bf16 v[156:159], a[12:15], a[172:175], v[156:159]
    v_max_u32 v28, v28, v232
    v_max_u32 v28, v28, v236
    v_mfma_f32_16x16x32_bf16 v[156:159], a[28:31], a[180:183], v[156:159]
    v_mfma_f32_16x16x32_bf16 v[156:159], a[44:47], a[188:191], v[156:159]
    v_cmp_eq_u32 vcc, -1, v28
    s_cbranch_vccz L_h2_x
    s_mov_b32 s3, 262144
L_h2:
    s_sleep 4
    s_add_u32 s13, s1, s9
    buffer_load_dwordx4 v[32:35], v18, s[48:51], s13 offen offset:0 sc1
    buffer_load_dwordx4 v[36:39], v18, s[48:51], s13 offen offset:1024 sc1
    s_add_u32 s9, s9, 40960
    s_cmp_eq_u32 s9, 286720
    s_cselect_b32 s9, 0, s9
    s_add_u32 s13, s1, s9
    buffer_load_dwordx4 v[40:43], v18, s[48:51], s13 offen offset:0 sc1
    buffer_load_dwordx4 v[44:47], v18, s[48:51], s13 offen offset:1024 sc1
    s_add_u32 s9, s9, 40960
    s_cmp_eq_u32 s9, 286720
    s_cselect_b32 s9, 0, s9
    s_add_u32 s13, s1, s9
    buffer_load_dwordx4 v[48:51], v18, s[48:51], s13 offen offset:0 sc1
    buffer_load_dwordx4 v[52:55], v18, s[48:51], s13 offen offset:1024 sc1
    s_add_u32 s9, s9, 40960
    s_cmp_eq_u32 s9, 286720
    s_cselect_b32 s9, 0, s9
    s_add_u32 s13, s1, s9
    buffer_load_dwordx4 v[56:59], v18, s[48:51], s13 offen offset:0 sc1
    buffer_load_dwordx4 v[60:63], v18, s[48:51], s13 offen offset:1024 sc1
    s_add_u32 s9, s9, 40960
    s_cmp_eq_u32 s9, 286720
    s_cselect_b32 s9, 0, s9
    s_add_u32 s13, s1, s9
    buffer_load_dwordx4 v[64:67], v18, s[48:51], s13 offen offset:0 sc1
    buffer_load_dwordx4 v[68:71], v18, s[48:51], s13 offen offset:1024 sc1
    s_add_u32 s9, s9, 40960
    s_cmp_eq_u32 s9, 286720
    s_cselect_b32 s9, 0, s9
    s_add_u32 s13, s1, s9
    buffer_load_dwordx4 v[80:83], v18, s[48:51], s13 offen offset:0 sc1
    buffer_load_dwordx4 v[84:87], v18, s[48:51], s13 offen offset:1024 sc1
    s_add_u32 s9, s9, 40960
    s_cmp_eq_u32 s9, 286720
    s_cselect_b32 s9, 0, s9
    s_add_u32 s13, s1, s9
    buffer_load_dwordx4 v[232:235], v18, s[48:51], s13 offen offset:0 sc1
    buffer_load_dwordx4 v[236:239], v18, s[48:51], s13 offen offset:1024 sc1
    s_add_u32 s9, s9, 40960
    s_cmp_eq_u32 s9, 286720
    s_cselect_b32 s9, 0, s9
    s_sub_u32 s3, s3, 1
    s_waitcnt vmcnt(0)
    v_mov_b32 v28, v32
    v_max_u32 v28, v28, v36
    v_max_u32 v28, v28, v40
    v_max_u32 v28, v28, v44
    v_max_u32 v28, v28, v48
    v_max_u32 v28, v28, v52
    v_max_u32 v28, v28, v56
    v_max_u32 v28, v28, v60
    v_max_u32 v28, v28, v64
    v_max_u32 v28, v28, v68
    v_max_u32 v28, v28, v80
    v_max_u32 v28, v28, v84
    v_max_u32 v28, v28, v232
    v_max_u32 v28, v28, v236
    v_cmp_eq_u32 vcc, -1, v28
    s_cmp_eq_u32 s3, 0
    s_cbranch_scc1 L_h2_x
    s_cbranch_vccnz L_h2
L_h2_x:
    v_mfma_f32_16x16x32_bf16 v[96:99], a[48:51], v[32:35], v[96:99]
    buffer_load_dwordx4 v[240:243], v2, s[48:51], s60 offen sc1
    s_lshl_b32 s3, s35, 12
    v_mfma_f32_16x16x32_bf16 v[96:99], a[64:67], v[40:43], v[96:99]
    v_add_u32 v5, s3, v16
    s_waitcnt lgkmcnt(0)
    v_mfma_f32_16x16x32_bf16 v[96:99], a[192:195], v[48:51], v[96:99]
    v_mfma_f32_16x16x32_bf16 v[96:99], a[208:211], v[56:59], v[96:99]
    s_barrier
    v_mfma_f32_16x16x32_bf16 v[96:99], a[224:227], v[64:67], v[96:99]
    v_mfma_f32_16x16x32_bf16 v[96:99], a[240:243], v[80:83], v[96:99]
    v_mfma_f32_16x16x32_bf16 v[96:99], v[208:211], v[232:235], v[96:99]
    buffer_load_dwordx4 v[244:247], v2, s[48:51], s60 offen offset:64 sc1
    v_mfma_f32_16x16x32_bf16 v[100:103], a[48:51], v[36:39], v[100:103]
    v_mfma_f32_16x16x32_bf16 v[100:103], a[64:67], v[44:47], v[100:103]
    v_mfma_f32_16x16x32_bf16 v[100:103], a[192:195], v[52:55], v[100:103]
    v_mfma_f32_16x16x32_bf16 v[100:103], a[208:211], v[60:63], v[100:103]
    v_mfma_f32_16x16x32_bf16 v[100:103], a[224:227], v[68:71], v[100:103]
    v_mfma_f32_16x16x32_bf16 v[100:103], a[240:243], v[84:87], v[100:103]
    buffer_load_dwordx4 v[248:251], v4, s[52:55], s95 offen
    v_mfma_f32_16x16x32_bf16 v[100:103], v[208:211], v[236:239], v[100:103]
    v_mfma_f32_16x16x32_bf16 v[112:115], a[52:55], v[32:35], v[112:115]
    ds_write_b128 v5, v[96:99] offset:0
    v_mfma_f32_16x16x32_bf16 v[112:115], a[68:71], v[40:43], v[112:115]
    v_mfma_f32_16x16x32_bf16 v[112:115], a[196:199], v[48:51], v[112:115]
    v_mfma_f32_16x16x32_bf16 v[112:115], a[212:215], v[56:59], v[112:115]
    v_mfma_f32_16x16x32_bf16 v[112:115], a[228:231], v[64:67], v[112:115]
    buffer_load_dwordx4 v[252:255], v4, s[52:55], s95 offen offset:64
    v_mfma_f32_16x16x32_bf16 v[112:115], a[244:247], v[80:83], v[112:115]
    v_mfma_f32_16x16x32_bf16 v[112:115], v[212:215], v[232:235], v[112:115]
    v_mfma_f32_16x16x32_bf16 v[116:119], a[52:55], v[36:39], v[116:119]
    ds_write_b128 v5, v[100:103] offset:16384
    v_mfma_f32_16x16x32_bf16 v[116:119], a[68:71], v[44:47], v[116:119]
    v_mfma_f32_16x16x32_bf16 v[116:119], a[196:199], v[52:55], v[116:119]
    v_mfma_f32_16x16x32_bf16 v[116:119], a[212:215], v[60:63], v[116:119]
    v_mfma_f32_16x16x32_bf16 v[116:119], a[228:231], v[68:71], v[116:119]
    v_mfma_f32_16x16x32_bf16 v[116:119], a[244:247], v[84:87], v[116:119]
    v_mfma_f32_16x16x32_bf16 v[116:119], v[212:215], v[236:239], v[116:119]
    v_mfma_f32_16x16x32_bf16 v[128:131], a[56:59], v[32:35], v[128:131]
    ds_write_b128 v5, v[112:115] offset:1024
    v_mfma_f32_16x16x32_bf16 v[128:131], a[72:75], v[40:43], v[128:131]
    v_mfma_f32_16x16x32_bf16 v[128:131], a[200:203], v[48:51], v[128:131]
    v_mfma_f32_16x16x32_bf16 v[128:131], a[216:219], v[56:59], v[128:131]
    v_mfma_f32_16x16x32_bf16 v[128:131], a[232:235], v[64:67], v[128:131]
    v_mfma_f32_16x16x32_bf16 v[128:131], a[248:251], v[80:83], v[128:131]
    v_mfma_f32_16x16x32_bf16 v[128:131], v[216:219], v[232:235], v[128:131]
    v_mfma_f32_16x16x32_bf16 v[132:135], a[56:59], v[36:39], v[132:135]
    ds_write_b128 v5, v[116:119] offset:17408
    v_mfma_f32_16x16x32_bf16 v[132:135], a[72:75], v[44:47], v[132:135]
    v_mfma_f32_16x16x32_bf16 v[132:135], a[200:203], v[52:55], v[132:135]
    v_mfma_f32_16x16x32_bf16 v[132:135], a[216:219], v[60:63], v[132:135]
    v_mfma_f32_16x16x32_bf16 v[132:135], a[232:235], v[68:71], v[132:135]
    v_mfma_f32_16x16x32_bf16 v[132:135], a[248:251], v[84:87], v[132:135]
    v_mfma_f32_16x16x32_bf16 v[132:135], v[216:219], v[236:239], v[132:135]
    s_waitcnt vmcnt(4)
    v_accvgpr_read_b32 v29, a80
    v_mov_b32 v28, v29
    v_mfma_f32_16x16x32_bf16 v[144:147], a[60:63], v[32:35], v[144:147]
    ds_write_b128 v5, v[128:131] offset:2048
    v_accvgpr_read_b32 v29, a84
    v_mfma_f32_16x16x32_bf16 v[144:147], a[76:79], v[40:43], v[144:147]
    v_max_u32 v28, v28, v29
    v_accvgpr_read_b32 v29, a88
    v_mfma_f32_16x16x32_bf16 v[144:147], a[204:207], v[48:51], v[144:147]
    v_max_u32 v28, v28, v29
    v_accvgpr_read_b32 v29, a92
    v_mfma_f32_16x16x32_bf16 v[144:147], a[220:223], v[56:59], v[144:147]
    v_max_u32 v28, v28, v29
    v_accvgpr_read_b32 v29, a96
    v_mfma_f32_16x16x32_bf16 v[144:147], a[236:239], v[64:67], v[144:147]
    v_max_u32 v28, v28, v29
    v_accvgpr_read_b32 v29, a100
    v_mfma_f32_16x16x32_bf16 v[144:147], a[252:255], v[80:83], v[144:147]
    v_max_u32 v28, v28, v29
    v_accvgpr_read_b32 v29, a104
    v_mfma_f32_16x16x32_bf16 v[144:147], v[220:223], v[232:235], v[144:147]
    v_max_u32 v28, v28, v29
    v_accvgpr_read_b32 v29, a108
    v_mfma_f32_16x16x32_bf16 v[148:151], a[60:63], v[36:39], v[148:151]
    ds_write_b128 v5, v[132:135] offset:18432
    v_max_u32 v28, v28, v29
    v_mfma_f32_16x16x32_bf16 v[148:151], a[76:79], v[44:47], v[148:151]
    v_accvgpr_read_b32 v29, a112
    v_max_u32 v28, v28, v29
    v_mfma_f32_16x16x32_bf16 v[148:151], a[204:207], v[52:55], v[148:151]
    v_accvgpr_read_b32 v29, a116
    v_max_u32 v28, v28, v29
    v_mfma_f32_16x16x32_bf16 v[148:151], a[220:223], v[60:63], v[148:151]
    v_accvgpr_read_b32 v29, a120
    v_max_u32 v28, v28, v29
    v_mfma_f32_16x16x32_bf16 v[148:151], a[236:239], v[68:71], v[148:151]
    v_accvgpr_read_b32 v29, a124
    v_max_u32 v28, v28, v29
    v_mfma_f32_16x16x32_bf16 v[148:151], a[252:255], v[84:87], v[148:151]
    v_accvgpr_read_b32 v29, a128
    v_max_u32 v28, v28, v29
    v_mfma_f32_16x16x32_bf16 v[148:151], v[220:223], v[236:239], v[148:151]
    v_accvgpr_read_b32 v29, a132
    v_max_u32 v28, v28, v29
    v_cmp_eq_u32 vcc, -1, v28
    s_cbranch_vccz L_h3_x
    s_mov_b32 s3, 262144
L_h3:
    s_sleep 4
    s_add_u32 s13, s1, s9
    buffer_load_dwordx4 a[80:83], v18, s[48:51], s13 offen offset:2048 sc1
    buffer_load_dwordx4 a[84:87], v18, s[48:51], s13 offen offset:3072 sc1
    s_add_u32 s9, s9, 40960
    s_cmp_eq_u32 s9, 286720
    s_cselect_b32 s9, 0, s9
    s_add_u32 s13, s1, s9
    buffer_load_dwordx4 a[88:91], v18, s[48:51], s13 offen offset:2048 sc1
    buffer_load_dwordx4 a[92:95], v18, s[48:51], s13 offen offset:3072 sc1
    s_add_u32 s9, s9, 40960
    s_cmp_eq_u32 s9, 286720
    s_cselect_b32 s9, 0, s9
    s_add_u32 s13, s1, s9
    buffer_load_dwordx4 a[96:99], v18, s[48:51], s13 offen offset:2048 sc1
    buffer_load_dwordx4 a[100:103], v18, s[48:51], s13 offen offset:3072 sc1
    s_add_u32 s9, s9, 40960
    s_cmp_eq_u32 s9, 286720
    s_cselect_b32 s9, 0, s9
    s_add_u32 s13, s1, s9
    buffer_load_dwordx4 a[104:107], v18, s[48:51], s13 offen offset:2048 sc1
    buffer_load_dwordx4 a[108:111], v18, s[48:51], s13 offen offset:3072 sc1
    s_add_u32 s9, s9, 40960
    s_cmp_eq_u32 s9, 286720
    s_cselect_b32 s9, 0, s9
    s_add_u32 s13, s1, s9
    buffer_load_dwordx4 a[112:115], v18, s[48:51], s13 offen offset:2048 sc1
    buffer_load_dwordx4 a[116:119], v18, s[48:51], s13 offen offset:3072 sc1
    s_add_u32 s9, s9, 40960
    s_cmp_eq_u32 s9, 286720
    s_cselect_b32 s9, 0, s9
    s_add_u32 s13, s1, s9
    buffer_load_dwordx4 a[120:123], v18, s[48:51], s13 offen offset:2048 sc1
    buffer_load_dwordx4 a[124:127], v18, s[48:51], s13 offen offset:3072 sc1
    s_add_u32 s9, s9, 40960
    s_cmp_eq_u32 s9, 286720
    s_cselect_b32 s9, 0, s9
    s_add_u32 s13, s1, s9
    buffer_load_dwordx4 a[128:131], v18, s[48:51], s13 offen offset:2048 sc1
    buffer_load_dwordx4 a[132:135], v18, s[48:51], s13 offen offset:3072 sc1
    s_add_u32 s9, s9, 40960
    s_cmp_eq_u32 s9, 286720
    s_cselect_b32 s9, 0, s9
    s_sub_u32 s3, s3, 1
    s_waitcnt vmcnt(0)
    v_accvgpr_read_b32 v29, a80
    v_mov_b32 v28, v29
    v_accvgpr_read_b32 v29, a84
    v_max_u32 v28, v28, v29
    v_accvgpr_read_b32 v29, a88
    v_max_u32 v28, v28, v29
    v_accvgpr_read_b32 v29, a92
    v_max_u32 v28, v28, v29
    v_accvgpr_read_b32 v29, a96
    v_max_u32 v28, v28, v29
    v_accvgpr_read_b32 v29, a100
    v_max_u32 v28, v28, v29
    v_accvgpr_read_b32 v29, a104
    v_max_u32 v28, v28, v29
    v_accvgpr_read_b32 v29, a108
    v_max_u32 v28, v28, v29
    v_accvgpr_read_b32 v29, a112
    v_max_u32 v28, v28, v29
    v_accvgpr_read_b32 v29, a116
    v_max_u32 v28, v28, v29
    v_accvgpr_read_b32 v29, a120
    v_max_u32 v28, v28, v29
    v_accvgpr_read_b32 v29, a124
    v_max_u32 v28, v28, v29
    v_accvgpr_read_b32 v29, a128
    v_max_u32 v28, v28, v29
    v_accvgpr_read_b32 v29, a132
    v_max_u32 v28, v28, v29
    v_cmp_eq_u32 vcc, -1, v28
    s_cmp_eq_u32 s3, 0
    s_cbranch_scc1 L_h3_x
    s_cbranch_vccnz L_h3
L_h3_x:
    v_mfma_f32_16x16x32_bf16 v[104:107], a[48:51], a[80:83], v[104:107]
    s_lshl_b32 s60, s35, 14
    v_add_u32 v6, s60, v16
    v_mfma_f32_16x16x32_bf16 v[104:107], a[64:67], a[88:91], v[104:107]
    v_lshlrev_b32 v7, 5, v3
    s_lshl_b32 s60, s59, 8
    v_mfma_f32_16x16x32_bf16 v[104:107], a[192:195], a[96:99], v[104:107]
    ds_write_b128 v5, v[144:147] offset:3072
    s_add_u32 s60, s60, 154496
    v_mfma_f32_16x16x32_bf16 v[104:107], a[208:211], a[104:107], v[104:107]
    v_add_u32 v7, s60, v7
    v_and_b32 v8, 7, v1
    v_mfma_f32_16x16x32_bf16 v[104:107], a[224:227], a[112:115], v[104:107]
    v_lshlrev_b32 v8, 10, v8
L_stub16:
    s_cbranch_execz L_stub20
    v_lshl_add_u32 v8, v3, 4, v8
    v_mfma_f32_16x16x32_bf16 v[104:107], a[240:243], a[120:123], v[104:107]
    v_bfe_u32 v9, v1, 3, 1
    v_lshl_add_u32 v8, v9, 6, v8
    v_mfma_f32_16x16x32_bf16 v[104:107], v[208:211], a[128:131], v[104:107]
    ds_read_b128 v[64:67], v7 offset:0
    v_mfma_f32_16x16x32_bf16 v[108:111], a[48:51], a[84:87], v[108:111]
    ds_read_b128 v[68:71], v7 offset:16
    v_mfma_f32_16x16x32_bf16 v[108:111], a[64:67], a[92:95], v[108:111]
    ds_read_b128 v[72:75], v7 offset:128
    v_mfma_f32_16x16x32_bf16 v[108:111], a[192:195], a[100:103], v[108:111]
    ds_write_b128 v5, v[148:151] offset:19456
    v_mfma_f32_16x16x32_bf16 v[108:111], a[208:211], a[108:111], v[108:111]
    ds_read_b128 v[76:79], v7 offset:144
    s_waitcnt vmcnt(3)
    v_lshlrev_b32 v32, 16, v240
    v_mfma_f32_16x16x32_bf16 v[108:111], a[224:227], a[116:119], v[108:111]
    v_and_b32 v33, 0xffff0000, v240
    s_waitcnt vmcnt(1)
    v_lshlrev_b32 v48, 16, v248
    v_mfma_f32_16x16x32_bf16 v[108:111], a[240:243], a[124:127], v[108:111]
    v_and_b32 v49, 0xffff0000, v248
    v_lshlrev_b32 v34, 16, v241
    v_mfma_f32_16x16x32_bf16 v[108:111], v[208:211], a[132:135], v[108:111]
    v_and_b32 v35, 0xffff0000, v241
    v_lshlrev_b32 v50, 16, v249
    v_mfma_f32_16x16x32_bf16 v[120:123], a[52:55], a[80:83], v[120:123]
    ds_write_b128 v5, v[104:107] offset:32768
    v_and_b32 v51, 0xffff0000, v249
    v_mfma_f32_16x16x32_bf16 v[120:123], a[68:71], a[88:91], v[120:123]
    v_lshlrev_b32 v36, 16, v242
    v_and_b32 v37, 0xffff0000, v242
    v_mfma_f32_16x16x32_bf16 v[120:123], a[196:199], a[96:99], v[120:123]
    v_lshlrev_b32 v52, 16, v250
    v_and_b32 v53, 0xffff0000, v250
    v_mfma_f32_16x16x32_bf16 v[120:123], a[212:215], a[104:107], v[120:123]
    v_lshlrev_b32 v38, 16, v243
    v_and_b32 v39, 0xffff0000, v243
    v_mfma_f32_16x16x32_bf16 v[120:123], a[228:231], a[112:115], v[120:123]
    v_lshlrev_b32 v54, 16, v251
    v_and_b32 v55, 0xffff0000, v251
    v_mfma_f32_16x16x32_bf16 v[120:123], a[244:247], a[120:123], v[120:123]
    v_lshlrev_b32 v40, 16, v244
    v_and_b32 v41, 0xffff0000, v244
    v_mfma_f32_16x16x32_bf16 v[120:123], v[212:215], a[128:131], v[120:123]
    s_waitcnt vmcnt(0)
    v_lshlrev_b32 v56, 16, v252
    v_and_b32 v57, 0xffff0000, v252
    v_mfma_f32_16x16x32_bf16 v[124:127], a[52:55], a[84:87], v[124:127]
    ds_write_b128 v5, v[108:111] offset:49152
    v_lshlrev_b32 v42, 16, v245
    v_mfma_f32_16x16x32_bf16 v[124:127], a[68:71], a[92:95], v[124:127]
    v_and_b32 v43, 0xffff0000, v245
    v_lshlrev_b32 v58, 16, v253
    v_mfma_f32_16x16x32_bf16 v[124:127], a[196:199], a[100:103], v[124:127]
    v_and_b32 v59, 0xffff0000, v253
    v_lshlrev_b32 v44, 16, v246
    v_mfma_f32_16x16x32_bf16 v[124:127], a[212:215], a[108:111], v[124:127]
    v_and_b32 v45, 0xffff0000, v246
    v_lshlrev_b32 v60, 16, v254
    v_mfma_f32_16x16x32_bf16 v[124:127], a[228:231], a[116:119], v[124:127]
    v_and_b32 v61, 0xffff0000, v254
    v_lshlrev_b32 v46, 16, v247
    v_mfma_f32_16x16x32_bf16 v[124:127], a[244:247], a[124:127], v[124:127]
    v_and_b32 v47, 0xffff0000, v247
    v_lshlrev_b32 v62, 16, v255
    v_mfma_f32_16x16x32_bf16 v[124:127], v[212:215], a[132:135], v[124:127]
    v_and_b32 v63, 0xffff0000, v255
    s_mov_b32 s52, s28
    v_mfma_f32_16x16x32_bf16 v[136:139], a[56:59], a[80:83], v[136:139]
    ds_write_b128 v5, v[120:123] offset:33792
    s_mov_b32 s53, s29
    v_mfma_f32_16x16x32_bf16 v[136:139], a[72:75], a[88:91], v[136:139]
    s_mov_b32 s54, 2097152
    s_mov_b32 s55, 0x20000
    v_mfma_f32_16x16x32_bf16 v[136:139], a[200:203], a[96:99], v[136:139]
    v_mfma_f32_16x16x32_bf16 v[136:139], a[216:219], a[104:107], v[136:139]
    v_mfma_f32_16x16x32_bf16 v[136:139], a[232:235], a[112:115], v[136:139]
    v_mfma_f32_16x16x32_bf16 v[136:139], a[248:251], a[120:123], v[136:139]
    v_mfma_f32_16x16x32_bf16 v[136:139], v[216:219], a[128:131], v[136:139]
    v_mfma_f32_16x16x32_bf16 v[140:143], a[56:59], a[84:87], v[140:143]
    ds_write_b128 v5, v[124:127] offset:50176
    v_mfma_f32_16x16x32_bf16 v[140:143], a[72:75], a[92:95], v[140:143]
    v_mfma_f32_16x16x32_bf16 v[140:143], a[200:203], a[100:103], v[140:143]
    v_mfma_f32_16x16x32_bf16 v[140:143], a[216:219], a[108:111], v[140:143]
    v_mfma_f32_16x16x32_bf16 v[140:143], a[232:235], a[116:119], v[140:143]
    v_mfma_f32_16x16x32_bf16 v[140:143], a[248:251], a[124:127], v[140:143]
    v_mfma_f32_16x16x32_bf16 v[140:143], v[216:219], a[132:135], v[140:143]
    v_mfma_f32_16x16x32_bf16 v[152:155], a[60:63], a[80:83], v[152:155]
    ds_write_b128 v5, v[136:139] offset:34816
    v_mfma_f32_16x16x32_bf16 v[152:155], a[76:79], a[88:91], v[152:155]
    v_mfma_f32_16x16x32_bf16 v[152:155], a[204:207], a[96:99], v[152:155]
    v_mfma_f32_16x16x32_bf16 v[152:155], a[220:223], a[104:107], v[152:155]
    v_mfma_f32_16x16x32_bf16 v[152:155], a[236:239], a[112:115], v[152:155]
    v_mfma_f32_16x16x32_bf16 v[152:155], a[252:255], a[120:123], v[152:155]
    v_mfma_f32_16x16x32_bf16 v[152:155], v[220:223], a[128:131], v[152:155]
    v_mfma_f32_16x16x32_bf16 v[156:159], a[60:63], a[84:87], v[156:159]
    ds_write_b128 v5, v[140:143] offset:51200
    v_mfma_f32_16x16x32_bf16 v[156:159], a[76:79], a[92:95], v[156:159]
    v_mfma_f32_16x16x32_bf16 v[156:159], a[204:207], a[100:103], v[156:159]
    v_mfma_f32_16x16x32_bf16 v[156:159], a[220:223], a[108:111], v[156:159]
    v_mfma_f32_16x16x32_bf16 v[156:159], a[236:239], a[116:119], v[156:159]
    v_mfma_f32_16x16x32_bf16 v[156:159], a[252:255], a[124:127], v[156:159]
    v_mfma_f32_16x16x32_bf16 v[156:159], v[220:223], a[132:135], v[156:159]
    ds_write_b128 v5, v[152:155] offset:35840
    s_nop 6
    ds_write_b128 v5, v[156:159] offset:52224
    s_waitcnt lgkmcnt(0)
    s_barrier
    ds_read_b128 v[96:99], v6 offset:0
    ds_read_b128 v[100:103], v6 offset:1024
    ds_read_b128 v[104:107], v6 offset:2048
    ds_read_b128 v[108:111], v6 offset:3072
    ds_read_b128 v[112:115], v6 offset:4096
    ds_read_b128 v[116:119], v6 offset:5120
    ds_read_b128 v[120:123], v6 offset:6144
    ds_read_b128 v[124:127], v6 offset:7168
    ds_read_b128 v[128:131], v6 offset:8192
    ds_read_b128 v[132:135], v6 offset:9216
    ds_read_b128 v[136:139], v6 offset:10240
    ds_read_b128 v[140:143], v6 offset:11264
    ds_read_b128 v[144:147], v6 offset:12288
    ds_read_b128 v[148:151], v6 offset:13312
    ds_read_b128 v[152:155], v6 offset:14336
    ds_read_b128 v[156:159], v6 offset:15360
    s_waitcnt lgkmcnt(15)
    v_pk_add_f32 v[48:49], v[48:49], v[96:97]
    v_pk_add_f32 v[50:51], v[50:51], v[98:99]
    s_waitcnt lgkmcnt(14)
    v_pk_add_f32 v[52:53], v[52:53], v[100:101]
    v_pk_add_f32 v[54:55], v[54:55], v[102:103]
    s_waitcnt lgkmcnt(13)
    v_pk_add_f32 v[56:57], v[56:57], v[104:105]
    v_pk_add_f32 v[58:59], v[58:59], v[106:107]
    s_waitcnt lgkmcnt(12)
    v_pk_add_f32 v[60:61], v[60:61], v[108:109]
    v_pk_add_f32 v[62:63], v[62:63], v[110:111]
    s_waitcnt lgkmcnt(11)
    v_pk_add_f32 v[48:49], v[48:49], v[112:113]
    v_pk_add_f32 v[50:51], v[50:51], v[114:115]
    s_waitcnt lgkmcnt(10)
    v_pk_add_f32 v[52:53], v[52:53], v[116:117]
    v_pk_add_f32 v[54:55], v[54:55], v[118:119]
    s_waitcnt lgkmcnt(9)
    v_pk_add_f32 v[56:57], v[56:57], v[120:121]
    v_pk_add_f32 v[58:59], v[58:59], v[122:123]
    s_waitcnt lgkmcnt(7)
    v_pk_add_f32 v[60:61], v[60:61], v[124:125]
    v_pk_add_f32 v[62:63], v[62:63], v[126:127]
    v_pk_add_f32 v[48:49], v[48:49], v[128:129]
    v_pk_add_f32 v[50:51], v[50:51], v[130:131]
    s_waitcnt lgkmcnt(2)
    v_pk_add_f32 v[52:53], v[52:53], v[132:133]
    v_pk_add_f32 v[54:55], v[54:55], v[134:135]
    v_pk_add_f32 v[56:57], v[56:57], v[136:137]
    v_pk_add_f32 v[58:59], v[58:59], v[138:139]
    v_pk_add_f32 v[60:61], v[60:61], v[140:141]
    v_pk_add_f32 v[62:63], v[62:63], v[142:143]
    v_pk_add_f32 v[48:49], v[48:49], v[144:145]
    v_pk_add_f32 v[50:51], v[50:51], v[146:147]
    v_pk_add_f32 v[52:53], v[52:53], v[148:149]
    v_pk_add_f32 v[54:55], v[54:55], v[150:151]
    s_waitcnt lgkmcnt(0)
    v_pk_add_f32 v[56:57], v[56:57], v[152:153]
    v_pk_add_f32 v[58:59], v[58:59], v[154:155]
    v_pk_add_f32 v[60:61], v[60:61], v[156:157]
    v_pk_add_f32 v[62:63], v[62:63], v[158:159]
    v_pk_fma_f32 v[32:33], v[48:49], v[64:65], v[32:33]
    v_pk_fma_f32 v[34:35], v[50:51], v[66:67], v[34:35]
    v_pk_fma_f32 v[36:37], v[52:53], v[68:69], v[36:37]
    v_pk_fma_f32 v[38:39], v[54:55], v[70:71], v[38:39]
    v_pk_fma_f32 v[40:41], v[56:57], v[72:73], v[40:41]
    v_pk_fma_f32 v[42:43], v[58:59], v[74:75], v[42:43]
    v_pk_fma_f32 v[44:45], v[60:61], v[76:77], v[44:45]
    v_pk_fma_f32 v[46:47], v[62:63], v[78:79], v[46:47]
    v_cvt_pk_bf16_f32 v80, v32, v33
    v_cvt_pk_bf16_f32 v81, v34, v35
    v_cvt_pk_bf16_f32 v82, v36, v37
    v_cvt_pk_bf16_f32 v83, v38, v39
    v_cvt_pk_bf16_f32 v84, v40, v41
    v_cvt_pk_bf16_f32 v85, v42, v43
    v_cvt_pk_bf16_f32 v86, v44, v45
    v_cvt_pk_bf16_f32 v87, v46, v47
    v_mov_b32 v88, v80
    v_mov_b32 v89, v81
    v_mov_b32 v90, v82
    v_mov_b32 v91, v83
    v_mov_b32_dpp v80, v84 row_ror:8 row_mask:0xf bank_mask:0xc
    v_mov_b32_dpp v81, v85 row_ror:8 row_mask:0xf bank_mask:0xc
    v_mov_b32_dpp v82, v86 row_ror:8 row_mask:0xf bank_mask:0xc
    v_mov_b32_dpp v83, v87 row_ror:8 row_mask:0xf bank_mask:0xc
    buffer_store_dwordx4 v[80:83], v8, s[52:55], s92 offen sc1 nt
    v_mov_b32_dpp v84, v88 row_ror:8 row_mask:0xf bank_mask:0x3
    v_mov_b32_dpp v85, v89 row_ror:8 row_mask:0xf bank_mask:0x3
    v_mov_b32_dpp v86, v90 row_ror:8 row_mask:0xf bank_mask:0x3
    v_mov_b32_dpp v87, v91 row_ror:8 row_mask:0xf bank_mask:0x3
    s_add_u32 s92, s92, 8192
    buffer_store_dwordx4 v[84:87], v8, s[52:55], s92 offen sc1 nt
    s_endpgm
L_redo:
    s_waitcnt vmcnt(0) lgkmcnt(0)
    s_nop 15
    s_mov_b32 s95, 1
    s_mov_b32 s3, 8
    s_barrier
L_redo_c:
    s_add_u32 m0, s6, 0
    s_nop 0
    buffer_load_dwordx4 v22, s[40:43], s8 offen offset:0 lds
    buffer_load_dwordx4 v23, s[40:43], s8 offen offset:1024 lds
    buffer_load_dwordx4 v24, s[40:43], s8 offen offset:2048 lds
    buffer_load_dwordx4 v25, s[40:43], s8 offen offset:3072 lds
    s_add_u32 s8, s8, 16384
    s_and_b32 s8, s8, 0x1ffff
    s_waitcnt vmcnt(0)
    s_barrier
    ds_read_b128 a[192:195], v17 offset:0
    ds_read_b128 a[196:199], v18 offset:0
    ds_read_b128 a[200:203], v19 offset:0
    ds_read_b128 a[204:207], v20 offset:0
    s_waitcnt lgkmcnt(3)
    v_mfma_f32_16x16x32_bf16 v[96:99], a[192:195], v[32:35], 0
    s_waitcnt lgkmcnt(2)
    v_mfma_f32_16x16x32_bf16 v[96:99], a[196:199], v[48:51], v[96:99]
    s_waitcnt lgkmcnt(1)
    v_mfma_f32_16x16x32_bf16 v[96:99], a[200:203], v[64:67], v[96:99]
    s_waitcnt lgkmcnt(0)
    v_mfma_f32_16x16x32_bf16 v[96:99], a[204:207], v[80:83], v[96:99]
    v_mfma_f32_16x16x32_bf16 v[100:103], a[192:195], v[36:39], 0
    v_mfma_f32_16x16x32_bf16 v[100:103], a[196:199], v[52:55], v[100:103]
    v_mfma_f32_16x16x32_bf16 v[100:103], a[200:203], v[68:71], v[100:103]
    v_mfma_f32_16x16x32_bf16 v[100:103], a[204:207], v[84:87], v[100:103]
    v_mfma_f32_16x16x32_bf16 v[104:107], a[192:195], v[40:43], 0
    v_mfma_f32_16x16x32_bf16 v[104:107], a[196:199], v[56:59], v[104:107]
    v_mfma_f32_16x16x32_bf16 v[104:107], a[200:203], v[72:75], v[104:107]
    v_mfma_f32_16x16x32_bf16 v[104:107], a[204:207], v[88:91], v[104:107]
    v_mfma_f32_16x16x32_bf16 v[108:111], a[192:195], v[44:47], 0
    v_mfma_f32_16x16x32_bf16 v[108:111], a[196:199], v[60:63], v[108:111]
    v_mfma_f32_16x16x32_bf16 v[108:111], a[200:203], v[76:79], v[108:111]
    v_mfma_f32_16x16x32_bf16 v[108:111], a[204:207], v[92:95], v[108:111]
    v_max3_f32 v6, v6, v96, v97
    v_max3_f32 v6, v6, v98, v99
    v_max3_f32 v7, v7, v100, v101
    v_max3_f32 v7, v7, v102, v103
    v_max3_f32 v8, v8, v104, v105
    v_max3_f32 v8, v8, v106, v107
    s_nop 1
    v_max3_f32 v15, v15, v108, v109
    v_max3_f32 v15, v15, v110, v111
    ds_read_b128 a[192:195], v17 offset:1024
    ds_read_b128 a[196:199], v18 offset:1024
    ds_read_b128 a[200:203], v19 offset:1024
    ds_read_b128 a[204:207], v20 offset:1024
    s_waitcnt lgkmcnt(3)
    v_mfma_f32_16x16x32_bf16 v[96:99], a[192:195], v[32:35], 0
    s_waitcnt lgkmcnt(2)
    v_mfma_f32_16x16x32_bf16 v[96:99], a[196:199], v[48:51], v[96:99]
    s_waitcnt lgkmcnt(1)
    v_mfma_f32_16x16x32_bf16 v[96:99], a[200:203], v[64:67], v[96:99]
    s_waitcnt lgkmcnt(0)
    v_mfma_f32_16x16x32_bf16 v[96:99], a[204:207], v[80:83], v[96:99]
    v_mfma_f32_16x16x32_bf16 v[100:103], a[192:195], v[36:39], 0
    v_mfma_f32_16x16x32_bf16 v[100:103], a[196:199], v[52:55], v[100:103]
    v_mfma_f32_16x16x32_bf16 v[100:103], a[200:203], v[68:71], v[100:103]
    v_mfma_f32_16x16x32_bf16 v[100:103], a[204:207], v[84:87], v[100:103]
    v_mfma_f32_16x16x32_bf16 v[104:107], a[192:195], v[40:43], 0
    v_mfma_f32_16x16x32_bf16 v[104:107], a[196:199], v[56:59], v[104:107]
    v_mfma_f32_16x16x32_bf16 v[104:107], a[200:203], v[72:75], v[104:107]
    v_mfma_f32_16x16x32_bf16 v[104:107], a[204:207], v[88:91], v[104:107]
    v_mfma_f32_16x16x32_bf16 v[108:111], a[192:195], v[44:47], 0
    v_mfma_f32_16x16x32_bf16 v[108:111], a[196:199], v[60:63], v[108:111]
    v_mfma_f32_16x16x32_bf16 v[108:111], a[200:203], v[76:79], v[108:111]
    v_mfma_f32_16x16x32_bf16 v[108:111], a[204:207], v[92:95], v[108:111]
    v_max3_f32 v6, v6, v96, v97
    v_max3_f32 v6, v6, v98, v99
    v_max3_f32 v7, v7, v100, v101
    v_max3_f32 v7, v7, v102, v103
    v_max3_f32 v8, v8, v104, v105
    v_max3_f32 v8, v8, v106, v107
    s_nop 1
    v_max3_f32 v15, v15, v108, v109
    v_max3_f32 v15, v15, v110, v111
    ds_read_b128 a[192:195], v17 offset:2048
    ds_read_b128 a[196:199], v18 offset:2048
    ds_read_b128 a[200:203], v19 offset:2048
    ds_read_b128 a[204:207], v20 offset:2048
    s_waitcnt lgkmcnt(3)
    v_mfma_f32_16x16x32_bf16 v[96:99], a[192:195], v[32:35], 0
    s_waitcnt lgkmcnt(2)
    v_mfma_f32_16x16x32_bf16 v[96:99], a[196:199], v[48:51], v[96:99]
    s_waitcnt lgkmcnt(1)
    v_mfma_f32_16x16x32_bf16 v[96:99], a[200:203], v[64:67], v[96:99]
    s_waitcnt lgkmcnt(0)
    v_mfma_f32_16x16x32_bf16 v[96:99], a[204:207], v[80:83], v[96:99]
    v_mfma_f32_16x16x32_bf16 v[100:103], a[192:195], v[36:39], 0
    v_mfma_f32_16x16x32_bf16 v[100:103], a[196:199], v[52:55], v[100:103]
    v_mfma_f32_16x16x32_bf16 v[100:103], a[200:203], v[68:71], v[100:103]
    v_mfma_f32_16x16x32_bf16 v[100:103], a[204:207], v[84:87], v[100:103]
    v_mfma_f32_16x16x32_bf16 v[104:107], a[192:195], v[40:43], 0
    v_mfma_f32_16x16x32_bf16 v[104:107], a[196:199], v[56:59], v[104:107]
    v_mfma_f32_16x16x32_bf16 v[104:107], a[200:203], v[72:75], v[104:107]
    v_mfma_f32_16x16x32_bf16 v[104:107], a[204:207], v[88:91], v[104:107]
    v_mfma_f32_16x16x32_bf16 v[108:111], a[192:195], v[44:47], 0
    v_mfma_f32_16x16x32_bf16 v[108:111], a[196:199], v[60:63], v[108:111]
    v_mfma_f32_16x16x32_bf16 v[108:111], a[200:203], v[76:79], v[108:111]
    v_mfma_f32_16x16x32_bf16 v[108:111], a[204:207], v[92:95], v[108:111]
    v_max3_f32 v6, v6, v96, v97
    v_max3_f32 v6, v6, v98, v99
    v_max3_f32 v7, v7, v100, v101
    v_max3_f32 v7, v7, v102, v103
    v_max3_f32 v8, v8, v104, v105
    v_max3_f32 v8, v8, v106, v107
    s_nop 1
    v_max3_f32 v15, v15, v108, v109
    v_max3_f32 v15, v15, v110, v111
    ds_read_b128 a[192:195], v17 offset:3072
    ds_read_b128 a[196:199], v18 offset:3072
    ds_read_b128 a[200:203], v19 offset:3072
    ds_read_b128 a[204:207], v20 offset:3072
    s_waitcnt lgkmcnt(3)
    v_mfma_f32_16x16x32_bf16 v[96:99], a[192:195], v[32:35], 0
    s_waitcnt lgkmcnt(2)
    v_mfma_f32_16x16x32_bf16 v[96:99], a[196:199], v[48:51], v[96:99]
    s_waitcnt lgkmcnt(1)
    v_mfma_f32_16x16x32_bf16 v[96:99], a[200:203], v[64:67], v[96:99]
    s_waitcnt lgkmcnt(0)
    v_mfma_f32_16x16x32_bf16 v[96:99], a[204:207], v[80:83], v[96:99]
    v_mfma_f32_16x16x32_bf16 v[100:103], a[192:195], v[36:39], 0
    v_mfma_f32_16x16x32_bf16 v[100:103], a[196:199], v[52:55], v[100:103]
    v_mfma_f32_16x16x32_bf16 v[100:103], a[200:203], v[68:71], v[100:103]
    v_mfma_f32_16x16x32_bf16 v[100:103], a[204:207], v[84:87], v[100:103]
    v_mfma_f32_16x16x32_bf16 v[104:107], a[192:195], v[40:43], 0
    v_mfma_f32_16x16x32_bf16 v[104:107], a[196:199], v[56:59], v[104:107]
    v_mfma_f32_16x16x32_bf16 v[104:107], a[200:203], v[72:75], v[104:107]
    v_mfma_f32_16x16x32_bf16 v[104:107], a[204:207], v[88:91], v[104:107]
    v_mfma_f32_16x16x32_bf16 v[108:111], a[192:195], v[44:47], 0
    v_mfma_f32_16x16x32_bf16 v[108:111], a[196:199], v[60:63], v[108:111]
    v_mfma_f32_16x16x32_bf16 v[108:111], a[200:203], v[76:79], v[108:111]
    v_mfma_f32_16x16x32_bf16 v[108:111], a[204:207], v[92:95], v[108:111]
    v_max3_f32 v6, v6, v96, v97
    v_max3_f32 v6, v6, v98, v99
    v_max3_f32 v7, v7, v100, v101
    v_max3_f32 v7, v7, v102, v103
    v_max3_f32 v8, v8, v104, v105
    v_max3_f32 v8, v8, v106, v107
    s_nop 1
    v_max3_f32 v15, v15, v108, v109
    v_max3_f32 v15, v15, v110, v111
    s_barrier
    s_sub_u32 s3, s3, 1
    s_cmp_lg_u32 s3, 0
    s_cbranch_scc1 L_redo_c
    v_lshrrev_b32 v2, 5, v1
    v_lshlrev_b32 v2, 4, v2
    v_bfe_u32 v3, v1, 2, 3
    v_add_u32 v2, v2, v3
    v_mul_u32_u24 v2, 1024, v2
    v_and_b32 v3, 3, v1
    v_lshl_add_u32 v11, v3, 4, v2
    v_add_u32 v12, 7160, v11
    v_add_u32 v13, 30704, v11
    v_add_u32 v14, 37864, v11
    s_lshl_b32 s60, s56, 19
    s_lshl_b32 s61, s35, 6
    s_and_b32 s61, s61, 1023
    s_add_u32 s60, s60, s61
    v_and_b32 v3, 3, v1
    v_mov_b32 v2, 0x3f803f80
    v_cmp_eq_u32 vcc, 0, v3
    s_nop 1
    v_cndmask_b32 v2, 0, v2, vcc
    v_accvgpr_write_b32 a240, v2
    v_accvgpr_write_b32 a241, v2
    v_accvgpr_write_b32 a242, v2
    v_accvgpr_write_b32 a243, v2
    s_and_b32 s14, s57, 3
    s_lshl_b32 s92, s14, 8
    s_bfe_u32 s15, s57, 0x20002
    s_and_b32 s15, s15, 3
    s_lshl_b32 s94, s15, 17
    s_mul_i32 s93, s97, 57344
    s_mul_i32 s60, s35, 14336
    s_add_u32 s93, s93, s60
    s_mov_b32 s52, s16
    s_mov_b32 s53, s17
    s_mov_b32 s54, 1835008
    s_mov_b32 s55, 0x20000
    v_lshrrev_b32 v2, 5, v1
    v_lshlrev_b32 v2, 4, v2
    v_bfe_u32 v3, v1, 2, 3
    v_add_u32 v2, v2, v3
    v_mul_u32_u24 v2, 6144, v2
    v_and_b32 v3, 3, v1
    v_lshl_add_u32 v2, v3, 4, v2
    v_add_u32 v3, 48120, v2
    v_add_u32 v4, 194544, v2
    v_add_u32 v5, 242664, v2
    v_lshlrev_b32 v30, 2, v0
    s_add_u32 s60, s35, 0
    s_and_b32 s60, s60, 3
    s_mul_i32 s61, s60, 16512
    s_cmp_eq_u32 s60, 2
    s_cselect_b32 s61, 32896, s61
    s_cmp_eq_u32 s60, 3
    s_cselect_b32 s85, 65920, s61
    s_add_u32 s60, s15, 0
    s_and_b32 s60, s60, 3
    s_mul_i32 s61, s60, 16512
    s_cmp_eq_u32 s60, 2
    s_cselect_b32 s61, 32896, s61
    s_cmp_eq_u32 s60, 3
    s_cselect_b32 s86, 65920, s61
    s_add_u32 s60, s15, 1
    s_and_b32 s60, s60, 3
    s_mul_i32 s61, s60, 16512
    s_cmp_eq_u32 s60, 2
    s_cselect_b32 s61, 32896, s61
    s_cmp_eq_u32 s60, 3
    s_cselect_b32 s87, 65920, s61
    s_add_u32 s60, s15, 2
    s_and_b32 s60, s60, 3
    s_mul_i32 s61, s60, 16512
    s_cmp_eq_u32 s60, 2
    s_cselect_b32 s61, 32896, s61
    s_cmp_eq_u32 s60, 3
    s_cselect_b32 s88, 65920, s61
    s_add_u32 s60, s15, 3
    s_and_b32 s60, s60, 3
    s_mul_i32 s61, s60, 16512
    s_cmp_eq_u32 s60, 2
    s_cselect_b32 s61, 32896, s61
    s_cmp_eq_u32 s60, 3
    s_cselect_b32 s89, 65920, s61
    s_sub_u32 s3, s96, 2
    s_lshl_b32 s13, s3, 5
    s_add_u32 s13, s13, s97
    s_lshl_b32 s60, s13, 6
    s_mul_i32 s61, s35, 786432
    s_add_u32 s60, s60, s61
    s_add_u32 s60, s60, 2048
    s_cmp_lt_u32 s3, 2
    s_cselect_b32 s10, s60, 268435456
    s_cselect_b32 s62, 0, 268435456
    s_mov_b32 s12, s2
    s_cmp_lg_u32 s35, 0
    s_cselect_b32 s11, 268435456, 0
    s_mov_b32 s0, s24
    s_mov_b32 s1, s25
    s_mov_b32 s2, 1024
    s_mov_b32 s3, 0x20000
    s_add_u32 m0, s6, 0
    s_nop 0
    buffer_load_dwordx4 v22, s[40:43], s8 offen offset:0 lds
    buffer_load_dwordx4 v23, s[40:43], s8 offen offset:1024 lds
    buffer_load_dwordx4 v24, s[40:43], s8 offen offset:2048 lds
    buffer_load_dwordx4 v25, s[40:43], s8 offen offset:3072 lds
    s_add_u32 s8, s8, 16384
    s_and_b32 s8, s8, 0x1ffff
    s_add_u32 m0, s6, 16512
    s_nop 0
    buffer_load_dwordx4 v22, s[40:43], s8 offen offset:0 lds
    buffer_load_dwordx4 v23, s[40:43], s8 offen offset:1024 lds
    buffer_load_dwordx4 v24, s[40:43], s8 offen offset:2048 lds
    buffer_load_dwordx4 v25, s[40:43], s8 offen offset:3072 lds
    s_add_u32 s8, s8, 16384
    s_and_b32 s8, s8, 0x1ffff
    s_add_u32 m0, s7, 0
    s_nop 0
    buffer_load_dwordx4 v26, s[44:47], s9 offen offset:0 lds
    buffer_load_dwordx4 v27, s[44:47], s9 offen offset:1032 lds
    buffer_load_dwordx4 v28, s[44:47], s9 offen offset:2064 lds
    buffer_load_dwordx4 v29, s[44:47], s9 offen offset:3096 lds
    s_add_u32 s9, s9, 16384
    s_and_b32 s9, s9, 0x1ffff
    s_waitcnt vmcnt(0)
    s_barrier
    ds_read_b128 a[192:195], v17 offset:0
    ds_read_b128 a[196:199], v18 offset:0
    ds_read_b128 a[200:203], v19 offset:0
    ds_read_b128 a[204:207], v20 offset:0
    s_waitcnt lgkmcnt(0)
    s_branch L_attn
L_end:
    s_endpgm
L_stub17:
L_stub18:
L_stub19:
L_stub20:
L_stub21:
L_stub22:
L_stub23:
    s_setpc_b64 s[100:101]
L_codeend:
.section .rodata,"a"
.p2align 6
.amdhsa_kernel adaLN_cond__sliding_block_cached__mixer_channel_mlp__prompt_kernel
  .amdhsa_next_free_vgpr 512
  .amdhsa_next_free_sgpr 102
  .amdhsa_accum_offset 256
  .amdhsa_group_segment_fixed_size 0
  .amdhsa_kernarg_size 120
  .amdhsa_user_sgpr_count 2
  .amdhsa_user_sgpr_kernarg_segment_ptr 1
  .amdhsa_system_sgpr_workgroup_id_x 1
.end_amdhsa_kernel
```
